```python
import torch

def _softmax(x, axis=-1):
    return torch.softmax(x, dim=axis)
def _gelu(x):
    return torch.nn.functional.gelu(x, approximate="tanh")
def _silu(x):
    return torch.nn.functional.silu(x)
def _sigmoid(x):
    return torch.sigmoid(x)
def _layernorm(x, axis=-1, eps=1e-5):
    m = x.mean(dim=axis, keepdim=True)
    v = x.var(dim=axis, keepdim=True, unbiased=False)
    return (x - m) / torch.sqrt(v + eps)
def _scatter_add(tgt, idx, src, axis=0):
    return tgt.clone().index_add_(axis, idx, src)
def _segment_sum(src, seg, n):
    out = torch.zeros((n,) + src.shape[1:], dtype=src.dtype)
    return out.index_add_(0, seg, src)
def _pad(x, pw):
    flat = tuple(v for pair in reversed(pw) for v in pair)
    return torch.nn.functional.pad(x, flat)

kernel_name = 'concat_heads__mha_block_cached__mha_block_cached__near_ridge'

def setup_inputs():

    _w = (lambda a: (lambda t: t.to(torch.bfloat16) if t.is_floating_point() else t)(torch.as_tensor(a)))
    def _A_setup():
        B, Sq, D = 8, 160, 448
        H, Sk, Dh = 16, 1024, 256
        return {
            "x": _w((lambda *s: torch.randn(*s, dtype=torch.bfloat16) * 0.8)(B, Sq, D)),
            "k_cache": _w((lambda *s: torch.randn(*s, dtype=torch.bfloat16) * 0.8)(B, H, Sk, Dh)),
            "v_cache": _w((lambda *s: torch.randn(*s, dtype=torch.bfloat16) * 0.05)(B, H, Sk, Dh)),
            "wq": _w((lambda *s: torch.randn(*s, dtype=torch.bfloat16) * 0.8)(D, H * Dh) * (D ** -0.5)),
            "wo": _w((lambda *s: torch.randn(*s, dtype=torch.bfloat16) * 0.05)(H * Dh, D) * ((H * Dh) ** -0.5)),
        }
    _A_in = _A_setup()

    def _B_setup():
        B, Sq, D = 8, 160, 448
        H, Sk, Dh = 16, 1024, 256
        return {
            "x": _w((lambda *s: torch.randn(*s, dtype=torch.bfloat16) * 0.8)(B, Sq, D)),
            "k_cache": _w((lambda *s: torch.randn(*s, dtype=torch.bfloat16) * 0.8)(B, H, Sk, Dh)),
            "v_cache": _w((lambda *s: torch.randn(*s, dtype=torch.bfloat16) * 0.05)(B, H, Sk, Dh)),
            "wq": _w((lambda *s: torch.randn(*s, dtype=torch.bfloat16) * 0.8)(D, H * Dh) * (D ** -0.5)),
            "wo": _w((lambda *s: torch.randn(*s, dtype=torch.bfloat16) * 0.05)(H * Dh, D) * ((H * Dh) ** -0.5)),
        }
    _B_in = _B_setup()

    return {
        "A_x": _A_in["x"],
        "A_k_cache": _A_in["k_cache"],
        "A_v_cache": _A_in["v_cache"],
        "A_wq": _A_in["wq"],
        "A_wo": _A_in["wo"],
        "B_x": _B_in["x"],
        "B_k_cache": _B_in["k_cache"],
        "B_v_cache": _B_in["v_cache"],
        "B_wq": _B_in["wq"],
        "B_wo": _B_in["wo"],
    }

def reference(A_x, A_k_cache, A_v_cache, A_wq, A_wo, B_x, B_k_cache, B_v_cache, B_wq, B_wo):
    def _A_ref(x, k_cache, v_cache, wq, wo):
        B, Sq, D = x.shape
        H, Dh = 16, 256
        q = (lambda x, *d: x.permute(*d))((x @ wq).reshape(B, Sq, H, Dh), 0, 2, 1, 3)
        scores = torch.einsum("bhqd,bhkd->bhqk", q, k_cache) * (Dh ** -0.5)
        p = _softmax(scores, axis=-1)
        o = torch.einsum("bhqk,bhkd->bhqd", p, v_cache)
        return (lambda x, *d: x.permute(*d))(o, 0, 2, 1, 3).reshape(B, Sq, H * Dh) @ wo

    def _B_ref(x, k_cache, v_cache, wq, wo):
        B, Sq, D = x.shape
        H, Dh = 16, 256
        q = (lambda x, *d: x.permute(*d))((x @ wq).reshape(B, Sq, H, Dh), 0, 2, 1, 3)
        scores = torch.einsum("bhqd,bhkd->bhqk", q, k_cache) * (Dh ** -0.5)
        p = _softmax(scores, axis=-1)
        o = torch.einsum("bhqk,bhkd->bhqd", p, v_cache)
        return (lambda x, *d: x.permute(*d))(o, 0, 2, 1, 3).reshape(B, Sq, H * Dh) @ wo

    a = _A_ref(A_x, A_k_cache, A_v_cache, A_wq, A_wo)
    b = _B_ref(B_x, B_k_cache, B_v_cache, B_wq, B_wo)
    return torch.concatenate([a, b], axis=-1)
```

```asm
; @launch grid=(256,1,1) block=(256,1,1) lds=163840
.amdgcn_target "amdgcn-amd-amdhsa--gfx950"
.text
.globl concat_heads__mha_block_cached__mha_block_cached__near_ridge_kernel
.p2align 8
.type concat_heads__mha_block_cached__mha_block_cached__near_ridge_kernel,@function
concat_heads__mha_block_cached__mha_block_cached__near_ridge_kernel:
s_cmp_ge_u32 s2, 256
s_cbranch_scc1 L_attn_end
s_mov_b32 s37, 0
L_again:
s_and_b32 s47, s2, 7
s_lshr_b32 s51, s47, 2
s_mul_i32 s48, s51, 40
s_add_u32 s4, s0, s48
s_addc_u32 s5, s1, 0
s_load_dwordx8 s[64:71], s[4:5], 0
s_load_dwordx2 s[60:61], s[4:5], 32
s_load_dwordx2 s[72:73], s[0:1], 96
s_load_dwordx4 s[92:95], s[0:1], 80
s_getpc_b64 s[24:25]
L_cw0:
s_mov_b32 s27, 0x20000
v_and_b32 v100, 63, v0
v_lshrrev_b32 v104, 6, v0
s_lshr_b32 s48, s2, 3
s_lshl_b32 s49, s48, 9
v_lshlrev_b32 v105, 14, v100
v_lshl_add_u32 v105, v104, 7, v105
v_add_u32 v105, s49, v105
v_min_u32 v105, L_code_end-L_cw0-4, v105
v_mov_b32 v109, s25
v_add_co_u32 v108, vcc, s24, v105
s_nop 1
v_addc_co_u32 v109, vcc, 0, v109, vcc
global_load_dword a224, v[108:109], off
v_readfirstlane_b32 s28, v104
s_and_b32 s53, s47, 3
s_lshl_b32 s53, s53, 2
s_and_b32 s49, s48, 3
s_add_u32 s53, s53, s49
s_lshr_b32 s52, s48, 2
s_lshl_b32 s54, s49, 1
s_add_u32 s54, s54, s52
s_sub_u32 s49, s54, 7
s_cmp_ge_u32 s54, 7
s_cselect_b32 s54, s49, s54
s_lshl_b32 s57, s54, 19
s_lshl_b32 s58, s54, 7
s_lshl_b32 s29, s28, 13
s_movk_i32 s62, 0x9c
s_lshl_b32 s47, s28, 1
s_lshr_b32 s47, s62, s47
s_and_b32 s47, s47, 3
v_lshrrev_b32 v101, 4, v100
v_bfe_u32 v102, v100, 2, 2
v_and_b32 v103, 3, v100
v_xor_b32 v104, s47, v103
v_lshlrev_b32 v104, 4, v104
v_lshl_add_u32 v104, v101, 6, v104
s_lshl_b32 s47, s28, 17
v_lshl_add_u32 v105, v102, 13, v104
v_add_u32 v193, s47, v105
v_add_u32 v192, 768, v193
v_add_u32 v194, 31488, v193
v_add_u32 v195, 30720, v193
v_add_u32 v196, 66304, v193
v_add_u32 v197, 65536, v193
v_add_u32 v198, 97024, v193
v_add_u32 v199, 96256, v193
v_bfe_u32 v105, v100, 2, 3
v_mul_u32_u24 v105, 896, v105
v_lshrrev_b32 v106, 5, v100
v_lshl_add_u32 v105, v106, 6, v105
v_and_b32 v106, 1, v101
v_mul_u32_u24 v106, 3, v106
v_xor_b32 v106, v106, v103
v_lshl_add_u32 v105, v106, 4, v105
s_mul_i32 s47, s28, 28672
v_add_u32 v200, s47, v105
v_xor_b32 v106, 16, v200
v_add_u32 v201, 6144, v106
v_add_u32 v202, 12288, v200
v_add_u32 v203, 18432, v106
s_and_b32 s48, s28, 1
s_lshl_b32 s48, s48, 4
v_xor_b32 v106, s48, v105
s_mul_i32 s47, s28, 7168
s_add_u32 s47, s47, 114688
v_add_u32 v204, s47, v106
s_lshl_b32 s49, s28, 12
s_lshl_b32 s50, s28, 10
s_mul_i32 s47, s52, 143360
s_lshl_b32 s48, s53, 9
s_mov_b32 s18, 143360
s_mov_b32 s19, 0x20000
s_mov_b32 s23, 0x20000
s_sub_u32 s22, 3670784, s48
s_waitcnt lgkmcnt(0)
s_add_u32 s20, s70, s48
s_addc_u32 s21, s71, 0
s_sub_u32 s20, s20, 768
s_subb_u32 s21, s21, 0
s_add_u32 s16, s64, s47
s_addc_u32 s17, s65, 0
s_add_u32 m0, s29, 98304
s_nop 0
buffer_load_dwordx4 v192, s[20:23], s57 offen offset:0 lds
buffer_load_dwordx4 v193, s[20:23], s57 offen offset:1024 lds
buffer_load_dwordx4 v194, s[20:23], s57 offen offset:2048 lds
buffer_load_dwordx4 v195, s[20:23], s57 offen offset:3072 lds
s_add_u32 m0, s29, 102400
s_nop 0
buffer_load_dwordx4 v196, s[20:23], s57 offen offset:0 lds
buffer_load_dwordx4 v197, s[20:23], s57 offen offset:1024 lds
buffer_load_dwordx4 v198, s[20:23], s57 offen offset:2048 lds
buffer_load_dwordx4 v199, s[20:23], s57 offen offset:3072 lds
s_add_u32 s57, s57, 0x80000
s_cmp_eq_u32 s57, 0x380000
s_cselect_b32 s57, 0, s57
s_add_u32 m0, s49, 131072
s_nop 0
buffer_load_dwordx4 v200, s[16:19], s58 offen offset:0 lds
buffer_load_dwordx4 v201, s[16:19], s58 offen offset:1024 lds
buffer_load_dwordx4 v202, s[16:19], s58 offen offset:2048 lds
buffer_load_dwordx4 v203, s[16:19], s58 offen offset:3072 lds
s_add_u32 m0, s50, 147456
s_nop 0
buffer_load_dwordx4 v204, s[16:19], s58 offen lds
s_add_u32 s58, s58, 128
s_cmp_eq_u32 s58, 896
s_cselect_b32 s58, 0, s58
s_lshl_b32 s47, s52, 4
s_add_u32 s47, s47, s53
s_lshl_b32 s48, s47, 19
s_add_u32 s8, s66, s48
s_addc_u32 s9, s67, 0
s_sub_u32 s8, s8, 768
s_subb_u32 s9, s9, 0
s_mov_b32 s10, 525056
s_mov_b32 s11, 0x20000
s_add_u32 s12, s68, s48
s_addc_u32 s13, s69, 0
s_sub_u32 s12, s12, 768
s_subb_u32 s13, s13, 0
s_mov_b32 s14, 525056
s_mov_b32 s15, 0x20000
s_lshl_b32 s48, s51, 7
s_add_u32 s47, s47, s48
s_mul_i32 s47, s47, 144384
s_add_u32 s24, s72, s47
s_addc_u32 s25, s73, 0
s_mov_b32 s26, 144384
v_lshl_add_u32 v105, v102, 9, v104
v_add_u32 v249, s29, v105
v_add_u32 v248, 768, v249
s_and_b32 s47, s28, 1
s_lshl_b32 s48, s47, 13
s_sub_u32 s33, 4096, s48
s_sub_u32 s34, 0x10000, s33
s_sub_u32 s35, 0xfffe8000, s33
s_lshl_b32 s48, s47, 12
s_lshl_b32 s47, s47, 10
v_lshlrev_b32 v106, 1, v101
v_bfe_u32 v106, s62, v106, 2
v_lshrrev_b32 v105, 1, v103
v_xor_b32 v106, v106, v105
v_lshl_add_u32 v106, v106, 4, s47
v_lshl_add_u32 v106, v101, 13, v106
v_lshl_add_u32 v106, v102, 6, v106
v_and_b32 v105, 1, v103
v_lshl_add_u32 v205, v105, 3, v106
v_xor_b32 v206, 32, v205
v_add_u32 v207, 65536, v205
v_add_u32 v208, 65536, v206
s_add_u32 s36, s48, 32768
v_add_u32 v246, s36, v205
v_add_u32 v247, s36, v206
v_lshlrev_b32 v107, 1, v102
v_bfe_u32 v107, s62, v107, 2
s_movk_i32 s36, 0xd8
v_lshlrev_b32 v106, 1, v101
v_bfe_u32 v106, s36, v106, 2
s_add_u32 s48, s48, s47
v_xor_b32 v106, v106, v107
v_lshl_add_u32 v106, v106, 4, s48
v_lshl_add_u32 v106, v102, 13, v106
v_lshl_add_u32 v244, v103, 6, v106
v_xor_b32 v245, 1024, v244
v_and_b32 v106, 1, v101
v_lshlrev_b32 v106, 1, v106
v_xor_b32 v106, v106, v107
v_lshlrev_b32 v106, 4, v106
v_and_b32 v105, 7, v100
v_lshl_add_u32 v106, v105, 6, v106
v_lshrrev_b32 v105, 5, v100
v_lshl_add_u32 v106, v105, 9, v106
v_bfe_u32 v104, v100, 3, 1
v_lshl_add_u32 v106, v104, 10, v106
s_lshr_b32 s48, s28, 1
s_lshl_b32 s47, s48, 13
s_add_u32 s47, s47, 32768
v_add_u32 v209, s47, v106
v_xor_b32 v210, 16, v209
v_add_u32 v211, 98304, v209
v_add_u32 v212, 98304, v210
s_lshl_b32 s47, s48, 11
s_add_u32 s47, s47, 147456
v_add_u32 v213, s47, v106
v_xor_b32 v214, 16, v213
v_lshl_add_u32 v250, v100, 4, s29
v_xor_b32 v251, 0x2000, v250
s_mul_i32 s47, s48, 320
s_add_u32 s47, s47, 159744
v_and_b32 v105, 15, v100
v_lshl_add_u32 v252, v105, 2, s47
v_mov_b32 v106, 0x7f800000
ds_write_b32 v252, v106 offset:0
ds_write_b32 v252, v106 offset:64
ds_write_b32 v252, v106 offset:128
ds_write_b32 v252, v106 offset:192
ds_write_b32 v252, v106 offset:256
s_mov_b32 s55, 0x3db8aa3b
s_mov_b32 s32, 0x53800000
s_mov_b32 s47, 0x3f803f80
v_accvgpr_write_b32 a244, s47
v_accvgpr_write_b32 a245, s47
v_accvgpr_write_b32 a246, s47
v_accvgpr_write_b32 a247, s47
s_add_u32 m0, s49, 32768
s_nop 0
buffer_load_dwordx4 v200, s[16:19], s58 offen offset:0 lds
buffer_load_dwordx4 v201, s[16:19], s58 offen offset:1024 lds
buffer_load_dwordx4 v202, s[16:19], s58 offen offset:2048 lds
buffer_load_dwordx4 v203, s[16:19], s58 offen offset:3072 lds
s_add_u32 m0, s50, 151552
s_nop 0
buffer_load_dwordx4 v204, s[16:19], s58 offen lds
s_add_u32 s58, s58, 128
s_cmp_eq_u32 s58, 896
s_cselect_b32 s58, 0, s58
s_add_u32 m0, s29, 0
s_nop 0
buffer_load_dwordx4 v192, s[20:23], s57 offen offset:0 lds
buffer_load_dwordx4 v193, s[20:23], s57 offen offset:1024 lds
buffer_load_dwordx4 v194, s[20:23], s57 offen offset:2048 lds
buffer_load_dwordx4 v195, s[20:23], s57 offen offset:3072 lds
s_add_u32 m0, s29, 4096
s_nop 0
buffer_load_dwordx4 v196, s[20:23], s57 offen offset:0 lds
buffer_load_dwordx4 v197, s[20:23], s57 offen offset:1024 lds
buffer_load_dwordx4 v198, s[20:23], s57 offen offset:2048 lds
buffer_load_dwordx4 v199, s[20:23], s57 offen offset:3072 lds
s_add_u32 s57, s57, 0x80000
s_cmp_eq_u32 s57, 0x380000
s_cselect_b32 s57, 0, s57
s_add_u32 m0, s29, 65536
s_nop 0
buffer_load_dwordx4 v192, s[20:23], s57 offen offset:0 lds
buffer_load_dwordx4 v193, s[20:23], s57 offen offset:1024 lds
buffer_load_dwordx4 v194, s[20:23], s57 offen offset:2048 lds
buffer_load_dwordx4 v195, s[20:23], s57 offen offset:3072 lds
s_add_u32 m0, s29, 69632
s_nop 0
buffer_load_dwordx4 v196, s[20:23], s57 offen offset:0 lds
buffer_load_dwordx4 v197, s[20:23], s57 offen offset:1024 lds
buffer_load_dwordx4 v198, s[20:23], s57 offen offset:2048 lds
buffer_load_dwordx4 v199, s[20:23], s57 offen offset:3072 lds
s_add_u32 s57, s57, 0x80000
s_cmp_eq_u32 s57, 0x380000
s_cselect_b32 s57, 0, s57
s_add_u32 m0, s49, 49152
s_nop 0
buffer_load_dwordx4 v200, s[16:19], s58 offen offset:0 lds
buffer_load_dwordx4 v201, s[16:19], s58 offen offset:1024 lds
buffer_load_dwordx4 v202, s[16:19], s58 offen offset:2048 lds
buffer_load_dwordx4 v203, s[16:19], s58 offen offset:3072 lds
s_add_u32 m0, s50, 155648
s_nop 0
buffer_load_dwordx4 v204, s[16:19], s58 offen lds
s_add_u32 s58, s58, 128
s_cmp_eq_u32 s58, 896
s_cselect_b32 s58, 0, s58
v_add_u32 v105, s37, v100
v_lshlrev_b32 v105, 8, v105
v_add_u32 v105, 144128, v105
v_mov_b32 v104, 0
buffer_store_dword v104, v105, s[24:27], 0 offen sc1
s_waitcnt vmcnt(27) lgkmcnt(0)
s_barrier
s_mov_b32 s45, 0
ds_read_b128 a[104:107], v211 offset:0
ds_read_b128 a[108:111], v211 offset:2048
ds_read_b128 a[112:115], v211 offset:4096
ds_read_b64_tr_b16 a[16:17], v207 offset:32768
ds_read_b128 a[116:119], v211 offset:6144
ds_read_b64_tr_b16 a[18:19], v207 offset:34816
ds_read_b128 a[120:123], v213 offset:0
ds_read_b64_tr_b16 a[20:21], v207 offset:36864
ds_read_b128 a[124:127], v212 offset:0
ds_read_b64_tr_b16 a[22:23], v207 offset:38912
ds_read_b128 a[128:131], v212 offset:2048
s_waitcnt lgkmcnt(5)
v_mfma_f32_16x16x32_bf16 v[0:3], a[16:19], a[104:107], 0
buffer_load_dwordx4 v[160:163], v248, s[8:11], s45 offen offset:0 nt
s_waitcnt lgkmcnt(1)
v_mfma_f32_16x16x32_bf16 v[0:3], a[20:23], a[124:127], v[0:3]
ds_read_b128 a[132:135], v212 offset:4096
ds_read_b128 a[136:139], v212 offset:6144
v_mfma_f32_16x16x32_bf16 v[32:35], a[16:19], a[108:111], 0
buffer_load_dwordx4 v[164:167], v249, s[8:11], s45 offen offset:1024 nt
s_waitcnt lgkmcnt(2)
v_mfma_f32_16x16x32_bf16 v[32:35], a[20:23], a[128:131], v[32:35]
ds_read_b128 a[140:143], v214 offset:0
ds_read_b64_tr_b16 a[24:25], v208 offset:32768
v_mfma_f32_16x16x32_bf16 v[64:67], a[16:19], a[112:115], 0
buffer_load_dwordx4 v[168:171], v248, s[8:11], s45 offen offset:2048 nt
s_waitcnt lgkmcnt(3)
v_mfma_f32_16x16x32_bf16 v[64:67], a[20:23], a[132:135], v[64:67]
ds_read_b64_tr_b16 a[26:27], v208 offset:34816
ds_read_b64_tr_b16 a[28:29], v208 offset:36864
v_mfma_f32_16x16x32_bf16 v[96:99], a[16:19], a[116:119], 0
buffer_load_dwordx4 v[172:175], v249, s[8:11], s45 offen offset:3072 nt
s_waitcnt lgkmcnt(4)
v_mfma_f32_16x16x32_bf16 v[96:99], a[20:23], a[136:139], v[96:99]
ds_read_b64_tr_b16 a[30:31], v208 offset:38912
ds_read_b64_tr_b16 a[32:33], v207 offset:33024
v_mfma_f32_16x16x32_bf16 v[128:131], a[16:19], a[120:123], 0
ds_read_b64_tr_b16 a[34:35], v207 offset:35072
s_waitcnt lgkmcnt(6)
v_mfma_f32_16x16x32_bf16 v[128:131], a[20:23], a[140:143], v[128:131]
ds_read_b64_tr_b16 a[36:37], v207 offset:37120
s_waitcnt lgkmcnt(5)
v_mfma_f32_16x16x32_bf16 v[4:7], a[24:27], a[104:107], 0
ds_read_b64_tr_b16 a[38:39], v207 offset:39168
s_waitcnt lgkmcnt(4)
v_mfma_f32_16x16x32_bf16 v[4:7], a[28:31], a[124:127], v[4:7]
ds_read_b64_tr_b16 a[40:41], v208 offset:33024
ds_read_b64_tr_b16 a[42:43], v208 offset:35072
v_mfma_f32_16x16x32_bf16 v[36:39], a[24:27], a[108:111], 0
ds_read_b64_tr_b16 a[44:45], v208 offset:37120
ds_read_b64_tr_b16 a[46:47], v208 offset:39168
v_mfma_f32_16x16x32_bf16 v[36:39], a[28:31], a[128:131], v[36:39]
ds_read_b64_tr_b16 a[0:1], v207 offset:33280
ds_read_b64_tr_b16 a[2:3], v207 offset:35328
v_mfma_f32_16x16x32_bf16 v[68:71], a[24:27], a[112:115], 0
ds_read_b64_tr_b16 a[4:5], v207 offset:37376
ds_read_b64_tr_b16 a[6:7], v207 offset:39424
v_mfma_f32_16x16x32_bf16 v[68:71], a[28:31], a[132:135], v[68:71]
ds_read_b64_tr_b16 a[8:9], v208 offset:33280
ds_read_b64_tr_b16 a[10:11], v208 offset:35328
v_mfma_f32_16x16x32_bf16 v[100:103], a[24:27], a[116:119], 0
ds_read_b64_tr_b16 a[12:13], v208 offset:37376
v_mfma_f32_16x16x32_bf16 v[100:103], a[28:31], a[136:139], v[100:103]
s_waitcnt lgkmcnt(8)
ds_read_b64_tr_b16 a[14:15], v208 offset:39424
ds_read_b64_tr_b16 a[16:17], v207 offset:33536
v_mfma_f32_16x16x32_bf16 v[132:135], a[24:27], a[120:123], 0
ds_read_b64_tr_b16 a[18:19], v207 offset:35584
ds_read_b64_tr_b16 a[20:21], v207 offset:37632
v_mfma_f32_16x16x32_bf16 v[132:135], a[28:31], a[140:143], v[132:135]
ds_read_b64_tr_b16 a[22:23], v207 offset:39680
s_waitcnt lgkmcnt(12)
v_mfma_f32_16x16x32_bf16 v[8:11], a[32:35], a[104:107], 0
ds_read_b64_tr_b16 a[24:25], v208 offset:33536
ds_read_b64_tr_b16 a[26:27], v208 offset:35584
v_mfma_f32_16x16x32_bf16 v[8:11], a[36:39], a[124:127], v[8:11]
ds_read_b64_tr_b16 a[28:29], v208 offset:37632
s_waitcnt lgkmcnt(8)
ds_read_b64_tr_b16 a[30:31], v208 offset:39680
v_mfma_f32_16x16x32_bf16 v[40:43], a[32:35], a[108:111], 0
v_mfma_f32_16x16x32_bf16 v[40:43], a[36:39], a[128:131], v[40:43]
v_mfma_f32_16x16x32_bf16 v[72:75], a[32:35], a[112:115], 0
v_mfma_f32_16x16x32_bf16 v[72:75], a[36:39], a[132:135], v[72:75]
v_mfma_f32_16x16x32_bf16 v[104:107], a[32:35], a[116:119], 0
v_mfma_f32_16x16x32_bf16 v[104:107], a[36:39], a[136:139], v[104:107]
v_mfma_f32_16x16x32_bf16 v[136:139], a[32:35], a[120:123], 0
v_mfma_f32_16x16x32_bf16 v[136:139], a[36:39], a[140:143], v[136:139]
v_mfma_f32_16x16x32_bf16 v[12:15], a[40:43], a[104:107], 0
v_mfma_f32_16x16x32_bf16 v[12:15], a[44:47], a[124:127], v[12:15]
v_mfma_f32_16x16x32_bf16 v[44:47], a[40:43], a[108:111], 0
v_mfma_f32_16x16x32_bf16 v[44:47], a[44:47], a[128:131], v[44:47]
v_mfma_f32_16x16x32_bf16 v[76:79], a[40:43], a[112:115], 0
v_mfma_f32_16x16x32_bf16 v[76:79], a[44:47], a[132:135], v[76:79]
v_mfma_f32_16x16x32_bf16 v[108:111], a[40:43], a[116:119], 0
v_mfma_f32_16x16x32_bf16 v[108:111], a[44:47], a[136:139], v[108:111]
v_mfma_f32_16x16x32_bf16 v[140:143], a[40:43], a[120:123], 0
v_mfma_f32_16x16x32_bf16 v[140:143], a[44:47], a[140:143], v[140:143]
s_waitcnt lgkmcnt(0)
v_mfma_f32_16x16x32_bf16 v[16:19], a[0:3], a[104:107], 0
v_mfma_f32_16x16x32_bf16 v[16:19], a[4:7], a[124:127], v[16:19]
v_mfma_f32_16x16x32_bf16 v[48:51], a[0:3], a[108:111], 0
v_mfma_f32_16x16x32_bf16 v[48:51], a[4:7], a[128:131], v[48:51]
v_mfma_f32_16x16x32_bf16 v[80:83], a[0:3], a[112:115], 0
v_mfma_f32_16x16x32_bf16 v[80:83], a[4:7], a[132:135], v[80:83]
v_mfma_f32_16x16x32_bf16 v[112:115], a[0:3], a[116:119], 0
v_mfma_f32_16x16x32_bf16 v[112:115], a[4:7], a[136:139], v[112:115]
v_mfma_f32_16x16x32_bf16 v[144:147], a[0:3], a[120:123], 0
v_mfma_f32_16x16x32_bf16 v[144:147], a[4:7], a[140:143], v[144:147]
v_mfma_f32_16x16x32_bf16 v[20:23], a[8:11], a[104:107], 0
v_mfma_f32_16x16x32_bf16 v[20:23], a[12:15], a[124:127], v[20:23]
v_mfma_f32_16x16x32_bf16 v[52:55], a[8:11], a[108:111], 0
v_mfma_f32_16x16x32_bf16 v[52:55], a[12:15], a[128:131], v[52:55]
v_mfma_f32_16x16x32_bf16 v[84:87], a[8:11], a[112:115], 0
v_mfma_f32_16x16x32_bf16 v[84:87], a[12:15], a[132:135], v[84:87]
v_mfma_f32_16x16x32_bf16 v[116:119], a[8:11], a[116:119], 0
v_mfma_f32_16x16x32_bf16 v[116:119], a[12:15], a[136:139], v[116:119]
v_mfma_f32_16x16x32_bf16 v[148:151], a[8:11], a[120:123], 0
v_mfma_f32_16x16x32_bf16 v[148:151], a[12:15], a[140:143], v[148:151]
v_mfma_f32_16x16x32_bf16 v[24:27], a[16:19], a[104:107], 0
v_mfma_f32_16x16x32_bf16 v[24:27], a[20:23], a[124:127], v[24:27]
v_mfma_f32_16x16x32_bf16 v[56:59], a[16:19], a[108:111], 0
v_mfma_f32_16x16x32_bf16 v[56:59], a[20:23], a[128:131], v[56:59]
v_mfma_f32_16x16x32_bf16 v[88:91], a[16:19], a[112:115], 0
v_mfma_f32_16x16x32_bf16 v[88:91], a[20:23], a[132:135], v[88:91]
v_mfma_f32_16x16x32_bf16 v[120:123], a[16:19], a[116:119], 0
v_mfma_f32_16x16x32_bf16 v[120:123], a[20:23], a[136:139], v[120:123]
s_waitcnt vmcnt(18) lgkmcnt(0)
s_barrier
ds_read_b128 a[64:67], v209 offset:0
ds_read_b128 a[68:71], v209 offset:2048
v_mfma_f32_16x16x32_bf16 v[152:155], a[16:19], a[120:123], 0
ds_read_b128 a[72:75], v209 offset:4096
ds_read_b64_tr_b16 a[32:33], v205 offset:0
v_mfma_f32_16x16x32_bf16 v[152:155], a[20:23], a[140:143], v[152:155]
s_add_u32 m0, s29, 98304
ds_read_b128 a[76:79], v209 offset:6144
v_mfma_f32_16x16x32_bf16 v[28:31], a[24:27], a[104:107], 0
buffer_load_dwordx4 v192, s[20:23], s57 offen offset:0 lds
ds_read_b64_tr_b16 a[34:35], v205 offset:2048
v_mfma_f32_16x16x32_bf16 v[28:31], a[28:31], a[124:127], v[28:31]
ds_read_b128 a[80:83], v213 offset:4096
ds_read_b64_tr_b16 a[36:37], v205 offset:4096
v_mfma_f32_16x16x32_bf16 v[60:63], a[24:27], a[108:111], 0
buffer_load_dwordx4 v193, s[20:23], s57 offen offset:1024 lds
ds_read_b128 a[84:87], v210 offset:0
v_mfma_f32_16x16x32_bf16 v[60:63], a[28:31], a[128:131], v[60:63]
ds_read_b64_tr_b16 a[38:39], v205 offset:6144
ds_read_b128 a[88:91], v210 offset:2048
v_mfma_f32_16x16x32_bf16 v[92:95], a[24:27], a[112:115], 0
buffer_load_dwordx4 v194, s[20:23], s57 offen offset:2048 lds
ds_read_b128 a[92:95], v210 offset:4096
v_mfma_f32_16x16x32_bf16 v[92:95], a[28:31], a[132:135], v[92:95]
ds_read_b128 a[96:99], v210 offset:6144
ds_read_b128 a[100:103], v214 offset:4096
v_mfma_f32_16x16x32_bf16 v[124:127], a[24:27], a[116:119], 0
buffer_load_dwordx4 v195, s[20:23], s57 offen offset:3072 lds
ds_read_b64_tr_b16 a[40:41], v206 offset:0
v_mfma_f32_16x16x32_bf16 v[124:127], a[28:31], a[136:139], v[124:127]
s_add_u32 m0, s29, 102400
s_waitcnt lgkmcnt(8)
ds_read_b64_tr_b16 a[42:43], v206 offset:2048
v_mfma_f32_16x16x32_bf16 v[156:159], a[24:27], a[120:123], 0
buffer_load_dwordx4 v196, s[20:23], s57 offen offset:0 lds
ds_read_b64_tr_b16 a[44:45], v206 offset:4096
v_mfma_f32_16x16x32_bf16 v[156:159], a[28:31], a[140:143], v[156:159]
ds_read_b64_tr_b16 a[46:47], v206 offset:6144
s_waitcnt lgkmcnt(9)
v_mfma_f32_16x16x32_bf16 v[0:3], a[32:35], a[64:67], v[0:3]
buffer_load_dwordx4 v197, s[20:23], s57 offen offset:1024 lds
s_waitcnt lgkmcnt(7)
v_mfma_f32_16x16x32_bf16 v[0:3], a[36:39], a[84:87], v[0:3]
ds_read_b64_tr_b16 a[0:1], v205 offset:256
ds_read_b64_tr_b16 a[2:3], v205 offset:2304
v_mfma_f32_16x16x32_bf16 v[32:35], a[32:35], a[68:71], v[32:35]
buffer_load_dwordx4 v198, s[20:23], s57 offen offset:2048 lds
ds_read_b64_tr_b16 a[4:5], v205 offset:4352
v_mfma_f32_16x16x32_bf16 v[32:35], a[36:39], a[88:91], v[32:35]
ds_read_b64_tr_b16 a[6:7], v205 offset:6400
ds_read_b64_tr_b16 a[8:9], v206 offset:256
v_mfma_f32_16x16x32_bf16 v[64:67], a[32:35], a[72:75], v[64:67]
buffer_load_dwordx4 v199, s[20:23], s57 offen offset:3072 lds
s_add_u32 s57, s57, 0x80000
s_cmp_eq_u32 s57, 0x380000
s_cselect_b32 s57, 0, s57
s_waitcnt lgkmcnt(7)
v_mfma_f32_16x16x32_bf16 v[64:67], a[36:39], a[92:95], v[64:67]
s_add_u32 m0, s49, 131072
ds_read_b64_tr_b16 a[10:11], v206 offset:2304
v_mfma_f32_16x16x32_bf16 v[96:99], a[32:35], a[76:79], v[96:99]
buffer_load_dwordx4 v200, s[16:19], s58 offen offset:0 lds
ds_read_b64_tr_b16 a[12:13], v206 offset:4352
v_mfma_f32_16x16x32_bf16 v[96:99], a[36:39], a[96:99], v[96:99]
ds_read_b64_tr_b16 a[14:15], v206 offset:6400
ds_read_b64_tr_b16 a[16:17], v205 offset:512
v_mfma_f32_16x16x32_bf16 v[128:131], a[32:35], a[80:83], v[128:131]
buffer_load_dwordx4 v201, s[16:19], s58 offen offset:1024 lds
ds_read_b64_tr_b16 a[18:19], v205 offset:2560
v_mfma_f32_16x16x32_bf16 v[128:131], a[36:39], a[100:103], v[128:131]
ds_read_b64_tr_b16 a[20:21], v205 offset:4608
ds_read_b64_tr_b16 a[22:23], v205 offset:6656
v_mfma_f32_16x16x32_bf16 v[4:7], a[40:43], a[64:67], v[4:7]
buffer_load_dwordx4 v202, s[16:19], s58 offen offset:2048 lds
s_waitcnt lgkmcnt(7)
v_mfma_f32_16x16x32_bf16 v[4:7], a[44:47], a[84:87], v[4:7]
ds_read_b64_tr_b16 a[24:25], v206 offset:512
ds_read_b64_tr_b16 a[26:27], v206 offset:2560
v_mfma_f32_16x16x32_bf16 v[36:39], a[40:43], a[68:71], v[36:39]
buffer_load_dwordx4 v203, s[16:19], s58 offen offset:3072 lds
ds_read_b64_tr_b16 a[28:29], v206 offset:4608
v_mfma_f32_16x16x32_bf16 v[36:39], a[44:47], a[88:91], v[36:39]
s_add_u32 m0, s50, 147456
ds_read_b64_tr_b16 a[30:31], v206 offset:6656
v_mfma_f32_16x16x32_bf16 v[68:71], a[40:43], a[72:75], v[68:71]
buffer_load_dwordx4 v204, s[16:19], s58 offen lds
ds_read_b64_tr_b16 a[32:33], v205 offset:768
v_mfma_f32_16x16x32_bf16 v[68:71], a[44:47], a[92:95], v[68:71]
s_add_u32 s58, s58, 128
s_cmp_eq_u32 s58, 896
s_cselect_b32 s58, 0, s58
v_mfma_f32_16x16x32_bf16 v[100:103], a[40:43], a[76:79], v[100:103]
ds_read_b64_tr_b16 a[34:35], v205 offset:2816
ds_read_b64_tr_b16 a[36:37], v205 offset:4864
v_mfma_f32_16x16x32_bf16 v[100:103], a[44:47], a[96:99], v[100:103]
s_mov_b32 s45, 4096
ds_read_b64_tr_b16 a[38:39], v205 offset:6912
v_mfma_f32_16x16x32_bf16 v[132:135], a[40:43], a[80:83], v[132:135]
buffer_load_dwordx4 v[176:179], v248, s[8:11], s45 offen offset:0 nt
s_waitcnt lgkmcnt(8)
ds_read_b64_tr_b16 a[40:41], v206 offset:768
v_mfma_f32_16x16x32_bf16 v[132:135], a[44:47], a[100:103], v[132:135]
ds_read_b64_tr_b16 a[42:43], v206 offset:2816
ds_read_b64_tr_b16 a[44:45], v206 offset:4864
v_mfma_f32_16x16x32_bf16 v[8:11], a[0:3], a[64:67], v[8:11]
buffer_load_dwordx4 v[180:183], v249, s[8:11], s45 offen offset:1024 nt
ds_read_b64_tr_b16 a[46:47], v206 offset:6912
v_mfma_f32_16x16x32_bf16 v[8:11], a[4:7], a[84:87], v[8:11]
v_mfma_f32_16x16x32_bf16 v[40:43], a[0:3], a[68:71], v[40:43]
buffer_load_dwordx4 v[184:187], v248, s[8:11], s45 offen offset:2048 nt
v_mfma_f32_16x16x32_bf16 v[40:43], a[4:7], a[88:91], v[40:43]
v_mfma_f32_16x16x32_bf16 v[72:75], a[0:3], a[72:75], v[72:75]
buffer_load_dwordx4 v[188:191], v249, s[8:11], s45 offen offset:3072 nt
v_mfma_f32_16x16x32_bf16 v[72:75], a[4:7], a[92:95], v[72:75]
v_mfma_f32_16x16x32_bf16 v[104:107], a[0:3], a[76:79], v[104:107]
v_mfma_f32_16x16x32_bf16 v[104:107], a[4:7], a[96:99], v[104:107]
v_mfma_f32_16x16x32_bf16 v[136:139], a[0:3], a[80:83], v[136:139]
v_mfma_f32_16x16x32_bf16 v[136:139], a[4:7], a[100:103], v[136:139]
s_waitcnt lgkmcnt(0)
v_mfma_f32_16x16x32_bf16 v[12:15], a[8:11], a[64:67], v[12:15]
v_mfma_f32_16x16x32_bf16 v[12:15], a[12:15], a[84:87], v[12:15]
v_mfma_f32_16x16x32_bf16 v[44:47], a[8:11], a[68:71], v[44:47]
v_mfma_f32_16x16x32_bf16 v[44:47], a[12:15], a[88:91], v[44:47]
v_mfma_f32_16x16x32_bf16 v[76:79], a[8:11], a[72:75], v[76:79]
v_mfma_f32_16x16x32_bf16 v[76:79], a[12:15], a[92:95], v[76:79]
v_mfma_f32_16x16x32_bf16 v[108:111], a[8:11], a[76:79], v[108:111]
v_mfma_f32_16x16x32_bf16 v[108:111], a[12:15], a[96:99], v[108:111]
v_mfma_f32_16x16x32_bf16 v[140:143], a[8:11], a[80:83], v[140:143]
v_mfma_f32_16x16x32_bf16 v[140:143], a[12:15], a[100:103], v[140:143]
v_mfma_f32_16x16x32_bf16 v[16:19], a[16:19], a[64:67], v[16:19]
v_mfma_f32_16x16x32_bf16 v[16:19], a[20:23], a[84:87], v[16:19]
v_mfma_f32_16x16x32_bf16 v[48:51], a[16:19], a[68:71], v[48:51]
v_mfma_f32_16x16x32_bf16 v[48:51], a[20:23], a[88:91], v[48:51]
v_mfma_f32_16x16x32_bf16 v[80:83], a[16:19], a[72:75], v[80:83]
v_mfma_f32_16x16x32_bf16 v[80:83], a[20:23], a[92:95], v[80:83]
v_mfma_f32_16x16x32_bf16 v[112:115], a[16:19], a[76:79], v[112:115]
v_mfma_f32_16x16x32_bf16 v[112:115], a[20:23], a[96:99], v[112:115]
v_mfma_f32_16x16x32_bf16 v[144:147], a[16:19], a[80:83], v[144:147]
v_mfma_f32_16x16x32_bf16 v[144:147], a[20:23], a[100:103], v[144:147]
v_mfma_f32_16x16x32_bf16 v[20:23], a[24:27], a[64:67], v[20:23]
v_mfma_f32_16x16x32_bf16 v[20:23], a[28:31], a[84:87], v[20:23]
v_mfma_f32_16x16x32_bf16 v[52:55], a[24:27], a[68:71], v[52:55]
v_mfma_f32_16x16x32_bf16 v[52:55], a[28:31], a[88:91], v[52:55]
v_mfma_f32_16x16x32_bf16 v[84:87], a[24:27], a[72:75], v[84:87]
v_mfma_f32_16x16x32_bf16 v[84:87], a[28:31], a[92:95], v[84:87]
v_mfma_f32_16x16x32_bf16 v[116:119], a[24:27], a[76:79], v[116:119]
v_mfma_f32_16x16x32_bf16 v[116:119], a[28:31], a[96:99], v[116:119]
v_mfma_f32_16x16x32_bf16 v[148:151], a[24:27], a[80:83], v[148:151]
v_mfma_f32_16x16x32_bf16 v[148:151], a[28:31], a[100:103], v[148:151]
v_mfma_f32_16x16x32_bf16 v[24:27], a[32:35], a[64:67], v[24:27]
v_mfma_f32_16x16x32_bf16 v[24:27], a[36:39], a[84:87], v[24:27]
v_mfma_f32_16x16x32_bf16 v[56:59], a[32:35], a[68:71], v[56:59]
v_mfma_f32_16x16x32_bf16 v[56:59], a[36:39], a[88:91], v[56:59]
v_mfma_f32_16x16x32_bf16 v[88:91], a[32:35], a[72:75], v[88:91]
v_mfma_f32_16x16x32_bf16 v[88:91], a[36:39], a[92:95], v[88:91]
v_mfma_f32_16x16x32_bf16 v[120:123], a[32:35], a[76:79], v[120:123]
v_mfma_f32_16x16x32_bf16 v[120:123], a[36:39], a[96:99], v[120:123]
s_waitcnt vmcnt(22) lgkmcnt(0)
s_barrier
ds_read_b128 a[104:107], v209 offset:16384
ds_read_b128 a[108:111], v209 offset:18432
v_mfma_f32_16x16x32_bf16 v[152:155], a[32:35], a[80:83], v[152:155]
ds_read_b128 a[112:115], v209 offset:20480
ds_read_b64_tr_b16 a[0:1], v207 offset:0
v_mfma_f32_16x16x32_bf16 v[152:155], a[36:39], a[100:103], v[152:155]
s_add_u32 m0, s29, 0
ds_read_b128 a[116:119], v209 offset:22528
v_mfma_f32_16x16x32_bf16 v[28:31], a[40:43], a[64:67], v[28:31]
buffer_load_dwordx4 v192, s[20:23], s57 offen offset:0 lds
ds_read_b64_tr_b16 a[2:3], v207 offset:2048
v_mfma_f32_16x16x32_bf16 v[28:31], a[44:47], a[84:87], v[28:31]
ds_read_b128 a[120:123], v213 offset:8192
ds_read_b64_tr_b16 a[4:5], v207 offset:4096
v_mfma_f32_16x16x32_bf16 v[60:63], a[40:43], a[68:71], v[60:63]
buffer_load_dwordx4 v193, s[20:23], s57 offen offset:1024 lds
ds_read_b128 a[124:127], v210 offset:16384
v_mfma_f32_16x16x32_bf16 v[60:63], a[44:47], a[88:91], v[60:63]
ds_read_b64_tr_b16 a[6:7], v207 offset:6144
ds_read_b128 a[128:131], v210 offset:18432
v_mfma_f32_16x16x32_bf16 v[92:95], a[40:43], a[72:75], v[92:95]
buffer_load_dwordx4 v194, s[20:23], s57 offen offset:2048 lds
ds_read_b128 a[132:135], v210 offset:20480
v_mfma_f32_16x16x32_bf16 v[92:95], a[44:47], a[92:95], v[92:95]
ds_read_b128 a[136:139], v210 offset:22528
ds_read_b128 a[140:143], v214 offset:8192
v_mfma_f32_16x16x32_bf16 v[124:127], a[40:43], a[76:79], v[124:127]
buffer_load_dwordx4 v195, s[20:23], s57 offen offset:3072 lds
ds_read_b64_tr_b16 a[8:9], v208 offset:0
v_mfma_f32_16x16x32_bf16 v[124:127], a[44:47], a[96:99], v[124:127]
s_add_u32 m0, s29, 4096
s_waitcnt lgkmcnt(8)
ds_read_b64_tr_b16 a[10:11], v208 offset:2048
v_mfma_f32_16x16x32_bf16 v[156:159], a[40:43], a[80:83], v[156:159]
buffer_load_dwordx4 v196, s[20:23], s57 offen offset:0 lds
ds_read_b64_tr_b16 a[12:13], v208 offset:4096
v_mfma_f32_16x16x32_bf16 v[156:159], a[44:47], a[100:103], v[156:159]
ds_read_b64_tr_b16 a[14:15], v208 offset:6144
s_waitcnt lgkmcnt(9)
v_mfma_f32_16x16x32_bf16 v[0:3], a[0:3], a[104:107], v[0:3]
buffer_load_dwordx4 v197, s[20:23], s57 offen offset:1024 lds
s_waitcnt lgkmcnt(7)
v_mfma_f32_16x16x32_bf16 v[0:3], a[4:7], a[124:127], v[0:3]
ds_read_b64_tr_b16 a[16:17], v207 offset:256
ds_read_b64_tr_b16 a[18:19], v207 offset:2304
v_mfma_f32_16x16x32_bf16 v[32:35], a[0:3], a[108:111], v[32:35]
buffer_load_dwordx4 v198, s[20:23], s57 offen offset:2048 lds
ds_read_b64_tr_b16 a[20:21], v207 offset:4352
v_mfma_f32_16x16x32_bf16 v[32:35], a[4:7], a[128:131], v[32:35]
ds_read_b64_tr_b16 a[22:23], v207 offset:6400
ds_read_b64_tr_b16 a[24:25], v208 offset:256
v_mfma_f32_16x16x32_bf16 v[64:67], a[0:3], a[112:115], v[64:67]
buffer_load_dwordx4 v199, s[20:23], s57 offen offset:3072 lds
s_add_u32 s57, s57, 0x80000
s_cmp_eq_u32 s57, 0x380000
s_cselect_b32 s57, 0, s57
s_waitcnt lgkmcnt(7)
v_mfma_f32_16x16x32_bf16 v[64:67], a[4:7], a[132:135], v[64:67]
s_add_u32 m0, s49, 32768
ds_read_b64_tr_b16 a[26:27], v208 offset:2304
v_mfma_f32_16x16x32_bf16 v[96:99], a[0:3], a[116:119], v[96:99]
buffer_load_dwordx4 v200, s[16:19], s58 offen offset:0 lds
ds_read_b64_tr_b16 a[28:29], v208 offset:4352
v_mfma_f32_16x16x32_bf16 v[96:99], a[4:7], a[136:139], v[96:99]
ds_read_b64_tr_b16 a[30:31], v208 offset:6400
ds_read_b64_tr_b16 a[32:33], v207 offset:512
v_mfma_f32_16x16x32_bf16 v[128:131], a[0:3], a[120:123], v[128:131]
buffer_load_dwordx4 v201, s[16:19], s58 offen offset:1024 lds
ds_read_b64_tr_b16 a[34:35], v207 offset:2560
v_mfma_f32_16x16x32_bf16 v[128:131], a[4:7], a[140:143], v[128:131]
ds_read_b64_tr_b16 a[36:37], v207 offset:4608
ds_read_b64_tr_b16 a[38:39], v207 offset:6656
v_mfma_f32_16x16x32_bf16 v[4:7], a[8:11], a[104:107], v[4:7]
buffer_load_dwordx4 v202, s[16:19], s58 offen offset:2048 lds
s_waitcnt lgkmcnt(7)
v_mfma_f32_16x16x32_bf16 v[4:7], a[12:15], a[124:127], v[4:7]
ds_read_b64_tr_b16 a[40:41], v208 offset:512
ds_read_b64_tr_b16 a[42:43], v208 offset:2560
v_mfma_f32_16x16x32_bf16 v[36:39], a[8:11], a[108:111], v[36:39]
buffer_load_dwordx4 v203, s[16:19], s58 offen offset:3072 lds
ds_read_b64_tr_b16 a[44:45], v208 offset:4608
v_mfma_f32_16x16x32_bf16 v[36:39], a[12:15], a[128:131], v[36:39]
s_add_u32 m0, s50, 151552
ds_read_b64_tr_b16 a[46:47], v208 offset:6656
v_mfma_f32_16x16x32_bf16 v[68:71], a[8:11], a[112:115], v[68:71]
buffer_load_dwordx4 v204, s[16:19], s58 offen lds
ds_read_b64_tr_b16 a[0:1], v207 offset:768
v_mfma_f32_16x16x32_bf16 v[68:71], a[12:15], a[132:135], v[68:71]
s_add_u32 s58, s58, 128
s_cmp_eq_u32 s58, 896
s_cselect_b32 s58, 0, s58
v_mfma_f32_16x16x32_bf16 v[100:103], a[8:11], a[116:119], v[100:103]
ds_read_b64_tr_b16 a[2:3], v207 offset:2816
ds_read_b64_tr_b16 a[4:5], v207 offset:4864
v_mfma_f32_16x16x32_bf16 v[100:103], a[12:15], a[136:139], v[100:103]
s_mov_b32 s46, 0
ds_read_b64_tr_b16 a[6:7], v207 offset:6912
v_mfma_f32_16x16x32_bf16 v[132:135], a[8:11], a[120:123], v[132:135]
buffer_load_dwordx4 a[144:147], v248, s[12:15], s46 offen offset:0 nt
s_waitcnt lgkmcnt(8)
ds_read_b64_tr_b16 a[8:9], v208 offset:768
v_mfma_f32_16x16x32_bf16 v[132:135], a[12:15], a[140:143], v[132:135]
ds_read_b64_tr_b16 a[10:11], v208 offset:2816
ds_read_b64_tr_b16 a[12:13], v208 offset:4864
v_mfma_f32_16x16x32_bf16 v[8:11], a[16:19], a[104:107], v[8:11]
buffer_load_dwordx4 a[148:151], v249, s[12:15], s46 offen offset:1024 nt
ds_read_b64_tr_b16 a[14:15], v208 offset:6912
v_mfma_f32_16x16x32_bf16 v[8:11], a[20:23], a[124:127], v[8:11]
v_mfma_f32_16x16x32_bf16 v[40:43], a[16:19], a[108:111], v[40:43]
buffer_load_dwordx4 a[152:155], v248, s[12:15], s46 offen offset:2048 nt
v_mfma_f32_16x16x32_bf16 v[40:43], a[20:23], a[128:131], v[40:43]
v_mfma_f32_16x16x32_bf16 v[72:75], a[16:19], a[112:115], v[72:75]
buffer_load_dwordx4 a[156:159], v249, s[12:15], s46 offen offset:3072 nt
v_mfma_f32_16x16x32_bf16 v[72:75], a[20:23], a[132:135], v[72:75]
v_mfma_f32_16x16x32_bf16 v[104:107], a[16:19], a[116:119], v[104:107]
v_mfma_f32_16x16x32_bf16 v[104:107], a[20:23], a[136:139], v[104:107]
v_mfma_f32_16x16x32_bf16 v[136:139], a[16:19], a[120:123], v[136:139]
v_mfma_f32_16x16x32_bf16 v[136:139], a[20:23], a[140:143], v[136:139]
s_waitcnt lgkmcnt(0)
v_mfma_f32_16x16x32_bf16 v[12:15], a[24:27], a[104:107], v[12:15]
v_mfma_f32_16x16x32_bf16 v[12:15], a[28:31], a[124:127], v[12:15]
v_mfma_f32_16x16x32_bf16 v[44:47], a[24:27], a[108:111], v[44:47]
v_mfma_f32_16x16x32_bf16 v[44:47], a[28:31], a[128:131], v[44:47]
v_mfma_f32_16x16x32_bf16 v[76:79], a[24:27], a[112:115], v[76:79]
v_mfma_f32_16x16x32_bf16 v[76:79], a[28:31], a[132:135], v[76:79]
v_mfma_f32_16x16x32_bf16 v[108:111], a[24:27], a[116:119], v[108:111]
v_mfma_f32_16x16x32_bf16 v[108:111], a[28:31], a[136:139], v[108:111]
v_mfma_f32_16x16x32_bf16 v[140:143], a[24:27], a[120:123], v[140:143]
v_mfma_f32_16x16x32_bf16 v[140:143], a[28:31], a[140:143], v[140:143]
v_mfma_f32_16x16x32_bf16 v[16:19], a[32:35], a[104:107], v[16:19]
v_mfma_f32_16x16x32_bf16 v[16:19], a[36:39], a[124:127], v[16:19]
v_mfma_f32_16x16x32_bf16 v[48:51], a[32:35], a[108:111], v[48:51]
v_mfma_f32_16x16x32_bf16 v[48:51], a[36:39], a[128:131], v[48:51]
v_mfma_f32_16x16x32_bf16 v[80:83], a[32:35], a[112:115], v[80:83]
v_mfma_f32_16x16x32_bf16 v[80:83], a[36:39], a[132:135], v[80:83]
v_mfma_f32_16x16x32_bf16 v[112:115], a[32:35], a[116:119], v[112:115]
v_mfma_f32_16x16x32_bf16 v[112:115], a[36:39], a[136:139], v[112:115]
v_mfma_f32_16x16x32_bf16 v[144:147], a[32:35], a[120:123], v[144:147]
v_mfma_f32_16x16x32_bf16 v[144:147], a[36:39], a[140:143], v[144:147]
v_mfma_f32_16x16x32_bf16 v[20:23], a[40:43], a[104:107], v[20:23]
v_mfma_f32_16x16x32_bf16 v[20:23], a[44:47], a[124:127], v[20:23]
v_mfma_f32_16x16x32_bf16 v[52:55], a[40:43], a[108:111], v[52:55]
v_mfma_f32_16x16x32_bf16 v[52:55], a[44:47], a[128:131], v[52:55]
v_mfma_f32_16x16x32_bf16 v[84:87], a[40:43], a[112:115], v[84:87]
v_mfma_f32_16x16x32_bf16 v[84:87], a[44:47], a[132:135], v[84:87]
v_mfma_f32_16x16x32_bf16 v[116:119], a[40:43], a[116:119], v[116:119]
v_mfma_f32_16x16x32_bf16 v[116:119], a[44:47], a[136:139], v[116:119]
v_mfma_f32_16x16x32_bf16 v[148:151], a[40:43], a[120:123], v[148:151]
v_mfma_f32_16x16x32_bf16 v[148:151], a[44:47], a[140:143], v[148:151]
v_mfma_f32_16x16x32_bf16 v[24:27], a[0:3], a[104:107], v[24:27]
v_mfma_f32_16x16x32_bf16 v[24:27], a[4:7], a[124:127], v[24:27]
v_mfma_f32_16x16x32_bf16 v[56:59], a[0:3], a[108:111], v[56:59]
v_mfma_f32_16x16x32_bf16 v[56:59], a[4:7], a[128:131], v[56:59]
v_mfma_f32_16x16x32_bf16 v[88:91], a[0:3], a[112:115], v[88:91]
v_mfma_f32_16x16x32_bf16 v[88:91], a[4:7], a[132:135], v[88:91]
v_mfma_f32_16x16x32_bf16 v[120:123], a[0:3], a[116:119], v[120:123]
v_mfma_f32_16x16x32_bf16 v[120:123], a[4:7], a[136:139], v[120:123]
s_waitcnt vmcnt(21) lgkmcnt(0)
s_barrier
ds_read_b128 a[64:67], v211 offset:0
ds_read_b128 a[68:71], v211 offset:2048
v_mfma_f32_16x16x32_bf16 v[152:155], a[0:3], a[120:123], v[152:155]
ds_read_b128 a[72:75], v211 offset:4096
ds_read_b64_tr_b16 a[16:17], v207 offset:32768
v_mfma_f32_16x16x32_bf16 v[152:155], a[4:7], a[140:143], v[152:155]
s_add_u32 m0, s29, 65536
ds_read_b128 a[76:79], v211 offset:6144
v_mfma_f32_16x16x32_bf16 v[28:31], a[8:11], a[104:107], v[28:31]
buffer_load_dwordx4 v192, s[20:23], s57 offen offset:0 lds
ds_read_b64_tr_b16 a[18:19], v207 offset:34816
v_mfma_f32_16x16x32_bf16 v[28:31], a[12:15], a[124:127], v[28:31]
ds_read_b128 a[80:83], v213 offset:0
ds_read_b64_tr_b16 a[20:21], v207 offset:36864
v_mfma_f32_16x16x32_bf16 v[60:63], a[8:11], a[108:111], v[60:63]
buffer_load_dwordx4 v193, s[20:23], s57 offen offset:1024 lds
ds_read_b128 a[84:87], v212 offset:0
v_mfma_f32_16x16x32_bf16 v[60:63], a[12:15], a[128:131], v[60:63]
ds_read_b64_tr_b16 a[22:23], v207 offset:38912
ds_read_b128 a[88:91], v212 offset:2048
v_mfma_f32_16x16x32_bf16 v[92:95], a[8:11], a[112:115], v[92:95]
buffer_load_dwordx4 v194, s[20:23], s57 offen offset:2048 lds
ds_read_b128 a[92:95], v212 offset:4096
v_mfma_f32_16x16x32_bf16 v[92:95], a[12:15], a[132:135], v[92:95]
ds_read_b128 a[96:99], v212 offset:6144
ds_read_b128 a[100:103], v214 offset:0
v_mfma_f32_16x16x32_bf16 v[124:127], a[8:11], a[116:119], v[124:127]
buffer_load_dwordx4 v195, s[20:23], s57 offen offset:3072 lds
ds_read_b64_tr_b16 a[24:25], v208 offset:32768
v_mfma_f32_16x16x32_bf16 v[124:127], a[12:15], a[136:139], v[124:127]
s_add_u32 m0, s29, 69632
s_waitcnt lgkmcnt(8)
ds_read_b64_tr_b16 a[26:27], v208 offset:34816
v_mfma_f32_16x16x32_bf16 v[156:159], a[8:11], a[120:123], v[156:159]
buffer_load_dwordx4 v196, s[20:23], s57 offen offset:0 lds
ds_read_b64_tr_b16 a[28:29], v208 offset:36864
v_mfma_f32_16x16x32_bf16 v[156:159], a[12:15], a[140:143], v[156:159]
ds_read_b64_tr_b16 a[30:31], v208 offset:38912
s_waitcnt lgkmcnt(9)
v_mfma_f32_16x16x32_bf16 v[0:3], a[16:19], a[64:67], v[0:3]
buffer_load_dwordx4 v197, s[20:23], s57 offen offset:1024 lds
s_waitcnt lgkmcnt(7)
v_mfma_f32_16x16x32_bf16 v[0:3], a[20:23], a[84:87], v[0:3]
ds_read_b64_tr_b16 a[32:33], v207 offset:33024
ds_read_b64_tr_b16 a[34:35], v207 offset:35072
v_mfma_f32_16x16x32_bf16 v[32:35], a[16:19], a[68:71], v[32:35]
buffer_load_dwordx4 v198, s[20:23], s57 offen offset:2048 lds
ds_read_b64_tr_b16 a[36:37], v207 offset:37120
v_mfma_f32_16x16x32_bf16 v[32:35], a[20:23], a[88:91], v[32:35]
ds_read_b64_tr_b16 a[38:39], v207 offset:39168
ds_read_b64_tr_b16 a[40:41], v208 offset:33024
v_mfma_f32_16x16x32_bf16 v[64:67], a[16:19], a[72:75], v[64:67]
buffer_load_dwordx4 v199, s[20:23], s57 offen offset:3072 lds
s_add_u32 s57, s57, 0x80000
s_cmp_eq_u32 s57, 0x380000
s_cselect_b32 s57, 0, s57
s_waitcnt lgkmcnt(7)
v_mfma_f32_16x16x32_bf16 v[64:67], a[20:23], a[92:95], v[64:67]
s_add_u32 m0, s49, 49152
ds_read_b64_tr_b16 a[42:43], v208 offset:35072
v_mfma_f32_16x16x32_bf16 v[96:99], a[16:19], a[76:79], v[96:99]
buffer_load_dwordx4 v200, s[16:19], s58 offen offset:0 lds
ds_read_b64_tr_b16 a[44:45], v208 offset:37120
v_mfma_f32_16x16x32_bf16 v[96:99], a[20:23], a[96:99], v[96:99]
ds_read_b64_tr_b16 a[46:47], v208 offset:39168
ds_read_b64_tr_b16 a[0:1], v207 offset:33280
v_mfma_f32_16x16x32_bf16 v[128:131], a[16:19], a[80:83], v[128:131]
buffer_load_dwordx4 v201, s[16:19], s58 offen offset:1024 lds
ds_read_b64_tr_b16 a[2:3], v207 offset:35328
v_mfma_f32_16x16x32_bf16 v[128:131], a[20:23], a[100:103], v[128:131]
ds_read_b64_tr_b16 a[4:5], v207 offset:37376
ds_read_b64_tr_b16 a[6:7], v207 offset:39424
v_mfma_f32_16x16x32_bf16 v[4:7], a[24:27], a[64:67], v[4:7]
buffer_load_dwordx4 v202, s[16:19], s58 offen offset:2048 lds
s_waitcnt lgkmcnt(7)
v_mfma_f32_16x16x32_bf16 v[4:7], a[28:31], a[84:87], v[4:7]
ds_read_b64_tr_b16 a[8:9], v208 offset:33280
ds_read_b64_tr_b16 a[10:11], v208 offset:35328
v_mfma_f32_16x16x32_bf16 v[36:39], a[24:27], a[68:71], v[36:39]
buffer_load_dwordx4 v203, s[16:19], s58 offen offset:3072 lds
ds_read_b64_tr_b16 a[12:13], v208 offset:37376
v_mfma_f32_16x16x32_bf16 v[36:39], a[28:31], a[88:91], v[36:39]
s_add_u32 m0, s50, 155648
ds_read_b64_tr_b16 a[14:15], v208 offset:39424
v_mfma_f32_16x16x32_bf16 v[68:71], a[24:27], a[72:75], v[68:71]
buffer_load_dwordx4 v204, s[16:19], s58 offen lds
ds_read_b64_tr_b16 a[16:17], v207 offset:33536
v_mfma_f32_16x16x32_bf16 v[68:71], a[28:31], a[92:95], v[68:71]
s_add_u32 s58, s58, 128
s_cmp_eq_u32 s58, 896
s_cselect_b32 s58, 0, s58
v_mfma_f32_16x16x32_bf16 v[100:103], a[24:27], a[76:79], v[100:103]
ds_read_b64_tr_b16 a[18:19], v207 offset:35584
ds_read_b64_tr_b16 a[20:21], v207 offset:37632
v_mfma_f32_16x16x32_bf16 v[100:103], a[28:31], a[96:99], v[100:103]
s_mov_b32 s46, 4096
ds_read_b64_tr_b16 a[22:23], v207 offset:39680
v_mfma_f32_16x16x32_bf16 v[132:135], a[24:27], a[80:83], v[132:135]
buffer_load_dwordx4 a[48:51], v248, s[12:15], s46 offen offset:0 nt
s_waitcnt lgkmcnt(8)
ds_read_b64_tr_b16 a[24:25], v208 offset:33536
v_mfma_f32_16x16x32_bf16 v[132:135], a[28:31], a[100:103], v[132:135]
ds_read_b64_tr_b16 a[26:27], v208 offset:35584
ds_read_b64_tr_b16 a[28:29], v208 offset:37632
v_mfma_f32_16x16x32_bf16 v[8:11], a[32:35], a[64:67], v[8:11]
buffer_load_dwordx4 a[52:55], v249, s[12:15], s46 offen offset:1024 nt
ds_read_b64_tr_b16 a[30:31], v208 offset:39680
v_mfma_f32_16x16x32_bf16 v[8:11], a[36:39], a[84:87], v[8:11]
v_mfma_f32_16x16x32_bf16 v[40:43], a[32:35], a[68:71], v[40:43]
buffer_load_dwordx4 a[56:59], v248, s[12:15], s46 offen offset:2048 nt
v_mfma_f32_16x16x32_bf16 v[40:43], a[36:39], a[88:91], v[40:43]
v_mfma_f32_16x16x32_bf16 v[72:75], a[32:35], a[72:75], v[72:75]
buffer_load_dwordx4 a[60:63], v249, s[12:15], s46 offen offset:3072 nt
v_mfma_f32_16x16x32_bf16 v[72:75], a[36:39], a[92:95], v[72:75]
v_mfma_f32_16x16x32_bf16 v[104:107], a[32:35], a[76:79], v[104:107]
v_mfma_f32_16x16x32_bf16 v[104:107], a[36:39], a[96:99], v[104:107]
v_mfma_f32_16x16x32_bf16 v[136:139], a[32:35], a[80:83], v[136:139]
v_mfma_f32_16x16x32_bf16 v[136:139], a[36:39], a[100:103], v[136:139]
s_waitcnt lgkmcnt(0)
v_mfma_f32_16x16x32_bf16 v[12:15], a[40:43], a[64:67], v[12:15]
v_mfma_f32_16x16x32_bf16 v[12:15], a[44:47], a[84:87], v[12:15]
v_mfma_f32_16x16x32_bf16 v[44:47], a[40:43], a[68:71], v[44:47]
v_mfma_f32_16x16x32_bf16 v[44:47], a[44:47], a[88:91], v[44:47]
v_mfma_f32_16x16x32_bf16 v[76:79], a[40:43], a[72:75], v[76:79]
v_mfma_f32_16x16x32_bf16 v[76:79], a[44:47], a[92:95], v[76:79]
v_mfma_f32_16x16x32_bf16 v[108:111], a[40:43], a[76:79], v[108:111]
v_mfma_f32_16x16x32_bf16 v[108:111], a[44:47], a[96:99], v[108:111]
v_mfma_f32_16x16x32_bf16 v[140:143], a[40:43], a[80:83], v[140:143]
v_mfma_f32_16x16x32_bf16 v[140:143], a[44:47], a[100:103], v[140:143]
v_mfma_f32_16x16x32_bf16 v[16:19], a[0:3], a[64:67], v[16:19]
v_mfma_f32_16x16x32_bf16 v[16:19], a[4:7], a[84:87], v[16:19]
v_mfma_f32_16x16x32_bf16 v[48:51], a[0:3], a[68:71], v[48:51]
v_mfma_f32_16x16x32_bf16 v[48:51], a[4:7], a[88:91], v[48:51]
v_mfma_f32_16x16x32_bf16 v[80:83], a[0:3], a[72:75], v[80:83]
v_mfma_f32_16x16x32_bf16 v[80:83], a[4:7], a[92:95], v[80:83]
v_mfma_f32_16x16x32_bf16 v[112:115], a[0:3], a[76:79], v[112:115]
v_mfma_f32_16x16x32_bf16 v[112:115], a[4:7], a[96:99], v[112:115]
v_mfma_f32_16x16x32_bf16 v[144:147], a[0:3], a[80:83], v[144:147]
v_mfma_f32_16x16x32_bf16 v[144:147], a[4:7], a[100:103], v[144:147]
v_mfma_f32_16x16x32_bf16 v[20:23], a[8:11], a[64:67], v[20:23]
v_mfma_f32_16x16x32_bf16 v[20:23], a[12:15], a[84:87], v[20:23]
v_mfma_f32_16x16x32_bf16 v[52:55], a[8:11], a[68:71], v[52:55]
v_mfma_f32_16x16x32_bf16 v[52:55], a[12:15], a[88:91], v[52:55]
v_mfma_f32_16x16x32_bf16 v[84:87], a[8:11], a[72:75], v[84:87]
v_mfma_f32_16x16x32_bf16 v[84:87], a[12:15], a[92:95], v[84:87]
v_mfma_f32_16x16x32_bf16 v[116:119], a[8:11], a[76:79], v[116:119]
v_mfma_f32_16x16x32_bf16 v[116:119], a[12:15], a[96:99], v[116:119]
v_mfma_f32_16x16x32_bf16 v[148:151], a[8:11], a[80:83], v[148:151]
v_mfma_f32_16x16x32_bf16 v[148:151], a[12:15], a[100:103], v[148:151]
v_mfma_f32_16x16x32_bf16 v[24:27], a[16:19], a[64:67], v[24:27]
v_mfma_f32_16x16x32_bf16 v[24:27], a[20:23], a[84:87], v[24:27]
v_mfma_f32_16x16x32_bf16 v[56:59], a[16:19], a[68:71], v[56:59]
v_mfma_f32_16x16x32_bf16 v[56:59], a[20:23], a[88:91], v[56:59]
v_mfma_f32_16x16x32_bf16 v[88:91], a[16:19], a[72:75], v[88:91]
v_mfma_f32_16x16x32_bf16 v[88:91], a[20:23], a[92:95], v[88:91]
v_mfma_f32_16x16x32_bf16 v[120:123], a[16:19], a[76:79], v[120:123]
v_mfma_f32_16x16x32_bf16 v[120:123], a[20:23], a[96:99], v[120:123]
s_waitcnt vmcnt(21) lgkmcnt(0)
s_barrier
ds_read_b128 a[104:107], v209 offset:0
ds_read_b128 a[108:111], v209 offset:2048
v_mfma_f32_16x16x32_bf16 v[152:155], a[16:19], a[80:83], v[152:155]
ds_read_b128 a[112:115], v209 offset:4096
ds_read_b64_tr_b16 a[32:33], v205 offset:0
v_mfma_f32_16x16x32_bf16 v[152:155], a[20:23], a[100:103], v[152:155]
s_add_u32 m0, s29, 98304
ds_read_b128 a[116:119], v209 offset:6144
v_mfma_f32_16x16x32_bf16 v[28:31], a[24:27], a[64:67], v[28:31]
buffer_load_dwordx4 v192, s[20:23], s57 offen offset:0 lds
ds_read_b64_tr_b16 a[34:35], v205 offset:2048
v_mfma_f32_16x16x32_bf16 v[28:31], a[28:31], a[84:87], v[28:31]
ds_read_b128 a[120:123], v213 offset:4096
ds_read_b64_tr_b16 a[36:37], v205 offset:4096
v_mfma_f32_16x16x32_bf16 v[60:63], a[24:27], a[68:71], v[60:63]
buffer_load_dwordx4 v193, s[20:23], s57 offen offset:1024 lds
ds_read_b128 a[124:127], v210 offset:0
v_mfma_f32_16x16x32_bf16 v[60:63], a[28:31], a[88:91], v[60:63]
ds_read_b64_tr_b16 a[38:39], v205 offset:6144
ds_read_b128 a[128:131], v210 offset:2048
v_mfma_f32_16x16x32_bf16 v[92:95], a[24:27], a[72:75], v[92:95]
buffer_load_dwordx4 v194, s[20:23], s57 offen offset:2048 lds
ds_read_b128 a[132:135], v210 offset:4096
v_mfma_f32_16x16x32_bf16 v[92:95], a[28:31], a[92:95], v[92:95]
ds_read_b128 a[136:139], v210 offset:6144
ds_read_b128 a[140:143], v214 offset:4096
v_mfma_f32_16x16x32_bf16 v[124:127], a[24:27], a[76:79], v[124:127]
buffer_load_dwordx4 v195, s[20:23], s57 offen offset:3072 lds
ds_read_b64_tr_b16 a[40:41], v206 offset:0
v_mfma_f32_16x16x32_bf16 v[124:127], a[28:31], a[96:99], v[124:127]
s_add_u32 m0, s29, 102400
s_waitcnt lgkmcnt(8)
ds_read_b64_tr_b16 a[42:43], v206 offset:2048
v_mfma_f32_16x16x32_bf16 v[156:159], a[24:27], a[80:83], v[156:159]
buffer_load_dwordx4 v196, s[20:23], s57 offen offset:0 lds
ds_read_b64_tr_b16 a[44:45], v206 offset:4096
v_mfma_f32_16x16x32_bf16 v[156:159], a[28:31], a[100:103], v[156:159]
ds_read_b64_tr_b16 a[46:47], v206 offset:6144
s_waitcnt lgkmcnt(9)
v_mfma_f32_16x16x32_bf16 v[0:3], a[32:35], a[104:107], v[0:3]
buffer_load_dwordx4 v197, s[20:23], s57 offen offset:1024 lds
s_waitcnt lgkmcnt(7)
v_mfma_f32_16x16x32_bf16 v[0:3], a[36:39], a[124:127], v[0:3]
ds_read_b64_tr_b16 a[0:1], v205 offset:256
ds_read_b64_tr_b16 a[2:3], v205 offset:2304
v_mfma_f32_16x16x32_bf16 v[32:35], a[32:35], a[108:111], v[32:35]
buffer_load_dwordx4 v198, s[20:23], s57 offen offset:2048 lds
ds_read_b64_tr_b16 a[4:5], v205 offset:4352
v_mfma_f32_16x16x32_bf16 v[32:35], a[36:39], a[128:131], v[32:35]
ds_read_b64_tr_b16 a[6:7], v205 offset:6400
ds_read_b64_tr_b16 a[8:9], v206 offset:256
v_mfma_f32_16x16x32_bf16 v[64:67], a[32:35], a[112:115], v[64:67]
buffer_load_dwordx4 v199, s[20:23], s57 offen offset:3072 lds
s_add_u32 s57, s57, 0x80000
s_cmp_eq_u32 s57, 0x380000
s_cselect_b32 s57, 0, s57
s_waitcnt lgkmcnt(7)
v_mfma_f32_16x16x32_bf16 v[64:67], a[36:39], a[132:135], v[64:67]
s_add_u32 m0, s49, 131072
ds_read_b64_tr_b16 a[10:11], v206 offset:2304
v_mfma_f32_16x16x32_bf16 v[96:99], a[32:35], a[116:119], v[96:99]
buffer_load_dwordx4 v200, s[16:19], s58 offen offset:0 lds
ds_read_b64_tr_b16 a[12:13], v206 offset:4352
v_mfma_f32_16x16x32_bf16 v[96:99], a[36:39], a[136:139], v[96:99]
ds_read_b64_tr_b16 a[14:15], v206 offset:6400
ds_read_b64_tr_b16 a[16:17], v205 offset:512
v_mfma_f32_16x16x32_bf16 v[128:131], a[32:35], a[120:123], v[128:131]
buffer_load_dwordx4 v201, s[16:19], s58 offen offset:1024 lds
ds_read_b64_tr_b16 a[18:19], v205 offset:2560
v_mfma_f32_16x16x32_bf16 v[128:131], a[36:39], a[140:143], v[128:131]
ds_read_b64_tr_b16 a[20:21], v205 offset:4608
ds_read_b64_tr_b16 a[22:23], v205 offset:6656
v_mfma_f32_16x16x32_bf16 v[4:7], a[40:43], a[104:107], v[4:7]
buffer_load_dwordx4 v202, s[16:19], s58 offen offset:2048 lds
s_waitcnt lgkmcnt(7)
v_mfma_f32_16x16x32_bf16 v[4:7], a[44:47], a[124:127], v[4:7]
ds_read_b64_tr_b16 a[24:25], v206 offset:512
ds_read_b64_tr_b16 a[26:27], v206 offset:2560
v_mfma_f32_16x16x32_bf16 v[36:39], a[40:43], a[108:111], v[36:39]
buffer_load_dwordx4 v203, s[16:19], s58 offen offset:3072 lds
ds_read_b64_tr_b16 a[28:29], v206 offset:4608
v_mfma_f32_16x16x32_bf16 v[36:39], a[44:47], a[128:131], v[36:39]
s_add_u32 m0, s50, 147456
ds_read_b64_tr_b16 a[30:31], v206 offset:6656
v_mfma_f32_16x16x32_bf16 v[68:71], a[40:43], a[112:115], v[68:71]
buffer_load_dwordx4 v204, s[16:19], s58 offen lds
ds_read_b64_tr_b16 a[32:33], v205 offset:768
v_mfma_f32_16x16x32_bf16 v[68:71], a[44:47], a[132:135], v[68:71]
s_add_u32 s58, s58, 128
s_cmp_eq_u32 s58, 896
s_cselect_b32 s58, 0, s58
v_mfma_f32_16x16x32_bf16 v[100:103], a[40:43], a[116:119], v[100:103]
ds_read_b64_tr_b16 a[34:35], v205 offset:2816
ds_read_b64_tr_b16 a[36:37], v205 offset:4864
v_mfma_f32_16x16x32_bf16 v[100:103], a[44:47], a[136:139], v[100:103]
ds_read_b64_tr_b16 a[38:39], v205 offset:6912
v_mfma_f32_16x16x32_bf16 v[132:135], a[40:43], a[120:123], v[132:135]
s_waitcnt lgkmcnt(8)
ds_read_b64_tr_b16 a[40:41], v206 offset:768
ds_read_b64_tr_b16 a[42:43], v206 offset:2816
v_mfma_f32_16x16x32_bf16 v[132:135], a[44:47], a[140:143], v[132:135]
s_mov_b32 s45, 32768
ds_read_b64_tr_b16 a[44:45], v206 offset:4864
v_mfma_f32_16x16x32_bf16 v[8:11], a[0:3], a[104:107], v[8:11]
buffer_load_dwordx4 a[160:163], v248, s[8:11], s45 offen offset:0 nt
ds_read_b64_tr_b16 a[46:47], v206 offset:6912
v_mfma_f32_16x16x32_bf16 v[8:11], a[4:7], a[124:127], v[8:11]
v_mfma_f32_16x16x32_bf16 v[40:43], a[0:3], a[108:111], v[40:43]
v_mfma_f32_16x16x32_bf16 v[40:43], a[4:7], a[128:131], v[40:43]
v_mfma_f32_16x16x32_bf16 v[72:75], a[0:3], a[112:115], v[72:75]
v_mfma_f32_16x16x32_bf16 v[72:75], a[4:7], a[132:135], v[72:75]
v_mfma_f32_16x16x32_bf16 v[104:107], a[0:3], a[116:119], v[104:107]
v_mfma_f32_16x16x32_bf16 v[104:107], a[4:7], a[136:139], v[104:107]
v_mfma_f32_16x16x32_bf16 v[136:139], a[0:3], a[120:123], v[136:139]
buffer_load_dwordx4 a[164:167], v249, s[8:11], s45 offen offset:1024 nt
v_mfma_f32_16x16x32_bf16 v[136:139], a[4:7], a[140:143], v[136:139]
s_waitcnt lgkmcnt(0)
v_mfma_f32_16x16x32_bf16 v[12:15], a[8:11], a[104:107], v[12:15]
v_mfma_f32_16x16x32_bf16 v[12:15], a[12:15], a[124:127], v[12:15]
v_mfma_f32_16x16x32_bf16 v[44:47], a[8:11], a[108:111], v[44:47]
v_mfma_f32_16x16x32_bf16 v[44:47], a[12:15], a[128:131], v[44:47]
v_mfma_f32_16x16x32_bf16 v[76:79], a[8:11], a[112:115], v[76:79]
v_mfma_f32_16x16x32_bf16 v[76:79], a[12:15], a[132:135], v[76:79]
v_mfma_f32_16x16x32_bf16 v[108:111], a[8:11], a[116:119], v[108:111]
buffer_load_dwordx4 a[168:171], v248, s[8:11], s45 offen offset:2048 nt
v_mfma_f32_16x16x32_bf16 v[108:111], a[12:15], a[136:139], v[108:111]
v_mfma_f32_16x16x32_bf16 v[140:143], a[8:11], a[120:123], v[140:143]
v_mfma_f32_16x16x32_bf16 v[140:143], a[12:15], a[140:143], v[140:143]
v_mfma_f32_16x16x32_bf16 v[16:19], a[16:19], a[104:107], v[16:19]
v_mfma_f32_16x16x32_bf16 v[16:19], a[20:23], a[124:127], v[16:19]
v_mfma_f32_16x16x32_bf16 v[48:51], a[16:19], a[108:111], v[48:51]
v_mfma_f32_16x16x32_bf16 v[48:51], a[20:23], a[128:131], v[48:51]
v_mfma_f32_16x16x32_bf16 v[80:83], a[16:19], a[112:115], v[80:83]
buffer_load_dwordx4 a[172:175], v249, s[8:11], s45 offen offset:3072 nt
v_mfma_f32_16x16x32_bf16 v[80:83], a[20:23], a[132:135], v[80:83]
v_mfma_f32_16x16x32_bf16 v[112:115], a[16:19], a[116:119], v[112:115]
v_mfma_f32_16x16x32_bf16 v[112:115], a[20:23], a[136:139], v[112:115]
v_mfma_f32_16x16x32_bf16 v[144:147], a[16:19], a[120:123], v[144:147]
v_mfma_f32_16x16x32_bf16 v[144:147], a[20:23], a[140:143], v[144:147]
v_mfma_f32_16x16x32_bf16 v[20:23], a[24:27], a[104:107], v[20:23]
v_mfma_f32_16x16x32_bf16 v[20:23], a[28:31], a[124:127], v[20:23]
s_mov_b32 s45, 36864
v_mfma_f32_16x16x32_bf16 v[52:55], a[24:27], a[108:111], v[52:55]
buffer_load_dwordx4 a[176:179], v248, s[8:11], s45 offen offset:0 nt
v_mfma_f32_16x16x32_bf16 v[52:55], a[28:31], a[128:131], v[52:55]
v_mfma_f32_16x16x32_bf16 v[84:87], a[24:27], a[112:115], v[84:87]
v_mfma_f32_16x16x32_bf16 v[84:87], a[28:31], a[132:135], v[84:87]
v_mfma_f32_16x16x32_bf16 v[116:119], a[24:27], a[116:119], v[116:119]
v_mfma_f32_16x16x32_bf16 v[116:119], a[28:31], a[136:139], v[116:119]
v_mfma_f32_16x16x32_bf16 v[148:151], a[24:27], a[120:123], v[148:151]
v_mfma_f32_16x16x32_bf16 v[148:151], a[28:31], a[140:143], v[148:151]
v_mfma_f32_16x16x32_bf16 v[24:27], a[32:35], a[104:107], v[24:27]
buffer_load_dwordx4 a[180:183], v249, s[8:11], s45 offen offset:1024 nt
v_mfma_f32_16x16x32_bf16 v[24:27], a[36:39], a[124:127], v[24:27]
v_mfma_f32_16x16x32_bf16 v[56:59], a[32:35], a[108:111], v[56:59]
v_mfma_f32_16x16x32_bf16 v[56:59], a[36:39], a[128:131], v[56:59]
v_mfma_f32_16x16x32_bf16 v[88:91], a[32:35], a[112:115], v[88:91]
v_mfma_f32_16x16x32_bf16 v[88:91], a[36:39], a[132:135], v[88:91]
v_mfma_f32_16x16x32_bf16 v[120:123], a[32:35], a[116:119], v[120:123]
v_mfma_f32_16x16x32_bf16 v[120:123], a[36:39], a[136:139], v[120:123]
s_waitcnt vmcnt(23) lgkmcnt(0)
s_barrier
ds_read_b128 a[64:67], v209 offset:16384
ds_read_b128 a[68:71], v209 offset:18432
v_mfma_f32_16x16x32_bf16 v[152:155], a[32:35], a[120:123], v[152:155]
buffer_load_dwordx4 a[184:187], v248, s[8:11], s45 offen offset:2048 nt
ds_read_b128 a[72:75], v209 offset:20480
v_mfma_f32_16x16x32_bf16 v[152:155], a[36:39], a[140:143], v[152:155]
ds_read_b64_tr_b16 a[0:1], v207 offset:0
ds_read_b128 a[76:79], v209 offset:22528
v_mfma_f32_16x16x32_bf16 v[28:31], a[40:43], a[104:107], v[28:31]
ds_read_b64_tr_b16 a[2:3], v207 offset:2048
ds_read_b128 a[80:83], v213 offset:8192
v_mfma_f32_16x16x32_bf16 v[28:31], a[44:47], a[124:127], v[28:31]
ds_read_b64_tr_b16 a[4:5], v207 offset:4096
ds_read_b128 a[84:87], v210 offset:16384
v_mfma_f32_16x16x32_bf16 v[60:63], a[40:43], a[108:111], v[60:63]
ds_read_b64_tr_b16 a[6:7], v207 offset:6144
ds_read_b128 a[88:91], v210 offset:18432
v_mfma_f32_16x16x32_bf16 v[60:63], a[44:47], a[128:131], v[60:63]
ds_read_b128 a[92:95], v210 offset:20480
ds_read_b128 a[96:99], v210 offset:22528
v_mfma_f32_16x16x32_bf16 v[92:95], a[40:43], a[112:115], v[92:95]
ds_read_b128 a[100:103], v214 offset:8192
v_mfma_f32_16x16x32_bf16 v[92:95], a[44:47], a[132:135], v[92:95]
ds_read_b64_tr_b16 a[8:9], v208 offset:0
s_waitcnt lgkmcnt(8)
ds_read_b64_tr_b16 a[10:11], v208 offset:2048
v_mfma_f32_16x16x32_bf16 v[124:127], a[40:43], a[116:119], v[124:127]
buffer_load_dwordx4 a[188:191], v249, s[8:11], s45 offen offset:3072 nt
ds_read_b64_tr_b16 a[12:13], v208 offset:4096
v_mfma_f32_16x16x32_bf16 v[124:127], a[44:47], a[136:139], v[124:127]
ds_read_b64_tr_b16 a[14:15], v208 offset:6144
ds_write_b128 v250, v[160:163] offset:0
v_mfma_f32_16x16x32_bf16 v[156:159], a[40:43], a[120:123], v[156:159]
ds_write_b128 v250, v[164:167] offset:1024
v_mfma_f32_16x16x32_bf16 v[156:159], a[44:47], a[140:143], v[156:159]
s_waitcnt lgkmcnt(9)
v_mfma_f32_16x16x32_bf16 v[0:3], a[0:3], a[64:67], v[0:3]
v_mfma_f32_16x16x32_bf16 v[0:3], a[4:7], a[84:87], v[0:3]
ds_write_b128 v250, v[168:171] offset:2048
v_mfma_f32_16x16x32_bf16 v[32:35], a[0:3], a[68:71], v[32:35]
v_mfma_f32_16x16x32_bf16 v[32:35], a[4:7], a[88:91], v[32:35]
ds_write_b128 v250, v[172:175] offset:3072
v_mfma_f32_16x16x32_bf16 v[64:67], a[0:3], a[72:75], v[64:67]
s_waitcnt lgkmcnt(3)
v_mfma_f32_16x16x32_bf16 v[64:67], a[4:7], a[92:95], v[64:67]
v_mfma_f32_16x16x32_bf16 v[96:99], a[0:3], a[76:79], v[96:99]
v_mfma_f32_16x16x32_bf16 v[96:99], a[4:7], a[96:99], v[96:99]
s_waitcnt vmcnt(8) lgkmcnt(0)
s_barrier
ds_read_b128 a[104:107], v211 offset:0
ds_read_b128 a[108:111], v211 offset:2048
v_mfma_f32_16x16x32_bf16 v[128:131], a[0:3], a[80:83], v[128:131]
ds_read_b128 a[112:115], v211 offset:4096
ds_read_b64_tr_b16 a[16:17], v207 offset:32768
v_mfma_f32_16x16x32_bf16 v[128:131], a[4:7], a[100:103], v[128:131]
s_mov_b32 s45, 65536
ds_read_b128 a[116:119], v211 offset:6144
v_mfma_f32_16x16x32_bf16 v[4:7], a[8:11], a[64:67], v[4:7]
buffer_load_dwordx4 a[192:195], v248, s[8:11], s45 offen offset:0 nt
ds_read_b64_tr_b16 a[18:19], v207 offset:34816
v_mfma_f32_16x16x32_bf16 v[4:7], a[12:15], a[84:87], v[4:7]
ds_read_b128 a[120:123], v213 offset:0
ds_read_b64_tr_b16 a[20:21], v207 offset:36864
v_mfma_f32_16x16x32_bf16 v[36:39], a[8:11], a[68:71], v[36:39]
ds_read_b128 a[124:127], v212 offset:0
ds_read_b64_tr_b16 a[22:23], v207 offset:38912
v_mfma_f32_16x16x32_bf16 v[36:39], a[12:15], a[88:91], v[36:39]
ds_read_b128 a[128:131], v212 offset:2048
ds_read_b128 a[132:135], v212 offset:4096
v_mfma_f32_16x16x32_bf16 v[68:71], a[8:11], a[72:75], v[68:71]
ds_read_b128 a[136:139], v212 offset:6144
ds_read_b128 a[140:143], v214 offset:0
v_mfma_f32_16x16x32_bf16 v[68:71], a[12:15], a[92:95], v[68:71]
ds_read_b64_tr_b16 a[24:25], v208 offset:32768
s_waitcnt lgkmcnt(8)
ds_read_b64_tr_b16 a[26:27], v208 offset:34816
v_mfma_f32_16x16x32_bf16 v[100:103], a[8:11], a[76:79], v[100:103]
ds_read_b64_tr_b16 a[28:29], v208 offset:36864
ds_write_b128 v250, v[176:179] offset:4096
v_mfma_f32_16x16x32_bf16 v[100:103], a[12:15], a[96:99], v[100:103]
v_mfma_f32_16x16x32_bf16 v[132:135], a[8:11], a[80:83], v[132:135]
buffer_load_dwordx4 a[196:199], v249, s[8:11], s45 offen offset:1024 nt
v_mfma_f32_16x16x32_bf16 v[132:135], a[12:15], a[100:103], v[132:135]
ds_read_b64_tr_b16 a[30:31], v208 offset:38912
s_waitcnt lgkmcnt(9)
v_mfma_f32_16x16x32_bf16 v[0:3], a[16:19], a[104:107], v[0:3]
ds_read_b64_tr_b16 a[32:33], v207 offset:256
ds_read_b64_tr_b16 a[34:35], v207 offset:2304
v_mfma_f32_16x16x32_bf16 v[0:3], a[20:23], a[124:127], v[0:3]
ds_read_b64_tr_b16 a[36:37], v207 offset:4352
ds_read_b64_tr_b16 a[38:39], v207 offset:6400
v_mfma_f32_16x16x32_bf16 v[32:35], a[16:19], a[108:111], v[32:35]
ds_read_b64_tr_b16 a[40:41], v208 offset:256
s_waitcnt lgkmcnt(8)
v_mfma_f32_16x16x32_bf16 v[32:35], a[20:23], a[128:131], v[32:35]
ds_read_b64_tr_b16 a[42:43], v208 offset:2304
ds_read_b64_tr_b16 a[44:45], v208 offset:4352
v_mfma_f32_16x16x32_bf16 v[64:67], a[16:19], a[112:115], v[64:67]
ds_read_b64_tr_b16 a[46:47], v208 offset:6400
ds_read_b64_tr_b16 a[0:1], v207 offset:33024
v_mfma_f32_16x16x32_bf16 v[64:67], a[20:23], a[132:135], v[64:67]
ds_read_b64_tr_b16 a[2:3], v207 offset:35072
ds_read_b64_tr_b16 a[4:5], v207 offset:37120
v_mfma_f32_16x16x32_bf16 v[96:99], a[16:19], a[116:119], v[96:99]
buffer_load_dwordx4 a[200:203], v248, s[8:11], s45 offen offset:2048 nt
ds_read_b64_tr_b16 a[6:7], v207 offset:39168
v_mfma_f32_16x16x32_bf16 v[96:99], a[20:23], a[136:139], v[96:99]
s_waitcnt lgkmcnt(8)
ds_read_b64_tr_b16 a[8:9], v208 offset:33024
ds_read_b64_tr_b16 a[10:11], v208 offset:35072
v_mfma_f32_16x16x32_bf16 v[128:131], a[16:19], a[120:123], v[128:131]
ds_read_b64_tr_b16 a[12:13], v208 offset:37120
ds_read_b64_tr_b16 a[14:15], v208 offset:39168
v_mfma_f32_16x16x32_bf16 v[128:131], a[20:23], a[140:143], v[128:131]
ds_read_b64_tr_b16 a[16:17], v207 offset:512
ds_read_b64_tr_b16 a[18:19], v207 offset:2560
v_mfma_f32_16x16x32_bf16 v[4:7], a[24:27], a[104:107], v[4:7]
ds_read_b64_tr_b16 a[20:21], v207 offset:4608
s_waitcnt lgkmcnt(12)
v_mfma_f32_16x16x32_bf16 v[4:7], a[28:31], a[124:127], v[4:7]
s_barrier
ds_read_b64_tr_b16 a[22:23], v207 offset:6656
ds_write_b128 v250, v[180:183] offset:5120
v_mfma_f32_16x16x32_bf16 v[36:39], a[24:27], a[108:111], v[36:39]
ds_write_b128 v250, v[184:187] offset:6144
v_mfma_f32_16x16x32_bf16 v[36:39], a[28:31], a[128:131], v[36:39]
v_mfma_f32_16x16x32_bf16 v[68:71], a[24:27], a[112:115], v[68:71]
buffer_load_dwordx4 a[204:207], v249, s[8:11], s45 offen offset:3072 nt
s_waitcnt lgkmcnt(8)
ds_write_b128 v250, v[188:191] offset:7168
v_mfma_f32_16x16x32_bf16 v[68:71], a[28:31], a[132:135], v[68:71]
v_mfma_f32_16x16x32_bf16 v[100:103], a[24:27], a[116:119], v[100:103]
v_mfma_f32_16x16x32_bf16 v[100:103], a[28:31], a[136:139], v[100:103]
v_mfma_f32_16x16x32_bf16 v[132:135], a[24:27], a[120:123], v[132:135]
v_mfma_f32_16x16x32_bf16 v[132:135], a[28:31], a[140:143], v[132:135]
ds_read_b64_tr_b16 a[24:25], v208 offset:512
ds_read_b64_tr_b16 a[26:27], v208 offset:2560
v_mfma_f32_16x16x32_bf16 v[8:11], a[32:35], a[64:67], v[8:11]
ds_read_b64_tr_b16 a[28:29], v208 offset:4608
ds_read_b64_tr_b16 a[30:31], v208 offset:6656
v_mfma_f32_16x16x32_bf16 v[8:11], a[36:39], a[84:87], v[8:11]
s_mov_b32 s45, 69632
v_mul_f32 v0, s55, v0
v_mfma_f32_16x16x32_bf16 v[40:43], a[32:35], a[68:71], v[40:43]
buffer_load_dwordx4 a[208:211], v248, s[8:11], s45 offen offset:0 nt
v_mul_f32 v1, s55, v1
v_mfma_f32_16x16x32_bf16 v[40:43], a[36:39], a[88:91], v[40:43]
v_mul_f32 v2, s55, v2
v_mul_f32 v3, s55, v3
v_mfma_f32_16x16x32_bf16 v[72:75], a[32:35], a[72:75], v[72:75]
v_mul_f32 v4, s55, v4
v_mul_f32 v5, s55, v5
v_mfma_f32_16x16x32_bf16 v[72:75], a[36:39], a[92:95], v[72:75]
v_mul_f32 v6, s55, v6
v_mul_f32 v7, s55, v7
v_mfma_f32_16x16x32_bf16 v[104:107], a[32:35], a[76:79], v[104:107]
v_cvt_pk_bf16_f32 v0, v0, v1
v_cvt_pk_bf16_f32 v1, v2, v3
v_mfma_f32_16x16x32_bf16 v[104:107], a[36:39], a[96:99], v[104:107]
v_cvt_pk_bf16_f32 v2, v4, v5
v_cvt_pk_bf16_f32 v3, v6, v7
v_mfma_f32_16x16x32_bf16 v[136:139], a[32:35], a[80:83], v[136:139]
v_mul_f32 v32, s55, v32
v_mul_f32 v33, s55, v33
v_mfma_f32_16x16x32_bf16 v[136:139], a[36:39], a[100:103], v[136:139]
v_mul_f32 v34, s55, v34
ds_read_b64_tr_b16 a[32:33], v207 offset:33280
v_mfma_f32_16x16x32_bf16 v[12:15], a[40:43], a[64:67], v[12:15]
buffer_load_dwordx4 a[212:215], v249, s[8:11], s45 offen offset:1024 nt
s_waitcnt lgkmcnt(1)
v_mfma_f32_16x16x32_bf16 v[12:15], a[44:47], a[84:87], v[12:15]
ds_read_b64_tr_b16 a[34:35], v207 offset:35328
ds_read_b64_tr_b16 a[36:37], v207 offset:37376
v_mfma_f32_16x16x32_bf16 v[44:47], a[40:43], a[68:71], v[44:47]
ds_read_b64_tr_b16 a[38:39], v207 offset:39424
v_mul_f32 v35, s55, v35
v_mfma_f32_16x16x32_bf16 v[44:47], a[44:47], a[88:91], v[44:47]
v_mul_f32 v36, s55, v36
v_mul_f32 v37, s55, v37
v_mfma_f32_16x16x32_bf16 v[76:79], a[40:43], a[72:75], v[76:79]
v_mul_f32 v38, s55, v38
v_mul_f32 v39, s55, v39
v_mfma_f32_16x16x32_bf16 v[76:79], a[44:47], a[92:95], v[76:79]
v_permlane16_swap_b32 v0, v2
v_permlane16_swap_b32 v1, v3
v_mfma_f32_16x16x32_bf16 v[108:111], a[40:43], a[76:79], v[108:111]
ds_write_b128 v251, v[0:3] offset:32768
v_mfma_f32_16x16x32_bf16 v[108:111], a[44:47], a[96:99], v[108:111]
v_cvt_pk_bf16_f32 v32, v32, v33
v_cvt_pk_bf16_f32 v33, v34, v35
v_mfma_f32_16x16x32_bf16 v[140:143], a[40:43], a[80:83], v[140:143]
buffer_load_dwordx4 a[216:219], v248, s[8:11], s45 offen offset:2048 nt
v_cvt_pk_bf16_f32 v34, v36, v37
v_mfma_f32_16x16x32_bf16 v[140:143], a[44:47], a[100:103], v[140:143]
v_cvt_pk_bf16_f32 v35, v38, v39
v_mul_f32 v64, s55, v64
v_mfma_f32_16x16x32_bf16 v[8:11], a[0:3], a[104:107], v[8:11]
v_mul_f32 v65, s55, v65
v_mul_f32 v66, s55, v66
v_mfma_f32_16x16x32_bf16 v[8:11], a[4:7], a[124:127], v[8:11]
ds_read_b64_tr_b16 a[40:41], v208 offset:33280
ds_read_b64_tr_b16 a[42:43], v208 offset:35328
v_mfma_f32_16x16x32_bf16 v[40:43], a[0:3], a[108:111], v[40:43]
ds_read_b64_tr_b16 a[44:45], v208 offset:37376
ds_read_b64_tr_b16 a[46:47], v208 offset:39424
v_mfma_f32_16x16x32_bf16 v[40:43], a[4:7], a[128:131], v[40:43]
v_mul_f32 v67, s55, v67
v_mul_f32 v68, s55, v68
v_mfma_f32_16x16x32_bf16 v[72:75], a[0:3], a[112:115], v[72:75]
v_mul_f32 v69, s55, v69
v_mul_f32 v70, s55, v70
v_mul_f32 v71, s55, v71
v_mfma_f32_16x16x32_bf16 v[72:75], a[4:7], a[132:135], v[72:75]
v_permlane16_swap_b32 v32, v34
v_permlane16_swap_b32 v33, v35
v_mfma_f32_16x16x32_bf16 v[104:107], a[0:3], a[116:119], v[104:107]
buffer_load_dwordx4 a[220:223], v249, s[8:11], s45 offen offset:3072 nt
ds_write_b128 v251, v[32:35] offset:33792
v_cvt_pk_bf16_f32 v64, v64, v65
v_cvt_pk_bf16_f32 v65, v66, v67
v_mfma_f32_16x16x32_bf16 v[104:107], a[4:7], a[136:139], v[104:107]
v_cvt_pk_bf16_f32 v66, v68, v69
v_cvt_pk_bf16_f32 v67, v70, v71
v_mfma_f32_16x16x32_bf16 v[136:139], a[0:3], a[120:123], v[136:139]
v_mul_f32 v96, s55, v96
v_mul_f32 v97, s55, v97
v_mul_f32 v98, s55, v98
v_mfma_f32_16x16x32_bf16 v[136:139], a[4:7], a[140:143], v[136:139]
ds_read_b64_tr_b16 a[0:1], v207 offset:768
ds_read_b64_tr_b16 a[2:3], v207 offset:2816
v_mul_f32 v99, s55, v99
v_mul_f32 v100, s55, v100
v_mfma_f32_16x16x32_bf16 v[12:15], a[8:11], a[104:107], v[12:15]
ds_read_b64_tr_b16 a[4:5], v207 offset:4864
ds_read_b64_tr_b16 a[6:7], v207 offset:6912
v_mul_f32 v101, s55, v101
v_mul_f32 v102, s55, v102
v_mul_f32 v103, s55, v103
v_mfma_f32_16x16x32_bf16 v[12:15], a[12:15], a[124:127], v[12:15]
v_permlane16_swap_b32 v64, v66
v_permlane16_swap_b32 v65, v67
v_mfma_f32_16x16x32_bf16 v[44:47], a[8:11], a[108:111], v[44:47]
ds_write_b128 v251, v[64:67] offset:34816
v_cvt_pk_bf16_f32 v96, v96, v97
v_cvt_pk_bf16_f32 v97, v98, v99
v_mfma_f32_16x16x32_bf16 v[44:47], a[12:15], a[128:131], v[44:47]
v_cvt_pk_bf16_f32 v98, v100, v101
v_cvt_pk_bf16_f32 v99, v102, v103
v_mfma_f32_16x16x32_bf16 v[76:79], a[8:11], a[112:115], v[76:79]
v_mul_f32 v128, s55, v128
v_mul_f32 v129, s55, v129
v_mul_f32 v130, s55, v130
v_mfma_f32_16x16x32_bf16 v[76:79], a[12:15], a[132:135], v[76:79]
v_mul_f32 v131, s55, v131
v_mul_f32 v132, s55, v132
v_mfma_f32_16x16x32_bf16 v[108:111], a[8:11], a[116:119], v[108:111]
v_mul_f32 v133, s55, v133
v_mul_f32 v134, s55, v134
v_mul_f32 v135, s55, v135
v_mfma_f32_16x16x32_bf16 v[108:111], a[12:15], a[136:139], v[108:111]
v_permlane16_swap_b32 v96, v98
v_permlane16_swap_b32 v97, v99
v_mfma_f32_16x16x32_bf16 v[140:143], a[8:11], a[120:123], v[140:143]
s_waitcnt lgkmcnt(8)
ds_read_b64_tr_b16 a[8:9], v208 offset:768
ds_read_b64_tr_b16 a[10:11], v208 offset:2816
ds_write_b128 v251, v[96:99] offset:35840
v_cvt_pk_bf16_f32 v128, v128, v129
v_cvt_pk_bf16_f32 v129, v130, v131
v_mfma_f32_16x16x32_bf16 v[140:143], a[12:15], a[140:143], v[140:143]
s_mov_b32 s45, 98304
v_cvt_pk_bf16_f32 v130, v132, v133
v_cvt_pk_bf16_f32 v131, v134, v135
v_mfma_f32_16x16x32_bf16 v[16:19], a[16:19], a[64:67], v[16:19]
buffer_load_dwordx4 v[220:223], v248, s[8:11], s45 offen offset:0 nt
ds_read_b64_tr_b16 a[12:13], v208 offset:4864
v_permlane16_swap_b32 v128, v130
v_permlane16_swap_b32 v129, v131
ds_write_b128 v251, v[128:131] offset:36864
v_mfma_f32_16x16x32_bf16 v[16:19], a[20:23], a[84:87], v[16:19]
v_mul_f32 v8, s55, v8
v_mul_f32 v9, s55, v9
v_mfma_f32_16x16x32_bf16 v[48:51], a[16:19], a[68:71], v[48:51]
v_mul_f32 v10, s55, v10
v_mul_f32 v11, s55, v11
v_mfma_f32_16x16x32_bf16 v[48:51], a[20:23], a[88:91], v[48:51]
v_mul_f32 v12, s55, v12
v_mul_f32 v13, s55, v13
v_mfma_f32_16x16x32_bf16 v[80:83], a[16:19], a[72:75], v[80:83]
v_mul_f32 v14, s55, v14
v_mul_f32 v15, s55, v15
v_mfma_f32_16x16x32_bf16 v[80:83], a[20:23], a[92:95], v[80:83]
v_cvt_pk_bf16_f32 v8, v8, v9
v_cvt_pk_bf16_f32 v9, v10, v11
v_mfma_f32_16x16x32_bf16 v[112:115], a[16:19], a[76:79], v[112:115]
v_cvt_pk_bf16_f32 v10, v12, v13
v_cvt_pk_bf16_f32 v11, v14, v15
v_mfma_f32_16x16x32_bf16 v[112:115], a[20:23], a[96:99], v[112:115]
v_mul_f32 v40, s55, v40
v_mul_f32 v41, s55, v41
v_mfma_f32_16x16x32_bf16 v[144:147], a[16:19], a[80:83], v[144:147]
buffer_load_dwordx4 v[224:227], v249, s[8:11], s45 offen offset:1024 nt
v_mul_f32 v42, s55, v42
v_mfma_f32_16x16x32_bf16 v[144:147], a[20:23], a[100:103], v[144:147]
ds_read_b64_tr_b16 a[14:15], v208 offset:6912
ds_read_b64_tr_b16 a[16:17], v207 offset:33536
v_mfma_f32_16x16x32_bf16 v[20:23], a[24:27], a[64:67], v[20:23]
s_waitcnt lgkmcnt(8)
ds_read_b64_tr_b16 a[18:19], v207 offset:35584
ds_read_b64_tr_b16 a[20:21], v207 offset:37632
v_mfma_f32_16x16x32_bf16 v[20:23], a[28:31], a[84:87], v[20:23]
ds_read_b64_tr_b16 a[22:23], v207 offset:39680
v_mul_f32 v43, s55, v43
v_mfma_f32_16x16x32_bf16 v[52:55], a[24:27], a[68:71], v[52:55]
v_mul_f32 v44, s55, v44
v_mul_f32 v45, s55, v45
v_mfma_f32_16x16x32_bf16 v[52:55], a[28:31], a[88:91], v[52:55]
v_mul_f32 v46, s55, v46
v_mul_f32 v47, s55, v47
v_mfma_f32_16x16x32_bf16 v[84:87], a[24:27], a[72:75], v[84:87]
v_permlane16_swap_b32 v8, v10
v_permlane16_swap_b32 v9, v11
v_mfma_f32_16x16x32_bf16 v[84:87], a[28:31], a[92:95], v[84:87]
ds_write_b128 v251, v[8:11] offset:37888
v_mfma_f32_16x16x32_bf16 v[116:119], a[24:27], a[76:79], v[116:119]
buffer_load_dwordx4 v[228:231], v248, s[8:11], s45 offen offset:2048 nt
v_cvt_pk_bf16_f32 v40, v40, v41
v_mfma_f32_16x16x32_bf16 v[116:119], a[28:31], a[96:99], v[116:119]
v_cvt_pk_bf16_f32 v41, v42, v43
v_cvt_pk_bf16_f32 v42, v44, v45
v_mfma_f32_16x16x32_bf16 v[148:151], a[24:27], a[80:83], v[148:151]
v_cvt_pk_bf16_f32 v43, v46, v47
v_mul_f32 v72, s55, v72
v_mfma_f32_16x16x32_bf16 v[148:151], a[28:31], a[100:103], v[148:151]
v_mul_f32 v73, s55, v73
s_waitcnt lgkmcnt(1)
v_mfma_f32_16x16x32_bf16 v[16:19], a[32:35], a[104:107], v[16:19]
v_mul_f32 v74, s55, v74
ds_read_b64_tr_b16 a[24:25], v208 offset:33536
v_mfma_f32_16x16x32_bf16 v[16:19], a[36:39], a[124:127], v[16:19]
ds_read_b64_tr_b16 a[26:27], v208 offset:35584
ds_read_b64_tr_b16 a[28:29], v208 offset:37632
v_mfma_f32_16x16x32_bf16 v[48:51], a[32:35], a[108:111], v[48:51]
ds_read_b64_tr_b16 a[30:31], v208 offset:39680
v_mul_f32 v75, s55, v75
v_mfma_f32_16x16x32_bf16 v[48:51], a[36:39], a[128:131], v[48:51]
v_mul_f32 v76, s55, v76
v_mul_f32 v77, s55, v77
v_mfma_f32_16x16x32_bf16 v[80:83], a[32:35], a[112:115], v[80:83]
buffer_load_dwordx4 v[232:235], v249, s[8:11], s45 offen offset:3072 nt
v_mul_f32 v78, s55, v78
v_mul_f32 v79, s55, v79
v_mfma_f32_16x16x32_bf16 v[80:83], a[36:39], a[132:135], v[80:83]
v_permlane16_swap_b32 v40, v42
v_permlane16_swap_b32 v41, v43
v_mfma_f32_16x16x32_bf16 v[112:115], a[32:35], a[116:119], v[112:115]
ds_write_b128 v251, v[40:43] offset:38912
v_cvt_pk_bf16_f32 v72, v72, v73
v_cvt_pk_bf16_f32 v73, v74, v75
v_mfma_f32_16x16x32_bf16 v[112:115], a[36:39], a[136:139], v[112:115]
v_cvt_pk_bf16_f32 v74, v76, v77
v_cvt_pk_bf16_f32 v75, v78, v79
v_mfma_f32_16x16x32_bf16 v[144:147], a[32:35], a[120:123], v[144:147]
v_mul_f32 v104, s55, v104
v_mul_f32 v105, s55, v105
v_mul_f32 v106, s55, v106
v_mfma_f32_16x16x32_bf16 v[144:147], a[36:39], a[140:143], v[144:147]
v_mul_f32 v107, s55, v107
v_mul_f32 v108, s55, v108
v_mfma_f32_16x16x32_bf16 v[20:23], a[40:43], a[104:107], v[20:23]
v_mul_f32 v109, s55, v109
v_mul_f32 v110, s55, v110
v_mul_f32 v111, s55, v111
v_mfma_f32_16x16x32_bf16 v[20:23], a[44:47], a[124:127], v[20:23]
s_mov_b32 s45, 102400
v_permlane16_swap_b32 v72, v74
v_permlane16_swap_b32 v73, v75
v_mfma_f32_16x16x32_bf16 v[52:55], a[40:43], a[108:111], v[52:55]
buffer_load_dwordx4 v[236:239], v248, s[8:11], s45 offen offset:0 nt
ds_write_b128 v251, v[72:75] offset:39936
v_cvt_pk_bf16_f32 v104, v104, v105
v_cvt_pk_bf16_f32 v105, v106, v107
v_mfma_f32_16x16x32_bf16 v[52:55], a[44:47], a[128:131], v[52:55]
v_cvt_pk_bf16_f32 v106, v108, v109
v_cvt_pk_bf16_f32 v107, v110, v111
v_mfma_f32_16x16x32_bf16 v[84:87], a[40:43], a[112:115], v[84:87]
v_mul_f32 v136, s55, v136
v_mul_f32 v137, s55, v137
v_mul_f32 v138, s55, v138
v_mfma_f32_16x16x32_bf16 v[84:87], a[44:47], a[132:135], v[84:87]
v_mul_f32 v139, s55, v139
v_mul_f32 v140, s55, v140
v_mfma_f32_16x16x32_bf16 v[116:119], a[40:43], a[116:119], v[116:119]
v_mul_f32 v141, s55, v141
v_mul_f32 v142, s55, v142
v_mul_f32 v143, s55, v143
v_mfma_f32_16x16x32_bf16 v[116:119], a[44:47], a[136:139], v[116:119]
v_permlane16_swap_b32 v104, v106
v_permlane16_swap_b32 v105, v107
v_mfma_f32_16x16x32_bf16 v[148:151], a[40:43], a[120:123], v[148:151]
v_add_u32 v251, 0x18000, v251
ds_write_b128 v251, v[104:107] offset:32768
v_cvt_pk_bf16_f32 v136, v136, v137
v_cvt_pk_bf16_f32 v137, v138, v139
v_mfma_f32_16x16x32_bf16 v[148:151], a[44:47], a[140:143], v[148:151]
v_cvt_pk_bf16_f32 v138, v140, v141
v_cvt_pk_bf16_f32 v139, v142, v143
v_mfma_f32_16x16x32_bf16 v[24:27], a[0:3], a[64:67], v[24:27]
buffer_load_dwordx4 v[240:243], v249, s[8:11], s45 offen offset:1024 nt
v_permlane16_swap_b32 v136, v138
v_permlane16_swap_b32 v137, v139
ds_write_b128 v251, v[136:139] offset:33792
v_mfma_f32_16x16x32_bf16 v[24:27], a[4:7], a[84:87], v[24:27]
v_mul_f32 v16, s55, v16
v_mul_f32 v17, s55, v17
v_mfma_f32_16x16x32_bf16 v[56:59], a[0:3], a[68:71], v[56:59]
v_mul_f32 v18, s55, v18
v_mul_f32 v19, s55, v19
v_mfma_f32_16x16x32_bf16 v[56:59], a[4:7], a[88:91], v[56:59]
v_mul_f32 v20, s55, v20
v_mul_f32 v21, s55, v21
v_mfma_f32_16x16x32_bf16 v[88:91], a[0:3], a[72:75], v[88:91]
v_mul_f32 v22, s55, v22
v_mul_f32 v23, s55, v23
v_mfma_f32_16x16x32_bf16 v[88:91], a[4:7], a[92:95], v[88:91]
v_cvt_pk_bf16_f32 v16, v16, v17
v_cvt_pk_bf16_f32 v17, v18, v19
v_mfma_f32_16x16x32_bf16 v[120:123], a[0:3], a[76:79], v[120:123]
v_cvt_pk_bf16_f32 v18, v20, v21
v_cvt_pk_bf16_f32 v19, v22, v23
v_mfma_f32_16x16x32_bf16 v[120:123], a[4:7], a[96:99], v[120:123]
v_mul_f32 v48, s55, v48
v_mul_f32 v49, s55, v49
v_mfma_f32_16x16x32_bf16 v[152:155], a[0:3], a[80:83], v[152:155]
buffer_load_dwordx4 a[248:251], v248, s[8:11], s45 offen offset:2048 nt
v_mul_f32 v50, s55, v50
v_mfma_f32_16x16x32_bf16 v[152:155], a[4:7], a[100:103], v[152:155]
v_mul_f32 v51, s55, v51
v_mul_f32 v52, s55, v52
v_mfma_f32_16x16x32_bf16 v[28:31], a[8:11], a[64:67], v[28:31]
v_mul_f32 v53, s55, v53
v_mul_f32 v54, s55, v54
v_mfma_f32_16x16x32_bf16 v[28:31], a[12:15], a[84:87], v[28:31]
v_mul_f32 v55, s55, v55
v_permlane16_swap_b32 v16, v18
v_mfma_f32_16x16x32_bf16 v[60:63], a[8:11], a[68:71], v[60:63]
v_permlane16_swap_b32 v17, v19
ds_write_b128 v251, v[16:19] offset:34816
v_mfma_f32_16x16x32_bf16 v[60:63], a[12:15], a[88:91], v[60:63]
v_cvt_pk_bf16_f32 v48, v48, v49
v_cvt_pk_bf16_f32 v49, v50, v51
v_mfma_f32_16x16x32_bf16 v[92:95], a[8:11], a[72:75], v[92:95]
v_cvt_pk_bf16_f32 v50, v52, v53
v_cvt_pk_bf16_f32 v51, v54, v55
v_mfma_f32_16x16x32_bf16 v[92:95], a[12:15], a[92:95], v[92:95]
v_mul_f32 v80, s55, v80
v_mul_f32 v81, s55, v81
v_mfma_f32_16x16x32_bf16 v[124:127], a[8:11], a[76:79], v[124:127]
buffer_load_dwordx4 a[252:255], v249, s[8:11], s45 offen offset:3072 nt
v_mul_f32 v82, s55, v82
v_mfma_f32_16x16x32_bf16 v[124:127], a[12:15], a[96:99], v[124:127]
v_mul_f32 v83, s55, v83
v_mul_f32 v84, s55, v84
v_mfma_f32_16x16x32_bf16 v[156:159], a[8:11], a[80:83], v[156:159]
v_mul_f32 v85, s55, v85
v_mul_f32 v86, s55, v86
v_mfma_f32_16x16x32_bf16 v[156:159], a[12:15], a[100:103], v[156:159]
v_mul_f32 v87, s55, v87
v_permlane16_swap_b32 v48, v50
v_mfma_f32_16x16x32_bf16 v[24:27], a[16:19], a[104:107], v[24:27]
v_permlane16_swap_b32 v49, v51
ds_write_b128 v251, v[48:51] offset:35840
v_mfma_f32_16x16x32_bf16 v[24:27], a[20:23], a[124:127], v[24:27]
v_cvt_pk_bf16_f32 v80, v80, v81
v_cvt_pk_bf16_f32 v81, v82, v83
v_mfma_f32_16x16x32_bf16 v[56:59], a[16:19], a[108:111], v[56:59]
v_cvt_pk_bf16_f32 v82, v84, v85
v_cvt_pk_bf16_f32 v83, v86, v87
v_mfma_f32_16x16x32_bf16 v[56:59], a[20:23], a[128:131], v[56:59]
v_mul_f32 v112, s55, v112
v_mul_f32 v113, s55, v113
v_mfma_f32_16x16x32_bf16 v[88:91], a[16:19], a[112:115], v[88:91]
v_mul_f32 v114, s55, v114
v_mul_f32 v115, s55, v115
v_mfma_f32_16x16x32_bf16 v[88:91], a[20:23], a[132:135], v[88:91]
v_mul_f32 v116, s55, v116
v_mul_f32 v117, s55, v117
v_mfma_f32_16x16x32_bf16 v[120:123], a[16:19], a[116:119], v[120:123]
v_mul_f32 v118, s55, v118
v_mul_f32 v119, s55, v119
v_mfma_f32_16x16x32_bf16 v[120:123], a[20:23], a[136:139], v[120:123]
s_waitcnt lgkmcnt(0)
s_barrier
ds_read_b128 a[32:35], v244 offset:0
ds_read_b128 a[64:67], v250 offset:32768
v_mfma_f32_16x16x32_bf16 v[152:155], a[16:19], a[120:123], v[152:155]
ds_read_b128 a[68:71], v250 offset:33792
ds_read_b128 a[72:75], v250 offset:34816
v_mfma_f32_16x16x32_bf16 v[152:155], a[20:23], a[140:143], v[152:155]
s_mov_b32 s46, 32768
s_add_u32 m0, s29, 98304
v_permlane16_swap_b32 v80, v82
v_permlane16_swap_b32 v81, v83
v_mfma_f32_16x16x32_bf16 v[28:31], a[24:27], a[104:107], v[28:31]
buffer_load_dwordx4 v248, s[12:15], s46 offen offset:0 nt lds
ds_read_b128 a[76:79], v250 offset:35840
v_add_u32 v251, 0xffff8000, v251
ds_write_b128 v251, v[80:83] offset:0
v_cvt_pk_bf16_f32 v112, v112, v113
v_cvt_pk_bf16_f32 v113, v114, v115
v_mfma_f32_16x16x32_bf16 v[28:31], a[28:31], a[124:127], v[28:31]
v_cvt_pk_bf16_f32 v114, v116, v117
v_cvt_pk_bf16_f32 v115, v118, v119
v_mfma_f32_16x16x32_bf16 v[60:63], a[24:27], a[108:111], v[60:63]
v_mul_f32 v144, s55, v144
v_mul_f32 v145, s55, v145
v_mul_f32 v146, s55, v146
v_mfma_f32_16x16x32_bf16 v[60:63], a[28:31], a[128:131], v[60:63]
ds_read_b128 a[80:83], v250 offset:36864
ds_read_b128 a[36:39], v244 offset:2048
v_mul_f32 v147, s55, v147
v_mul_f32 v148, s55, v148
v_mfma_f32_16x16x32_bf16 v[92:95], a[24:27], a[112:115], v[92:95]
ds_read_b128 a[84:87], v250 offset:37888
ds_read_b128 a[88:91], v250 offset:38912
v_mul_f32 v149, s55, v149
v_mul_f32 v150, s55, v150
v_mul_f32 v151, s55, v151
v_mfma_f32_16x16x32_bf16 v[92:95], a[28:31], a[132:135], v[92:95]
ds_read_b128 a[92:95], v250 offset:39936
v_add_u32 v250, 0x18000, v250
ds_read_b128 a[96:99], v250 offset:32768
v_permlane16_swap_b32 v112, v114
v_permlane16_swap_b32 v113, v115
v_mfma_f32_16x16x32_bf16 v[124:127], a[24:27], a[116:119], v[124:127]
ds_read_b128 a[100:103], v250 offset:33792
ds_read_b128 a[40:43], v244 offset:256
ds_write_b128 v251, v[112:115] offset:1024
v_cvt_pk_bf16_f32 v144, v144, v145
v_cvt_pk_bf16_f32 v145, v146, v147
v_mfma_f32_16x16x32_bf16 v[124:127], a[28:31], a[136:139], v[124:127]
v_cvt_pk_bf16_f32 v146, v148, v149
v_cvt_pk_bf16_f32 v147, v150, v151
v_mfma_f32_16x16x32_bf16 v[156:159], a[24:27], a[120:123], v[156:159]
buffer_load_dwordx4 v249, s[12:15], s46 offen offset:1024 nt lds
s_waitcnt lgkmcnt(8)
ds_read_b128 a[104:107], v250 offset:34816
v_permlane16_swap_b32 v144, v146
v_permlane16_swap_b32 v145, v147
ds_write_b128 v251, v[144:147] offset:2048
v_mfma_f32_16x16x32_bf16 v[156:159], a[28:31], a[140:143], v[156:159]
v_mfma_f32_16x16x32_bf16 v[160:163], a[32:35], v[0:3], 0
v_mfma_f32_16x16x32_bf16 v[164:167], a[32:35], v[32:35], 0
v_mul_f32 v24, s55, v24
v_mul_f32 v25, s55, v25
v_mfma_f32_16x16x32_bf16 v[168:171], a[32:35], v[64:67], 0
v_mul_f32 v26, s55, v26
ds_read_b128 a[108:111], v250 offset:35840
v_mfma_f32_16x16x32_bf16 v[184:187], a[32:35], v[96:99], 0
v_mul_f32 v27, s55, v27
v_mul_f32 v28, s55, v28
v_mfma_f32_16x16x32_bf16 v[188:191], a[32:35], v[128:131], 0
v_mul_f32 v29, s55, v29
s_waitcnt lgkmcnt(3)
v_mfma_f32_16x16x32_bf16 v[172:175], a[36:39], v[0:3], 0
ds_read_b128 a[44:47], v244 offset:2304
ds_read_b128 a[0:3], v245 offset:0
v_mfma_f32_16x16x32_bf16 v[176:179], a[36:39], v[32:35], 0
buffer_load_dwordx4 v248, s[12:15], s46 offen offset:2048 nt lds
ds_read_b128 a[4:7], v245 offset:2048
v_mfma_f32_16x16x32_bf16 v[180:183], a[36:39], v[64:67], 0
ds_read_b128 a[8:11], v245 offset:256
ds_read_b128 a[12:15], v244 offset:512
v_mfma_f32_16x16x32_bf16 v[192:195], a[36:39], v[96:99], 0
ds_read_b128 a[16:19], v244 offset:2560
ds_read_b128 a[20:23], v244 offset:768
v_mfma_f32_16x16x32_bf16 v[196:199], a[36:39], v[128:131], 0
ds_read_b128 a[24:27], v244 offset:2816
ds_read_b128 a[28:31], v245 offset:512
v_mfma_f32_16x16x32_bf16 v[160:163], a[40:43], v[8:11], v[160:163]
ds_read_b128 a[32:35], v245 offset:768
ds_read_b128 a[36:39], v245 offset:2304
v_mfma_f32_16x16x32_bf16 v[164:167], a[40:43], v[40:43], v[164:167]
v_mul_f32 v30, s55, v30
v_mul_f32 v31, s55, v31
v_mfma_f32_16x16x32_bf16 v[168:171], a[40:43], v[72:75], v[168:171]
v_cvt_pk_bf16_f32 v24, v24, v25
v_cvt_pk_bf16_f32 v25, v26, v27
v_mfma_f32_16x16x32_bf16 v[184:187], a[40:43], v[104:107], v[184:187]
v_cvt_pk_bf16_f32 v26, v28, v29
v_cvt_pk_bf16_f32 v27, v30, v31
v_mfma_f32_16x16x32_bf16 v[188:191], a[40:43], v[136:139], v[188:191]
buffer_load_dwordx4 v249, s[12:15], s46 offen offset:3072 nt lds
s_waitcnt lgkmcnt(6)
v_mfma_f32_16x16x32_bf16 v[172:175], a[44:47], v[8:11], v[172:175]
ds_read_b128 a[40:43], v245 offset:2560
v_mul_f32 v56, s55, v56
v_mfma_f32_16x16x32_bf16 v[176:179], a[44:47], v[40:43], v[176:179]
v_mul_f32 v57, s55, v57
v_mul_f32 v58, s55, v58
v_mfma_f32_16x16x32_bf16 v[180:183], a[44:47], v[72:75], v[180:183]
v_mul_f32 v59, s55, v59
v_mul_f32 v60, s55, v60
v_mfma_f32_16x16x32_bf16 v[192:195], a[44:47], v[104:107], v[192:195]
v_mul_f32 v61, s55, v61
v_mul_f32 v62, s55, v62
v_mul_f32 v63, s55, v63
v_mfma_f32_16x16x32_bf16 v[196:199], a[44:47], v[136:139], v[196:199]
ds_read_b128 a[44:47], v245 offset:2816
v_permlane16_swap_b32 v24, v26
v_permlane16_swap_b32 v25, v27
v_mfma_f32_16x16x32_bf16 v[160:163], a[0:3], a[64:67], v[160:163]
ds_write_b128 v251, v[24:27] offset:3072
v_cvt_pk_bf16_f32 v56, v56, v57
v_cvt_pk_bf16_f32 v57, v58, v59
v_mfma_f32_16x16x32_bf16 v[164:167], a[0:3], a[68:71], v[164:167]
s_mov_b32 s46, 36864
s_add_u32 m0, s29, 102400
v_cvt_pk_bf16_f32 v58, v60, v61
v_cvt_pk_bf16_f32 v59, v62, v63
v_mfma_f32_16x16x32_bf16 v[168:171], a[0:3], a[72:75], v[168:171]
buffer_load_dwordx4 v248, s[12:15], s46 offen offset:0 nt lds
v_mul_f32 v88, s55, v88
v_mul_f32 v89, s55, v89
v_mul_f32 v90, s55, v90
v_mfma_f32_16x16x32_bf16 v[184:187], a[0:3], a[76:79], v[184:187]
v_add_u32 v250, 0xffff0000, v250
ds_write_b128 v250, a[144:147] offset:0
v_mul_f32 v91, s55, v91
v_mul_f32 v92, s55, v92
v_mfma_f32_16x16x32_bf16 v[188:191], a[0:3], a[80:83], v[188:191]
ds_write_b128 v250, a[148:151] offset:1024
v_mul_f32 v93, s55, v93
v_mul_f32 v94, s55, v94
v_mul_f32 v95, s55, v95
v_mfma_f32_16x16x32_bf16 v[172:175], a[4:7], a[64:67], v[172:175]
ds_write_b128 v250, a[152:155] offset:2048
v_permlane16_swap_b32 v56, v58
v_permlane16_swap_b32 v57, v59
v_mfma_f32_16x16x32_bf16 v[176:179], a[4:7], a[68:71], v[176:179]
ds_write_b128 v251, v[56:59] offset:4096
v_cvt_pk_bf16_f32 v88, v88, v89
v_cvt_pk_bf16_f32 v89, v90, v91
v_mfma_f32_16x16x32_bf16 v[180:183], a[4:7], a[72:75], v[180:183]
v_cvt_pk_bf16_f32 v90, v92, v93
v_cvt_pk_bf16_f32 v91, v94, v95
v_mfma_f32_16x16x32_bf16 v[192:195], a[4:7], a[76:79], v[192:195]
v_mul_f32 v120, s55, v120
v_mul_f32 v121, s55, v121
v_mul_f32 v122, s55, v122
v_mfma_f32_16x16x32_bf16 v[196:199], a[4:7], a[80:83], v[196:199]
ds_write_b128 v250, a[156:159] offset:3072
v_mul_f32 v123, s55, v123
v_mul_f32 v124, s55, v124
v_mfma_f32_16x16x32_bf16 v[160:163], a[8:11], a[84:87], v[160:163]
buffer_load_dwordx4 v249, s[12:15], s46 offen offset:1024 nt lds
v_mul_f32 v125, s55, v125
v_mul_f32 v126, s55, v126
v_mul_f32 v127, s55, v127
v_mfma_f32_16x16x32_bf16 v[164:167], a[8:11], a[88:91], v[164:167]
ds_write_b128 v250, a[48:51] offset:4096
v_permlane16_swap_b32 v88, v90
v_permlane16_swap_b32 v89, v91
v_mfma_f32_16x16x32_bf16 v[168:171], a[8:11], a[92:95], v[168:171]
s_waitcnt lgkmcnt(8)
ds_write_b128 v251, v[88:91] offset:5120
v_cvt_pk_bf16_f32 v120, v120, v121
v_cvt_pk_bf16_f32 v121, v122, v123
v_mfma_f32_16x16x32_bf16 v[184:187], a[8:11], a[96:99], v[184:187]
v_cvt_pk_bf16_f32 v122, v124, v125
v_cvt_pk_bf16_f32 v123, v126, v127
v_mfma_f32_16x16x32_bf16 v[188:191], a[8:11], a[100:103], v[188:191]
v_mul_f32 v152, s55, v152
ds_write_b128 v250, a[52:55] offset:5120
v_mul_f32 v153, s55, v153
v_mul_f32 v154, s55, v154
v_mfma_f32_16x16x32_bf16 v[160:163], a[12:15], v[16:19], v[160:163]
v_mul_f32 v155, s55, v155
v_mul_f32 v156, s55, v156
v_mfma_f32_16x16x32_bf16 v[164:167], a[12:15], v[48:51], v[164:167]
ds_write_b128 v250, a[56:59] offset:6144
v_mul_f32 v157, s55, v157
v_mul_f32 v158, s55, v158
v_mul_f32 v159, s55, v159
v_mfma_f32_16x16x32_bf16 v[168:171], a[12:15], v[80:83], v[168:171]
v_permlane16_swap_b32 v120, v122
v_permlane16_swap_b32 v121, v123
v_mfma_f32_16x16x32_bf16 v[184:187], a[12:15], v[112:115], v[184:187]
buffer_load_dwordx4 v248, s[12:15], s46 offen offset:2048 nt lds
ds_write_b128 v251, v[120:123] offset:6144
v_cvt_pk_bf16_f32 v152, v152, v153
v_cvt_pk_bf16_f32 v153, v154, v155
v_mfma_f32_16x16x32_bf16 v[188:191], a[12:15], v[144:147], v[188:191]
v_cvt_pk_bf16_f32 v154, v156, v157
v_cvt_pk_bf16_f32 v155, v158, v159
s_waitcnt lgkmcnt(3)
v_mfma_f32_16x16x32_bf16 v[172:175], a[16:19], v[16:19], v[172:175]
ds_write_b128 v250, a[60:63] offset:7168
v_permlane16_swap_b32 v152, v154
v_permlane16_swap_b32 v153, v155
ds_write_b128 v251, v[152:155] offset:7168
v_mfma_f32_16x16x32_bf16 v[176:179], a[16:19], v[48:51], v[176:179]
v_mfma_f32_16x16x32_bf16 v[180:183], a[16:19], v[80:83], v[180:183]
s_waitcnt lgkmcnt(0)
s_barrier
ds_read_b128 a[112:115], v250 offset:32768
ds_read_b128 a[116:119], v250 offset:33792
v_mfma_f32_16x16x32_bf16 v[192:195], a[16:19], v[112:115], v[192:195]
ds_read_b128 a[120:123], v250 offset:34816
ds_read_b128 a[124:127], v250 offset:35840
v_mfma_f32_16x16x32_bf16 v[196:199], a[16:19], v[144:147], v[196:199]
ds_read_b128 a[128:131], v250 offset:36864
ds_read_b128 a[132:135], v250 offset:37888
v_mfma_f32_16x16x32_bf16 v[160:163], a[20:23], v[24:27], v[160:163]
ds_read_b128 a[136:139], v250 offset:38912
ds_read_b128 a[140:143], v250 offset:39936
v_mfma_f32_16x16x32_bf16 v[164:167], a[20:23], v[56:59], v[164:167]
buffer_load_dwordx4 v249, s[12:15], s46 offen offset:3072 nt lds
v_mfma_f32_16x16x32_bf16 v[168:171], a[20:23], v[88:91], v[168:171]
s_waitcnt vmcnt(20)
v_add_u32 v250, 0x10000, v250
ds_write_b128 v250, a[192:195] offset:32768
v_mfma_f32_16x16x32_bf16 v[184:187], a[20:23], v[120:123], v[184:187]
ds_write_b128 v250, a[196:199] offset:33792
v_mfma_f32_16x16x32_bf16 v[188:191], a[20:23], v[152:155], v[188:191]
v_mfma_f32_16x16x32_bf16 v[172:175], a[24:27], v[24:27], v[172:175]
v_mfma_f32_16x16x32_bf16 v[176:179], a[24:27], v[56:59], v[176:179]
ds_write_b128 v250, a[200:203] offset:34816
v_mfma_f32_16x16x32_bf16 v[180:183], a[24:27], v[88:91], v[180:183]
v_mfma_f32_16x16x32_bf16 v[192:195], a[24:27], v[120:123], v[192:195]
ds_write_b128 v250, a[204:207] offset:35840
v_mfma_f32_16x16x32_bf16 v[196:199], a[24:27], v[152:155], v[196:199]
v_mfma_f32_16x16x32_bf16 v[160:163], a[28:31], a[104:107], v[160:163]
v_mfma_f32_16x16x32_bf16 v[164:167], a[28:31], a[108:111], v[164:167]
s_waitcnt lgkmcnt(2)
v_mfma_f32_16x16x32_bf16 v[168:171], a[28:31], a[112:115], v[168:171]
v_mfma_f32_16x16x32_bf16 v[184:187], a[28:31], a[116:119], v[184:187]
v_mfma_f32_16x16x32_bf16 v[188:191], a[28:31], a[120:123], v[188:191]
v_mfma_f32_16x16x32_bf16 v[160:163], a[32:35], a[124:127], v[160:163]
v_mfma_f32_16x16x32_bf16 v[164:167], a[32:35], a[128:131], v[164:167]
v_mfma_f32_16x16x32_bf16 v[168:171], a[32:35], a[132:135], v[168:171]
v_min3_f32 v200, -v160, -v161, -v162
v_min_f32 v200, -v163, v200
v_mfma_f32_16x16x32_bf16 v[184:187], a[32:35], a[136:139], v[184:187]
v_min3_f32 v204, -v164, -v165, -v166
v_min_f32 v204, -v167, v204
v_mfma_f32_16x16x32_bf16 v[188:191], a[32:35], a[140:143], v[188:191]
v_min3_f32 v208, -v168, -v169, -v170
v_min_f32 v208, -v171, v208
v_mfma_f32_16x16x32_bf16 v[172:175], a[36:39], a[84:87], v[172:175]
v_min3_f32 v212, -v184, -v185, -v186
v_min_f32 v212, -v187, v212
v_mfma_f32_16x16x32_bf16 v[176:179], a[36:39], a[88:91], v[176:179]
v_min3_f32 v216, -v188, -v189, -v190
v_min_f32 v216, -v191, v216
v_mfma_f32_16x16x32_bf16 v[180:183], a[36:39], a[92:95], v[180:183]
s_cmp_lg_u32 s37, 0
s_cbranch_scc1 L_tmax
L_tmax_ret:
v_mfma_f32_16x16x32_bf16 v[192:195], a[36:39], a[96:99], v[192:195]
ds_min_f32 v252, v200 offset:0
ds_min_f32 v252, v204 offset:64
v_mfma_f32_16x16x32_bf16 v[196:199], a[36:39], a[100:103], v[196:199]
ds_min_f32 v252, v208 offset:128
ds_min_f32 v252, v212 offset:192
v_mfma_f32_16x16x32_bf16 v[172:175], a[40:43], a[104:107], v[172:175]
ds_min_f32 v252, v216 offset:256
v_mfma_f32_16x16x32_bf16 v[176:179], a[40:43], a[108:111], v[176:179]
v_mfma_f32_16x16x32_bf16 v[180:183], a[40:43], a[112:115], v[180:183]
v_mfma_f32_16x16x32_bf16 v[192:195], a[40:43], a[116:119], v[192:195]
s_waitcnt lgkmcnt(0)
s_barrier
ds_read_b64_tr_b16 a[0:1], v246 offset:0
ds_read_b64_tr_b16 a[2:3], v246 offset:2048
ds_read2_b32 v[200:201], v252 offset0:0 offset1:0
ds_read2_b32 v[204:205], v252 offset0:16 offset1:16
ds_read2_b32 v[208:209], v252 offset0:32 offset1:32
ds_read2_b32 v[212:213], v252 offset0:48 offset1:48
ds_read2_b32 v[216:217], v252 offset0:64 offset1:64
ds_read2_b32 v[202:203], v252 offset0:0 offset1:0
ds_read2_b32 v[206:207], v252 offset0:16 offset1:16
ds_read2_b32 v[210:211], v252 offset0:32 offset1:32
ds_read2_b32 v[214:215], v252 offset0:48 offset1:48
ds_read2_b32 v[218:219], v252 offset0:64 offset1:64
s_waitcnt lgkmcnt(9)
v_add_f32 v160, v160, v200
v_add_f32 v161, v161, v200
v_add_f32 v162, v162, v200
v_mfma_f32_16x16x32_bf16 v[196:199], a[40:43], a[120:123], v[196:199]
v_add_f32 v163, v163, v200
v_exp_f32 v160, v160
v_exp_f32 v161, v161
v_exp_f32 v162, v162
v_cvt_pk_bf16_f32 v160, v160, v161
v_exp_f32 v163, v163
s_waitcnt lgkmcnt(8)
v_add_f32 v164, v164, v204
v_add_f32 v165, v165, v204
v_add_f32 v166, v166, v204
v_mfma_f32_16x16x32_bf16 v[172:175], a[44:47], a[124:127], v[172:175]
v_add_f32 v167, v167, v204
v_exp_f32 v164, v164
v_cvt_pk_bf16_f32 v161, v162, v163
v_exp_f32 v165, v165
v_exp_f32 v166, v166
v_cvt_pk_bf16_f32 v164, v164, v165
v_exp_f32 v167, v167
s_waitcnt lgkmcnt(7)
v_add_f32 v168, v168, v208
v_add_f32 v169, v169, v208
v_add_f32 v170, v170, v208
v_mfma_f32_16x16x32_bf16 v[176:179], a[44:47], a[128:131], v[176:179]
v_add_f32 v171, v171, v208
v_exp_f32 v168, v168
v_cvt_pk_bf16_f32 v165, v166, v167
v_exp_f32 v169, v169
v_exp_f32 v170, v170
v_cvt_pk_bf16_f32 v168, v168, v169
v_exp_f32 v171, v171
s_nop 0
v_cvt_pk_bf16_f32 v169, v170, v171
v_mfma_f32_16x16x32_bf16 v[180:183], a[44:47], a[132:135], v[180:183]
v_mfma_f32_16x16x32_bf16 v[192:195], a[44:47], a[136:139], v[192:195]
v_mfma_f32_16x16x32_bf16 v[196:199], a[44:47], a[140:143], v[196:199]
s_mov_b32 s46, 65536
s_add_u32 m0, s29, 0
v_add_f32 v172, v172, v200
v_add_f32 v173, v173, v200
v_add_f32 v174, v174, v200
v_add_f32 v175, v175, v200
v_exp_f32 v172, v172
v_exp_f32 v173, v173
v_exp_f32 v174, v174
v_cvt_pk_bf16_f32 v162, v172, v173
v_exp_f32 v175, v175
v_add_f32 v176, v176, v204
v_add_f32 v177, v177, v204
v_add_f32 v178, v178, v204
v_add_f32 v179, v179, v204
v_exp_f32 v176, v176
v_cvt_pk_bf16_f32 v163, v174, v175
v_exp_f32 v177, v177
v_exp_f32 v178, v178
v_cvt_pk_bf16_f32 v166, v176, v177
v_exp_f32 v179, v179
v_add_f32 v180, v180, v208
v_add_f32 v181, v181, v208
v_add_f32 v182, v182, v208
v_add_f32 v183, v183, v208
v_exp_f32 v180, v180
v_cvt_pk_bf16_f32 v167, v178, v179
v_exp_f32 v181, v181
v_exp_f32 v182, v182
v_cvt_pk_bf16_f32 v170, v180, v181
v_exp_f32 v183, v183
s_nop 0
v_cvt_pk_bf16_f32 v171, v182, v183
v_mfma_f32_16x16x32_bf16 a[224:227], a[244:247], v[160:163], 0
buffer_load_dwordx4 v248, s[12:15], s46 offen offset:0 nt lds
ds_read_b64_tr_b16 a[4:5], v247 offset:0
v_mfma_f32_16x16x32_bf16 a[228:231], a[244:247], v[164:167], 0
ds_read_b64_tr_b16 a[6:7], v247 offset:2048
ds_read_b64_tr_b16 a[8:9], v246 offset:256
v_mfma_f32_16x16x32_bf16 a[232:235], a[244:247], v[168:171], 0
ds_read_b64_tr_b16 a[10:11], v246 offset:2304
s_waitcnt lgkmcnt(4)
v_mfma_f32_16x16x32_bf16 v[4:7], a[0:3], v[160:163], 0
ds_read_b64_tr_b16 a[12:13], v247 offset:256
ds_read_b64_tr_b16 a[14:15], v247 offset:2304
v_mfma_f32_16x16x32_bf16 v[68:71], a[0:3], v[164:167], 0
ds_read_b64_tr_b16 a[16:17], v246 offset:512
ds_read_b64_tr_b16 a[18:19], v246 offset:2560
v_mfma_f32_16x16x32_bf16 v[132:135], a[0:3], v[168:171], 0
ds_read_b64_tr_b16 a[20:21], v247 offset:512
s_waitcnt lgkmcnt(7)
v_mfma_f32_16x16x32_bf16 v[12:15], a[4:7], v[160:163], 0
buffer_load_dwordx4 v249, s[12:15], s46 offen offset:1024 nt lds
ds_read_b64_tr_b16 a[22:23], v247 offset:2560
v_add_u32 v251, 0x8000, v251
ds_write_b128 v251, v[160:163] offset:37888
v_mfma_f32_16x16x32_bf16 v[76:79], a[4:7], v[164:167], 0
v_add_u32 v250, 0xffff8000, v250
ds_write_b128 v250, a[160:163] offset:0
ds_write_b128 v251, v[164:167] offset:38912
ds_write_b128 v251, v[168:171] offset:39936
v_mfma_f32_16x16x32_bf16 v[140:143], a[4:7], v[168:171], 0
s_waitcnt lgkmcnt(0)
s_barrier
ds_read_b64_tr_b16 a[24:25], v246 offset:768
ds_read_b64_tr_b16 a[26:27], v246 offset:2816
v_mfma_f32_16x16x32_bf16 v[20:23], a[8:11], v[160:163], 0
v_add_u32 v250, 0x8000, v250
ds_read_b128 v[172:175], v250 offset:37888
ds_read_b64_tr_b16 a[28:29], v247 offset:768
v_mfma_f32_16x16x32_bf16 v[84:87], a[8:11], v[164:167], 0
ds_read_b128 v[176:179], v250 offset:38912
ds_read_b64_tr_b16 a[30:31], v247 offset:2816
v_mfma_f32_16x16x32_bf16 v[148:151], a[8:11], v[168:171], 0
ds_read_b128 v[180:183], v250 offset:39936
v_add_u32 v250, 0xffff8000, v250
ds_write_b128 v250, a[164:167] offset:1024
v_add_f32 v184, v184, v212
v_mfma_f32_16x16x32_bf16 v[28:31], a[12:15], v[160:163], 0
buffer_load_dwordx4 v248, s[12:15], s46 offen offset:2048 nt lds
ds_write_b128 v250, a[168:171] offset:2048
v_add_f32 v185, v185, v212
v_mfma_f32_16x16x32_bf16 v[92:95], a[12:15], v[164:167], 0
v_add_f32 v186, v186, v212
v_add_f32 v187, v187, v212
v_mfma_f32_16x16x32_bf16 v[156:159], a[12:15], v[168:171], 0
ds_write_b128 v250, a[172:175] offset:3072
v_mfma_f32_16x16x32_bf16 v[36:39], a[16:19], v[160:163], 0
v_exp_f32 v184, v184
v_mfma_f32_16x16x32_bf16 v[100:103], a[16:19], v[164:167], 0
ds_write_b128 v250, a[176:179] offset:4096
v_exp_f32 v185, v185
v_mfma_f32_16x16x32_bf16 a[144:147], a[16:19], v[168:171], 0
v_exp_f32 v186, v186
v_mfma_f32_16x16x32_bf16 v[44:47], a[20:23], v[160:163], 0
buffer_load_dwordx4 v249, s[12:15], s46 offen offset:3072 nt lds
v_cvt_pk_bf16_f32 v184, v184, v185
v_mfma_f32_16x16x32_bf16 v[108:111], a[20:23], v[164:167], 0
v_exp_f32 v187, v187
v_mfma_f32_16x16x32_bf16 a[148:151], a[20:23], v[168:171], 0
ds_write_b128 v250, a[180:183] offset:5120
v_add_f32 v188, v188, v216
s_waitcnt lgkmcnt(3)
v_mfma_f32_16x16x32_bf16 v[52:55], a[24:27], v[160:163], 0
v_add_f32 v189, v189, v216
v_add_f32 v190, v190, v216
v_mfma_f32_16x16x32_bf16 v[116:119], a[24:27], v[164:167], 0
v_add_u32 v246, s33, v246
ds_read_b64_tr_b16 a[32:33], v246 offset:0
v_add_f32 v191, v191, v216
v_mfma_f32_16x16x32_bf16 a[152:155], a[24:27], v[168:171], 0
s_mov_b32 s46, 69632
s_add_u32 m0, s29, 4096
ds_read_b64_tr_b16 a[34:35], v246 offset:2048
v_exp_f32 v188, v188
v_mfma_f32_16x16x32_bf16 v[60:63], a[28:31], v[160:163], 0
buffer_load_dwordx4 v248, s[12:15], s46 offen offset:0 nt lds
ds_write_b128 v250, a[184:187] offset:6144
v_cvt_pk_bf16_f32 v185, v186, v187
v_mfma_f32_16x16x32_bf16 v[124:127], a[28:31], v[164:167], 0
v_add_u32 v247, s33, v247
ds_read_b64_tr_b16 a[36:37], v247 offset:0
v_exp_f32 v189, v189
v_mfma_f32_16x16x32_bf16 a[156:159], a[28:31], v[168:171], 0
ds_read_b64_tr_b16 a[38:39], v247 offset:2048
s_waitcnt lgkmcnt(3)
v_mfma_f32_16x16x32_bf16 v[4:7], a[32:35], v[172:175], v[4:7]
ds_read_b64_tr_b16 a[40:41], v246 offset:256
ds_read_b64_tr_b16 a[42:43], v246 offset:2304
v_exp_f32 v190, v190
v_cvt_pk_bf16_f32 v188, v188, v189
v_mfma_f32_16x16x32_bf16 v[68:71], a[32:35], v[176:179], v[68:71]
ds_read_b64_tr_b16 a[44:45], v247 offset:256
ds_read_b64_tr_b16 a[46:47], v247 offset:2304
v_mfma_f32_16x16x32_bf16 v[132:135], a[32:35], v[180:183], v[132:135]
ds_read_b64_tr_b16 a[48:49], v246 offset:512
v_exp_f32 v191, v191
s_nop 0
v_cvt_pk_bf16_f32 v189, v190, v191
s_waitcnt lgkmcnt(5)
v_mfma_f32_16x16x32_bf16 v[12:15], a[36:39], v[172:175], v[12:15]
buffer_load_dwordx4 v249, s[12:15], s46 offen offset:1024 nt lds
ds_read_b64_tr_b16 a[50:51], v246 offset:2560
v_add_f32 v192, v192, v212
v_mfma_f32_16x16x32_bf16 v[76:79], a[36:39], v[176:179], v[76:79]
ds_read_b64_tr_b16 a[52:53], v247 offset:512
ds_read_b64_tr_b16 a[54:55], v247 offset:2560
v_add_f32 v193, v193, v212
v_add_f32 v194, v194, v212
v_mfma_f32_16x16x32_bf16 v[140:143], a[36:39], v[180:183], v[140:143]
ds_read_b64_tr_b16 a[56:57], v246 offset:768
v_add_f32 v195, v195, v212
s_waitcnt lgkmcnt(7)
v_mfma_f32_16x16x32_bf16 v[20:23], a[40:43], v[172:175], v[20:23]
ds_read_b64_tr_b16 a[58:59], v246 offset:2816
ds_read_b64_tr_b16 a[60:61], v247 offset:768
v_exp_f32 v192, v192
v_mfma_f32_16x16x32_bf16 v[84:87], a[40:43], v[176:179], v[84:87]
ds_read_b64_tr_b16 a[62:63], v247 offset:2816
ds_write_b128 v250, a[188:191] offset:7168
v_mfma_f32_16x16x32_bf16 v[148:151], a[40:43], v[180:183], v[148:151]
v_exp_f32 v193, v193
s_waitcnt lgkmcnt(9)
v_mfma_f32_16x16x32_bf16 v[28:31], a[44:47], v[172:175], v[28:31]
v_exp_f32 v194, v194
v_mfma_f32_16x16x32_bf16 v[92:95], a[44:47], v[176:179], v[92:95]
v_cvt_pk_bf16_f32 v186, v192, v193
s_waitcnt vmcnt(22)
v_mfma_f32_16x16x32_bf16 v[156:159], a[44:47], v[180:183], v[156:159]
v_add_u32 v250, 0x8000, v250
ds_write_b128 v250, a[208:211] offset:36864
v_exp_f32 v195, v195
s_waitcnt lgkmcnt(6)
v_mfma_f32_16x16x32_bf16 v[36:39], a[48:51], v[172:175], v[36:39]
ds_write_b128 v250, a[212:215] offset:37888
v_add_f32 v196, v196, v216
v_add_f32 v197, v197, v216
v_mfma_f32_16x16x32_bf16 v[100:103], a[48:51], v[176:179], v[100:103]
ds_write_b128 v250, a[216:219] offset:38912
v_add_f32 v198, v198, v216
v_mfma_f32_16x16x32_bf16 a[144:147], a[48:51], v[180:183], a[144:147]
v_add_f32 v199, v199, v216
v_mfma_f32_16x16x32_bf16 v[44:47], a[52:55], v[172:175], v[44:47]
v_exp_f32 v196, v196
v_mfma_f32_16x16x32_bf16 v[108:111], a[52:55], v[176:179], v[108:111]
ds_write_b128 v250, a[220:223] offset:39936
v_cvt_pk_bf16_f32 v187, v194, v195
v_mfma_f32_16x16x32_bf16 a[148:151], a[52:55], v[180:183], a[148:151]
v_exp_f32 v197, v197
s_waitcnt lgkmcnt(4)
v_mfma_f32_16x16x32_bf16 v[52:55], a[56:59], v[172:175], v[52:55]
v_add_u32 v251, 0xfffe8000, v251
ds_write_b128 v251, v[184:187] offset:6144
v_mfma_f32_16x16x32_bf16 v[116:119], a[56:59], v[176:179], v[116:119]
v_exp_f32 v198, v198
v_mfma_f32_16x16x32_bf16 a[152:155], a[56:59], v[180:183], a[152:155]
v_cvt_pk_bf16_f32 v190, v196, v197
v_mfma_f32_16x16x32_bf16 v[60:63], a[60:63], v[172:175], v[60:63]
v_exp_f32 v199, v199
v_mfma_f32_16x16x32_bf16 v[124:127], a[60:63], v[176:179], v[124:127]
v_cvt_pk_bf16_f32 v191, v198, v199
ds_write_b128 v251, v[188:191] offset:7168
v_mfma_f32_16x16x32_bf16 a[156:159], a[60:63], v[180:183], a[156:159]
v_mfma_f32_16x16x32_bf16 a[236:239], a[244:247], v[184:187], 0
v_mfma_f32_16x16x32_bf16 a[240:243], a[244:247], v[188:191], 0
v_mfma_f32_16x16x32_bf16 a[160:163], a[0:3], v[184:187], 0
v_mfma_f32_16x16x32_bf16 a[192:195], a[0:3], v[188:191], 0
s_waitcnt lgkmcnt(0)
s_barrier
v_add_u32 v244, 0x10000, v244
ds_read_b128 a[0:3], v244 offset:0
v_mfma_f32_16x16x32_bf16 a[164:167], a[4:7], v[184:187], 0
v_add_u32 v250, 0xfffe8000, v250
ds_read_b128 v[192:195], v250 offset:6144
v_mfma_f32_16x16x32_bf16 a[196:199], a[4:7], v[188:191], 0
ds_read_b128 v[196:199], v250 offset:7168
ds_read_b128 a[4:7], v244 offset:256
v_mfma_f32_16x16x32_bf16 a[168:171], a[8:11], v[184:187], 0
v_mfma_f32_16x16x32_bf16 a[200:203], a[8:11], v[188:191], 0
ds_read_b128 a[8:11], v244 offset:512
v_mfma_f32_16x16x32_bf16 a[172:175], a[12:15], v[184:187], 0
v_mfma_f32_16x16x32_bf16 a[204:207], a[12:15], v[188:191], 0
ds_read_b128 a[12:15], v244 offset:768
v_mfma_f32_16x16x32_bf16 a[176:179], a[16:19], v[184:187], 0
v_mfma_f32_16x16x32_bf16 a[208:211], a[16:19], v[188:191], 0
v_add_u32 v245, 0x10000, v245
ds_read_b128 a[16:19], v245 offset:0
v_mfma_f32_16x16x32_bf16 a[180:183], a[20:23], v[184:187], 0
v_mfma_f32_16x16x32_bf16 a[212:215], a[20:23], v[188:191], 0
ds_read_b128 a[20:23], v245 offset:256
v_mfma_f32_16x16x32_bf16 a[184:187], a[24:27], v[184:187], 0
v_mfma_f32_16x16x32_bf16 a[216:219], a[24:27], v[188:191], 0
ds_read_b128 a[24:27], v245 offset:512
v_mfma_f32_16x16x32_bf16 a[188:191], a[28:31], v[184:187], 0
v_mfma_f32_16x16x32_bf16 a[220:223], a[28:31], v[188:191], 0
ds_read_b128 a[28:31], v245 offset:768
s_waitcnt lgkmcnt(8)
v_mfma_f32_16x16x32_bf16 a[160:163], a[32:35], v[192:195], a[160:163]
s_waitcnt lgkmcnt(7)
v_mfma_f32_16x16x32_bf16 a[192:195], a[32:35], v[196:199], a[192:195]
ds_read_b128 a[32:35], v244 offset:2048
v_mfma_f32_16x16x32_bf16 a[164:167], a[36:39], v[192:195], a[164:167]
v_mfma_f32_16x16x32_bf16 a[196:199], a[36:39], v[196:199], a[196:199]
ds_read_b128 a[36:39], v244 offset:2304
v_mfma_f32_16x16x32_bf16 a[168:171], a[40:43], v[192:195], a[168:171]
v_mfma_f32_16x16x32_bf16 a[200:203], a[40:43], v[196:199], a[200:203]
v_mfma_f32_16x16x32_bf16 a[172:175], a[44:47], v[192:195], a[172:175]
v_mfma_f32_16x16x32_bf16 a[204:207], a[44:47], v[196:199], a[204:207]
v_mfma_f32_16x16x32_bf16 a[176:179], a[48:51], v[192:195], a[176:179]
v_mfma_f32_16x16x32_bf16 a[208:211], a[48:51], v[196:199], a[208:211]
v_mfma_f32_16x16x32_bf16 a[180:183], a[52:55], v[192:195], a[180:183]
v_mfma_f32_16x16x32_bf16 a[212:215], a[52:55], v[196:199], a[212:215]
v_mfma_f32_16x16x32_bf16 a[184:187], a[56:59], v[192:195], a[184:187]
v_mfma_f32_16x16x32_bf16 a[216:219], a[56:59], v[196:199], a[216:219]
v_mfma_f32_16x16x32_bf16 a[188:191], a[60:63], v[192:195], a[188:191]
v_mfma_f32_16x16x32_bf16 a[220:223], a[60:63], v[196:199], a[220:223]
ds_read_b128 a[40:43], v244 offset:2560
v_mfma_f32_16x16x32_bf16 v[160:163], a[0:3], v[0:3], v[200:203]
ds_read_b128 a[44:47], v244 offset:2816
s_waitcnt lgkmcnt(10)
v_mfma_f32_16x16x32_bf16 v[160:163], a[4:7], v[8:11], v[160:163]
s_mov_b32 s46, 69632
s_add_u32 m0, s29, 4096
s_waitcnt lgkmcnt(9)
v_mfma_f32_16x16x32_bf16 v[160:163], a[8:11], v[16:19], v[160:163]
s_waitcnt vmcnt(5)
buffer_load_dwordx4 v248, s[12:15], s46 offen offset:2048 nt lds
s_waitcnt lgkmcnt(8)
v_mfma_f32_16x16x32_bf16 v[160:163], a[12:15], v[24:27], v[160:163]
ds_read_b128 a[48:51], v245 offset:2048
s_waitcnt lgkmcnt(8)
v_mfma_f32_16x16x32_bf16 v[160:163], a[16:19], a[64:67], v[160:163]
ds_read_b128 a[52:55], v245 offset:2304
s_waitcnt lgkmcnt(8)
v_mfma_f32_16x16x32_bf16 v[160:163], a[20:23], a[84:87], v[160:163]
ds_read_b128 a[56:59], v245 offset:2560
s_waitcnt lgkmcnt(8)
v_mfma_f32_16x16x32_bf16 v[160:163], a[24:27], a[104:107], v[160:163]
ds_read_b128 a[60:63], v245 offset:2816
s_waitcnt lgkmcnt(8)
v_mfma_f32_16x16x32_bf16 v[160:163], a[28:31], a[124:127], v[160:163]
v_mfma_f32_16x16x32_bf16 v[164:167], a[0:3], v[32:35], v[204:207]
v_mfma_f32_16x16x32_bf16 v[164:167], a[4:7], v[40:43], v[164:167]
v_mfma_f32_16x16x32_bf16 v[164:167], a[8:11], v[48:51], v[164:167]
v_mfma_f32_16x16x32_bf16 v[164:167], a[12:15], v[56:59], v[164:167]
v_mfma_f32_16x16x32_bf16 v[164:167], a[16:19], a[68:71], v[164:167]
v_mfma_f32_16x16x32_bf16 v[164:167], a[20:23], a[88:91], v[164:167]
s_waitcnt vmcnt(5)
buffer_load_dwordx4 v249, s[12:15], s46 offen offset:3072 nt lds
v_mfma_f32_16x16x32_bf16 v[164:167], a[24:27], a[108:111], v[164:167]
v_mfma_f32_16x16x32_bf16 v[164:167], a[28:31], a[128:131], v[164:167]
ds_write_b128 v250, v[220:223] offset:32768
v_mfma_f32_16x16x32_bf16 v[168:171], a[0:3], v[64:67], v[208:211]
v_mfma_f32_16x16x32_bf16 v[168:171], a[4:7], v[72:75], v[168:171]
v_mfma_f32_16x16x32_bf16 v[168:171], a[8:11], v[80:83], v[168:171]
v_mfma_f32_16x16x32_bf16 v[168:171], a[12:15], v[88:91], v[168:171]
v_mfma_f32_16x16x32_bf16 v[168:171], a[16:19], a[72:75], v[168:171]
v_mfma_f32_16x16x32_bf16 v[168:171], a[20:23], a[92:95], v[168:171]
v_mfma_f32_16x16x32_bf16 v[168:171], a[24:27], a[112:115], v[168:171]
v_mfma_f32_16x16x32_bf16 v[168:171], a[28:31], a[132:135], v[168:171]
s_mov_b32 s46, 98304
s_waitcnt lgkmcnt(0)
v_mfma_f32_16x16x32_bf16 v[172:175], a[32:35], v[0:3], v[200:203]
s_waitcnt vmcnt(5)
buffer_load_dwordx4 v[220:223], v248, s[12:15], s46 offen offset:0 nt
v_mfma_f32_16x16x32_bf16 v[172:175], a[36:39], v[8:11], v[172:175]
v_exp_f32 v160, v160
v_mfma_f32_16x16x32_bf16 v[172:175], a[40:43], v[16:19], v[172:175]
ds_write_b128 v250, v[224:227] offset:33792
v_mfma_f32_16x16x32_bf16 v[172:175], a[44:47], v[24:27], v[172:175]
v_exp_f32 v161, v161
v_mfma_f32_16x16x32_bf16 v[172:175], a[48:51], a[64:67], v[172:175]
v_exp_f32 v162, v162
v_mfma_f32_16x16x32_bf16 v[172:175], a[52:55], a[84:87], v[172:175]
v_cvt_pk_bf16_f32 v160, v160, v161
v_mfma_f32_16x16x32_bf16 v[172:175], a[56:59], a[104:107], v[172:175]
v_exp_f32 v163, v163
v_mfma_f32_16x16x32_bf16 v[172:175], a[60:63], a[124:127], v[172:175]
v_exp_f32 v164, v164
v_mfma_f32_16x16x32_bf16 v[176:179], a[32:35], v[32:35], v[204:207]
v_cvt_pk_bf16_f32 v161, v162, v163
v_mfma_f32_16x16x32_bf16 v[176:179], a[36:39], v[40:43], v[176:179]
v_exp_f32 v165, v165
v_mfma_f32_16x16x32_bf16 v[176:179], a[40:43], v[48:51], v[176:179]
s_waitcnt lgkmcnt(0)
v_mfma_f32_16x16x32_bf16 v[176:179], a[44:47], v[56:59], v[176:179]
s_waitcnt vmcnt(5)
buffer_load_dwordx4 v[224:227], v249, s[12:15], s46 offen offset:1024 nt
v_exp_f32 v166, v166
v_mfma_f32_16x16x32_bf16 v[176:179], a[48:51], a[68:71], v[176:179]
v_cvt_pk_bf16_f32 v164, v164, v165
v_mfma_f32_16x16x32_bf16 v[176:179], a[52:55], a[88:91], v[176:179]
ds_write_b128 v250, v[228:231] offset:34816
v_exp_f32 v167, v167
v_mfma_f32_16x16x32_bf16 v[176:179], a[56:59], a[108:111], v[176:179]
v_exp_f32 v168, v168
v_mfma_f32_16x16x32_bf16 v[176:179], a[60:63], a[128:131], v[176:179]
v_cvt_pk_bf16_f32 v165, v166, v167
v_mfma_f32_16x16x32_bf16 v[180:183], a[32:35], v[64:67], v[208:211]
v_exp_f32 v169, v169
v_mfma_f32_16x16x32_bf16 v[180:183], a[36:39], v[72:75], v[180:183]
v_exp_f32 v170, v170
v_mfma_f32_16x16x32_bf16 v[180:183], a[40:43], v[80:83], v[180:183]
v_cvt_pk_bf16_f32 v168, v168, v169
v_mfma_f32_16x16x32_bf16 v[180:183], a[44:47], v[88:91], v[180:183]
v_exp_f32 v171, v171
v_mfma_f32_16x16x32_bf16 v[180:183], a[48:51], a[72:75], v[180:183]
v_cvt_pk_bf16_f32 v169, v170, v171
v_mfma_f32_16x16x32_bf16 v[180:183], a[52:55], a[92:95], v[180:183]
s_waitcnt lgkmcnt(0)
v_mfma_f32_16x16x32_bf16 v[180:183], a[56:59], a[112:115], v[180:183]
s_waitcnt vmcnt(5)
buffer_load_dwordx4 v[228:231], v248, s[12:15], s46 offen offset:2048 nt
v_mfma_f32_16x16x32_bf16 v[180:183], a[60:63], a[132:135], v[180:183]
v_mfma_f32_16x16x32_bf16 v[184:187], a[0:3], v[96:99], v[212:215]
ds_write_b128 v250, v[232:235] offset:35840
v_mfma_f32_16x16x32_bf16 v[184:187], a[4:7], v[104:107], v[184:187]
v_exp_f32 v172, v172
v_exp_f32 v173, v173
v_exp_f32 v174, v174
v_cvt_pk_bf16_f32 v162, v172, v173
v_mfma_f32_16x16x32_bf16 v[184:187], a[8:11], v[112:115], v[184:187]
v_exp_f32 v175, v175
v_mfma_f32_16x16x32_bf16 v[184:187], a[12:15], v[120:123], v[184:187]
v_exp_f32 v176, v176
v_mfma_f32_16x16x32_bf16 v[184:187], a[16:19], a[76:79], v[184:187]
v_cvt_pk_bf16_f32 v163, v174, v175
v_mfma_f32_16x16x32_bf16 v[184:187], a[20:23], a[96:99], v[184:187]
v_exp_f32 v177, v177
v_mfma_f32_16x16x32_bf16 v[184:187], a[24:27], a[116:119], v[184:187]
ds_write_b128 v251, v[160:163] offset:37888
v_mfma_f32_16x16x32_bf16 v[184:187], a[28:31], a[136:139], v[184:187]
v_exp_f32 v178, v178
v_mfma_f32_16x16x32_bf16 v[188:191], a[0:3], v[128:131], v[216:219]
s_waitcnt lgkmcnt(1)
v_cvt_pk_bf16_f32 v166, v176, v177
v_mfma_f32_16x16x32_bf16 v[188:191], a[4:7], v[136:139], v[188:191]
s_waitcnt vmcnt(5)
buffer_load_dwordx4 v[232:235], v249, s[12:15], s46 offen offset:3072 nt
v_mfma_f32_16x16x32_bf16 v[188:191], a[8:11], v[144:147], v[188:191]
v_exp_f32 v179, v179
v_mfma_f32_16x16x32_bf16 v[188:191], a[12:15], v[152:155], v[188:191]
ds_write_b128 v250, v[236:239] offset:36864
v_exp_f32 v180, v180
v_mfma_f32_16x16x32_bf16 v[188:191], a[16:19], a[80:83], v[188:191]
v_cvt_pk_bf16_f32 v167, v178, v179
v_mfma_f32_16x16x32_bf16 v[188:191], a[20:23], a[100:103], v[188:191]
v_exp_f32 v181, v181
v_mfma_f32_16x16x32_bf16 v[188:191], a[24:27], a[120:123], v[188:191]
ds_write_b128 v251, v[164:167] offset:38912
v_mfma_f32_16x16x32_bf16 v[188:191], a[28:31], a[140:143], v[188:191]
v_exp_f32 v182, v182
v_mfma_f32_16x16x32_bf16 v[192:195], a[32:35], v[96:99], v[212:215]
v_cvt_pk_bf16_f32 v170, v180, v181
v_mfma_f32_16x16x32_bf16 v[192:195], a[36:39], v[104:107], v[192:195]
v_exp_f32 v183, v183
v_mfma_f32_16x16x32_bf16 v[192:195], a[40:43], v[112:115], v[192:195]
v_cvt_pk_bf16_f32 v171, v182, v183
ds_write_b128 v251, v[168:171] offset:39936
v_mfma_f32_16x16x32_bf16 v[192:195], a[44:47], v[120:123], v[192:195]
s_mov_b32 s46, 102400
s_waitcnt lgkmcnt(2)
v_mfma_f32_16x16x32_bf16 v[192:195], a[48:51], a[76:79], v[192:195]
s_waitcnt vmcnt(5)
buffer_load_dwordx4 v[236:239], v248, s[12:15], s46 offen offset:0 nt
s_waitcnt lgkmcnt(0)
s_barrier
v_add_u32 v246, s34, v246
ds_read_b64_tr_b16 a[0:1], v246 offset:0
v_mfma_f32_16x16x32_bf16 v[192:195], a[52:55], a[96:99], v[192:195]
ds_read_b64_tr_b16 a[2:3], v246 offset:2048
v_mfma_f32_16x16x32_bf16 v[192:195], a[56:59], a[116:119], v[192:195]
v_add_u32 v247, s34, v247
ds_read_b64_tr_b16 a[4:5], v247 offset:0
v_mfma_f32_16x16x32_bf16 v[192:195], a[60:63], a[136:139], v[192:195]
ds_read_b64_tr_b16 a[6:7], v247 offset:2048
ds_read_b64_tr_b16 a[8:9], v246 offset:256
v_mfma_f32_16x16x32_bf16 v[196:199], a[32:35], v[128:131], v[216:219]
ds_read_b64_tr_b16 a[10:11], v246 offset:2304
ds_read_b64_tr_b16 a[12:13], v247 offset:256
v_mfma_f32_16x16x32_bf16 v[196:199], a[36:39], v[136:139], v[196:199]
ds_read_b64_tr_b16 a[14:15], v247 offset:2304
ds_read_b64_tr_b16 a[16:17], v246 offset:512
v_mfma_f32_16x16x32_bf16 v[196:199], a[40:43], v[144:147], v[196:199]
ds_read_b64_tr_b16 a[18:19], v246 offset:2560
ds_read_b64_tr_b16 a[20:21], v247 offset:512
v_mfma_f32_16x16x32_bf16 v[196:199], a[44:47], v[152:155], v[196:199]
ds_read_b64_tr_b16 a[22:23], v247 offset:2560
v_mfma_f32_16x16x32_bf16 v[196:199], a[48:51], a[80:83], v[196:199]
v_mfma_f32_16x16x32_bf16 v[196:199], a[52:55], a[100:103], v[196:199]
v_mfma_f32_16x16x32_bf16 v[196:199], a[56:59], a[120:123], v[196:199]
s_add_u32 m0, s29, 69632
v_mfma_f32_16x16x32_bf16 v[196:199], a[60:63], a[140:143], v[196:199]
s_waitcnt vmcnt(5)
buffer_load_dwordx4 v249, s[12:15], s46 offen offset:1024 nt lds
v_mfma_f32_16x16x32_bf16 a[224:227], a[244:247], v[160:163], a[224:227]
v_exp_f32 v184, v184
v_mfma_f32_16x16x32_bf16 a[228:231], a[244:247], v[164:167], a[228:231]
v_exp_f32 v185, v185
v_mfma_f32_16x16x32_bf16 a[232:235], a[244:247], v[168:171], a[232:235]
ds_read_b128 v[172:175], v250 offset:37888
s_waitcnt lgkmcnt(5)
v_mfma_f32_16x16x32_bf16 v[4:7], a[0:3], v[160:163], v[4:7]
v_exp_f32 v186, v186
v_mfma_f32_16x16x32_bf16 v[68:71], a[0:3], v[164:167], v[68:71]
ds_read_b128 v[176:179], v250 offset:38912
v_cvt_pk_bf16_f32 v184, v184, v185
v_mfma_f32_16x16x32_bf16 v[132:135], a[0:3], v[168:171], v[132:135]
v_exp_f32 v187, v187
v_mfma_f32_16x16x32_bf16 v[12:15], a[4:7], v[160:163], v[12:15]
ds_read_b128 v[180:183], v250 offset:39936
ds_read_b64_tr_b16 a[24:25], v246 offset:768
v_mfma_f32_16x16x32_bf16 v[76:79], a[4:7], v[164:167], v[76:79]
ds_read_b64_tr_b16 a[26:27], v246 offset:2816
ds_read_b64_tr_b16 a[28:29], v247 offset:768
v_mfma_f32_16x16x32_bf16 v[140:143], a[4:7], v[168:171], v[140:143]
v_exp_f32 v188, v188
v_mfma_f32_16x16x32_bf16 v[20:23], a[8:11], v[160:163], v[20:23]
v_cvt_pk_bf16_f32 v185, v186, v187
ds_read_b64_tr_b16 a[30:31], v247 offset:2816
v_mfma_f32_16x16x32_bf16 v[84:87], a[8:11], v[164:167], v[84:87]
v_exp_f32 v189, v189
v_mfma_f32_16x16x32_bf16 v[148:151], a[8:11], v[168:171], v[148:151]
v_add_u32 v246, s33, v246
ds_read_b64_tr_b16 a[32:33], v246 offset:0
v_mfma_f32_16x16x32_bf16 v[28:31], a[12:15], v[160:163], v[28:31]
ds_read_b64_tr_b16 a[34:35], v246 offset:2048
v_mfma_f32_16x16x32_bf16 v[92:95], a[12:15], v[164:167], v[92:95]
v_exp_f32 v190, v190
v_mfma_f32_16x16x32_bf16 v[156:159], a[12:15], v[168:171], v[156:159]
s_waitcnt lgkmcnt(8)
ds_write_b128 v250, v[240:243] offset:37888
s_waitcnt lgkmcnt(8)
ds_write_b128 v250, a[248:251] offset:38912
s_waitcnt lgkmcnt(5)
v_mfma_f32_16x16x32_bf16 v[36:39], a[16:19], v[160:163], v[36:39]
v_cvt_pk_bf16_f32 v188, v188, v189
v_mfma_f32_16x16x32_bf16 v[100:103], a[16:19], v[164:167], v[100:103]
s_waitcnt lgkmcnt(1)
v_mfma_f32_16x16x32_bf16 a[144:147], a[16:19], v[168:171], a[144:147]
s_waitcnt vmcnt(5)
buffer_load_dwordx4 v[240:243], v248, s[12:15], s46 offen offset:2048 nt
v_mfma_f32_16x16x32_bf16 v[44:47], a[20:23], v[160:163], v[44:47]
v_add_u32 v247, s33, v247
ds_read_b64_tr_b16 a[36:37], v247 offset:0
v_mfma_f32_16x16x32_bf16 v[108:111], a[20:23], v[164:167], v[108:111]
ds_read_b64_tr_b16 a[38:39], v247 offset:2048
ds_read_b64_tr_b16 a[40:41], v246 offset:256
v_mfma_f32_16x16x32_bf16 a[148:151], a[20:23], v[168:171], a[148:151]
v_exp_f32 v191, v191
v_mfma_f32_16x16x32_bf16 v[52:55], a[24:27], v[160:163], v[52:55]
s_waitcnt lgkmcnt(3)
v_cvt_pk_bf16_f32 v189, v190, v191
v_mfma_f32_16x16x32_bf16 v[116:119], a[24:27], v[164:167], v[116:119]
s_waitcnt vmcnt(5)
buffer_load_dwordx4 a[248:251], v249, s[12:15], s46 offen offset:3072 nt
v_mfma_f32_16x16x32_bf16 a[152:155], a[24:27], v[168:171], a[152:155]
ds_read_b64_tr_b16 a[42:43], v246 offset:2304
v_mfma_f32_16x16x32_bf16 v[60:63], a[28:31], v[160:163], v[60:63]
ds_write_b128 v250, a[252:255] offset:39936
v_mfma_f32_16x16x32_bf16 v[124:127], a[28:31], v[164:167], v[124:127]
v_exp_f32 v192, v192
v_mfma_f32_16x16x32_bf16 a[156:159], a[28:31], v[168:171], a[156:159]
ds_read_b64_tr_b16 a[44:45], v247 offset:256
ds_read_b64_tr_b16 a[46:47], v247 offset:2304
v_mfma_f32_16x16x32_bf16 v[4:7], a[32:35], v[172:175], v[4:7]
v_exp_f32 v193, v193
v_mfma_f32_16x16x32_bf16 v[68:71], a[32:35], v[176:179], v[68:71]
ds_read_b64_tr_b16 a[48:49], v246 offset:512
ds_read_b64_tr_b16 a[50:51], v246 offset:2560
v_mfma_f32_16x16x32_bf16 v[132:135], a[32:35], v[180:183], v[132:135]
ds_read_b64_tr_b16 a[52:53], v247 offset:512
s_waitcnt lgkmcnt(7)
v_mfma_f32_16x16x32_bf16 v[12:15], a[36:39], v[172:175], v[12:15]
v_exp_f32 v194, v194
v_mfma_f32_16x16x32_bf16 v[76:79], a[36:39], v[176:179], v[76:79]
v_cvt_pk_bf16_f32 v186, v192, v193
ds_read_b64_tr_b16 a[54:55], v247 offset:2560
v_mfma_f32_16x16x32_bf16 v[140:143], a[36:39], v[180:183], v[140:143]
s_mov_b32 s45, 131072
s_waitcnt lgkmcnt(6)
v_mfma_f32_16x16x32_bf16 v[20:23], a[40:43], v[172:175], v[20:23]
s_waitcnt vmcnt(5)
buffer_load_dwordx4 a[252:255], v248, s[8:11], s45 offen offset:0 nt
v_mfma_f32_16x16x32_bf16 v[84:87], a[40:43], v[176:179], v[84:87]
v_exp_f32 v195, v195
v_mfma_f32_16x16x32_bf16 v[148:151], a[40:43], v[180:183], v[148:151]
ds_read_b64_tr_b16 a[56:57], v246 offset:768
s_waitcnt lgkmcnt(3)
v_mfma_f32_16x16x32_bf16 v[28:31], a[44:47], v[172:175], v[28:31]
v_exp_f32 v196, v196
v_mfma_f32_16x16x32_bf16 v[92:95], a[44:47], v[176:179], v[92:95]
ds_read_b64_tr_b16 a[58:59], v246 offset:2816
v_cvt_pk_bf16_f32 v187, v194, v195
v_mfma_f32_16x16x32_bf16 v[156:159], a[44:47], v[180:183], v[156:159]
ds_read_b64_tr_b16 a[60:61], v247 offset:768
ds_read_b64_tr_b16 a[62:63], v247 offset:2816
v_mfma_f32_16x16x32_bf16 v[36:39], a[48:51], v[172:175], v[36:39]
v_exp_f32 v197, v197
v_mfma_f32_16x16x32_bf16 v[100:103], a[48:51], v[176:179], v[100:103]
v_add_u32 v251, 0x10000, v251
ds_write_b128 v251, v[184:187] offset:6144
v_mfma_f32_16x16x32_bf16 a[144:147], a[48:51], v[180:183], a[144:147]
s_waitcnt lgkmcnt(5)
v_mfma_f32_16x16x32_bf16 v[44:47], a[52:55], v[172:175], v[44:47]
v_exp_f32 v198, v198
v_mfma_f32_16x16x32_bf16 v[108:111], a[52:55], v[176:179], v[108:111]
v_cvt_pk_bf16_f32 v190, v196, v197
v_mfma_f32_16x16x32_bf16 a[148:151], a[52:55], v[180:183], a[148:151]
s_waitcnt lgkmcnt(3)
v_mfma_f32_16x16x32_bf16 v[52:55], a[56:59], v[172:175], v[52:55]
v_exp_f32 v199, v199
v_mfma_f32_16x16x32_bf16 v[116:119], a[56:59], v[176:179], v[116:119]
v_cvt_pk_bf16_f32 v191, v198, v199
ds_write_b128 v251, v[188:191] offset:7168
v_mfma_f32_16x16x32_bf16 a[152:155], a[56:59], v[180:183], a[152:155]
s_waitcnt lgkmcnt(1)
v_mfma_f32_16x16x32_bf16 v[60:63], a[60:63], v[172:175], v[60:63]
v_mfma_f32_16x16x32_bf16 v[124:127], a[60:63], v[176:179], v[124:127]
v_mfma_f32_16x16x32_bf16 a[156:159], a[60:63], v[180:183], a[156:159]
v_mfma_f32_16x16x32_bf16 a[236:239], a[244:247], v[184:187], a[236:239]
v_mfma_f32_16x16x32_bf16 a[240:243], a[244:247], v[188:191], a[240:243]
v_mfma_f32_16x16x32_bf16 a[160:163], a[0:3], v[184:187], a[160:163]
v_mfma_f32_16x16x32_bf16 a[192:195], a[0:3], v[188:191], a[192:195]
s_add_u32 m0, s29, 98304
s_waitcnt lgkmcnt(0)
s_barrier
v_add_u32 v244, 0x10000, v244
ds_read_b128 a[0:3], v244 offset:0
v_mfma_f32_16x16x32_bf16 a[164:167], a[4:7], v[184:187], a[164:167]
v_add_u32 v250, 0x10000, v250
ds_read_b128 v[192:195], v250 offset:6144
s_waitcnt vmcnt(5)
buffer_load_dwordx4 v249, s[8:11], s45 offen offset:1024 nt lds
v_mfma_f32_16x16x32_bf16 a[196:199], a[4:7], v[188:191], a[196:199]
ds_read_b128 v[196:199], v250 offset:7168
s_waitcnt vmcnt(5)
buffer_load_dwordx4 v248, s[8:11], s45 offen offset:2048 nt lds
v_mfma_f32_16x16x32_bf16 a[168:171], a[8:11], v[184:187], a[168:171]
ds_read_b128 a[4:7], v244 offset:256
v_mfma_f32_16x16x32_bf16 a[200:203], a[8:11], v[188:191], a[200:203]
ds_read_b128 a[8:11], v244 offset:512
v_mfma_f32_16x16x32_bf16 a[172:175], a[12:15], v[184:187], a[172:175]
v_mfma_f32_16x16x32_bf16 a[204:207], a[12:15], v[188:191], a[204:207]
ds_read_b128 a[12:15], v244 offset:768
v_mfma_f32_16x16x32_bf16 a[176:179], a[16:19], v[184:187], a[176:179]
v_mfma_f32_16x16x32_bf16 a[208:211], a[16:19], v[188:191], a[208:211]
v_add_u32 v245, 0x10000, v245
ds_read_b128 a[16:19], v245 offset:0
v_mfma_f32_16x16x32_bf16 a[180:183], a[20:23], v[184:187], a[180:183]
v_mfma_f32_16x16x32_bf16 a[212:215], a[20:23], v[188:191], a[212:215]
ds_read_b128 a[20:23], v245 offset:256
v_mfma_f32_16x16x32_bf16 a[184:187], a[24:27], v[184:187], a[184:187]
v_mfma_f32_16x16x32_bf16 a[216:219], a[24:27], v[188:191], a[216:219]
s_waitcnt vmcnt(5)
buffer_load_dwordx4 v249, s[8:11], s45 offen offset:3072 nt lds
v_mfma_f32_16x16x32_bf16 a[188:191], a[28:31], v[184:187], a[188:191]
ds_read_b128 a[24:27], v245 offset:512
v_mfma_f32_16x16x32_bf16 a[220:223], a[28:31], v[188:191], a[220:223]
ds_read_b128 a[28:31], v245 offset:768
s_waitcnt lgkmcnt(8)
v_mfma_f32_16x16x32_bf16 a[160:163], a[32:35], v[192:195], a[160:163]
s_waitcnt lgkmcnt(7)
v_mfma_f32_16x16x32_bf16 a[192:195], a[32:35], v[196:199], a[192:195]
ds_read_b128 a[32:35], v244 offset:2048
v_mfma_f32_16x16x32_bf16 a[164:167], a[36:39], v[192:195], a[164:167]
v_mfma_f32_16x16x32_bf16 a[196:199], a[36:39], v[196:199], a[196:199]
ds_read_b128 a[36:39], v244 offset:2304
v_mfma_f32_16x16x32_bf16 a[168:171], a[40:43], v[192:195], a[168:171]
v_mfma_f32_16x16x32_bf16 a[200:203], a[40:43], v[196:199], a[200:203]
v_mfma_f32_16x16x32_bf16 a[172:175], a[44:47], v[192:195], a[172:175]
v_mfma_f32_16x16x32_bf16 a[204:207], a[44:47], v[196:199], a[204:207]
s_mov_b32 s45, 135168
s_add_u32 m0, s29, 102400
v_mfma_f32_16x16x32_bf16 a[176:179], a[48:51], v[192:195], a[176:179]
s_waitcnt vmcnt(5)
buffer_load_dwordx4 v248, s[8:11], s45 offen offset:0 nt lds
v_mfma_f32_16x16x32_bf16 a[208:211], a[48:51], v[196:199], a[208:211]
v_mfma_f32_16x16x32_bf16 a[180:183], a[52:55], v[192:195], a[180:183]
v_mfma_f32_16x16x32_bf16 a[212:215], a[52:55], v[196:199], a[212:215]
ds_write_b128 v250, v[220:223] offset:0
v_mfma_f32_16x16x32_bf16 a[184:187], a[56:59], v[192:195], a[184:187]
v_mfma_f32_16x16x32_bf16 a[216:219], a[56:59], v[196:199], a[216:219]
v_mfma_f32_16x16x32_bf16 a[188:191], a[60:63], v[192:195], a[188:191]
v_mfma_f32_16x16x32_bf16 a[220:223], a[60:63], v[196:199], a[220:223]
ds_read_b128 a[40:43], v244 offset:2560
v_mfma_f32_16x16x32_bf16 v[160:163], a[0:3], v[0:3], v[200:203]
ds_read_b128 a[44:47], v244 offset:2816
s_waitcnt lgkmcnt(11)
v_mfma_f32_16x16x32_bf16 v[160:163], a[4:7], v[8:11], v[160:163]
ds_read_b128 a[48:51], v245 offset:2048
s_waitcnt lgkmcnt(11)
v_mfma_f32_16x16x32_bf16 v[160:163], a[8:11], v[16:19], v[160:163]
ds_read_b128 a[52:55], v245 offset:2304
s_waitcnt lgkmcnt(11)
v_mfma_f32_16x16x32_bf16 v[160:163], a[12:15], v[24:27], v[160:163]
s_waitcnt lgkmcnt(4)
v_mfma_f32_16x16x32_bf16 v[160:163], a[16:19], a[64:67], v[160:163]
s_waitcnt vmcnt(5)
buffer_load_dwordx4 v[220:223], v249, s[8:11], s45 offen offset:1024 nt
v_mfma_f32_16x16x32_bf16 v[160:163], a[20:23], a[84:87], v[160:163]
ds_read_b128 a[56:59], v245 offset:2560
v_mfma_f32_16x16x32_bf16 v[160:163], a[24:27], a[104:107], v[160:163]
ds_write_b128 v250, v[224:227] offset:1024
v_mfma_f32_16x16x32_bf16 v[160:163], a[28:31], a[124:127], v[160:163]
ds_read_b128 a[60:63], v245 offset:2816
v_mfma_f32_16x16x32_bf16 v[164:167], a[0:3], v[32:35], v[204:207]
v_mfma_f32_16x16x32_bf16 v[164:167], a[4:7], v[40:43], v[164:167]
v_mfma_f32_16x16x32_bf16 v[164:167], a[8:11], v[48:51], v[164:167]
v_mfma_f32_16x16x32_bf16 v[164:167], a[12:15], v[56:59], v[164:167]
v_mfma_f32_16x16x32_bf16 v[164:167], a[16:19], a[68:71], v[164:167]
v_mfma_f32_16x16x32_bf16 v[164:167], a[20:23], a[88:91], v[164:167]
v_mfma_f32_16x16x32_bf16 v[164:167], a[24:27], a[108:111], v[164:167]
s_waitcnt lgkmcnt(1)
v_mfma_f32_16x16x32_bf16 v[164:167], a[28:31], a[128:131], v[164:167]
s_waitcnt vmcnt(5)
buffer_load_dwordx4 v[224:227], v248, s[8:11], s45 offen offset:2048 nt
v_mfma_f32_16x16x32_bf16 v[168:171], a[0:3], v[64:67], v[208:211]
v_mfma_f32_16x16x32_bf16 v[168:171], a[4:7], v[72:75], v[168:171]
ds_write_b128 v250, v[228:231] offset:2048
v_mfma_f32_16x16x32_bf16 v[168:171], a[8:11], v[80:83], v[168:171]
v_mfma_f32_16x16x32_bf16 v[168:171], a[12:15], v[88:91], v[168:171]
v_mfma_f32_16x16x32_bf16 v[168:171], a[16:19], a[72:75], v[168:171]
v_mfma_f32_16x16x32_bf16 v[168:171], a[20:23], a[92:95], v[168:171]
v_mfma_f32_16x16x32_bf16 v[168:171], a[24:27], a[112:115], v[168:171]
v_mfma_f32_16x16x32_bf16 v[168:171], a[28:31], a[132:135], v[168:171]
s_waitcnt lgkmcnt(1)
v_mfma_f32_16x16x32_bf16 v[172:175], a[32:35], v[0:3], v[200:203]
v_mfma_f32_16x16x32_bf16 v[172:175], a[36:39], v[8:11], v[172:175]
s_waitcnt lgkmcnt(0)
v_mfma_f32_16x16x32_bf16 v[172:175], a[40:43], v[16:19], v[172:175]
s_waitcnt vmcnt(5)
buffer_load_dwordx4 v[228:231], v249, s[8:11], s45 offen offset:3072 nt
v_exp_f32 v160, v160
v_mfma_f32_16x16x32_bf16 v[172:175], a[44:47], v[24:27], v[172:175]
v_exp_f32 v161, v161
v_mfma_f32_16x16x32_bf16 v[172:175], a[48:51], a[64:67], v[172:175]
ds_write_b128 v250, v[232:235] offset:3072
v_exp_f32 v162, v162
v_mfma_f32_16x16x32_bf16 v[172:175], a[52:55], a[84:87], v[172:175]
v_cvt_pk_bf16_f32 v160, v160, v161
v_mfma_f32_16x16x32_bf16 v[172:175], a[56:59], a[104:107], v[172:175]
v_exp_f32 v163, v163
v_mfma_f32_16x16x32_bf16 v[172:175], a[60:63], a[124:127], v[172:175]
v_exp_f32 v164, v164
v_mfma_f32_16x16x32_bf16 v[176:179], a[32:35], v[32:35], v[204:207]
v_cvt_pk_bf16_f32 v161, v162, v163
v_mfma_f32_16x16x32_bf16 v[176:179], a[36:39], v[40:43], v[176:179]
v_exp_f32 v165, v165
v_mfma_f32_16x16x32_bf16 v[176:179], a[40:43], v[48:51], v[176:179]
v_exp_f32 v166, v166
v_mfma_f32_16x16x32_bf16 v[176:179], a[44:47], v[56:59], v[176:179]
v_cvt_pk_bf16_f32 v164, v164, v165
v_mfma_f32_16x16x32_bf16 v[176:179], a[48:51], a[68:71], v[176:179]
s_mov_b32 s46, 131072
s_waitcnt lgkmcnt(0)
v_mfma_f32_16x16x32_bf16 v[176:179], a[52:55], a[88:91], v[176:179]
s_waitcnt vmcnt(5)
buffer_load_dwordx4 v[232:235], v248, s[12:15], s46 offen offset:0 nt
v_exp_f32 v167, v167
v_mfma_f32_16x16x32_bf16 v[176:179], a[56:59], a[108:111], v[176:179]
v_exp_f32 v168, v168
v_mfma_f32_16x16x32_bf16 v[176:179], a[60:63], a[128:131], v[176:179]
ds_write_b128 v250, v[236:239] offset:4096
v_cvt_pk_bf16_f32 v165, v166, v167
v_mfma_f32_16x16x32_bf16 v[180:183], a[32:35], v[64:67], v[208:211]
v_exp_f32 v169, v169
v_mfma_f32_16x16x32_bf16 v[180:183], a[36:39], v[72:75], v[180:183]
v_exp_f32 v170, v170
v_mfma_f32_16x16x32_bf16 v[180:183], a[40:43], v[80:83], v[180:183]
v_cvt_pk_bf16_f32 v168, v168, v169
v_mfma_f32_16x16x32_bf16 v[180:183], a[44:47], v[88:91], v[180:183]
v_exp_f32 v171, v171
v_mfma_f32_16x16x32_bf16 v[180:183], a[48:51], a[72:75], v[180:183]
v_cvt_pk_bf16_f32 v169, v170, v171
v_mfma_f32_16x16x32_bf16 v[180:183], a[52:55], a[92:95], v[180:183]
v_mfma_f32_16x16x32_bf16 v[180:183], a[56:59], a[112:115], v[180:183]
v_mfma_f32_16x16x32_bf16 v[180:183], a[60:63], a[132:135], v[180:183]
s_waitcnt lgkmcnt(0)
v_mfma_f32_16x16x32_bf16 v[184:187], a[0:3], v[96:99], v[212:215]
s_waitcnt vmcnt(5)
buffer_load_dwordx4 v[236:239], v249, s[12:15], s46 offen offset:1024 nt
v_mfma_f32_16x16x32_bf16 v[184:187], a[4:7], v[104:107], v[184:187]
v_exp_f32 v172, v172
v_exp_f32 v173, v173
v_exp_f32 v174, v174
v_cvt_pk_bf16_f32 v162, v172, v173
v_mfma_f32_16x16x32_bf16 v[184:187], a[8:11], v[112:115], v[184:187]
ds_write_b128 v250, v[240:243] offset:6144
v_exp_f32 v175, v175
v_mfma_f32_16x16x32_bf16 v[184:187], a[12:15], v[120:123], v[184:187]
v_exp_f32 v176, v176
v_mfma_f32_16x16x32_bf16 v[184:187], a[16:19], a[76:79], v[184:187]
v_cvt_pk_bf16_f32 v163, v174, v175
v_mfma_f32_16x16x32_bf16 v[184:187], a[20:23], a[96:99], v[184:187]
v_exp_f32 v177, v177
v_mfma_f32_16x16x32_bf16 v[184:187], a[24:27], a[116:119], v[184:187]
ds_write_b128 v251, v[160:163] offset:37888
v_mfma_f32_16x16x32_bf16 v[184:187], a[28:31], a[136:139], v[184:187]
v_exp_f32 v178, v178
v_mfma_f32_16x16x32_bf16 v[188:191], a[0:3], v[128:131], v[216:219]
v_cvt_pk_bf16_f32 v166, v176, v177
v_mfma_f32_16x16x32_bf16 v[188:191], a[4:7], v[136:139], v[188:191]
v_exp_f32 v179, v179
v_mfma_f32_16x16x32_bf16 v[188:191], a[8:11], v[144:147], v[188:191]
s_waitcnt lgkmcnt(1)
v_mfma_f32_16x16x32_bf16 v[188:191], a[12:15], v[152:155], v[188:191]
s_waitcnt vmcnt(5)
buffer_load_dwordx4 v[240:243], v248, s[12:15], s46 offen offset:2048 nt
v_exp_f32 v180, v180
v_mfma_f32_16x16x32_bf16 v[188:191], a[16:19], a[80:83], v[188:191]
v_cvt_pk_bf16_f32 v167, v178, v179
v_mfma_f32_16x16x32_bf16 v[188:191], a[20:23], a[100:103], v[188:191]
v_exp_f32 v181, v181
v_mfma_f32_16x16x32_bf16 v[188:191], a[24:27], a[120:123], v[188:191]
ds_write_b128 v251, v[164:167] offset:38912
v_mfma_f32_16x16x32_bf16 v[188:191], a[28:31], a[140:143], v[188:191]
v_exp_f32 v182, v182
v_mfma_f32_16x16x32_bf16 v[192:195], a[32:35], v[96:99], v[212:215]
v_cvt_pk_bf16_f32 v170, v180, v181
v_mfma_f32_16x16x32_bf16 v[192:195], a[36:39], v[104:107], v[192:195]
v_exp_f32 v183, v183
v_mfma_f32_16x16x32_bf16 v[192:195], a[40:43], v[112:115], v[192:195]
v_cvt_pk_bf16_f32 v171, v182, v183
ds_write_b128 v251, v[168:171] offset:39936
v_mfma_f32_16x16x32_bf16 v[192:195], a[44:47], v[120:123], v[192:195]
v_mfma_f32_16x16x32_bf16 v[192:195], a[48:51], a[76:79], v[192:195]
s_waitcnt lgkmcnt(0)
s_barrier
v_add_u32 v246, s35, v246
ds_read_b64_tr_b16 a[0:1], v246 offset:0
v_mfma_f32_16x16x32_bf16 v[192:195], a[52:55], a[96:99], v[192:195]
s_add_u32 m0, s29, 131072
ds_read_b64_tr_b16 a[2:3], v246 offset:2048
v_mfma_f32_16x16x32_bf16 v[192:195], a[56:59], a[116:119], v[192:195]
s_waitcnt vmcnt(5)
buffer_load_dwordx4 v249, s[12:15], s46 offen offset:3072 nt lds
v_mfma_f32_16x16x32_bf16 v[192:195], a[60:63], a[136:139], v[192:195]
v_add_u32 v247, s35, v247
ds_read_b64_tr_b16 a[4:5], v247 offset:0
v_mfma_f32_16x16x32_bf16 v[196:199], a[32:35], v[128:131], v[216:219]
ds_read_b64_tr_b16 a[6:7], v247 offset:2048
ds_read_b64_tr_b16 a[8:9], v246 offset:256
v_mfma_f32_16x16x32_bf16 v[196:199], a[36:39], v[136:139], v[196:199]
ds_read_b64_tr_b16 a[10:11], v246 offset:2304
ds_read_b64_tr_b16 a[12:13], v247 offset:256
v_mfma_f32_16x16x32_bf16 v[196:199], a[40:43], v[144:147], v[196:199]
ds_read_b64_tr_b16 a[14:15], v247 offset:2304
ds_read_b64_tr_b16 a[16:17], v246 offset:512
v_mfma_f32_16x16x32_bf16 v[196:199], a[44:47], v[152:155], v[196:199]
ds_read_b64_tr_b16 a[18:19], v246 offset:2560
ds_read_b64_tr_b16 a[20:21], v247 offset:512
v_mfma_f32_16x16x32_bf16 v[196:199], a[48:51], a[80:83], v[196:199]
ds_read_b64_tr_b16 a[22:23], v247 offset:2560
v_mfma_f32_16x16x32_bf16 v[196:199], a[52:55], a[100:103], v[196:199]
v_mfma_f32_16x16x32_bf16 v[196:199], a[56:59], a[120:123], v[196:199]
v_mfma_f32_16x16x32_bf16 v[196:199], a[60:63], a[140:143], v[196:199]
v_exp_f32 v184, v184
v_mfma_f32_16x16x32_bf16 a[224:227], a[244:247], v[160:163], a[224:227]
s_mov_b32 s46, 135168
s_add_u32 m0, s29, 135168
v_mfma_f32_16x16x32_bf16 a[228:231], a[244:247], v[164:167], a[228:231]
s_waitcnt vmcnt(5)
buffer_load_dwordx4 v248, s[12:15], s46 offen offset:0 nt lds
v_mfma_f32_16x16x32_bf16 a[232:235], a[244:247], v[168:171], a[232:235]
ds_read_b128 v[172:175], v250 offset:37888
s_waitcnt lgkmcnt(5)
v_mfma_f32_16x16x32_bf16 v[4:7], a[0:3], v[160:163], v[4:7]
v_exp_f32 v185, v185
v_mfma_f32_16x16x32_bf16 v[68:71], a[0:3], v[164:167], v[68:71]
ds_read_b128 v[176:179], v250 offset:38912
ds_read_b64_tr_b16 a[24:25], v246 offset:768
v_mfma_f32_16x16x32_bf16 v[132:135], a[0:3], v[168:171], v[132:135]
v_exp_f32 v186, v186
v_mfma_f32_16x16x32_bf16 v[12:15], a[4:7], v[160:163], v[12:15]
ds_read_b128 v[180:183], v250 offset:39936
v_cvt_pk_bf16_f32 v184, v184, v185
v_mfma_f32_16x16x32_bf16 v[76:79], a[4:7], v[164:167], v[76:79]
v_exp_f32 v187, v187
v_mfma_f32_16x16x32_bf16 v[140:143], a[4:7], v[168:171], v[140:143]
ds_read_b64_tr_b16 a[26:27], v246 offset:2816
ds_read_b64_tr_b16 a[28:29], v247 offset:768
v_mfma_f32_16x16x32_bf16 v[20:23], a[8:11], v[160:163], v[20:23]
v_exp_f32 v188, v188
v_mfma_f32_16x16x32_bf16 v[84:87], a[8:11], v[164:167], v[84:87]
v_cvt_pk_bf16_f32 v185, v186, v187
ds_read_b64_tr_b16 a[30:31], v247 offset:2816
v_mfma_f32_16x16x32_bf16 v[148:151], a[8:11], v[168:171], v[148:151]
v_exp_f32 v189, v189
v_mfma_f32_16x16x32_bf16 v[28:31], a[12:15], v[160:163], v[28:31]
v_add_u32 v246, s33, v246
ds_read_b64_tr_b16 a[32:33], v246 offset:0
v_mfma_f32_16x16x32_bf16 v[92:95], a[12:15], v[164:167], v[92:95]
s_waitcnt vmcnt(5)
buffer_load_dwordx4 v249, s[12:15], s46 offen offset:1024 nt lds
v_mfma_f32_16x16x32_bf16 v[156:159], a[12:15], v[168:171], v[156:159]
ds_read_b64_tr_b16 a[34:35], v246 offset:2048
s_waitcnt lgkmcnt(5)
v_mfma_f32_16x16x32_bf16 v[36:39], a[16:19], v[160:163], v[36:39]
ds_write_b128 v250, a[248:251] offset:7168
v_mfma_f32_16x16x32_bf16 v[100:103], a[16:19], v[164:167], v[100:103]
v_exp_f32 v190, v190
v_mfma_f32_16x16x32_bf16 a[144:147], a[16:19], v[168:171], a[144:147]
v_cvt_pk_bf16_f32 v188, v188, v189
v_mfma_f32_16x16x32_bf16 v[44:47], a[20:23], v[160:163], v[44:47]
v_add_u32 v247, s33, v247
ds_read_b64_tr_b16 a[36:37], v247 offset:0
v_mfma_f32_16x16x32_bf16 v[108:111], a[20:23], v[164:167], v[108:111]
ds_read_b64_tr_b16 a[38:39], v247 offset:2048
ds_read_b64_tr_b16 a[40:41], v246 offset:256
v_mfma_f32_16x16x32_bf16 a[148:151], a[20:23], v[168:171], a[148:151]
ds_read_b64_tr_b16 a[42:43], v246 offset:2304
s_waitcnt lgkmcnt(6)
v_mfma_f32_16x16x32_bf16 v[52:55], a[24:27], v[160:163], v[52:55]
v_exp_f32 v191, v191
v_mfma_f32_16x16x32_bf16 v[116:119], a[24:27], v[164:167], v[116:119]
v_cvt_pk_bf16_f32 v189, v190, v191
ds_read_b64_tr_b16 a[44:45], v247 offset:256
v_mfma_f32_16x16x32_bf16 a[152:155], a[24:27], v[168:171], a[152:155]
s_waitcnt lgkmcnt(5)
ds_read_b64_tr_b16 a[46:47], v247 offset:2304
v_mfma_f32_16x16x32_bf16 v[60:63], a[28:31], v[160:163], v[60:63]
s_waitcnt vmcnt(5)
buffer_load_dwordx4 a[248:251], v248, s[12:15], s46 offen offset:2048 nt
v_mfma_f32_16x16x32_bf16 v[124:127], a[28:31], v[164:167], v[124:127]
v_exp_f32 v192, v192
v_mfma_f32_16x16x32_bf16 a[156:159], a[28:31], v[168:171], a[156:159]
ds_write_b128 v250, a[252:255] offset:32768
s_waitcnt lgkmcnt(4)
v_mfma_f32_16x16x32_bf16 v[4:7], a[32:35], v[172:175], v[4:7]
v_exp_f32 v193, v193
v_mfma_f32_16x16x32_bf16 v[68:71], a[32:35], v[176:179], v[68:71]
ds_read_b64_tr_b16 a[48:49], v246 offset:512
ds_read_b64_tr_b16 a[50:51], v246 offset:2560
v_mfma_f32_16x16x32_bf16 v[132:135], a[32:35], v[180:183], v[132:135]
v_exp_f32 v194, v194
v_mfma_f32_16x16x32_bf16 v[12:15], a[36:39], v[172:175], v[12:15]
v_cvt_pk_bf16_f32 v186, v192, v193
ds_read_b64_tr_b16 a[52:53], v247 offset:512
v_mfma_f32_16x16x32_bf16 v[76:79], a[36:39], v[176:179], v[76:79]
ds_read_b64_tr_b16 a[54:55], v247 offset:2560
ds_read_b64_tr_b16 a[56:57], v246 offset:768
v_mfma_f32_16x16x32_bf16 v[140:143], a[36:39], v[180:183], v[140:143]
ds_read_b64_tr_b16 a[58:59], v246 offset:2816
s_waitcnt lgkmcnt(7)
v_mfma_f32_16x16x32_bf16 v[20:23], a[40:43], v[172:175], v[20:23]
v_exp_f32 v195, v195
v_mfma_f32_16x16x32_bf16 v[84:87], a[40:43], v[176:179], v[84:87]
s_waitcnt lgkmcnt(6)
ds_read_b64_tr_b16 a[60:61], v247 offset:768
v_mfma_f32_16x16x32_bf16 v[148:151], a[40:43], v[180:183], v[148:151]
s_waitcnt vmcnt(5)
buffer_load_dwordx4 a[252:255], v249, s[12:15], s46 offen offset:3072 nt
v_mfma_f32_16x16x32_bf16 v[28:31], a[44:47], v[172:175], v[28:31]
v_exp_f32 v196, v196
v_mfma_f32_16x16x32_bf16 v[92:95], a[44:47], v[176:179], v[92:95]
ds_write_b128 v250, v[220:223] offset:37888
v_mfma_f32_16x16x32_bf16 v[156:159], a[44:47], v[180:183], v[156:159]
v_cvt_pk_bf16_f32 v187, v194, v195
s_waitcnt lgkmcnt(3)
v_mfma_f32_16x16x32_bf16 v[36:39], a[48:51], v[172:175], v[36:39]
ds_read_b64_tr_b16 a[62:63], v247 offset:2816
v_mfma_f32_16x16x32_bf16 v[100:103], a[48:51], v[176:179], v[100:103]
v_exp_f32 v197, v197
v_mfma_f32_16x16x32_bf16 a[144:147], a[48:51], v[180:183], a[144:147]
v_add_u32 v251, 0x8000, v251
ds_write_b128 v251, v[184:187] offset:38912
v_mfma_f32_16x16x32_bf16 v[44:47], a[52:55], v[172:175], v[44:47]
v_exp_f32 v198, v198
v_mfma_f32_16x16x32_bf16 v[108:111], a[52:55], v[176:179], v[108:111]
v_cvt_pk_bf16_f32 v190, v196, v197
v_mfma_f32_16x16x32_bf16 a[148:151], a[52:55], v[180:183], a[148:151]
s_waitcnt lgkmcnt(2)
v_mfma_f32_16x16x32_bf16 v[52:55], a[56:59], v[172:175], v[52:55]
s_mov_b32 s45, 163840
v_mfma_f32_16x16x32_bf16 v[116:119], a[56:59], v[176:179], v[116:119]
s_waitcnt vmcnt(5)
buffer_load_dwordx4 v[220:223], v248, s[8:11], s45 offen offset:0 nt
v_mfma_f32_16x16x32_bf16 a[152:155], a[56:59], v[180:183], a[152:155]
v_exp_f32 v199, v199
s_waitcnt lgkmcnt(1)
v_mfma_f32_16x16x32_bf16 v[60:63], a[60:63], v[172:175], v[60:63]
v_cvt_pk_bf16_f32 v191, v198, v199
ds_write_b128 v251, v[188:191] offset:39936
v_mfma_f32_16x16x32_bf16 v[124:127], a[60:63], v[176:179], v[124:127]
v_mfma_f32_16x16x32_bf16 a[156:159], a[60:63], v[180:183], a[156:159]
v_mfma_f32_16x16x32_bf16 a[236:239], a[244:247], v[184:187], a[236:239]
v_mfma_f32_16x16x32_bf16 a[240:243], a[244:247], v[188:191], a[240:243]
v_mfma_f32_16x16x32_bf16 a[160:163], a[0:3], v[184:187], a[160:163]
v_mfma_f32_16x16x32_bf16 a[192:195], a[0:3], v[188:191], a[192:195]
s_waitcnt lgkmcnt(0)
s_barrier
v_add_u32 v244, 0xfffe8000, v244
ds_read_b128 a[0:3], v244 offset:0
v_mfma_f32_16x16x32_bf16 a[164:167], a[4:7], v[184:187], a[164:167]
v_add_u32 v250, 0x8000, v250
ds_read_b128 v[192:195], v250 offset:38912
v_mfma_f32_16x16x32_bf16 a[196:199], a[4:7], v[188:191], a[196:199]
ds_read_b128 v[196:199], v250 offset:39936
s_add_u32 m0, s29, 0
v_mfma_f32_16x16x32_bf16 a[168:171], a[8:11], v[184:187], a[168:171]
s_waitcnt vmcnt(5)
buffer_load_dwordx4 v249, s[8:11], s45 offen offset:1024 nt lds
v_mfma_f32_16x16x32_bf16 a[200:203], a[8:11], v[188:191], a[200:203]
ds_read_b128 a[4:7], v244 offset:256
ds_read_b128 a[8:11], v244 offset:512
v_mfma_f32_16x16x32_bf16 a[172:175], a[12:15], v[184:187], a[172:175]
v_mfma_f32_16x16x32_bf16 a[204:207], a[12:15], v[188:191], a[204:207]
ds_read_b128 a[12:15], v244 offset:768
v_mfma_f32_16x16x32_bf16 a[176:179], a[16:19], v[184:187], a[176:179]
v_mfma_f32_16x16x32_bf16 a[208:211], a[16:19], v[188:191], a[208:211]
v_add_u32 v245, 0xfffe8000, v245
ds_read_b128 a[16:19], v245 offset:0
v_mfma_f32_16x16x32_bf16 a[180:183], a[20:23], v[184:187], a[180:183]
v_mfma_f32_16x16x32_bf16 a[212:215], a[20:23], v[188:191], a[212:215]
ds_read_b128 a[20:23], v245 offset:256
v_mfma_f32_16x16x32_bf16 a[184:187], a[24:27], v[184:187], a[184:187]
v_mfma_f32_16x16x32_bf16 a[216:219], a[24:27], v[188:191], a[216:219]
ds_read_b128 a[24:27], v245 offset:512
v_mfma_f32_16x16x32_bf16 a[188:191], a[28:31], v[184:187], a[188:191]
v_mfma_f32_16x16x32_bf16 a[220:223], a[28:31], v[188:191], a[220:223]
s_waitcnt vmcnt(5)
buffer_load_dwordx4 v248, s[8:11], s45 offen offset:2048 nt lds
s_waitcnt lgkmcnt(7)
v_mfma_f32_16x16x32_bf16 a[160:163], a[32:35], v[192:195], a[160:163]
ds_read_b128 a[28:31], v245 offset:768
s_waitcnt lgkmcnt(7)
v_mfma_f32_16x16x32_bf16 a[192:195], a[32:35], v[196:199], a[192:195]
ds_read_b128 a[32:35], v244 offset:2048
v_mfma_f32_16x16x32_bf16 a[164:167], a[36:39], v[192:195], a[164:167]
v_mfma_f32_16x16x32_bf16 a[196:199], a[36:39], v[196:199], a[196:199]
ds_read_b128 a[36:39], v244 offset:2304
v_mfma_f32_16x16x32_bf16 a[168:171], a[40:43], v[192:195], a[168:171]
v_mfma_f32_16x16x32_bf16 a[200:203], a[40:43], v[196:199], a[200:203]
v_mfma_f32_16x16x32_bf16 a[172:175], a[44:47], v[192:195], a[172:175]
v_mfma_f32_16x16x32_bf16 a[204:207], a[44:47], v[196:199], a[204:207]
v_mfma_f32_16x16x32_bf16 a[176:179], a[48:51], v[192:195], a[176:179]
v_mfma_f32_16x16x32_bf16 a[208:211], a[48:51], v[196:199], a[208:211]
v_mfma_f32_16x16x32_bf16 a[180:183], a[52:55], v[192:195], a[180:183]
s_waitcnt vmcnt(5)
buffer_load_dwordx4 v249, s[8:11], s45 offen offset:3072 nt lds
v_mfma_f32_16x16x32_bf16 a[212:215], a[52:55], v[196:199], a[212:215]
v_mfma_f32_16x16x32_bf16 a[184:187], a[56:59], v[192:195], a[184:187]
v_mfma_f32_16x16x32_bf16 a[216:219], a[56:59], v[196:199], a[216:219]
v_mfma_f32_16x16x32_bf16 a[188:191], a[60:63], v[192:195], a[188:191]
v_mfma_f32_16x16x32_bf16 a[220:223], a[60:63], v[196:199], a[220:223]
ds_read_b128 a[40:43], v244 offset:2560
v_mfma_f32_16x16x32_bf16 v[160:163], a[0:3], v[0:3], v[200:203]
ds_read_b128 a[44:47], v244 offset:2816
s_waitcnt lgkmcnt(10)
v_mfma_f32_16x16x32_bf16 v[160:163], a[4:7], v[8:11], v[160:163]
ds_read_b128 a[48:51], v245 offset:2048
s_waitcnt lgkmcnt(10)
v_mfma_f32_16x16x32_bf16 v[160:163], a[8:11], v[16:19], v[160:163]
ds_read_b128 a[52:55], v245 offset:2304
s_waitcnt lgkmcnt(10)
v_mfma_f32_16x16x32_bf16 v[160:163], a[12:15], v[24:27], v[160:163]
ds_read_b128 a[56:59], v245 offset:2560
s_waitcnt lgkmcnt(10)
v_mfma_f32_16x16x32_bf16 v[160:163], a[16:19], a[64:67], v[160:163]
ds_read_b128 a[60:63], v245 offset:2816
s_waitcnt lgkmcnt(10)
v_mfma_f32_16x16x32_bf16 v[160:163], a[20:23], a[84:87], v[160:163]
s_mov_b32 s45, 167936
s_add_u32 m0, s29, 4096
s_waitcnt lgkmcnt(9)
v_mfma_f32_16x16x32_bf16 v[160:163], a[24:27], a[104:107], v[160:163]
s_waitcnt vmcnt(5)
buffer_load_dwordx4 v248, s[8:11], s45 offen offset:0 nt lds
s_waitcnt lgkmcnt(8)
v_mfma_f32_16x16x32_bf16 v[160:163], a[28:31], a[124:127], v[160:163]
v_mfma_f32_16x16x32_bf16 v[164:167], a[0:3], v[32:35], v[204:207]
ds_write_b128 v250, v[224:227] offset:6144
v_mfma_f32_16x16x32_bf16 v[164:167], a[4:7], v[40:43], v[164:167]
v_mfma_f32_16x16x32_bf16 v[164:167], a[8:11], v[48:51], v[164:167]
v_mfma_f32_16x16x32_bf16 v[164:167], a[12:15], v[56:59], v[164:167]
v_mfma_f32_16x16x32_bf16 v[164:167], a[16:19], a[68:71], v[164:167]
v_mfma_f32_16x16x32_bf16 v[164:167], a[20:23], a[88:91], v[164:167]
v_mfma_f32_16x16x32_bf16 v[164:167], a[24:27], a[108:111], v[164:167]
v_mfma_f32_16x16x32_bf16 v[164:167], a[28:31], a[128:131], v[164:167]
v_mfma_f32_16x16x32_bf16 v[168:171], a[0:3], v[64:67], v[208:211]
s_waitcnt lgkmcnt(0)
v_mfma_f32_16x16x32_bf16 v[168:171], a[4:7], v[72:75], v[168:171]
s_waitcnt vmcnt(5)
buffer_load_dwordx4 v[224:227], v249, s[8:11], s45 offen offset:1024 nt
v_mfma_f32_16x16x32_bf16 v[168:171], a[8:11], v[80:83], v[168:171]
v_mfma_f32_16x16x32_bf16 v[168:171], a[12:15], v[88:91], v[168:171]
ds_write_b128 v250, v[228:231] offset:7168
v_mfma_f32_16x16x32_bf16 v[168:171], a[16:19], a[72:75], v[168:171]
v_mfma_f32_16x16x32_bf16 v[168:171], a[20:23], a[92:95], v[168:171]
v_mfma_f32_16x16x32_bf16 v[168:171], a[24:27], a[112:115], v[168:171]
v_mfma_f32_16x16x32_bf16 v[168:171], a[28:31], a[132:135], v[168:171]
v_mfma_f32_16x16x32_bf16 v[172:175], a[32:35], v[0:3], v[200:203]
v_mfma_f32_16x16x32_bf16 v[172:175], a[36:39], v[8:11], v[172:175]
v_exp_f32 v160, v160
v_mfma_f32_16x16x32_bf16 v[172:175], a[40:43], v[16:19], v[172:175]
v_exp_f32 v161, v161
v_mfma_f32_16x16x32_bf16 v[172:175], a[44:47], v[24:27], v[172:175]
s_waitcnt lgkmcnt(0)
v_mfma_f32_16x16x32_bf16 v[172:175], a[48:51], a[64:67], v[172:175]
s_waitcnt vmcnt(5)
buffer_load_dwordx4 v[228:231], v248, s[8:11], s45 offen offset:2048 nt
v_exp_f32 v162, v162
v_mfma_f32_16x16x32_bf16 v[172:175], a[52:55], a[84:87], v[172:175]
v_cvt_pk_bf16_f32 v160, v160, v161
v_mfma_f32_16x16x32_bf16 v[172:175], a[56:59], a[104:107], v[172:175]
ds_write_b128 v250, v[232:235] offset:32768
v_exp_f32 v163, v163
v_mfma_f32_16x16x32_bf16 v[172:175], a[60:63], a[124:127], v[172:175]
v_exp_f32 v164, v164
v_mfma_f32_16x16x32_bf16 v[176:179], a[32:35], v[32:35], v[204:207]
v_cvt_pk_bf16_f32 v161, v162, v163
v_mfma_f32_16x16x32_bf16 v[176:179], a[36:39], v[40:43], v[176:179]
v_exp_f32 v165, v165
v_mfma_f32_16x16x32_bf16 v[176:179], a[40:43], v[48:51], v[176:179]
v_exp_f32 v166, v166
v_mfma_f32_16x16x32_bf16 v[176:179], a[44:47], v[56:59], v[176:179]
v_cvt_pk_bf16_f32 v164, v164, v165
v_mfma_f32_16x16x32_bf16 v[176:179], a[48:51], a[68:71], v[176:179]
v_exp_f32 v167, v167
v_mfma_f32_16x16x32_bf16 v[176:179], a[52:55], a[88:91], v[176:179]
v_exp_f32 v168, v168
v_mfma_f32_16x16x32_bf16 v[176:179], a[56:59], a[108:111], v[176:179]
s_waitcnt lgkmcnt(0)
v_cvt_pk_bf16_f32 v165, v166, v167
v_mfma_f32_16x16x32_bf16 v[176:179], a[60:63], a[128:131], v[176:179]
s_waitcnt vmcnt(5)
buffer_load_dwordx4 v[232:235], v249, s[8:11], s45 offen offset:3072 nt
v_mfma_f32_16x16x32_bf16 v[180:183], a[32:35], v[64:67], v[208:211]
v_exp_f32 v169, v169
v_mfma_f32_16x16x32_bf16 v[180:183], a[36:39], v[72:75], v[180:183]
ds_write_b128 v250, v[236:239] offset:33792
v_mfma_f32_16x16x32_bf16 v[180:183], a[40:43], v[80:83], v[180:183]
v_exp_f32 v170, v170
v_cvt_pk_bf16_f32 v168, v168, v169
v_mfma_f32_16x16x32_bf16 v[180:183], a[44:47], v[88:91], v[180:183]
v_exp_f32 v171, v171
v_mfma_f32_16x16x32_bf16 v[180:183], a[48:51], a[72:75], v[180:183]
v_cvt_pk_bf16_f32 v169, v170, v171
v_mfma_f32_16x16x32_bf16 v[180:183], a[52:55], a[92:95], v[180:183]
v_mfma_f32_16x16x32_bf16 v[180:183], a[56:59], a[112:115], v[180:183]
v_mfma_f32_16x16x32_bf16 v[180:183], a[60:63], a[132:135], v[180:183]
v_mfma_f32_16x16x32_bf16 v[184:187], a[0:3], v[96:99], v[212:215]
v_mfma_f32_16x16x32_bf16 v[184:187], a[4:7], v[104:107], v[184:187]
s_mov_b32 s46, 163840
s_waitcnt lgkmcnt(0)
v_exp_f32 v172, v172
v_exp_f32 v173, v173
v_exp_f32 v174, v174
v_cvt_pk_bf16_f32 v162, v172, v173
v_mfma_f32_16x16x32_bf16 v[184:187], a[8:11], v[112:115], v[184:187]
s_waitcnt vmcnt(5)
buffer_load_dwordx4 v[236:239], v248, s[12:15], s46 offen offset:0 nt
v_exp_f32 v175, v175
v_mfma_f32_16x16x32_bf16 v[184:187], a[12:15], v[120:123], v[184:187]
v_exp_f32 v176, v176
v_mfma_f32_16x16x32_bf16 v[184:187], a[16:19], a[76:79], v[184:187]
ds_write_b128 v250, v[240:243] offset:34816
v_cvt_pk_bf16_f32 v163, v174, v175
v_mfma_f32_16x16x32_bf16 v[184:187], a[20:23], a[96:99], v[184:187]
v_exp_f32 v177, v177
v_mfma_f32_16x16x32_bf16 v[184:187], a[24:27], a[116:119], v[184:187]
v_add_u32 v251, 0xfffe8000, v251
ds_write_b128 v251, v[160:163] offset:5120
v_mfma_f32_16x16x32_bf16 v[184:187], a[28:31], a[136:139], v[184:187]
v_exp_f32 v178, v178
v_mfma_f32_16x16x32_bf16 v[188:191], a[0:3], v[128:131], v[216:219]
v_cvt_pk_bf16_f32 v166, v176, v177
v_mfma_f32_16x16x32_bf16 v[188:191], a[4:7], v[136:139], v[188:191]
v_exp_f32 v179, v179
v_mfma_f32_16x16x32_bf16 v[188:191], a[8:11], v[144:147], v[188:191]
v_exp_f32 v180, v180
v_mfma_f32_16x16x32_bf16 v[188:191], a[12:15], v[152:155], v[188:191]
v_cvt_pk_bf16_f32 v167, v178, v179
v_mfma_f32_16x16x32_bf16 v[188:191], a[16:19], a[80:83], v[188:191]
s_waitcnt lgkmcnt(1)
v_mfma_f32_16x16x32_bf16 v[188:191], a[20:23], a[100:103], v[188:191]
s_waitcnt vmcnt(5)
buffer_load_dwordx4 v[240:243], v249, s[12:15], s46 offen offset:1024 nt
v_exp_f32 v181, v181
v_mfma_f32_16x16x32_bf16 v[188:191], a[24:27], a[120:123], v[188:191]
ds_write_b128 v251, v[164:167] offset:6144
v_mfma_f32_16x16x32_bf16 v[188:191], a[28:31], a[140:143], v[188:191]
v_exp_f32 v182, v182
v_mfma_f32_16x16x32_bf16 v[192:195], a[32:35], v[96:99], v[212:215]
v_cvt_pk_bf16_f32 v170, v180, v181
v_mfma_f32_16x16x32_bf16 v[192:195], a[36:39], v[104:107], v[192:195]
v_exp_f32 v183, v183
v_mfma_f32_16x16x32_bf16 v[192:195], a[40:43], v[112:115], v[192:195]
v_cvt_pk_bf16_f32 v171, v182, v183
ds_write_b128 v251, v[168:171] offset:7168
v_mfma_f32_16x16x32_bf16 v[192:195], a[44:47], v[120:123], v[192:195]
v_mfma_f32_16x16x32_bf16 v[192:195], a[48:51], a[76:79], v[192:195]
s_waitcnt lgkmcnt(0)
s_barrier
v_add_u32 v246, s34, v246
ds_read_b64_tr_b16 a[0:1], v246 offset:0
v_mfma_f32_16x16x32_bf16 v[192:195], a[52:55], a[96:99], v[192:195]
ds_read_b64_tr_b16 a[2:3], v246 offset:2048
v_mfma_f32_16x16x32_bf16 v[192:195], a[56:59], a[116:119], v[192:195]
v_add_u32 v247, s34, v247
ds_read_b64_tr_b16 a[4:5], v247 offset:0
v_mfma_f32_16x16x32_bf16 v[192:195], a[60:63], a[136:139], v[192:195]
s_add_u32 m0, s29, 32768
ds_read_b64_tr_b16 a[6:7], v247 offset:2048
v_mfma_f32_16x16x32_bf16 v[196:199], a[32:35], v[128:131], v[216:219]
s_waitcnt vmcnt(5)
buffer_load_dwordx4 v248, s[12:15], s46 offen offset:2048 nt lds
v_mfma_f32_16x16x32_bf16 v[196:199], a[36:39], v[136:139], v[196:199]
ds_read_b64_tr_b16 a[8:9], v246 offset:256
ds_read_b64_tr_b16 a[10:11], v246 offset:2304
v_mfma_f32_16x16x32_bf16 v[196:199], a[40:43], v[144:147], v[196:199]
ds_read_b64_tr_b16 a[12:13], v247 offset:256
ds_read_b64_tr_b16 a[14:15], v247 offset:2304
v_mfma_f32_16x16x32_bf16 v[196:199], a[44:47], v[152:155], v[196:199]
ds_read_b64_tr_b16 a[16:17], v246 offset:512
ds_read_b64_tr_b16 a[18:19], v246 offset:2560
v_mfma_f32_16x16x32_bf16 v[196:199], a[48:51], a[80:83], v[196:199]
ds_read_b64_tr_b16 a[20:21], v247 offset:512
ds_read_b64_tr_b16 a[22:23], v247 offset:2560
v_mfma_f32_16x16x32_bf16 v[196:199], a[52:55], a[100:103], v[196:199]
v_mfma_f32_16x16x32_bf16 v[196:199], a[56:59], a[120:123], v[196:199]
v_mfma_f32_16x16x32_bf16 v[196:199], a[60:63], a[140:143], v[196:199]
v_exp_f32 v184, v184
v_mfma_f32_16x16x32_bf16 a[224:227], a[244:247], v[160:163], a[224:227]
v_exp_f32 v185, v185
v_mfma_f32_16x16x32_bf16 a[228:231], a[244:247], v[164:167], a[228:231]
v_exp_f32 v186, v186
v_mfma_f32_16x16x32_bf16 a[232:235], a[244:247], v[168:171], a[232:235]
v_add_u32 v250, 0xfffe8000, v250
ds_read_b128 v[172:175], v250 offset:5120
s_waitcnt lgkmcnt(5)
v_mfma_f32_16x16x32_bf16 v[4:7], a[0:3], v[160:163], v[4:7]
s_waitcnt vmcnt(5)
buffer_load_dwordx4 v249, s[12:15], s46 offen offset:3072 nt lds
v_mfma_f32_16x16x32_bf16 v[68:71], a[0:3], v[164:167], v[68:71]
ds_read_b128 v[176:179], v250 offset:6144
v_cvt_pk_bf16_f32 v184, v184, v185
v_mfma_f32_16x16x32_bf16 v[132:135], a[0:3], v[168:171], v[132:135]
v_exp_f32 v187, v187
v_mfma_f32_16x16x32_bf16 v[12:15], a[4:7], v[160:163], v[12:15]
ds_read_b128 v[180:183], v250 offset:7168
ds_read_b64_tr_b16 a[24:25], v246 offset:768
v_mfma_f32_16x16x32_bf16 v[76:79], a[4:7], v[164:167], v[76:79]
ds_read_b64_tr_b16 a[26:27], v246 offset:2816
ds_read_b64_tr_b16 a[28:29], v247 offset:768
v_mfma_f32_16x16x32_bf16 v[140:143], a[4:7], v[168:171], v[140:143]
v_exp_f32 v188, v188
v_mfma_f32_16x16x32_bf16 v[20:23], a[8:11], v[160:163], v[20:23]
v_cvt_pk_bf16_f32 v185, v186, v187
ds_read_b64_tr_b16 a[30:31], v247 offset:2816
v_mfma_f32_16x16x32_bf16 v[84:87], a[8:11], v[164:167], v[84:87]
v_exp_f32 v189, v189
v_mfma_f32_16x16x32_bf16 v[148:151], a[8:11], v[168:171], v[148:151]
v_add_u32 v246, s33, v246
ds_read_b64_tr_b16 a[32:33], v246 offset:0
v_mfma_f32_16x16x32_bf16 v[28:31], a[12:15], v[160:163], v[28:31]
ds_read_b64_tr_b16 a[34:35], v246 offset:2048
v_mfma_f32_16x16x32_bf16 v[92:95], a[12:15], v[164:167], v[92:95]
v_exp_f32 v190, v190
v_mfma_f32_16x16x32_bf16 v[156:159], a[12:15], v[168:171], v[156:159]
s_mov_b32 s46, 167936
s_add_u32 m0, s29, 36864
s_waitcnt lgkmcnt(3)
v_mfma_f32_16x16x32_bf16 v[36:39], a[16:19], v[160:163], v[36:39]
s_waitcnt vmcnt(5)
buffer_load_dwordx4 v248, s[12:15], s46 offen offset:0 nt lds
v_mfma_f32_16x16x32_bf16 v[100:103], a[16:19], v[164:167], v[100:103]
v_cvt_pk_bf16_f32 v188, v188, v189
v_mfma_f32_16x16x32_bf16 a[144:147], a[16:19], v[168:171], a[144:147]
v_add_u32 v247, s33, v247
ds_read_b64_tr_b16 a[36:37], v247 offset:0
v_mfma_f32_16x16x32_bf16 v[44:47], a[20:23], v[160:163], v[44:47]
ds_read_b64_tr_b16 a[38:39], v247 offset:2048
ds_read_b64_tr_b16 a[40:41], v246 offset:256
v_mfma_f32_16x16x32_bf16 v[108:111], a[20:23], v[164:167], v[108:111]
v_exp_f32 v191, v191
v_mfma_f32_16x16x32_bf16 a[148:151], a[20:23], v[168:171], a[148:151]
v_cvt_pk_bf16_f32 v189, v190, v191
ds_read_b64_tr_b16 a[42:43], v246 offset:2304
v_mfma_f32_16x16x32_bf16 v[52:55], a[24:27], v[160:163], v[52:55]
v_exp_f32 v192, v192
v_mfma_f32_16x16x32_bf16 v[116:119], a[24:27], v[164:167], v[116:119]
ds_read_b64_tr_b16 a[44:45], v247 offset:256
ds_read_b64_tr_b16 a[46:47], v247 offset:2304
v_mfma_f32_16x16x32_bf16 a[152:155], a[24:27], v[168:171], a[152:155]
ds_read_b64_tr_b16 a[48:49], v246 offset:512
s_waitcnt lgkmcnt(7)
v_mfma_f32_16x16x32_bf16 v[60:63], a[28:31], v[160:163], v[60:63]
v_exp_f32 v193, v193
v_mfma_f32_16x16x32_bf16 v[124:127], a[28:31], v[164:167], v[124:127]
v_exp_f32 v194, v194
v_mfma_f32_16x16x32_bf16 a[156:159], a[28:31], v[168:171], a[156:159]
s_waitcnt vmcnt(5)
buffer_load_dwordx4 v249, s[12:15], s46 offen offset:1024 nt lds
v_mfma_f32_16x16x32_bf16 v[4:7], a[32:35], v[172:175], v[4:7]
ds_read_b64_tr_b16 a[50:51], v246 offset:2560
v_cvt_pk_bf16_f32 v186, v192, v193
v_mfma_f32_16x16x32_bf16 v[68:71], a[32:35], v[176:179], v[68:71]
v_add_u32 v250, 0x18000, v250
ds_write_b128 v250, a[248:251] offset:38912
v_mfma_f32_16x16x32_bf16 v[132:135], a[32:35], v[180:183], v[132:135]
ds_read_b64_tr_b16 a[52:53], v247 offset:512
s_waitcnt lgkmcnt(4)
v_mfma_f32_16x16x32_bf16 v[12:15], a[36:39], v[172:175], v[12:15]
ds_read_b64_tr_b16 a[54:55], v247 offset:2560
ds_read_b64_tr_b16 a[56:57], v246 offset:768
v_mfma_f32_16x16x32_bf16 v[76:79], a[36:39], v[176:179], v[76:79]
v_exp_f32 v195, v195
v_mfma_f32_16x16x32_bf16 v[140:143], a[36:39], v[180:183], v[140:143]
v_exp_f32 v196, v196
v_mfma_f32_16x16x32_bf16 v[20:23], a[40:43], v[172:175], v[20:23]
ds_read_b64_tr_b16 a[58:59], v246 offset:2816
v_cvt_pk_bf16_f32 v187, v194, v195
v_mfma_f32_16x16x32_bf16 v[84:87], a[40:43], v[176:179], v[84:87]
ds_read_b64_tr_b16 a[60:61], v247 offset:768
ds_read_b64_tr_b16 a[62:63], v247 offset:2816
v_mfma_f32_16x16x32_bf16 v[148:151], a[40:43], v[180:183], v[148:151]
v_exp_f32 v197, v197
v_mfma_f32_16x16x32_bf16 v[28:31], a[44:47], v[172:175], v[28:31]
s_waitcnt lgkmcnt(6)
ds_write_b128 v251, v[184:187] offset:38912
v_mfma_f32_16x16x32_bf16 v[92:95], a[44:47], v[176:179], v[92:95]
s_waitcnt vmcnt(5)
buffer_load_dwordx4 a[248:251], v248, s[12:15], s46 offen offset:2048 nt
v_mfma_f32_16x16x32_bf16 v[156:159], a[44:47], v[180:183], v[156:159]
s_waitcnt lgkmcnt(4)
v_mfma_f32_16x16x32_bf16 v[36:39], a[48:51], v[172:175], v[36:39]
ds_write_b128 v250, a[252:255] offset:39936
v_mfma_f32_16x16x32_bf16 v[100:103], a[48:51], v[176:179], v[100:103]
v_exp_f32 v198, v198
v_mfma_f32_16x16x32_bf16 a[144:147], a[48:51], v[180:183], a[144:147]
v_cvt_pk_bf16_f32 v190, v196, v197
v_mfma_f32_16x16x32_bf16 v[44:47], a[52:55], v[172:175], v[44:47]
v_exp_f32 v199, v199
v_mfma_f32_16x16x32_bf16 v[108:111], a[52:55], v[176:179], v[108:111]
v_cvt_pk_bf16_f32 v191, v198, v199
ds_write_b128 v251, v[188:191] offset:39936
v_mfma_f32_16x16x32_bf16 a[148:151], a[52:55], v[180:183], a[148:151]
s_waitcnt lgkmcnt(2)
v_mfma_f32_16x16x32_bf16 v[52:55], a[56:59], v[172:175], v[52:55]
v_mfma_f32_16x16x32_bf16 v[116:119], a[56:59], v[176:179], v[116:119]
v_mfma_f32_16x16x32_bf16 a[152:155], a[56:59], v[180:183], a[152:155]
s_waitcnt lgkmcnt(1)
v_mfma_f32_16x16x32_bf16 v[60:63], a[60:63], v[172:175], v[60:63]
s_waitcnt vmcnt(5)
buffer_load_dwordx4 a[252:255], v249, s[12:15], s46 offen offset:3072 nt
v_mfma_f32_16x16x32_bf16 v[124:127], a[60:63], v[176:179], v[124:127]
v_mfma_f32_16x16x32_bf16 a[156:159], a[60:63], v[180:183], a[156:159]
v_mfma_f32_16x16x32_bf16 a[236:239], a[244:247], v[184:187], a[236:239]
v_mfma_f32_16x16x32_bf16 a[240:243], a[244:247], v[188:191], a[240:243]
v_mfma_f32_16x16x32_bf16 a[160:163], a[0:3], v[184:187], a[160:163]
v_mfma_f32_16x16x32_bf16 a[192:195], a[0:3], v[188:191], a[192:195]
s_waitcnt lgkmcnt(0)
s_barrier
v_add_u32 v244, 0x10000, v244
ds_read_b128 a[0:3], v244 offset:0
v_mfma_f32_16x16x32_bf16 a[164:167], a[4:7], v[184:187], a[164:167]
v_add_u32 v250, 0xffff0000, v250
ds_read_b128 v[192:195], v250 offset:6144
v_mfma_f32_16x16x32_bf16 a[196:199], a[4:7], v[188:191], a[196:199]
ds_read_b128 v[196:199], v250 offset:7168
ds_read_b128 a[4:7], v244 offset:256
v_mfma_f32_16x16x32_bf16 a[168:171], a[8:11], v[184:187], a[168:171]
v_mfma_f32_16x16x32_bf16 a[200:203], a[8:11], v[188:191], a[200:203]
s_mov_b32 s45, 196608
s_add_u32 m0, s29, 65536
v_mfma_f32_16x16x32_bf16 a[172:175], a[12:15], v[184:187], a[172:175]
s_waitcnt vmcnt(5)
buffer_load_dwordx4 v248, s[8:11], s45 offen offset:0 nt lds
v_mfma_f32_16x16x32_bf16 a[204:207], a[12:15], v[188:191], a[204:207]
ds_read_b128 a[8:11], v244 offset:512
ds_read_b128 a[12:15], v244 offset:768
v_mfma_f32_16x16x32_bf16 a[176:179], a[16:19], v[184:187], a[176:179]
v_mfma_f32_16x16x32_bf16 a[208:211], a[16:19], v[188:191], a[208:211]
v_add_u32 v245, 0x10000, v245
ds_read_b128 a[16:19], v245 offset:0
v_mfma_f32_16x16x32_bf16 a[180:183], a[20:23], v[184:187], a[180:183]
v_mfma_f32_16x16x32_bf16 a[212:215], a[20:23], v[188:191], a[212:215]
ds_read_b128 a[20:23], v245 offset:256
v_mfma_f32_16x16x32_bf16 a[184:187], a[24:27], v[184:187], a[184:187]
v_mfma_f32_16x16x32_bf16 a[216:219], a[24:27], v[188:191], a[216:219]
ds_read_b128 a[24:27], v245 offset:512
v_mfma_f32_16x16x32_bf16 a[188:191], a[28:31], v[184:187], a[188:191]
v_mfma_f32_16x16x32_bf16 a[220:223], a[28:31], v[188:191], a[220:223]
ds_read_b128 a[28:31], v245 offset:768
s_waitcnt lgkmcnt(8)
v_mfma_f32_16x16x32_bf16 a[160:163], a[32:35], v[192:195], a[160:163]
s_waitcnt lgkmcnt(7)
v_mfma_f32_16x16x32_bf16 a[192:195], a[32:35], v[196:199], a[192:195]
s_waitcnt vmcnt(5)
buffer_load_dwordx4 v249, s[8:11], s45 offen offset:1024 nt lds
v_mfma_f32_16x16x32_bf16 a[164:167], a[36:39], v[192:195], a[164:167]
ds_read_b128 a[32:35], v244 offset:2048
v_mfma_f32_16x16x32_bf16 a[196:199], a[36:39], v[196:199], a[196:199]
ds_read_b128 a[36:39], v244 offset:2304
v_mfma_f32_16x16x32_bf16 a[168:171], a[40:43], v[192:195], a[168:171]
v_mfma_f32_16x16x32_bf16 a[200:203], a[40:43], v[196:199], a[200:203]
v_mfma_f32_16x16x32_bf16 a[172:175], a[44:47], v[192:195], a[172:175]
v_mfma_f32_16x16x32_bf16 a[204:207], a[44:47], v[196:199], a[204:207]
v_mfma_f32_16x16x32_bf16 a[176:179], a[48:51], v[192:195], a[176:179]
v_mfma_f32_16x16x32_bf16 a[208:211], a[48:51], v[196:199], a[208:211]
v_mfma_f32_16x16x32_bf16 a[180:183], a[52:55], v[192:195], a[180:183]
v_mfma_f32_16x16x32_bf16 a[212:215], a[52:55], v[196:199], a[212:215]
v_mfma_f32_16x16x32_bf16 a[184:187], a[56:59], v[192:195], a[184:187]
s_waitcnt vmcnt(5)
buffer_load_dwordx4 v248, s[8:11], s45 offen offset:2048 nt lds
v_mfma_f32_16x16x32_bf16 a[216:219], a[56:59], v[196:199], a[216:219]
v_mfma_f32_16x16x32_bf16 a[188:191], a[60:63], v[192:195], a[188:191]
v_mfma_f32_16x16x32_bf16 a[220:223], a[60:63], v[196:199], a[220:223]
ds_read_b128 a[40:43], v244 offset:2560
v_mfma_f32_16x16x32_bf16 v[160:163], a[0:3], v[0:3], v[200:203]
ds_read_b128 a[44:47], v244 offset:2816
s_waitcnt lgkmcnt(10)
v_mfma_f32_16x16x32_bf16 v[160:163], a[4:7], v[8:11], v[160:163]
ds_read_b128 a[48:51], v245 offset:2048
s_waitcnt lgkmcnt(10)
v_mfma_f32_16x16x32_bf16 v[160:163], a[8:11], v[16:19], v[160:163]
ds_read_b128 a[52:55], v245 offset:2304
s_waitcnt lgkmcnt(10)
v_mfma_f32_16x16x32_bf16 v[160:163], a[12:15], v[24:27], v[160:163]
ds_read_b128 a[56:59], v245 offset:2560
s_waitcnt lgkmcnt(10)
v_mfma_f32_16x16x32_bf16 v[160:163], a[16:19], a[64:67], v[160:163]
ds_read_b128 a[60:63], v245 offset:2816
s_waitcnt lgkmcnt(10)
v_mfma_f32_16x16x32_bf16 v[160:163], a[20:23], a[84:87], v[160:163]
s_waitcnt lgkmcnt(9)
v_mfma_f32_16x16x32_bf16 v[160:163], a[24:27], a[104:107], v[160:163]
s_waitcnt lgkmcnt(8)
v_mfma_f32_16x16x32_bf16 v[160:163], a[28:31], a[124:127], v[160:163]
v_mfma_f32_16x16x32_bf16 v[164:167], a[0:3], v[32:35], v[204:207]
s_waitcnt vmcnt(5)
buffer_load_dwordx4 v249, s[8:11], s45 offen offset:3072 nt lds
v_mfma_f32_16x16x32_bf16 v[164:167], a[4:7], v[40:43], v[164:167]
v_mfma_f32_16x16x32_bf16 v[164:167], a[8:11], v[48:51], v[164:167]
v_mfma_f32_16x16x32_bf16 v[164:167], a[12:15], v[56:59], v[164:167]
v_mfma_f32_16x16x32_bf16 v[164:167], a[16:19], a[68:71], v[164:167]
v_mfma_f32_16x16x32_bf16 v[164:167], a[20:23], a[88:91], v[164:167]
v_mfma_f32_16x16x32_bf16 v[164:167], a[24:27], a[108:111], v[164:167]
v_mfma_f32_16x16x32_bf16 v[164:167], a[28:31], a[128:131], v[164:167]
v_mfma_f32_16x16x32_bf16 v[168:171], a[0:3], v[64:67], v[208:211]
v_mfma_f32_16x16x32_bf16 v[168:171], a[4:7], v[72:75], v[168:171]
v_mfma_f32_16x16x32_bf16 v[168:171], a[8:11], v[80:83], v[168:171]
s_mov_b32 s45, 200704
s_add_u32 m0, s29, 69632
v_mfma_f32_16x16x32_bf16 v[168:171], a[12:15], v[88:91], v[168:171]
s_waitcnt vmcnt(5)
buffer_load_dwordx4 v248, s[8:11], s45 offen offset:0 nt lds
v_mfma_f32_16x16x32_bf16 v[168:171], a[16:19], a[72:75], v[168:171]
v_mfma_f32_16x16x32_bf16 v[168:171], a[20:23], a[92:95], v[168:171]
v_add_u32 v250, 0xffff8000, v250
ds_write_b128 v250, v[220:223] offset:0
v_mfma_f32_16x16x32_bf16 v[168:171], a[24:27], a[112:115], v[168:171]
v_mfma_f32_16x16x32_bf16 v[168:171], a[28:31], a[132:135], v[168:171]
s_waitcnt lgkmcnt(1)
v_mfma_f32_16x16x32_bf16 v[172:175], a[32:35], v[0:3], v[200:203]
v_mfma_f32_16x16x32_bf16 v[172:175], a[36:39], v[8:11], v[172:175]
v_exp_f32 v160, v160
v_mfma_f32_16x16x32_bf16 v[172:175], a[40:43], v[16:19], v[172:175]
v_exp_f32 v161, v161
v_mfma_f32_16x16x32_bf16 v[172:175], a[44:47], v[24:27], v[172:175]
v_exp_f32 v162, v162
v_mfma_f32_16x16x32_bf16 v[172:175], a[48:51], a[64:67], v[172:175]
v_cvt_pk_bf16_f32 v160, v160, v161
v_mfma_f32_16x16x32_bf16 v[172:175], a[52:55], a[84:87], v[172:175]
s_waitcnt lgkmcnt(0)
v_mfma_f32_16x16x32_bf16 v[172:175], a[56:59], a[104:107], v[172:175]
s_waitcnt vmcnt(5)
buffer_load_dwordx4 v[220:223], v249, s[8:11], s45 offen offset:1024 nt
v_exp_f32 v163, v163
v_mfma_f32_16x16x32_bf16 v[172:175], a[60:63], a[124:127], v[172:175]
v_exp_f32 v164, v164
v_mfma_f32_16x16x32_bf16 v[176:179], a[32:35], v[32:35], v[204:207]
ds_write_b128 v250, v[224:227] offset:5120
v_cvt_pk_bf16_f32 v161, v162, v163
v_mfma_f32_16x16x32_bf16 v[176:179], a[36:39], v[40:43], v[176:179]
v_exp_f32 v165, v165
v_mfma_f32_16x16x32_bf16 v[176:179], a[40:43], v[48:51], v[176:179]
v_exp_f32 v166, v166
v_mfma_f32_16x16x32_bf16 v[176:179], a[44:47], v[56:59], v[176:179]
v_cvt_pk_bf16_f32 v164, v164, v165
v_mfma_f32_16x16x32_bf16 v[176:179], a[48:51], a[68:71], v[176:179]
v_exp_f32 v167, v167
v_mfma_f32_16x16x32_bf16 v[176:179], a[52:55], a[88:91], v[176:179]
v_exp_f32 v168, v168
v_mfma_f32_16x16x32_bf16 v[176:179], a[56:59], a[108:111], v[176:179]
v_cvt_pk_bf16_f32 v165, v166, v167
v_mfma_f32_16x16x32_bf16 v[176:179], a[60:63], a[128:131], v[176:179]
v_exp_f32 v169, v169
v_mfma_f32_16x16x32_bf16 v[180:183], a[32:35], v[64:67], v[208:211]
s_waitcnt lgkmcnt(0)
v_mfma_f32_16x16x32_bf16 v[180:183], a[36:39], v[72:75], v[180:183]
s_waitcnt vmcnt(5)
buffer_load_dwordx4 v[224:227], v248, s[8:11], s45 offen offset:2048 nt
v_mfma_f32_16x16x32_bf16 v[180:183], a[40:43], v[80:83], v[180:183]
v_exp_f32 v170, v170
v_cvt_pk_bf16_f32 v168, v168, v169
v_mfma_f32_16x16x32_bf16 v[180:183], a[44:47], v[88:91], v[180:183]
ds_write_b128 v250, v[228:231] offset:6144
v_mfma_f32_16x16x32_bf16 v[180:183], a[48:51], a[72:75], v[180:183]
v_exp_f32 v171, v171
s_nop 0
v_cvt_pk_bf16_f32 v169, v170, v171
v_mfma_f32_16x16x32_bf16 v[180:183], a[52:55], a[92:95], v[180:183]
v_mfma_f32_16x16x32_bf16 v[180:183], a[56:59], a[112:115], v[180:183]
v_mfma_f32_16x16x32_bf16 v[180:183], a[60:63], a[132:135], v[180:183]
v_mfma_f32_16x16x32_bf16 v[184:187], a[0:3], v[96:99], v[212:215]
v_mfma_f32_16x16x32_bf16 v[184:187], a[4:7], v[104:107], v[184:187]
v_exp_f32 v172, v172
v_exp_f32 v173, v173
v_exp_f32 v174, v174
v_cvt_pk_bf16_f32 v162, v172, v173
v_mfma_f32_16x16x32_bf16 v[184:187], a[8:11], v[112:115], v[184:187]
v_exp_f32 v175, v175
v_mfma_f32_16x16x32_bf16 v[184:187], a[12:15], v[120:123], v[184:187]
s_waitcnt lgkmcnt(0)
v_mfma_f32_16x16x32_bf16 v[184:187], a[16:19], a[76:79], v[184:187]
s_waitcnt vmcnt(5)
buffer_load_dwordx4 v[228:231], v249, s[8:11], s45 offen offset:3072 nt
v_exp_f32 v176, v176
v_cvt_pk_bf16_f32 v163, v174, v175
v_mfma_f32_16x16x32_bf16 v[184:187], a[20:23], a[96:99], v[184:187]
v_exp_f32 v177, v177
v_mfma_f32_16x16x32_bf16 v[184:187], a[24:27], a[116:119], v[184:187]
ds_write_b128 v250, v[232:235] offset:7168
v_add_u32 v251, 0x10000, v251
ds_write_b128 v251, v[160:163] offset:5120
v_mfma_f32_16x16x32_bf16 v[184:187], a[28:31], a[136:139], v[184:187]
v_exp_f32 v178, v178
v_mfma_f32_16x16x32_bf16 v[188:191], a[0:3], v[128:131], v[216:219]
v_cvt_pk_bf16_f32 v166, v176, v177
v_mfma_f32_16x16x32_bf16 v[188:191], a[4:7], v[136:139], v[188:191]
v_exp_f32 v179, v179
v_mfma_f32_16x16x32_bf16 v[188:191], a[8:11], v[144:147], v[188:191]
v_exp_f32 v180, v180
v_mfma_f32_16x16x32_bf16 v[188:191], a[12:15], v[152:155], v[188:191]
v_cvt_pk_bf16_f32 v167, v178, v179
v_mfma_f32_16x16x32_bf16 v[188:191], a[16:19], a[80:83], v[188:191]
v_exp_f32 v181, v181
v_mfma_f32_16x16x32_bf16 v[188:191], a[20:23], a[100:103], v[188:191]
ds_write_b128 v251, v[164:167] offset:6144
v_mfma_f32_16x16x32_bf16 v[188:191], a[24:27], a[120:123], v[188:191]
s_mov_b32 s46, 196608
s_waitcnt lgkmcnt(2)
v_mfma_f32_16x16x32_bf16 v[188:191], a[28:31], a[140:143], v[188:191]
s_waitcnt vmcnt(5)
buffer_load_dwordx4 v[232:235], v248, s[12:15], s46 offen offset:0 nt
v_exp_f32 v182, v182
v_mfma_f32_16x16x32_bf16 v[192:195], a[32:35], v[96:99], v[212:215]
v_cvt_pk_bf16_f32 v170, v180, v181
v_mfma_f32_16x16x32_bf16 v[192:195], a[36:39], v[104:107], v[192:195]
v_exp_f32 v183, v183
v_mfma_f32_16x16x32_bf16 v[192:195], a[40:43], v[112:115], v[192:195]
v_cvt_pk_bf16_f32 v171, v182, v183
ds_write_b128 v251, v[168:171] offset:7168
v_mfma_f32_16x16x32_bf16 v[192:195], a[44:47], v[120:123], v[192:195]
v_mfma_f32_16x16x32_bf16 v[192:195], a[48:51], a[76:79], v[192:195]
s_waitcnt lgkmcnt(0)
s_barrier
v_add_u32 v246, s34, v246
ds_read_b64_tr_b16 a[0:1], v246 offset:0
v_mfma_f32_16x16x32_bf16 v[192:195], a[52:55], a[96:99], v[192:195]
ds_read_b64_tr_b16 a[2:3], v246 offset:2048
v_mfma_f32_16x16x32_bf16 v[192:195], a[56:59], a[116:119], v[192:195]
v_add_u32 v247, s34, v247
ds_read_b64_tr_b16 a[4:5], v247 offset:0
v_mfma_f32_16x16x32_bf16 v[192:195], a[60:63], a[136:139], v[192:195]
ds_read_b64_tr_b16 a[6:7], v247 offset:2048
ds_read_b64_tr_b16 a[8:9], v246 offset:256
v_mfma_f32_16x16x32_bf16 v[196:199], a[32:35], v[128:131], v[216:219]
ds_read_b64_tr_b16 a[10:11], v246 offset:2304
ds_read_b64_tr_b16 a[12:13], v247 offset:256
v_mfma_f32_16x16x32_bf16 v[196:199], a[36:39], v[136:139], v[196:199]
s_add_u32 m0, s29, 98304
ds_read_b64_tr_b16 a[14:15], v247 offset:2304
v_mfma_f32_16x16x32_bf16 v[196:199], a[40:43], v[144:147], v[196:199]
s_waitcnt vmcnt(5)
buffer_load_dwordx4 v249, s[12:15], s46 offen offset:1024 nt lds
v_mfma_f32_16x16x32_bf16 v[196:199], a[44:47], v[152:155], v[196:199]
ds_read_b64_tr_b16 a[16:17], v246 offset:512
ds_read_b64_tr_b16 a[18:19], v246 offset:2560
v_mfma_f32_16x16x32_bf16 v[196:199], a[48:51], a[80:83], v[196:199]
ds_read_b64_tr_b16 a[20:21], v247 offset:512
ds_read_b64_tr_b16 a[22:23], v247 offset:2560
v_mfma_f32_16x16x32_bf16 v[196:199], a[52:55], a[100:103], v[196:199]
v_mfma_f32_16x16x32_bf16 v[196:199], a[56:59], a[120:123], v[196:199]
v_mfma_f32_16x16x32_bf16 v[196:199], a[60:63], a[140:143], v[196:199]
v_exp_f32 v184, v184
v_mfma_f32_16x16x32_bf16 a[224:227], a[244:247], v[160:163], a[224:227]
v_exp_f32 v185, v185
v_mfma_f32_16x16x32_bf16 a[228:231], a[244:247], v[164:167], a[228:231]
v_exp_f32 v186, v186
v_mfma_f32_16x16x32_bf16 a[232:235], a[244:247], v[168:171], a[232:235]
v_add_u32 v250, 0x10000, v250
ds_read_b128 v[172:175], v250 offset:5120
s_waitcnt lgkmcnt(5)
v_mfma_f32_16x16x32_bf16 v[4:7], a[0:3], v[160:163], v[4:7]
v_cvt_pk_bf16_f32 v184, v184, v185
ds_read_b64_tr_b16 a[24:25], v246 offset:768
v_mfma_f32_16x16x32_bf16 v[68:71], a[0:3], v[164:167], v[68:71]
ds_read_b128 v[176:179], v250 offset:6144
ds_read_b64_tr_b16 a[26:27], v246 offset:2816
v_mfma_f32_16x16x32_bf16 v[132:135], a[0:3], v[168:171], v[132:135]
s_waitcnt vmcnt(5)
buffer_load_dwordx4 v248, s[12:15], s46 offen offset:2048 nt lds
v_mfma_f32_16x16x32_bf16 v[12:15], a[4:7], v[160:163], v[12:15]
ds_read_b128 v[180:183], v250 offset:7168
ds_read_b64_tr_b16 a[28:29], v247 offset:768
v_mfma_f32_16x16x32_bf16 v[76:79], a[4:7], v[164:167], v[76:79]
v_exp_f32 v187, v187
v_mfma_f32_16x16x32_bf16 v[140:143], a[4:7], v[168:171], v[140:143]
v_exp_f32 v188, v188
v_mfma_f32_16x16x32_bf16 v[20:23], a[8:11], v[160:163], v[20:23]
v_cvt_pk_bf16_f32 v185, v186, v187
ds_read_b64_tr_b16 a[30:31], v247 offset:2816
v_mfma_f32_16x16x32_bf16 v[84:87], a[8:11], v[164:167], v[84:87]
v_exp_f32 v189, v189
v_mfma_f32_16x16x32_bf16 v[148:151], a[8:11], v[168:171], v[148:151]
v_add_u32 v246, s33, v246
ds_read_b64_tr_b16 a[32:33], v246 offset:0
v_mfma_f32_16x16x32_bf16 v[28:31], a[12:15], v[160:163], v[28:31]
ds_read_b64_tr_b16 a[34:35], v246 offset:2048
v_mfma_f32_16x16x32_bf16 v[92:95], a[12:15], v[164:167], v[92:95]
v_exp_f32 v190, v190
v_mfma_f32_16x16x32_bf16 v[156:159], a[12:15], v[168:171], v[156:159]
v_cvt_pk_bf16_f32 v188, v188, v189
s_waitcnt lgkmcnt(3)
v_mfma_f32_16x16x32_bf16 v[36:39], a[16:19], v[160:163], v[36:39]
v_add_u32 v247, s33, v247
ds_read_b64_tr_b16 a[36:37], v247 offset:0
v_mfma_f32_16x16x32_bf16 v[100:103], a[16:19], v[164:167], v[100:103]
ds_read_b64_tr_b16 a[38:39], v247 offset:2048
ds_read_b64_tr_b16 a[40:41], v246 offset:256
v_mfma_f32_16x16x32_bf16 a[144:147], a[16:19], v[168:171], a[144:147]
s_waitcnt vmcnt(5)
buffer_load_dwordx4 v249, s[12:15], s46 offen offset:3072 nt lds
v_mfma_f32_16x16x32_bf16 v[44:47], a[20:23], v[160:163], v[44:47]
v_exp_f32 v191, v191
v_mfma_f32_16x16x32_bf16 v[108:111], a[20:23], v[164:167], v[108:111]
v_cvt_pk_bf16_f32 v189, v190, v191
ds_read_b64_tr_b16 a[42:43], v246 offset:2304
v_mfma_f32_16x16x32_bf16 a[148:151], a[20:23], v[168:171], a[148:151]
v_exp_f32 v192, v192
v_mfma_f32_16x16x32_bf16 v[52:55], a[24:27], v[160:163], v[52:55]
ds_read_b64_tr_b16 a[44:45], v247 offset:256
ds_read_b64_tr_b16 a[46:47], v247 offset:2304
v_mfma_f32_16x16x32_bf16 v[116:119], a[24:27], v[164:167], v[116:119]
v_exp_f32 v193, v193
v_mfma_f32_16x16x32_bf16 a[152:155], a[24:27], v[168:171], a[152:155]
ds_read_b64_tr_b16 a[48:49], v246 offset:512
s_waitcnt lgkmcnt(4)
v_mfma_f32_16x16x32_bf16 v[60:63], a[28:31], v[160:163], v[60:63]
v_exp_f32 v194, v194
v_mfma_f32_16x16x32_bf16 v[124:127], a[28:31], v[164:167], v[124:127]
ds_read_b64_tr_b16 a[50:51], v246 offset:2560
v_cvt_pk_bf16_f32 v186, v192, v193
v_mfma_f32_16x16x32_bf16 a[156:159], a[28:31], v[168:171], a[156:159]
ds_read_b64_tr_b16 a[52:53], v247 offset:512
ds_read_b64_tr_b16 a[54:55], v247 offset:2560
v_mfma_f32_16x16x32_bf16 v[4:7], a[32:35], v[172:175], v[4:7]
s_mov_b32 s46, 200704
s_add_u32 m0, s29, 102400
v_mfma_f32_16x16x32_bf16 v[68:71], a[32:35], v[176:179], v[68:71]
s_waitcnt vmcnt(5)
buffer_load_dwordx4 v248, s[12:15], s46 offen offset:0 nt lds
v_mfma_f32_16x16x32_bf16 v[132:135], a[32:35], v[180:183], v[132:135]
v_exp_f32 v195, v195
v_mfma_f32_16x16x32_bf16 v[12:15], a[36:39], v[172:175], v[12:15]
ds_read_b64_tr_b16 a[56:57], v246 offset:768
ds_read_b64_tr_b16 a[58:59], v246 offset:2816
v_mfma_f32_16x16x32_bf16 v[76:79], a[36:39], v[176:179], v[76:79]
v_exp_f32 v196, v196
v_mfma_f32_16x16x32_bf16 v[140:143], a[36:39], v[180:183], v[140:143]
v_cvt_pk_bf16_f32 v187, v194, v195
s_waitcnt lgkmcnt(4)
v_mfma_f32_16x16x32_bf16 v[20:23], a[40:43], v[172:175], v[20:23]
ds_read_b64_tr_b16 a[60:61], v247 offset:768
ds_read_b64_tr_b16 a[62:63], v247 offset:2816
v_mfma_f32_16x16x32_bf16 v[84:87], a[40:43], v[176:179], v[84:87]
v_exp_f32 v197, v197
v_mfma_f32_16x16x32_bf16 v[148:151], a[40:43], v[180:183], v[148:151]
ds_write_b128 v251, v[184:187] offset:38912
v_mfma_f32_16x16x32_bf16 v[28:31], a[44:47], v[172:175], v[28:31]
v_exp_f32 v198, v198
v_mfma_f32_16x16x32_bf16 v[92:95], a[44:47], v[176:179], v[92:95]
v_cvt_pk_bf16_f32 v190, v196, v197
v_mfma_f32_16x16x32_bf16 v[156:159], a[44:47], v[180:183], v[156:159]
v_exp_f32 v199, v199
v_mfma_f32_16x16x32_bf16 v[36:39], a[48:51], v[172:175], v[36:39]
s_waitcnt vmcnt(5)
buffer_load_dwordx4 v249, s[12:15], s46 offen offset:1024 nt lds
v_mfma_f32_16x16x32_bf16 v[100:103], a[48:51], v[176:179], v[100:103]
v_cvt_pk_bf16_f32 v191, v198, v199
ds_write_b128 v251, v[188:191] offset:39936
v_mfma_f32_16x16x32_bf16 a[144:147], a[48:51], v[180:183], a[144:147]
v_add_u32 v250, 0xffff8000, v250
ds_write_b128 v250, v[236:239] offset:0
s_waitcnt lgkmcnt(3)
v_mfma_f32_16x16x32_bf16 v[44:47], a[52:55], v[172:175], v[44:47]
v_mfma_f32_16x16x32_bf16 v[108:111], a[52:55], v[176:179], v[108:111]
v_mfma_f32_16x16x32_bf16 a[148:151], a[52:55], v[180:183], a[148:151]
v_mfma_f32_16x16x32_bf16 v[52:55], a[56:59], v[172:175], v[52:55]
v_mfma_f32_16x16x32_bf16 v[116:119], a[56:59], v[176:179], v[116:119]
v_mfma_f32_16x16x32_bf16 a[152:155], a[56:59], v[180:183], a[152:155]
v_mfma_f32_16x16x32_bf16 v[60:63], a[60:63], v[172:175], v[60:63]
v_mfma_f32_16x16x32_bf16 v[124:127], a[60:63], v[176:179], v[124:127]
s_waitcnt lgkmcnt(0)
v_mfma_f32_16x16x32_bf16 a[156:159], a[60:63], v[180:183], a[156:159]
s_waitcnt vmcnt(5)
buffer_load_dwordx4 v[236:239], v248, s[12:15], s46 offen offset:2048 nt
v_mfma_f32_16x16x32_bf16 a[236:239], a[244:247], v[184:187], a[236:239]
v_mfma_f32_16x16x32_bf16 a[240:243], a[244:247], v[188:191], a[240:243]
ds_write_b128 v250, v[240:243] offset:1024
v_mfma_f32_16x16x32_bf16 a[160:163], a[0:3], v[184:187], a[160:163]
v_mfma_f32_16x16x32_bf16 a[192:195], a[0:3], v[188:191], a[192:195]
s_waitcnt lgkmcnt(0)
s_barrier
v_add_u32 v244, 0xfffe8000, v244
ds_read_b128 a[0:3], v244 offset:0
v_mfma_f32_16x16x32_bf16 a[164:167], a[4:7], v[184:187], a[164:167]
v_add_u32 v250, 0x10000, v250
ds_read_b128 v[192:195], v250 offset:6144
v_mfma_f32_16x16x32_bf16 a[196:199], a[4:7], v[188:191], a[196:199]
ds_read_b128 v[196:199], v250 offset:7168
ds_read_b128 a[4:7], v244 offset:256
v_mfma_f32_16x16x32_bf16 a[168:171], a[8:11], v[184:187], a[168:171]
v_mfma_f32_16x16x32_bf16 a[200:203], a[8:11], v[188:191], a[200:203]
ds_read_b128 a[8:11], v244 offset:512
v_mfma_f32_16x16x32_bf16 a[172:175], a[12:15], v[184:187], a[172:175]
v_mfma_f32_16x16x32_bf16 a[204:207], a[12:15], v[188:191], a[204:207]
ds_read_b128 a[12:15], v244 offset:768
v_mfma_f32_16x16x32_bf16 a[176:179], a[16:19], v[184:187], a[176:179]
s_waitcnt vmcnt(5)
buffer_load_dwordx4 v[240:243], v249, s[12:15], s46 offen offset:3072 nt
v_mfma_f32_16x16x32_bf16 a[208:211], a[16:19], v[188:191], a[208:211]
v_add_u32 v245, 0xfffe8000, v245
ds_read_b128 a[16:19], v245 offset:0
v_mfma_f32_16x16x32_bf16 a[180:183], a[20:23], v[184:187], a[180:183]
v_mfma_f32_16x16x32_bf16 a[212:215], a[20:23], v[188:191], a[212:215]
ds_read_b128 a[20:23], v245 offset:256
v_mfma_f32_16x16x32_bf16 a[184:187], a[24:27], v[184:187], a[184:187]
v_mfma_f32_16x16x32_bf16 a[216:219], a[24:27], v[188:191], a[216:219]
ds_read_b128 a[24:27], v245 offset:512
v_mfma_f32_16x16x32_bf16 a[188:191], a[28:31], v[184:187], a[188:191]
v_mfma_f32_16x16x32_bf16 a[220:223], a[28:31], v[188:191], a[220:223]
ds_read_b128 a[28:31], v245 offset:768
s_waitcnt lgkmcnt(8)
v_mfma_f32_16x16x32_bf16 a[160:163], a[32:35], v[192:195], a[160:163]
s_waitcnt lgkmcnt(7)
v_mfma_f32_16x16x32_bf16 a[192:195], a[32:35], v[196:199], a[192:195]
ds_read_b128 a[32:35], v244 offset:2048
v_mfma_f32_16x16x32_bf16 a[164:167], a[36:39], v[192:195], a[164:167]
s_mov_b32 s45, 229376
s_add_u32 m0, s29, 131072
v_mfma_f32_16x16x32_bf16 a[196:199], a[36:39], v[196:199], a[196:199]
s_waitcnt vmcnt(5)
buffer_load_dwordx4 v248, s[8:11], s45 offen offset:0 nt lds
v_mfma_f32_16x16x32_bf16 a[168:171], a[40:43], v[192:195], a[168:171]
ds_read_b128 a[36:39], v244 offset:2304
v_mfma_f32_16x16x32_bf16 a[200:203], a[40:43], v[196:199], a[200:203]
v_mfma_f32_16x16x32_bf16 a[172:175], a[44:47], v[192:195], a[172:175]
v_mfma_f32_16x16x32_bf16 a[204:207], a[44:47], v[196:199], a[204:207]
v_mfma_f32_16x16x32_bf16 a[176:179], a[48:51], v[192:195], a[176:179]
v_mfma_f32_16x16x32_bf16 a[208:211], a[48:51], v[196:199], a[208:211]
v_mfma_f32_16x16x32_bf16 a[180:183], a[52:55], v[192:195], a[180:183]
v_mfma_f32_16x16x32_bf16 a[212:215], a[52:55], v[196:199], a[212:215]
v_mfma_f32_16x16x32_bf16 a[184:187], a[56:59], v[192:195], a[184:187]
v_mfma_f32_16x16x32_bf16 a[216:219], a[56:59], v[196:199], a[216:219]
v_mfma_f32_16x16x32_bf16 a[188:191], a[60:63], v[192:195], a[188:191]
s_waitcnt vmcnt(5)
buffer_load_dwordx4 v249, s[8:11], s45 offen offset:1024 nt lds
v_mfma_f32_16x16x32_bf16 a[220:223], a[60:63], v[196:199], a[220:223]
ds_read_b128 a[40:43], v244 offset:2560
v_mfma_f32_16x16x32_bf16 v[160:163], a[0:3], v[0:3], v[200:203]
ds_read_b128 a[44:47], v244 offset:2816
s_waitcnt lgkmcnt(10)
v_mfma_f32_16x16x32_bf16 v[160:163], a[4:7], v[8:11], v[160:163]
ds_read_b128 a[48:51], v245 offset:2048
s_waitcnt lgkmcnt(10)
v_mfma_f32_16x16x32_bf16 v[160:163], a[8:11], v[16:19], v[160:163]
ds_read_b128 a[52:55], v245 offset:2304
s_waitcnt lgkmcnt(10)
v_mfma_f32_16x16x32_bf16 v[160:163], a[12:15], v[24:27], v[160:163]
ds_read_b128 a[56:59], v245 offset:2560
s_waitcnt lgkmcnt(10)
v_mfma_f32_16x16x32_bf16 v[160:163], a[16:19], a[64:67], v[160:163]
ds_read_b128 a[60:63], v245 offset:2816
s_waitcnt lgkmcnt(10)
v_mfma_f32_16x16x32_bf16 v[160:163], a[20:23], a[84:87], v[160:163]
s_waitcnt lgkmcnt(9)
v_mfma_f32_16x16x32_bf16 v[160:163], a[24:27], a[104:107], v[160:163]
s_waitcnt lgkmcnt(8)
v_mfma_f32_16x16x32_bf16 v[160:163], a[28:31], a[124:127], v[160:163]
v_mfma_f32_16x16x32_bf16 v[164:167], a[0:3], v[32:35], v[204:207]
v_mfma_f32_16x16x32_bf16 v[164:167], a[4:7], v[40:43], v[164:167]
v_mfma_f32_16x16x32_bf16 v[164:167], a[8:11], v[48:51], v[164:167]
s_waitcnt vmcnt(5)
buffer_load_dwordx4 v248, s[8:11], s45 offen offset:2048 nt lds
v_mfma_f32_16x16x32_bf16 v[164:167], a[12:15], v[56:59], v[164:167]
v_mfma_f32_16x16x32_bf16 v[164:167], a[16:19], a[68:71], v[164:167]
v_mfma_f32_16x16x32_bf16 v[164:167], a[20:23], a[88:91], v[164:167]
v_mfma_f32_16x16x32_bf16 v[164:167], a[24:27], a[108:111], v[164:167]
v_mfma_f32_16x16x32_bf16 v[164:167], a[28:31], a[128:131], v[164:167]
v_mfma_f32_16x16x32_bf16 v[168:171], a[0:3], v[64:67], v[208:211]
v_mfma_f32_16x16x32_bf16 v[168:171], a[4:7], v[72:75], v[168:171]
v_mfma_f32_16x16x32_bf16 v[168:171], a[8:11], v[80:83], v[168:171]
v_mfma_f32_16x16x32_bf16 v[168:171], a[12:15], v[88:91], v[168:171]
v_mfma_f32_16x16x32_bf16 v[168:171], a[16:19], a[72:75], v[168:171]
v_mfma_f32_16x16x32_bf16 v[168:171], a[20:23], a[92:95], v[168:171]
s_waitcnt vmcnt(5)
buffer_load_dwordx4 v249, s[8:11], s45 offen offset:3072 nt lds
v_mfma_f32_16x16x32_bf16 v[168:171], a[24:27], a[112:115], v[168:171]
v_mfma_f32_16x16x32_bf16 v[168:171], a[28:31], a[132:135], v[168:171]
s_waitcnt lgkmcnt(0)
v_mfma_f32_16x16x32_bf16 v[172:175], a[32:35], v[0:3], v[200:203]
v_mfma_f32_16x16x32_bf16 v[172:175], a[36:39], v[8:11], v[172:175]
v_exp_f32 v160, v160
v_mfma_f32_16x16x32_bf16 v[172:175], a[40:43], v[16:19], v[172:175]
v_exp_f32 v161, v161
v_mfma_f32_16x16x32_bf16 v[172:175], a[44:47], v[24:27], v[172:175]
v_exp_f32 v162, v162
v_mfma_f32_16x16x32_bf16 v[172:175], a[48:51], a[64:67], v[172:175]
v_cvt_pk_bf16_f32 v160, v160, v161
v_mfma_f32_16x16x32_bf16 v[172:175], a[52:55], a[84:87], v[172:175]
v_exp_f32 v163, v163
v_mfma_f32_16x16x32_bf16 v[172:175], a[56:59], a[104:107], v[172:175]
v_exp_f32 v164, v164
v_mfma_f32_16x16x32_bf16 v[172:175], a[60:63], a[124:127], v[172:175]
s_mov_b32 s45, 233472
s_add_u32 m0, s29, 135168
v_mfma_f32_16x16x32_bf16 v[176:179], a[32:35], v[32:35], v[204:207]
s_waitcnt vmcnt(5)
buffer_load_dwordx4 v248, s[8:11], s45 offen offset:0 nt lds
v_cvt_pk_bf16_f32 v161, v162, v163
v_mfma_f32_16x16x32_bf16 v[176:179], a[36:39], v[40:43], v[176:179]
v_exp_f32 v165, v165
v_mfma_f32_16x16x32_bf16 v[176:179], a[40:43], v[48:51], v[176:179]
v_add_u32 v250, 0xffff0000, v250
ds_write_b128 v250, a[248:251] offset:6144
v_mfma_f32_16x16x32_bf16 v[176:179], a[44:47], v[56:59], v[176:179]
v_exp_f32 v166, v166
v_mfma_f32_16x16x32_bf16 v[176:179], a[48:51], a[68:71], v[176:179]
v_cvt_pk_bf16_f32 v164, v164, v165
v_mfma_f32_16x16x32_bf16 v[176:179], a[52:55], a[88:91], v[176:179]
v_exp_f32 v167, v167
v_mfma_f32_16x16x32_bf16 v[176:179], a[56:59], a[108:111], v[176:179]
v_exp_f32 v168, v168
v_mfma_f32_16x16x32_bf16 v[176:179], a[60:63], a[128:131], v[176:179]
v_cvt_pk_bf16_f32 v165, v166, v167
v_mfma_f32_16x16x32_bf16 v[180:183], a[32:35], v[64:67], v[208:211]
v_exp_f32 v169, v169
v_mfma_f32_16x16x32_bf16 v[180:183], a[36:39], v[72:75], v[180:183]
v_exp_f32 v170, v170
v_mfma_f32_16x16x32_bf16 v[180:183], a[40:43], v[80:83], v[180:183]
s_waitcnt lgkmcnt(0)
v_cvt_pk_bf16_f32 v168, v168, v169
v_mfma_f32_16x16x32_bf16 v[180:183], a[44:47], v[88:91], v[180:183]
s_waitcnt vmcnt(5)
buffer_load_dwordx4 a[248:251], v249, s[8:11], s45 offen offset:1024 nt
v_mfma_f32_16x16x32_bf16 v[180:183], a[48:51], a[72:75], v[180:183]
v_exp_f32 v171, v171
s_nop 0
v_cvt_pk_bf16_f32 v169, v170, v171
v_mfma_f32_16x16x32_bf16 v[180:183], a[52:55], a[92:95], v[180:183]
ds_write_b128 v250, a[252:255] offset:7168
v_mfma_f32_16x16x32_bf16 v[180:183], a[56:59], a[112:115], v[180:183]
v_mfma_f32_16x16x32_bf16 v[180:183], a[60:63], a[132:135], v[180:183]
v_mfma_f32_16x16x32_bf16 v[184:187], a[0:3], v[96:99], v[212:215]
v_mfma_f32_16x16x32_bf16 v[184:187], a[4:7], v[104:107], v[184:187]
v_exp_f32 v172, v172
v_exp_f32 v173, v173
v_exp_f32 v174, v174
v_cvt_pk_bf16_f32 v162, v172, v173
v_mfma_f32_16x16x32_bf16 v[184:187], a[8:11], v[112:115], v[184:187]
v_exp_f32 v175, v175
v_mfma_f32_16x16x32_bf16 v[184:187], a[12:15], v[120:123], v[184:187]
v_exp_f32 v176, v176
v_mfma_f32_16x16x32_bf16 v[184:187], a[16:19], a[76:79], v[184:187]
v_cvt_pk_bf16_f32 v163, v174, v175
v_mfma_f32_16x16x32_bf16 v[184:187], a[20:23], a[96:99], v[184:187]
s_waitcnt lgkmcnt(0)
v_mfma_f32_16x16x32_bf16 v[184:187], a[24:27], a[116:119], v[184:187]
s_waitcnt vmcnt(5)
buffer_load_dwordx4 a[252:255], v248, s[8:11], s45 offen offset:2048 nt
v_exp_f32 v177, v177
v_add_u32 v251, 0x8000, v251
ds_write_b128 v251, v[160:163] offset:37888
v_mfma_f32_16x16x32_bf16 v[184:187], a[28:31], a[136:139], v[184:187]
v_exp_f32 v178, v178
v_mfma_f32_16x16x32_bf16 v[188:191], a[0:3], v[128:131], v[216:219]
ds_write_b128 v250, v[220:223] offset:37888
v_cvt_pk_bf16_f32 v166, v176, v177
v_mfma_f32_16x16x32_bf16 v[188:191], a[4:7], v[136:139], v[188:191]
v_exp_f32 v179, v179
v_mfma_f32_16x16x32_bf16 v[188:191], a[8:11], v[144:147], v[188:191]
v_exp_f32 v180, v180
v_mfma_f32_16x16x32_bf16 v[188:191], a[12:15], v[152:155], v[188:191]
v_cvt_pk_bf16_f32 v167, v178, v179
v_mfma_f32_16x16x32_bf16 v[188:191], a[16:19], a[80:83], v[188:191]
v_exp_f32 v181, v181
v_mfma_f32_16x16x32_bf16 v[188:191], a[20:23], a[100:103], v[188:191]
ds_write_b128 v251, v[164:167] offset:38912
v_mfma_f32_16x16x32_bf16 v[188:191], a[24:27], a[120:123], v[188:191]
v_exp_f32 v182, v182
v_mfma_f32_16x16x32_bf16 v[188:191], a[28:31], a[140:143], v[188:191]
v_cvt_pk_bf16_f32 v170, v180, v181
v_mfma_f32_16x16x32_bf16 v[192:195], a[32:35], v[96:99], v[212:215]
s_waitcnt lgkmcnt(1)
v_mfma_f32_16x16x32_bf16 v[192:195], a[36:39], v[104:107], v[192:195]
s_waitcnt vmcnt(5)
buffer_load_dwordx4 v[220:223], v249, s[8:11], s45 offen offset:3072 nt
v_exp_f32 v183, v183
v_mfma_f32_16x16x32_bf16 v[192:195], a[40:43], v[112:115], v[192:195]
v_cvt_pk_bf16_f32 v171, v182, v183
ds_write_b128 v251, v[168:171] offset:39936
v_mfma_f32_16x16x32_bf16 v[192:195], a[44:47], v[120:123], v[192:195]
v_mfma_f32_16x16x32_bf16 v[192:195], a[48:51], a[76:79], v[192:195]
s_waitcnt lgkmcnt(0)
s_barrier
v_add_u32 v246, s35, v246
ds_read_b64_tr_b16 a[0:1], v246 offset:0
v_mfma_f32_16x16x32_bf16 v[192:195], a[52:55], a[96:99], v[192:195]
ds_read_b64_tr_b16 a[2:3], v246 offset:2048
v_mfma_f32_16x16x32_bf16 v[192:195], a[56:59], a[116:119], v[192:195]
v_add_u32 v247, s35, v247
ds_read_b64_tr_b16 a[4:5], v247 offset:0
v_mfma_f32_16x16x32_bf16 v[192:195], a[60:63], a[136:139], v[192:195]
ds_read_b64_tr_b16 a[6:7], v247 offset:2048
ds_read_b64_tr_b16 a[8:9], v246 offset:256
v_mfma_f32_16x16x32_bf16 v[196:199], a[32:35], v[128:131], v[216:219]
ds_read_b64_tr_b16 a[10:11], v246 offset:2304
ds_read_b64_tr_b16 a[12:13], v247 offset:256
v_mfma_f32_16x16x32_bf16 v[196:199], a[36:39], v[136:139], v[196:199]
ds_read_b64_tr_b16 a[14:15], v247 offset:2304
ds_read_b64_tr_b16 a[16:17], v246 offset:512
v_mfma_f32_16x16x32_bf16 v[196:199], a[40:43], v[144:147], v[196:199]
ds_read_b64_tr_b16 a[18:19], v246 offset:2560
ds_read_b64_tr_b16 a[20:21], v247 offset:512
v_mfma_f32_16x16x32_bf16 v[196:199], a[44:47], v[152:155], v[196:199]
s_mov_b32 s46, 229376
s_add_u32 m0, s29, 0
v_mfma_f32_16x16x32_bf16 v[196:199], a[48:51], a[80:83], v[196:199]
s_waitcnt vmcnt(5)
buffer_load_dwordx4 v248, s[12:15], s46 offen offset:0 nt lds
v_mfma_f32_16x16x32_bf16 v[196:199], a[52:55], a[100:103], v[196:199]
ds_read_b64_tr_b16 a[22:23], v247 offset:2560
v_mfma_f32_16x16x32_bf16 v[196:199], a[56:59], a[120:123], v[196:199]
v_mfma_f32_16x16x32_bf16 v[196:199], a[60:63], a[140:143], v[196:199]
v_exp_f32 v184, v184
v_mfma_f32_16x16x32_bf16 a[224:227], a[244:247], v[160:163], a[224:227]
v_exp_f32 v185, v185
v_mfma_f32_16x16x32_bf16 a[228:231], a[244:247], v[164:167], a[228:231]
v_exp_f32 v186, v186
v_mfma_f32_16x16x32_bf16 a[232:235], a[244:247], v[168:171], a[232:235]
v_add_u32 v250, 0x10000, v250
ds_read_b128 v[172:175], v250 offset:37888
s_waitcnt lgkmcnt(5)
v_mfma_f32_16x16x32_bf16 v[4:7], a[0:3], v[160:163], v[4:7]
v_cvt_pk_bf16_f32 v184, v184, v185
ds_read_b64_tr_b16 a[24:25], v246 offset:768
v_mfma_f32_16x16x32_bf16 v[68:71], a[0:3], v[164:167], v[68:71]
ds_read_b128 v[176:179], v250 offset:38912
ds_read_b64_tr_b16 a[26:27], v246 offset:2816
v_mfma_f32_16x16x32_bf16 v[132:135], a[0:3], v[168:171], v[132:135]
v_exp_f32 v187, v187
v_mfma_f32_16x16x32_bf16 v[12:15], a[4:7], v[160:163], v[12:15]
ds_read_b128 v[180:183], v250 offset:39936
ds_read_b64_tr_b16 a[28:29], v247 offset:768
v_mfma_f32_16x16x32_bf16 v[76:79], a[4:7], v[164:167], v[76:79]
v_exp_f32 v188, v188
v_mfma_f32_16x16x32_bf16 v[140:143], a[4:7], v[168:171], v[140:143]
s_waitcnt vmcnt(5)
buffer_load_dwordx4 v249, s[12:15], s46 offen offset:1024 nt lds
v_mfma_f32_16x16x32_bf16 v[20:23], a[8:11], v[160:163], v[20:23]
v_cvt_pk_bf16_f32 v185, v186, v187
ds_read_b64_tr_b16 a[30:31], v247 offset:2816
v_mfma_f32_16x16x32_bf16 v[84:87], a[8:11], v[164:167], v[84:87]
v_exp_f32 v189, v189
v_mfma_f32_16x16x32_bf16 v[148:151], a[8:11], v[168:171], v[148:151]
v_add_u32 v246, s33, v246
ds_read_b64_tr_b16 a[32:33], v246 offset:0
v_mfma_f32_16x16x32_bf16 v[28:31], a[12:15], v[160:163], v[28:31]
ds_read_b64_tr_b16 a[34:35], v246 offset:2048
v_mfma_f32_16x16x32_bf16 v[92:95], a[12:15], v[164:167], v[92:95]
v_exp_f32 v190, v190
v_mfma_f32_16x16x32_bf16 v[156:159], a[12:15], v[168:171], v[156:159]
v_cvt_pk_bf16_f32 v188, v188, v189
s_waitcnt lgkmcnt(3)
v_mfma_f32_16x16x32_bf16 v[36:39], a[16:19], v[160:163], v[36:39]
v_add_u32 v247, s33, v247
ds_read_b64_tr_b16 a[36:37], v247 offset:0
v_mfma_f32_16x16x32_bf16 v[100:103], a[16:19], v[164:167], v[100:103]
ds_read_b64_tr_b16 a[38:39], v247 offset:2048
ds_read_b64_tr_b16 a[40:41], v246 offset:256
v_mfma_f32_16x16x32_bf16 a[144:147], a[16:19], v[168:171], a[144:147]
v_exp_f32 v191, v191
v_mfma_f32_16x16x32_bf16 v[44:47], a[20:23], v[160:163], v[44:47]
v_cvt_pk_bf16_f32 v189, v190, v191
ds_read_b64_tr_b16 a[42:43], v246 offset:2304
v_mfma_f32_16x16x32_bf16 v[108:111], a[20:23], v[164:167], v[108:111]
s_waitcnt vmcnt(5)
buffer_load_dwordx4 v248, s[12:15], s46 offen offset:2048 nt lds
v_mfma_f32_16x16x32_bf16 a[148:151], a[20:23], v[168:171], a[148:151]
v_exp_f32 v192, v192
v_mfma_f32_16x16x32_bf16 v[52:55], a[24:27], v[160:163], v[52:55]
ds_read_b64_tr_b16 a[44:45], v247 offset:256
ds_read_b64_tr_b16 a[46:47], v247 offset:2304
v_mfma_f32_16x16x32_bf16 v[116:119], a[24:27], v[164:167], v[116:119]
v_exp_f32 v193, v193
v_mfma_f32_16x16x32_bf16 a[152:155], a[24:27], v[168:171], a[152:155]
ds_read_b64_tr_b16 a[48:49], v246 offset:512
s_waitcnt lgkmcnt(4)
v_mfma_f32_16x16x32_bf16 v[60:63], a[28:31], v[160:163], v[60:63]
v_exp_f32 v194, v194
v_mfma_f32_16x16x32_bf16 v[124:127], a[28:31], v[164:167], v[124:127]
ds_read_b64_tr_b16 a[50:51], v246 offset:2560
v_cvt_pk_bf16_f32 v186, v192, v193
v_mfma_f32_16x16x32_bf16 a[156:159], a[28:31], v[168:171], a[156:159]
ds_read_b64_tr_b16 a[52:53], v247 offset:512
ds_read_b64_tr_b16 a[54:55], v247 offset:2560
v_mfma_f32_16x16x32_bf16 v[4:7], a[32:35], v[172:175], v[4:7]
v_exp_f32 v195, v195
v_mfma_f32_16x16x32_bf16 v[68:71], a[32:35], v[176:179], v[68:71]
ds_read_b64_tr_b16 a[56:57], v246 offset:768
ds_read_b64_tr_b16 a[58:59], v246 offset:2816
v_mfma_f32_16x16x32_bf16 v[132:135], a[32:35], v[180:183], v[132:135]
v_exp_f32 v196, v196
v_mfma_f32_16x16x32_bf16 v[12:15], a[36:39], v[172:175], v[12:15]
s_waitcnt vmcnt(5)
buffer_load_dwordx4 v249, s[12:15], s46 offen offset:3072 nt lds
v_mfma_f32_16x16x32_bf16 v[76:79], a[36:39], v[176:179], v[76:79]
v_cvt_pk_bf16_f32 v187, v194, v195
ds_read_b64_tr_b16 a[60:61], v247 offset:768
v_mfma_f32_16x16x32_bf16 v[140:143], a[36:39], v[180:183], v[140:143]
ds_read_b64_tr_b16 a[62:63], v247 offset:2816
s_waitcnt lgkmcnt(6)
v_mfma_f32_16x16x32_bf16 v[20:23], a[40:43], v[172:175], v[20:23]
v_exp_f32 v197, v197
v_mfma_f32_16x16x32_bf16 v[84:87], a[40:43], v[176:179], v[84:87]
v_add_u32 v251, 0xfffe8000, v251
ds_write_b128 v251, v[184:187] offset:6144
v_mfma_f32_16x16x32_bf16 v[148:151], a[40:43], v[180:183], v[148:151]
v_exp_f32 v198, v198
v_mfma_f32_16x16x32_bf16 v[28:31], a[44:47], v[172:175], v[28:31]
v_cvt_pk_bf16_f32 v190, v196, v197
v_mfma_f32_16x16x32_bf16 v[92:95], a[44:47], v[176:179], v[92:95]
v_exp_f32 v199, v199
v_mfma_f32_16x16x32_bf16 v[156:159], a[44:47], v[180:183], v[156:159]
v_cvt_pk_bf16_f32 v191, v198, v199
ds_write_b128 v251, v[188:191] offset:7168
v_mfma_f32_16x16x32_bf16 v[36:39], a[48:51], v[172:175], v[36:39]
v_mfma_f32_16x16x32_bf16 v[100:103], a[48:51], v[176:179], v[100:103]
s_mov_b32 s46, 233472
s_add_u32 m0, s29, 4096
v_mfma_f32_16x16x32_bf16 a[144:147], a[48:51], v[180:183], a[144:147]
s_waitcnt vmcnt(5)
buffer_load_dwordx4 v248, s[12:15], s46 offen offset:0 nt lds
s_waitcnt lgkmcnt(1)
v_mfma_f32_16x16x32_bf16 v[44:47], a[52:55], v[172:175], v[44:47]
v_add_u32 v250, 0xffff8000, v250
ds_write_b128 v250, v[224:227] offset:6144
ds_write_b128 v250, v[228:231] offset:7168
v_mfma_f32_16x16x32_bf16 v[108:111], a[52:55], v[176:179], v[108:111]
v_mfma_f32_16x16x32_bf16 a[148:151], a[52:55], v[180:183], a[148:151]
v_mfma_f32_16x16x32_bf16 v[52:55], a[56:59], v[172:175], v[52:55]
v_mfma_f32_16x16x32_bf16 v[116:119], a[56:59], v[176:179], v[116:119]
v_mfma_f32_16x16x32_bf16 a[152:155], a[56:59], v[180:183], a[152:155]
v_mfma_f32_16x16x32_bf16 v[60:63], a[60:63], v[172:175], v[60:63]
v_mfma_f32_16x16x32_bf16 v[124:127], a[60:63], v[176:179], v[124:127]
v_mfma_f32_16x16x32_bf16 a[156:159], a[60:63], v[180:183], a[156:159]
v_mfma_f32_16x16x32_bf16 a[236:239], a[244:247], v[184:187], a[236:239]
v_mfma_f32_16x16x32_bf16 a[240:243], a[244:247], v[188:191], a[240:243]
s_waitcnt vmcnt(5)
buffer_load_dwordx4 v249, s[12:15], s46 offen offset:1024 nt lds
v_mfma_f32_16x16x32_bf16 a[160:163], a[0:3], v[184:187], a[160:163]
v_mfma_f32_16x16x32_bf16 a[192:195], a[0:3], v[188:191], a[192:195]
s_waitcnt lgkmcnt(0)
s_barrier
v_add_u32 v244, 0x10000, v244
ds_read_b128 a[0:3], v244 offset:0
v_mfma_f32_16x16x32_bf16 a[164:167], a[4:7], v[184:187], a[164:167]
v_add_u32 v250, 0xffff0000, v250
ds_read_b128 v[192:195], v250 offset:6144
v_mfma_f32_16x16x32_bf16 a[196:199], a[4:7], v[188:191], a[196:199]
ds_read_b128 v[196:199], v250 offset:7168
ds_read_b128 a[4:7], v244 offset:256
v_mfma_f32_16x16x32_bf16 a[168:171], a[8:11], v[184:187], a[168:171]
v_mfma_f32_16x16x32_bf16 a[200:203], a[8:11], v[188:191], a[200:203]
ds_read_b128 a[8:11], v244 offset:512
v_mfma_f32_16x16x32_bf16 a[172:175], a[12:15], v[184:187], a[172:175]
v_mfma_f32_16x16x32_bf16 a[204:207], a[12:15], v[188:191], a[204:207]
ds_read_b128 a[12:15], v244 offset:768
v_mfma_f32_16x16x32_bf16 a[176:179], a[16:19], v[184:187], a[176:179]
v_mfma_f32_16x16x32_bf16 a[208:211], a[16:19], v[188:191], a[208:211]
v_mfma_f32_16x16x32_bf16 a[180:183], a[20:23], v[184:187], a[180:183]
s_waitcnt vmcnt(5)
buffer_load_dwordx4 v[224:227], v248, s[12:15], s46 offen offset:2048 nt
v_mfma_f32_16x16x32_bf16 a[212:215], a[20:23], v[188:191], a[212:215]
v_add_u32 v245, 0x10000, v245
ds_read_b128 a[16:19], v245 offset:0
v_mfma_f32_16x16x32_bf16 a[184:187], a[24:27], v[184:187], a[184:187]
ds_read_b128 a[20:23], v245 offset:256
v_mfma_f32_16x16x32_bf16 a[216:219], a[24:27], v[188:191], a[216:219]
ds_read_b128 a[24:27], v245 offset:512
v_mfma_f32_16x16x32_bf16 a[188:191], a[28:31], v[184:187], a[188:191]
v_mfma_f32_16x16x32_bf16 a[220:223], a[28:31], v[188:191], a[220:223]
ds_read_b128 a[28:31], v245 offset:768
s_waitcnt lgkmcnt(8)
v_mfma_f32_16x16x32_bf16 a[160:163], a[32:35], v[192:195], a[160:163]
s_waitcnt lgkmcnt(7)
v_mfma_f32_16x16x32_bf16 a[192:195], a[32:35], v[196:199], a[192:195]
ds_read_b128 a[32:35], v244 offset:2048
v_mfma_f32_16x16x32_bf16 a[164:167], a[36:39], v[192:195], a[164:167]
v_mfma_f32_16x16x32_bf16 a[196:199], a[36:39], v[196:199], a[196:199]
ds_read_b128 a[36:39], v244 offset:2304
v_mfma_f32_16x16x32_bf16 a[168:171], a[40:43], v[192:195], a[168:171]
v_mfma_f32_16x16x32_bf16 a[200:203], a[40:43], v[196:199], a[200:203]
s_waitcnt vmcnt(5)
buffer_load_dwordx4 v249, s[12:15], s46 offen offset:3072 nt lds
v_mfma_f32_16x16x32_bf16 a[172:175], a[44:47], v[192:195], a[172:175]
v_mfma_f32_16x16x32_bf16 a[204:207], a[44:47], v[196:199], a[204:207]
v_mfma_f32_16x16x32_bf16 a[176:179], a[48:51], v[192:195], a[176:179]
v_mfma_f32_16x16x32_bf16 a[208:211], a[48:51], v[196:199], a[208:211]
v_mfma_f32_16x16x32_bf16 a[180:183], a[52:55], v[192:195], a[180:183]
v_mfma_f32_16x16x32_bf16 a[212:215], a[52:55], v[196:199], a[212:215]
v_mfma_f32_16x16x32_bf16 a[184:187], a[56:59], v[192:195], a[184:187]
v_mfma_f32_16x16x32_bf16 a[216:219], a[56:59], v[196:199], a[216:219]
v_mfma_f32_16x16x32_bf16 a[188:191], a[60:63], v[192:195], a[188:191]
v_mfma_f32_16x16x32_bf16 a[220:223], a[60:63], v[196:199], a[220:223]
s_mov_b32 s45, 262144
s_add_u32 m0, s29, 32768
v_mfma_f32_16x16x32_bf16 v[160:163], a[0:3], v[0:3], v[200:203]
s_waitcnt vmcnt(5)
buffer_load_dwordx4 v248, s[8:11], s45 offen offset:0 nt lds
s_waitcnt lgkmcnt(8)
v_mfma_f32_16x16x32_bf16 v[160:163], a[4:7], v[8:11], v[160:163]
s_getpc_b64 s[16:17]
Lcw_1:
s_waitcnt lgkmcnt(7)
v_mfma_f32_16x16x32_bf16 v[160:163], a[8:11], v[16:19], v[160:163]
v_mbcnt_lo_u32_b32 v252, -1, 0
s_waitcnt lgkmcnt(6)
v_mfma_f32_16x16x32_bf16 v[160:163], a[12:15], v[24:27], v[160:163]
v_mbcnt_hi_u32_b32 v252, -1, v252
s_waitcnt lgkmcnt(5)
v_mfma_f32_16x16x32_bf16 v[160:163], a[16:19], a[64:67], v[160:163]
v_lshlrev_b32 v252, 14, v252
s_waitcnt lgkmcnt(4)
v_mfma_f32_16x16x32_bf16 v[160:163], a[20:23], a[84:87], v[160:163]
s_lshr_b32 s48, s2, 3
s_waitcnt lgkmcnt(3)
v_mfma_f32_16x16x32_bf16 v[160:163], a[24:27], a[104:107], v[160:163]
s_lshl_b32 s48, s48, 9
s_waitcnt lgkmcnt(2)
v_mfma_f32_16x16x32_bf16 v[160:163], a[28:31], a[124:127], v[160:163]
s_lshl_b32 s49, s28, 7
s_add_u32 s48, s48, s49
v_mfma_f32_16x16x32_bf16 v[164:167], a[0:3], v[32:35], v[204:207]
v_add_u32 v252, s48, v252
v_min_u32 v252, L_code_end-Lcw_1-4, v252
v_mfma_f32_16x16x32_bf16 v[164:167], a[4:7], v[40:43], v[164:167]
v_mov_b32 v253, s17
ds_read_b128 a[40:43], v244 offset:2560
v_mfma_f32_16x16x32_bf16 v[164:167], a[8:11], v[48:51], v[164:167]
ds_read_b128 a[44:47], v244 offset:2816
ds_read_b128 a[48:51], v245 offset:2048
v_mfma_f32_16x16x32_bf16 v[164:167], a[12:15], v[56:59], v[164:167]
v_add_co_u32 v252, vcc, s16, v252
s_nop 1
v_addc_co_u32 v253, vcc, 0, v253, vcc
v_mfma_f32_16x16x32_bf16 v[164:167], a[16:19], a[68:71], v[164:167]
s_waitcnt vmcnt(5)
buffer_load_dwordx4 v249, s[8:11], s45 offen offset:1024 nt lds
v_mfma_f32_16x16x32_bf16 v[164:167], a[20:23], a[88:91], v[164:167]
ds_read_b128 a[52:55], v245 offset:2304
ds_read_b128 a[56:59], v245 offset:2560
v_mfma_f32_16x16x32_bf16 v[164:167], a[24:27], a[108:111], v[164:167]
global_load_dword v252, v[252:253], off
ds_read_b128 a[60:63], v245 offset:2816
v_mfma_f32_16x16x32_bf16 v[164:167], a[28:31], a[128:131], v[164:167]
v_mfma_f32_16x16x32_bf16 v[168:171], a[0:3], v[64:67], v[208:211]
v_mfma_f32_16x16x32_bf16 v[168:171], a[4:7], v[72:75], v[168:171]
v_mfma_f32_16x16x32_bf16 v[168:171], a[8:11], v[80:83], v[168:171]
v_mfma_f32_16x16x32_bf16 v[168:171], a[12:15], v[88:91], v[168:171]
v_mfma_f32_16x16x32_bf16 v[168:171], a[16:19], a[72:75], v[168:171]
v_mfma_f32_16x16x32_bf16 v[168:171], a[20:23], a[92:95], v[168:171]
v_mfma_f32_16x16x32_bf16 v[168:171], a[24:27], a[112:115], v[168:171]
v_mfma_f32_16x16x32_bf16 v[168:171], a[28:31], a[132:135], v[168:171]
s_waitcnt vmcnt(5)
buffer_load_dwordx4 v248, s[8:11], s45 offen offset:2048 nt lds
s_waitcnt lgkmcnt(0)
v_mfma_f32_16x16x32_bf16 v[172:175], a[32:35], v[0:3], v[200:203]
v_mfma_f32_16x16x32_bf16 v[172:175], a[36:39], v[8:11], v[172:175]
v_exp_f32 v160, v160
v_mfma_f32_16x16x32_bf16 v[172:175], a[40:43], v[16:19], v[172:175]
v_exp_f32 v161, v161
v_mfma_f32_16x16x32_bf16 v[172:175], a[44:47], v[24:27], v[172:175]
v_exp_f32 v162, v162
v_mfma_f32_16x16x32_bf16 v[172:175], a[48:51], a[64:67], v[172:175]
v_cvt_pk_bf16_f32 v160, v160, v161
v_mfma_f32_16x16x32_bf16 v[172:175], a[52:55], a[84:87], v[172:175]
v_exp_f32 v163, v163
v_mfma_f32_16x16x32_bf16 v[172:175], a[56:59], a[104:107], v[172:175]
v_exp_f32 v164, v164
v_mfma_f32_16x16x32_bf16 v[172:175], a[60:63], a[124:127], v[172:175]
v_cvt_pk_bf16_f32 v161, v162, v163
v_mfma_f32_16x16x32_bf16 v[176:179], a[32:35], v[32:35], v[204:207]
v_exp_f32 v165, v165
v_mfma_f32_16x16x32_bf16 v[176:179], a[36:39], v[40:43], v[176:179]
v_exp_f32 v166, v166
v_mfma_f32_16x16x32_bf16 v[176:179], a[40:43], v[48:51], v[176:179]
s_waitcnt vmcnt(5)
buffer_load_dwordx4 v249, s[8:11], s45 offen offset:3072 nt lds
v_mfma_f32_16x16x32_bf16 v[176:179], a[44:47], v[56:59], v[176:179]
v_cvt_pk_bf16_f32 v164, v164, v165
v_mfma_f32_16x16x32_bf16 v[176:179], a[48:51], a[68:71], v[176:179]
v_exp_f32 v167, v167
v_mfma_f32_16x16x32_bf16 v[176:179], a[52:55], a[88:91], v[176:179]
v_exp_f32 v168, v168
v_mfma_f32_16x16x32_bf16 v[176:179], a[56:59], a[108:111], v[176:179]
v_cvt_pk_bf16_f32 v165, v166, v167
v_mfma_f32_16x16x32_bf16 v[176:179], a[60:63], a[128:131], v[176:179]
v_exp_f32 v169, v169
v_mfma_f32_16x16x32_bf16 v[180:183], a[32:35], v[64:67], v[208:211]
v_exp_f32 v170, v170
v_mfma_f32_16x16x32_bf16 v[180:183], a[36:39], v[72:75], v[180:183]
v_cvt_pk_bf16_f32 v168, v168, v169
v_mfma_f32_16x16x32_bf16 v[180:183], a[40:43], v[80:83], v[180:183]
v_exp_f32 v171, v171
v_mfma_f32_16x16x32_bf16 v[180:183], a[44:47], v[88:91], v[180:183]
v_cvt_pk_bf16_f32 v169, v170, v171
v_mfma_f32_16x16x32_bf16 v[180:183], a[48:51], a[72:75], v[180:183]
s_mov_b32 s45, 266240
s_add_u32 m0, s29, 36864
v_mfma_f32_16x16x32_bf16 v[180:183], a[52:55], a[92:95], v[180:183]
s_waitcnt vmcnt(5)
buffer_load_dwordx4 v248, s[8:11], s45 offen offset:0 nt lds
v_mfma_f32_16x16x32_bf16 v[180:183], a[56:59], a[112:115], v[180:183]
v_mfma_f32_16x16x32_bf16 v[180:183], a[60:63], a[132:135], v[180:183]
v_mfma_f32_16x16x32_bf16 v[184:187], a[0:3], v[96:99], v[212:215]
v_mfma_f32_16x16x32_bf16 v[184:187], a[4:7], v[104:107], v[184:187]
v_exp_f32 v172, v172
v_exp_f32 v173, v173
v_exp_f32 v174, v174
v_cvt_pk_bf16_f32 v162, v172, v173
v_mfma_f32_16x16x32_bf16 v[184:187], a[8:11], v[112:115], v[184:187]
v_exp_f32 v175, v175
v_mfma_f32_16x16x32_bf16 v[184:187], a[12:15], v[120:123], v[184:187]
v_exp_f32 v176, v176
v_mfma_f32_16x16x32_bf16 v[184:187], a[16:19], a[76:79], v[184:187]
v_cvt_pk_bf16_f32 v163, v174, v175
v_mfma_f32_16x16x32_bf16 v[184:187], a[20:23], a[96:99], v[184:187]
v_exp_f32 v177, v177
v_mfma_f32_16x16x32_bf16 v[184:187], a[24:27], a[116:119], v[184:187]
ds_write_b128 v251, v[160:163] offset:37888
v_mfma_f32_16x16x32_bf16 v[184:187], a[28:31], a[136:139], v[184:187]
v_mfma_f32_16x16x32_bf16 v[188:191], a[0:3], v[128:131], v[216:219]
v_add_u32 v250, 0x18000, v250
ds_write_b128 v250, v[232:235] offset:0
ds_write_b128 v250, v[236:239] offset:6144
ds_write_b128 v250, v[240:243] offset:7168
s_waitcnt vmcnt(5)
buffer_load_dwordx4 v[228:231], v249, s[8:11], s45 offen offset:1024 nt
v_exp_f32 v178, v178
v_cvt_pk_bf16_f32 v166, v176, v177
v_mfma_f32_16x16x32_bf16 v[188:191], a[4:7], v[136:139], v[188:191]
v_exp_f32 v179, v179
v_mfma_f32_16x16x32_bf16 v[188:191], a[8:11], v[144:147], v[188:191]
v_exp_f32 v180, v180
v_mfma_f32_16x16x32_bf16 v[188:191], a[12:15], v[152:155], v[188:191]
v_cvt_pk_bf16_f32 v167, v178, v179
v_mfma_f32_16x16x32_bf16 v[188:191], a[16:19], a[80:83], v[188:191]
v_exp_f32 v181, v181
v_mfma_f32_16x16x32_bf16 v[188:191], a[20:23], a[100:103], v[188:191]
ds_write_b128 v251, v[164:167] offset:38912
v_mfma_f32_16x16x32_bf16 v[188:191], a[24:27], a[120:123], v[188:191]
v_exp_f32 v182, v182
v_mfma_f32_16x16x32_bf16 v[188:191], a[28:31], a[140:143], v[188:191]
v_cvt_pk_bf16_f32 v170, v180, v181
v_mfma_f32_16x16x32_bf16 v[192:195], a[32:35], v[96:99], v[212:215]
v_exp_f32 v183, v183
v_mfma_f32_16x16x32_bf16 v[192:195], a[36:39], v[104:107], v[192:195]
v_cvt_pk_bf16_f32 v171, v182, v183
ds_write_b128 v251, v[168:171] offset:39936
v_mfma_f32_16x16x32_bf16 v[192:195], a[40:43], v[112:115], v[192:195]
s_waitcnt lgkmcnt(4)
v_mfma_f32_16x16x32_bf16 v[192:195], a[44:47], v[120:123], v[192:195]
s_waitcnt vmcnt(5)
buffer_load_dwordx4 v[232:235], v248, s[8:11], s45 offen offset:2048 nt
v_mfma_f32_16x16x32_bf16 v[192:195], a[48:51], a[76:79], v[192:195]
s_waitcnt lgkmcnt(0)
s_barrier
v_add_u32 v246, s34, v246
ds_read_b64_tr_b16 a[0:1], v246 offset:0
v_mfma_f32_16x16x32_bf16 v[192:195], a[52:55], a[96:99], v[192:195]
ds_read_b64_tr_b16 a[2:3], v246 offset:2048
v_mfma_f32_16x16x32_bf16 v[192:195], a[56:59], a[116:119], v[192:195]
v_add_u32 v247, s34, v247
ds_read_b64_tr_b16 a[4:5], v247 offset:0
v_mfma_f32_16x16x32_bf16 v[192:195], a[60:63], a[136:139], v[192:195]
ds_read_b64_tr_b16 a[6:7], v247 offset:2048
ds_read_b64_tr_b16 a[8:9], v246 offset:256
v_mfma_f32_16x16x32_bf16 v[196:199], a[32:35], v[128:131], v[216:219]
ds_read_b64_tr_b16 a[10:11], v246 offset:2304
ds_read_b64_tr_b16 a[12:13], v247 offset:256
v_mfma_f32_16x16x32_bf16 v[196:199], a[36:39], v[136:139], v[196:199]
ds_read_b64_tr_b16 a[14:15], v247 offset:2304
ds_read_b64_tr_b16 a[16:17], v246 offset:512
v_mfma_f32_16x16x32_bf16 v[196:199], a[40:43], v[144:147], v[196:199]
ds_read_b64_tr_b16 a[18:19], v246 offset:2560
ds_read_b64_tr_b16 a[20:21], v247 offset:512
v_mfma_f32_16x16x32_bf16 v[196:199], a[44:47], v[152:155], v[196:199]
ds_read_b64_tr_b16 a[22:23], v247 offset:2560
v_mfma_f32_16x16x32_bf16 v[196:199], a[48:51], a[80:83], v[196:199]
v_mfma_f32_16x16x32_bf16 v[196:199], a[52:55], a[100:103], v[196:199]
v_mfma_f32_16x16x32_bf16 v[196:199], a[56:59], a[120:123], v[196:199]
s_waitcnt vmcnt(5)
buffer_load_dwordx4 v[236:239], v249, s[8:11], s45 offen offset:3072 nt
v_mfma_f32_16x16x32_bf16 v[196:199], a[60:63], a[140:143], v[196:199]
v_exp_f32 v184, v184
v_mfma_f32_16x16x32_bf16 a[224:227], a[244:247], v[160:163], a[224:227]
v_exp_f32 v185, v185
v_mfma_f32_16x16x32_bf16 a[228:231], a[244:247], v[164:167], a[228:231]
v_exp_f32 v186, v186
v_mfma_f32_16x16x32_bf16 a[232:235], a[244:247], v[168:171], a[232:235]
v_add_u32 v250, 0xffff0000, v250
ds_read_b128 v[172:175], v250 offset:5120
s_waitcnt lgkmcnt(5)
v_mfma_f32_16x16x32_bf16 v[4:7], a[0:3], v[160:163], v[4:7]
v_cvt_pk_bf16_f32 v184, v184, v185
ds_read_b64_tr_b16 a[24:25], v246 offset:768
v_mfma_f32_16x16x32_bf16 v[68:71], a[0:3], v[164:167], v[68:71]
ds_read_b128 v[176:179], v250 offset:6144
ds_read_b64_tr_b16 a[26:27], v246 offset:2816
v_mfma_f32_16x16x32_bf16 v[132:135], a[0:3], v[168:171], v[132:135]
v_exp_f32 v187, v187
v_mfma_f32_16x16x32_bf16 v[12:15], a[4:7], v[160:163], v[12:15]
ds_read_b128 v[180:183], v250 offset:7168
ds_read_b64_tr_b16 a[28:29], v247 offset:768
v_mfma_f32_16x16x32_bf16 v[76:79], a[4:7], v[164:167], v[76:79]
v_exp_f32 v188, v188
v_mfma_f32_16x16x32_bf16 v[140:143], a[4:7], v[168:171], v[140:143]
v_cvt_pk_bf16_f32 v185, v186, v187
ds_read_b64_tr_b16 a[30:31], v247 offset:2816
v_mfma_f32_16x16x32_bf16 v[20:23], a[8:11], v[160:163], v[20:23]
s_mov_b32 s46, 262144
s_add_u32 m0, s29, 65536
v_mfma_f32_16x16x32_bf16 v[84:87], a[8:11], v[164:167], v[84:87]
s_waitcnt vmcnt(5)
buffer_load_dwordx4 v248, s[12:15], s46 offen offset:0 nt lds
v_mfma_f32_16x16x32_bf16 v[148:151], a[8:11], v[168:171], v[148:151]
v_exp_f32 v189, v189
v_mfma_f32_16x16x32_bf16 v[28:31], a[12:15], v[160:163], v[28:31]
v_add_u32 v246, s33, v246
ds_read_b64_tr_b16 a[32:33], v246 offset:0
v_mfma_f32_16x16x32_bf16 v[92:95], a[12:15], v[164:167], v[92:95]
ds_read_b64_tr_b16 a[34:35], v246 offset:2048
v_mfma_f32_16x16x32_bf16 v[156:159], a[12:15], v[168:171], v[156:159]
s_waitcnt lgkmcnt(3)
v_mfma_f32_16x16x32_bf16 v[36:39], a[16:19], v[160:163], v[36:39]
v_exp_f32 v190, v190
v_mfma_f32_16x16x32_bf16 v[100:103], a[16:19], v[164:167], v[100:103]
v_cvt_pk_bf16_f32 v188, v188, v189
v_mfma_f32_16x16x32_bf16 a[144:147], a[16:19], v[168:171], a[144:147]
v_add_u32 v247, s33, v247
ds_read_b64_tr_b16 a[36:37], v247 offset:0
v_mfma_f32_16x16x32_bf16 v[44:47], a[20:23], v[160:163], v[44:47]
ds_read_b64_tr_b16 a[38:39], v247 offset:2048
ds_read_b64_tr_b16 a[40:41], v246 offset:256
v_mfma_f32_16x16x32_bf16 v[108:111], a[20:23], v[164:167], v[108:111]
v_exp_f32 v191, v191
v_mfma_f32_16x16x32_bf16 a[148:151], a[20:23], v[168:171], a[148:151]
v_cvt_pk_bf16_f32 v189, v190, v191
ds_read_b64_tr_b16 a[42:43], v246 offset:2304
v_mfma_f32_16x16x32_bf16 v[52:55], a[24:27], v[160:163], v[52:55]
s_waitcnt vmcnt(5)
buffer_load_dwordx4 v249, s[12:15], s46 offen offset:1024 nt lds
v_mfma_f32_16x16x32_bf16 v[116:119], a[24:27], v[164:167], v[116:119]
v_exp_f32 v192, v192
v_mfma_f32_16x16x32_bf16 a[152:155], a[24:27], v[168:171], a[152:155]
ds_read_b64_tr_b16 a[44:45], v247 offset:256
s_waitcnt lgkmcnt(5)
v_mfma_f32_16x16x32_bf16 v[60:63], a[28:31], v[160:163], v[60:63]
ds_read_b64_tr_b16 a[46:47], v247 offset:2304
ds_read_b64_tr_b16 a[48:49], v246 offset:512
v_mfma_f32_16x16x32_bf16 v[124:127], a[28:31], v[164:167], v[124:127]
v_exp_f32 v193, v193
v_mfma_f32_16x16x32_bf16 a[156:159], a[28:31], v[168:171], a[156:159]
v_exp_f32 v194, v194
v_mfma_f32_16x16x32_bf16 v[4:7], a[32:35], v[172:175], v[4:7]
ds_read_b64_tr_b16 a[50:51], v246 offset:2560
v_cvt_pk_bf16_f32 v186, v192, v193
v_mfma_f32_16x16x32_bf16 v[68:71], a[32:35], v[176:179], v[68:71]
ds_read_b64_tr_b16 a[52:53], v247 offset:512
ds_read_b64_tr_b16 a[54:55], v247 offset:2560
v_mfma_f32_16x16x32_bf16 v[132:135], a[32:35], v[180:183], v[132:135]
ds_read_b64_tr_b16 a[56:57], v246 offset:768
s_waitcnt lgkmcnt(7)
v_mfma_f32_16x16x32_bf16 v[12:15], a[36:39], v[172:175], v[12:15]
v_exp_f32 v195, v195
v_mfma_f32_16x16x32_bf16 v[76:79], a[36:39], v[176:179], v[76:79]
v_exp_f32 v196, v196
v_mfma_f32_16x16x32_bf16 v[140:143], a[36:39], v[180:183], v[140:143]
s_waitcnt vmcnt(5)
buffer_load_dwordx4 v248, s[12:15], s46 offen offset:2048 nt lds
v_mfma_f32_16x16x32_bf16 v[20:23], a[40:43], v[172:175], v[20:23]
ds_read_b64_tr_b16 a[58:59], v246 offset:2816
v_cvt_pk_bf16_f32 v187, v194, v195
v_mfma_f32_16x16x32_bf16 v[84:87], a[40:43], v[176:179], v[84:87]
ds_read_b64_tr_b16 a[60:61], v247 offset:768
ds_read_b64_tr_b16 a[62:63], v247 offset:2816
v_mfma_f32_16x16x32_bf16 v[148:151], a[40:43], v[180:183], v[148:151]
s_waitcnt lgkmcnt(4)
v_mfma_f32_16x16x32_bf16 v[28:31], a[44:47], v[172:175], v[28:31]
v_exp_f32 v197, v197
v_mfma_f32_16x16x32_bf16 v[92:95], a[44:47], v[176:179], v[92:95]
v_add_u32 v251, 0x10000, v251
ds_write_b128 v251, v[184:187] offset:6144
v_mfma_f32_16x16x32_bf16 v[156:159], a[44:47], v[180:183], v[156:159]
v_exp_f32 v198, v198
v_mfma_f32_16x16x32_bf16 v[36:39], a[48:51], v[172:175], v[36:39]
v_cvt_pk_bf16_f32 v190, v196, v197
v_mfma_f32_16x16x32_bf16 v[100:103], a[48:51], v[176:179], v[100:103]
v_exp_f32 v199, v199
v_mfma_f32_16x16x32_bf16 a[144:147], a[48:51], v[180:183], a[144:147]
v_cvt_pk_bf16_f32 v191, v198, v199
ds_write_b128 v251, v[188:191] offset:7168
v_mfma_f32_16x16x32_bf16 v[44:47], a[52:55], v[172:175], v[44:47]
v_add_u32 v250, 0x10000, v250
ds_write_b128 v250, a[248:251] offset:37888
ds_write_b128 v250, a[252:255] offset:38912
ds_write_b128 v250, v[220:223] offset:39936
v_mfma_f32_16x16x32_bf16 v[108:111], a[52:55], v[176:179], v[108:111]
s_waitcnt vmcnt(5)
buffer_load_dwordx4 v249, s[12:15], s46 offen offset:3072 nt lds
v_mfma_f32_16x16x32_bf16 a[148:151], a[52:55], v[180:183], a[148:151]
s_waitcnt lgkmcnt(4)
v_mfma_f32_16x16x32_bf16 v[52:55], a[56:59], v[172:175], v[52:55]
v_mfma_f32_16x16x32_bf16 v[116:119], a[56:59], v[176:179], v[116:119]
v_mfma_f32_16x16x32_bf16 a[152:155], a[56:59], v[180:183], a[152:155]
v_mfma_f32_16x16x32_bf16 v[60:63], a[60:63], v[172:175], v[60:63]
v_mfma_f32_16x16x32_bf16 v[124:127], a[60:63], v[176:179], v[124:127]
v_mfma_f32_16x16x32_bf16 a[156:159], a[60:63], v[180:183], a[156:159]
v_mfma_f32_16x16x32_bf16 a[236:239], a[244:247], v[184:187], a[236:239]
v_mfma_f32_16x16x32_bf16 a[240:243], a[244:247], v[188:191], a[240:243]
v_mfma_f32_16x16x32_bf16 a[160:163], a[0:3], v[184:187], a[160:163]
s_mov_b32 s46, 266240
s_add_u32 m0, s29, 69632
v_mfma_f32_16x16x32_bf16 a[192:195], a[0:3], v[188:191], a[192:195]
s_waitcnt vmcnt(5)
buffer_load_dwordx4 v248, s[12:15], s46 offen offset:0 nt lds
s_waitcnt lgkmcnt(0)
s_barrier
v_add_u32 v244, 0x10000, v244
ds_read_b128 a[0:3], v244 offset:0
v_mfma_f32_16x16x32_bf16 a[164:167], a[4:7], v[184:187], a[164:167]
v_add_u32 v250, 0xffff8000, v250
ds_read_b128 v[192:195], v250 offset:6144
v_mfma_f32_16x16x32_bf16 a[196:199], a[4:7], v[188:191], a[196:199]
ds_read_b128 v[196:199], v250 offset:7168
ds_read_b128 a[4:7], v244 offset:256
v_mfma_f32_16x16x32_bf16 a[168:171], a[8:11], v[184:187], a[168:171]
v_mfma_f32_16x16x32_bf16 a[200:203], a[8:11], v[188:191], a[200:203]
ds_read_b128 a[8:11], v244 offset:512
v_mfma_f32_16x16x32_bf16 a[172:175], a[12:15], v[184:187], a[172:175]
v_mfma_f32_16x16x32_bf16 a[204:207], a[12:15], v[188:191], a[204:207]
ds_read_b128 a[12:15], v244 offset:768
v_mfma_f32_16x16x32_bf16 a[176:179], a[16:19], v[184:187], a[176:179]
v_mfma_f32_16x16x32_bf16 a[208:211], a[16:19], v[188:191], a[208:211]
v_add_u32 v245, 0x10000, v245
ds_read_b128 a[16:19], v245 offset:0
v_mfma_f32_16x16x32_bf16 a[180:183], a[20:23], v[184:187], a[180:183]
v_mfma_f32_16x16x32_bf16 a[212:215], a[20:23], v[188:191], a[212:215]
ds_read_b128 a[20:23], v245 offset:256
v_mfma_f32_16x16x32_bf16 a[184:187], a[24:27], v[184:187], a[184:187]
s_waitcnt vmcnt(5)
buffer_load_dwordx4 v249, s[12:15], s46 offen offset:1024 nt lds
v_mfma_f32_16x16x32_bf16 a[216:219], a[24:27], v[188:191], a[216:219]
ds_read_b128 a[24:27], v245 offset:512
v_mfma_f32_16x16x32_bf16 a[188:191], a[28:31], v[184:187], a[188:191]
v_mfma_f32_16x16x32_bf16 a[220:223], a[28:31], v[188:191], a[220:223]
ds_read_b128 a[28:31], v245 offset:768
s_waitcnt lgkmcnt(8)
v_mfma_f32_16x16x32_bf16 a[160:163], a[32:35], v[192:195], a[160:163]
s_waitcnt lgkmcnt(7)
v_mfma_f32_16x16x32_bf16 a[192:195], a[32:35], v[196:199], a[192:195]
ds_read_b128 a[32:35], v244 offset:2048
v_mfma_f32_16x16x32_bf16 a[164:167], a[36:39], v[192:195], a[164:167]
v_mfma_f32_16x16x32_bf16 a[196:199], a[36:39], v[196:199], a[196:199]
ds_read_b128 a[36:39], v244 offset:2304
v_mfma_f32_16x16x32_bf16 a[168:171], a[40:43], v[192:195], a[168:171]
v_mfma_f32_16x16x32_bf16 a[200:203], a[40:43], v[196:199], a[200:203]
v_mfma_f32_16x16x32_bf16 a[172:175], a[44:47], v[192:195], a[172:175]
v_mfma_f32_16x16x32_bf16 a[204:207], a[44:47], v[196:199], a[204:207]
s_waitcnt vmcnt(5)
buffer_load_dwordx4 v248, s[12:15], s46 offen offset:2048 nt lds
v_mfma_f32_16x16x32_bf16 a[176:179], a[48:51], v[192:195], a[176:179]
v_mfma_f32_16x16x32_bf16 a[208:211], a[48:51], v[196:199], a[208:211]
v_add_u32 v250, 0xffff0000, v250
ds_write_b128 v250, v[224:227] offset:6144
v_mfma_f32_16x16x32_bf16 a[180:183], a[52:55], v[192:195], a[180:183]
v_mfma_f32_16x16x32_bf16 a[212:215], a[52:55], v[196:199], a[212:215]
v_mfma_f32_16x16x32_bf16 a[184:187], a[56:59], v[192:195], a[184:187]
v_mfma_f32_16x16x32_bf16 a[216:219], a[56:59], v[196:199], a[216:219]
v_mfma_f32_16x16x32_bf16 a[188:191], a[60:63], v[192:195], a[188:191]
v_mfma_f32_16x16x32_bf16 a[220:223], a[60:63], v[196:199], a[220:223]
ds_read_b128 a[40:43], v244 offset:2560
v_mfma_f32_16x16x32_bf16 v[160:163], a[0:3], v[0:3], v[200:203]
ds_read_b128 a[44:47], v244 offset:2816
s_waitcnt lgkmcnt(11)
v_mfma_f32_16x16x32_bf16 v[160:163], a[4:7], v[8:11], v[160:163]
s_waitcnt lgkmcnt(10)
v_mfma_f32_16x16x32_bf16 v[160:163], a[8:11], v[16:19], v[160:163]
s_waitcnt vmcnt(5)
buffer_load_dwordx4 v249, s[12:15], s46 offen offset:3072 nt lds
s_waitcnt lgkmcnt(9)
v_mfma_f32_16x16x32_bf16 v[160:163], a[12:15], v[24:27], v[160:163]
ds_read_b128 a[48:51], v245 offset:2048
s_waitcnt lgkmcnt(9)
v_mfma_f32_16x16x32_bf16 v[160:163], a[16:19], a[64:67], v[160:163]
ds_read_b128 a[52:55], v245 offset:2304
s_waitcnt lgkmcnt(9)
v_mfma_f32_16x16x32_bf16 v[160:163], a[20:23], a[84:87], v[160:163]
ds_read_b128 a[56:59], v245 offset:2560
s_waitcnt lgkmcnt(9)
v_mfma_f32_16x16x32_bf16 v[160:163], a[24:27], a[104:107], v[160:163]
ds_read_b128 a[60:63], v245 offset:2816
s_waitcnt lgkmcnt(9)
v_mfma_f32_16x16x32_bf16 v[160:163], a[28:31], a[124:127], v[160:163]
v_mfma_f32_16x16x32_bf16 v[164:167], a[0:3], v[32:35], v[204:207]
v_mfma_f32_16x16x32_bf16 v[164:167], a[4:7], v[40:43], v[164:167]
v_mfma_f32_16x16x32_bf16 v[164:167], a[8:11], v[48:51], v[164:167]
v_mfma_f32_16x16x32_bf16 v[164:167], a[12:15], v[56:59], v[164:167]
v_mfma_f32_16x16x32_bf16 v[164:167], a[16:19], a[68:71], v[164:167]
v_mfma_f32_16x16x32_bf16 v[164:167], a[20:23], a[88:91], v[164:167]
s_mov_b32 s45, 294912
s_add_u32 m0, s29, 98304
v_mfma_f32_16x16x32_bf16 v[164:167], a[24:27], a[108:111], v[164:167]
s_waitcnt vmcnt(5)
buffer_load_dwordx4 v248, s[8:11], s45 offen offset:0 nt lds
v_mfma_f32_16x16x32_bf16 v[164:167], a[28:31], a[128:131], v[164:167]
v_mfma_f32_16x16x32_bf16 v[168:171], a[0:3], v[64:67], v[208:211]
v_mfma_f32_16x16x32_bf16 v[168:171], a[4:7], v[72:75], v[168:171]
v_mfma_f32_16x16x32_bf16 v[168:171], a[8:11], v[80:83], v[168:171]
v_mfma_f32_16x16x32_bf16 v[168:171], a[12:15], v[88:91], v[168:171]
v_mfma_f32_16x16x32_bf16 v[168:171], a[16:19], a[72:75], v[168:171]
v_mfma_f32_16x16x32_bf16 v[168:171], a[20:23], a[92:95], v[168:171]
v_mfma_f32_16x16x32_bf16 v[168:171], a[24:27], a[112:115], v[168:171]
v_mfma_f32_16x16x32_bf16 v[168:171], a[28:31], a[132:135], v[168:171]
s_waitcnt lgkmcnt(0)
v_mfma_f32_16x16x32_bf16 v[172:175], a[32:35], v[0:3], v[200:203]
v_mfma_f32_16x16x32_bf16 v[172:175], a[36:39], v[8:11], v[172:175]
s_waitcnt vmcnt(5)
buffer_load_dwordx4 v249, s[8:11], s45 offen offset:1024 nt lds
v_mfma_f32_16x16x32_bf16 v[172:175], a[40:43], v[16:19], v[172:175]
v_exp_f32 v160, v160
v_mfma_f32_16x16x32_bf16 v[172:175], a[44:47], v[24:27], v[172:175]
v_exp_f32 v161, v161
v_mfma_f32_16x16x32_bf16 v[172:175], a[48:51], a[64:67], v[172:175]
v_exp_f32 v162, v162
v_mfma_f32_16x16x32_bf16 v[172:175], a[52:55], a[84:87], v[172:175]
v_cvt_pk_bf16_f32 v160, v160, v161
v_mfma_f32_16x16x32_bf16 v[172:175], a[56:59], a[104:107], v[172:175]
v_exp_f32 v163, v163
v_mfma_f32_16x16x32_bf16 v[172:175], a[60:63], a[124:127], v[172:175]
v_exp_f32 v164, v164
v_mfma_f32_16x16x32_bf16 v[176:179], a[32:35], v[32:35], v[204:207]
v_cvt_pk_bf16_f32 v161, v162, v163
v_mfma_f32_16x16x32_bf16 v[176:179], a[36:39], v[40:43], v[176:179]
v_exp_f32 v165, v165
v_mfma_f32_16x16x32_bf16 v[176:179], a[40:43], v[48:51], v[176:179]
v_exp_f32 v166, v166
v_mfma_f32_16x16x32_bf16 v[176:179], a[44:47], v[56:59], v[176:179]
v_cvt_pk_bf16_f32 v164, v164, v165
v_mfma_f32_16x16x32_bf16 v[176:179], a[48:51], a[68:71], v[176:179]
s_waitcnt vmcnt(5)
buffer_load_dwordx4 v248, s[8:11], s45 offen offset:2048 nt lds
v_mfma_f32_16x16x32_bf16 v[176:179], a[52:55], a[88:91], v[176:179]
v_exp_f32 v167, v167
v_mfma_f32_16x16x32_bf16 v[176:179], a[56:59], a[108:111], v[176:179]
v_exp_f32 v168, v168
v_mfma_f32_16x16x32_bf16 v[176:179], a[60:63], a[128:131], v[176:179]
v_cvt_pk_bf16_f32 v165, v166, v167
v_mfma_f32_16x16x32_bf16 v[180:183], a[32:35], v[64:67], v[208:211]
v_exp_f32 v169, v169
v_mfma_f32_16x16x32_bf16 v[180:183], a[36:39], v[72:75], v[180:183]
v_exp_f32 v170, v170
v_mfma_f32_16x16x32_bf16 v[180:183], a[40:43], v[80:83], v[180:183]
v_cvt_pk_bf16_f32 v168, v168, v169
v_mfma_f32_16x16x32_bf16 v[180:183], a[44:47], v[88:91], v[180:183]
v_exp_f32 v171, v171
v_mfma_f32_16x16x32_bf16 v[180:183], a[48:51], a[72:75], v[180:183]
v_cvt_pk_bf16_f32 v169, v170, v171
v_mfma_f32_16x16x32_bf16 v[180:183], a[52:55], a[92:95], v[180:183]
v_mfma_f32_16x16x32_bf16 v[180:183], a[56:59], a[112:115], v[180:183]
v_mfma_f32_16x16x32_bf16 v[180:183], a[60:63], a[132:135], v[180:183]
s_waitcnt vmcnt(5)
buffer_load_dwordx4 v249, s[8:11], s45 offen offset:3072 nt lds
v_mfma_f32_16x16x32_bf16 v[184:187], a[0:3], v[96:99], v[212:215]
v_mfma_f32_16x16x32_bf16 v[184:187], a[4:7], v[104:107], v[184:187]
v_exp_f32 v172, v172
v_exp_f32 v173, v173
v_exp_f32 v174, v174
v_cvt_pk_bf16_f32 v162, v172, v173
v_mfma_f32_16x16x32_bf16 v[184:187], a[8:11], v[112:115], v[184:187]
v_exp_f32 v175, v175
v_mfma_f32_16x16x32_bf16 v[184:187], a[12:15], v[120:123], v[184:187]
v_exp_f32 v176, v176
v_mfma_f32_16x16x32_bf16 v[184:187], a[16:19], a[76:79], v[184:187]
v_cvt_pk_bf16_f32 v163, v174, v175
v_mfma_f32_16x16x32_bf16 v[184:187], a[20:23], a[96:99], v[184:187]
v_exp_f32 v177, v177
v_mfma_f32_16x16x32_bf16 v[184:187], a[24:27], a[116:119], v[184:187]
ds_write_b128 v251, v[160:163] offset:37888
v_mfma_f32_16x16x32_bf16 v[184:187], a[28:31], a[136:139], v[184:187]
v_exp_f32 v178, v178
v_mfma_f32_16x16x32_bf16 v[188:191], a[0:3], v[128:131], v[216:219]
v_cvt_pk_bf16_f32 v166, v176, v177
v_mfma_f32_16x16x32_bf16 v[188:191], a[4:7], v[136:139], v[188:191]
s_mov_b32 s45, 299008
s_add_u32 m0, s29, 102400
v_mfma_f32_16x16x32_bf16 v[188:191], a[8:11], v[144:147], v[188:191]
s_waitcnt vmcnt(5)
buffer_load_dwordx4 v248, s[8:11], s45 offen offset:0 nt lds
v_exp_f32 v179, v179
v_mfma_f32_16x16x32_bf16 v[188:191], a[12:15], v[152:155], v[188:191]
v_exp_f32 v180, v180
v_mfma_f32_16x16x32_bf16 v[188:191], a[16:19], a[80:83], v[188:191]
v_cvt_pk_bf16_f32 v167, v178, v179
v_mfma_f32_16x16x32_bf16 v[188:191], a[20:23], a[100:103], v[188:191]
v_exp_f32 v181, v181
v_mfma_f32_16x16x32_bf16 v[188:191], a[24:27], a[120:123], v[188:191]
ds_write_b128 v251, v[164:167] offset:38912
v_mfma_f32_16x16x32_bf16 v[188:191], a[28:31], a[140:143], v[188:191]
v_exp_f32 v182, v182
v_mfma_f32_16x16x32_bf16 v[192:195], a[32:35], v[96:99], v[212:215]
v_cvt_pk_bf16_f32 v170, v180, v181
v_mfma_f32_16x16x32_bf16 v[192:195], a[36:39], v[104:107], v[192:195]
v_exp_f32 v183, v183
v_mfma_f32_16x16x32_bf16 v[192:195], a[40:43], v[112:115], v[192:195]
v_cvt_pk_bf16_f32 v171, v182, v183
ds_write_b128 v251, v[168:171] offset:39936
v_mfma_f32_16x16x32_bf16 v[192:195], a[44:47], v[120:123], v[192:195]
v_mfma_f32_16x16x32_bf16 v[192:195], a[48:51], a[76:79], v[192:195]
s_waitcnt lgkmcnt(0)
s_barrier
v_add_u32 v246, s35, v246
ds_read_b64_tr_b16 a[0:1], v246 offset:0
v_mfma_f32_16x16x32_bf16 v[192:195], a[52:55], a[96:99], v[192:195]
s_waitcnt vmcnt(5)
buffer_load_dwordx4 v[240:243], v249, s[8:11], s45 offen offset:1024 nt
v_mfma_f32_16x16x32_bf16 v[192:195], a[56:59], a[116:119], v[192:195]
ds_read_b64_tr_b16 a[2:3], v246 offset:2048
v_mfma_f32_16x16x32_bf16 v[192:195], a[60:63], a[136:139], v[192:195]
ds_write_b128 v250, v[228:231] offset:37888
v_mfma_f32_16x16x32_bf16 v[196:199], a[32:35], v[128:131], v[216:219]
v_add_u32 v247, s35, v247
ds_read_b64_tr_b16 a[4:5], v247 offset:0
v_mfma_f32_16x16x32_bf16 v[196:199], a[36:39], v[136:139], v[196:199]
ds_read_b64_tr_b16 a[6:7], v247 offset:2048
ds_read_b64_tr_b16 a[8:9], v246 offset:256
v_mfma_f32_16x16x32_bf16 v[196:199], a[40:43], v[144:147], v[196:199]
ds_read_b64_tr_b16 a[10:11], v246 offset:2304
ds_read_b64_tr_b16 a[12:13], v247 offset:256
v_mfma_f32_16x16x32_bf16 v[196:199], a[44:47], v[152:155], v[196:199]
ds_read_b64_tr_b16 a[14:15], v247 offset:2304
ds_read_b64_tr_b16 a[16:17], v246 offset:512
v_mfma_f32_16x16x32_bf16 v[196:199], a[48:51], a[80:83], v[196:199]
ds_read_b64_tr_b16 a[18:19], v246 offset:2560
ds_read_b64_tr_b16 a[20:21], v247 offset:512
v_mfma_f32_16x16x32_bf16 v[196:199], a[52:55], a[100:103], v[196:199]
ds_read_b64_tr_b16 a[22:23], v247 offset:2560
v_mfma_f32_16x16x32_bf16 v[196:199], a[56:59], a[120:123], v[196:199]
v_mfma_f32_16x16x32_bf16 v[196:199], a[60:63], a[140:143], v[196:199]
ds_read_b64_tr_b16 a[24:25], v246 offset:768
v_mfma_f32_16x16x32_bf16 a[224:227], a[244:247], v[160:163], a[224:227]
s_waitcnt vmcnt(5)
buffer_load_dwordx4 a[248:251], v248, s[8:11], s45 offen offset:2048 nt
v_mfma_f32_16x16x32_bf16 a[228:231], a[244:247], v[164:167], a[228:231]
v_exp_f32 v184, v184
v_mfma_f32_16x16x32_bf16 a[232:235], a[244:247], v[168:171], a[232:235]
v_add_u32 v250, 0x18000, v250
ds_read_b128 v[172:175], v250 offset:5120
s_waitcnt lgkmcnt(8)
v_add_u32 v250, 0xffff0000, v250
ds_write_b128 v250, v[232:235] offset:6144
s_waitcnt lgkmcnt(7)
v_mfma_f32_16x16x32_bf16 v[4:7], a[0:3], v[160:163], v[4:7]
v_exp_f32 v185, v185
v_mfma_f32_16x16x32_bf16 v[68:71], a[0:3], v[164:167], v[68:71]
v_add_u32 v250, 0x10000, v250
ds_read_b128 v[176:179], v250 offset:6144
ds_read_b64_tr_b16 a[26:27], v246 offset:2816
v_mfma_f32_16x16x32_bf16 v[132:135], a[0:3], v[168:171], v[132:135]
v_exp_f32 v186, v186
v_mfma_f32_16x16x32_bf16 v[12:15], a[4:7], v[160:163], v[12:15]
ds_read_b128 v[180:183], v250 offset:7168
v_cvt_pk_bf16_f32 v184, v184, v185
v_mfma_f32_16x16x32_bf16 v[76:79], a[4:7], v[164:167], v[76:79]
v_exp_f32 v187, v187
v_mfma_f32_16x16x32_bf16 v[140:143], a[4:7], v[168:171], v[140:143]
v_exp_f32 v188, v188
v_mfma_f32_16x16x32_bf16 v[20:23], a[8:11], v[160:163], v[20:23]
v_cvt_pk_bf16_f32 v185, v186, v187
ds_read_b64_tr_b16 a[28:29], v247 offset:768
v_mfma_f32_16x16x32_bf16 v[84:87], a[8:11], v[164:167], v[84:87]
ds_read_b64_tr_b16 a[30:31], v247 offset:2816
v_mfma_f32_16x16x32_bf16 v[148:151], a[8:11], v[168:171], v[148:151]
v_mfma_f32_16x16x32_bf16 v[28:31], a[12:15], v[160:163], v[28:31]
s_waitcnt vmcnt(5)
buffer_load_dwordx4 a[252:255], v249, s[8:11], s45 offen offset:3072 nt
v_mfma_f32_16x16x32_bf16 v[92:95], a[12:15], v[164:167], v[92:95]
v_add_u32 v250, 0xffff0000, v250
ds_write_b128 v250, v[236:239] offset:7168
v_mfma_f32_16x16x32_bf16 v[156:159], a[12:15], v[168:171], v[156:159]
s_waitcnt lgkmcnt(3)
v_mfma_f32_16x16x32_bf16 v[36:39], a[16:19], v[160:163], v[36:39]
v_exp_f32 v189, v189
v_mfma_f32_16x16x32_bf16 v[100:103], a[16:19], v[164:167], v[100:103]
v_add_u32 v246, s33, v246
ds_read_b64_tr_b16 a[32:33], v246 offset:0
v_mfma_f32_16x16x32_bf16 a[144:147], a[16:19], v[168:171], a[144:147]
ds_read_b64_tr_b16 a[34:35], v246 offset:2048
v_mfma_f32_16x16x32_bf16 v[44:47], a[20:23], v[160:163], v[44:47]
v_exp_f32 v190, v190
v_mfma_f32_16x16x32_bf16 v[108:111], a[20:23], v[164:167], v[108:111]
v_cvt_pk_bf16_f32 v188, v188, v189
v_mfma_f32_16x16x32_bf16 a[148:151], a[20:23], v[168:171], a[148:151]
v_add_u32 v247, s33, v247
ds_read_b64_tr_b16 a[36:37], v247 offset:0
v_mfma_f32_16x16x32_bf16 v[52:55], a[24:27], v[160:163], v[52:55]
ds_read_b64_tr_b16 a[38:39], v247 offset:2048
ds_read_b64_tr_b16 a[40:41], v246 offset:256
v_mfma_f32_16x16x32_bf16 v[116:119], a[24:27], v[164:167], v[116:119]
s_mov_b32 s46, 294912
s_add_u32 m0, s29, 131072
v_mfma_f32_16x16x32_bf16 a[152:155], a[24:27], v[168:171], a[152:155]
s_waitcnt vmcnt(5)
buffer_load_dwordx4 v248, s[12:15], s46 offen offset:0 nt lds
s_waitcnt lgkmcnt(4)
v_mfma_f32_16x16x32_bf16 v[60:63], a[28:31], v[160:163], v[60:63]
v_exp_f32 v191, v191
v_mfma_f32_16x16x32_bf16 v[124:127], a[28:31], v[164:167], v[124:127]
v_cvt_pk_bf16_f32 v189, v190, v191
ds_read_b64_tr_b16 a[42:43], v246 offset:2304
v_mfma_f32_16x16x32_bf16 a[156:159], a[28:31], v[168:171], a[156:159]
ds_read_b64_tr_b16 a[44:45], v247 offset:256
s_waitcnt lgkmcnt(5)
v_mfma_f32_16x16x32_bf16 v[4:7], a[32:35], v[172:175], v[4:7]
v_exp_f32 v192, v192
v_mfma_f32_16x16x32_bf16 v[68:71], a[32:35], v[176:179], v[68:71]
ds_read_b64_tr_b16 a[46:47], v247 offset:2304
ds_read_b64_tr_b16 a[48:49], v246 offset:512
v_mfma_f32_16x16x32_bf16 v[132:135], a[32:35], v[180:183], v[132:135]
ds_read_b64_tr_b16 a[50:51], v246 offset:2560
s_waitcnt lgkmcnt(5)
v_mfma_f32_16x16x32_bf16 v[12:15], a[36:39], v[172:175], v[12:15]
v_exp_f32 v193, v193
v_mfma_f32_16x16x32_bf16 v[76:79], a[36:39], v[176:179], v[76:79]
v_exp_f32 v194, v194
v_mfma_f32_16x16x32_bf16 v[140:143], a[36:39], v[180:183], v[140:143]
v_cvt_pk_bf16_f32 v186, v192, v193
s_waitcnt lgkmcnt(4)
v_mfma_f32_16x16x32_bf16 v[20:23], a[40:43], v[172:175], v[20:23]
ds_read_b64_tr_b16 a[52:53], v247 offset:512
ds_read_b64_tr_b16 a[54:55], v247 offset:2560
v_mfma_f32_16x16x32_bf16 v[84:87], a[40:43], v[176:179], v[84:87]
s_waitcnt vmcnt(5)
buffer_load_dwordx4 v249, s[12:15], s46 offen offset:1024 nt lds
v_mfma_f32_16x16x32_bf16 v[148:151], a[40:43], v[180:183], v[148:151]
ds_read_b64_tr_b16 a[56:57], v246 offset:768
s_waitcnt lgkmcnt(4)
v_mfma_f32_16x16x32_bf16 v[28:31], a[44:47], v[172:175], v[28:31]
v_exp_f32 v195, v195
v_mfma_f32_16x16x32_bf16 v[92:95], a[44:47], v[176:179], v[92:95]
v_exp_f32 v196, v196
v_mfma_f32_16x16x32_bf16 v[156:159], a[44:47], v[180:183], v[156:159]
ds_read_b64_tr_b16 a[58:59], v246 offset:2816
s_waitcnt lgkmcnt(4)
v_mfma_f32_16x16x32_bf16 v[36:39], a[48:51], v[172:175], v[36:39]
v_cvt_pk_bf16_f32 v187, v194, v195
ds_read_b64_tr_b16 a[60:61], v247 offset:768
v_mfma_f32_16x16x32_bf16 v[100:103], a[48:51], v[176:179], v[100:103]
ds_read_b64_tr_b16 a[62:63], v247 offset:2816
v_mfma_f32_16x16x32_bf16 a[144:147], a[48:51], v[180:183], a[144:147]
s_waitcnt lgkmcnt(4)
v_mfma_f32_16x16x32_bf16 v[44:47], a[52:55], v[172:175], v[44:47]
v_exp_f32 v197, v197
v_mfma_f32_16x16x32_bf16 v[108:111], a[52:55], v[176:179], v[108:111]
v_add_u32 v251, 0x8000, v251
ds_write_b128 v251, v[184:187] offset:38912
v_mfma_f32_16x16x32_bf16 a[148:151], a[52:55], v[180:183], a[148:151]
s_waitcnt lgkmcnt(3)
v_mfma_f32_16x16x32_bf16 v[52:55], a[56:59], v[172:175], v[52:55]
s_waitcnt vmcnt(5)
buffer_load_dwordx4 v248, s[12:15], s46 offen offset:2048 nt lds
v_exp_f32 v198, v198
v_mfma_f32_16x16x32_bf16 v[116:119], a[56:59], v[176:179], v[116:119]
v_cvt_pk_bf16_f32 v190, v196, v197
v_mfma_f32_16x16x32_bf16 a[152:155], a[56:59], v[180:183], a[152:155]
v_exp_f32 v199, v199
s_waitcnt lgkmcnt(1)
v_mfma_f32_16x16x32_bf16 v[60:63], a[60:63], v[172:175], v[60:63]
v_cvt_pk_bf16_f32 v191, v198, v199
ds_write_b128 v251, v[188:191] offset:39936
v_mfma_f32_16x16x32_bf16 v[124:127], a[60:63], v[176:179], v[124:127]
v_mfma_f32_16x16x32_bf16 a[156:159], a[60:63], v[180:183], a[156:159]
v_mfma_f32_16x16x32_bf16 a[236:239], a[244:247], v[184:187], a[236:239]
v_mfma_f32_16x16x32_bf16 a[240:243], a[244:247], v[188:191], a[240:243]
v_mfma_f32_16x16x32_bf16 a[160:163], a[0:3], v[184:187], a[160:163]
v_mfma_f32_16x16x32_bf16 a[192:195], a[0:3], v[188:191], a[192:195]
s_waitcnt lgkmcnt(0)
s_barrier
v_add_u32 v244, 0xfffe8000, v244
ds_read_b128 a[0:3], v244 offset:0
v_mfma_f32_16x16x32_bf16 a[164:167], a[4:7], v[184:187], a[164:167]
v_add_u32 v250, 0x10000, v250
ds_read_b128 v[192:195], v250 offset:38912
v_mfma_f32_16x16x32_bf16 a[196:199], a[4:7], v[188:191], a[196:199]
ds_read_b128 v[196:199], v250 offset:39936
s_waitcnt vmcnt(5)
buffer_load_dwordx4 v249, s[12:15], s46 offen offset:3072 nt lds
v_mfma_f32_16x16x32_bf16 a[168:171], a[8:11], v[184:187], a[168:171]
ds_read_b128 a[4:7], v244 offset:256
v_mfma_f32_16x16x32_bf16 a[200:203], a[8:11], v[188:191], a[200:203]
ds_read_b128 a[8:11], v244 offset:512
v_mfma_f32_16x16x32_bf16 a[172:175], a[12:15], v[184:187], a[172:175]
v_mfma_f32_16x16x32_bf16 a[204:207], a[12:15], v[188:191], a[204:207]
ds_read_b128 a[12:15], v244 offset:768
v_mfma_f32_16x16x32_bf16 a[176:179], a[16:19], v[184:187], a[176:179]
v_mfma_f32_16x16x32_bf16 a[208:211], a[16:19], v[188:191], a[208:211]
v_add_u32 v245, 0xfffe8000, v245
ds_read_b128 a[16:19], v245 offset:0
v_mfma_f32_16x16x32_bf16 a[180:183], a[20:23], v[184:187], a[180:183]
v_mfma_f32_16x16x32_bf16 a[212:215], a[20:23], v[188:191], a[212:215]
ds_read_b128 a[20:23], v245 offset:256
v_mfma_f32_16x16x32_bf16 a[184:187], a[24:27], v[184:187], a[184:187]
v_mfma_f32_16x16x32_bf16 a[216:219], a[24:27], v[188:191], a[216:219]
s_mov_b32 s46, 299008
s_add_u32 m0, s29, 135168
v_mfma_f32_16x16x32_bf16 a[188:191], a[28:31], v[184:187], a[188:191]
s_waitcnt vmcnt(5)
buffer_load_dwordx4 v248, s[12:15], s46 offen offset:0 nt lds
v_mfma_f32_16x16x32_bf16 a[220:223], a[28:31], v[188:191], a[220:223]
ds_read_b128 a[24:27], v245 offset:512
ds_read_b128 a[28:31], v245 offset:768
s_waitcnt lgkmcnt(8)
v_mfma_f32_16x16x32_bf16 a[160:163], a[32:35], v[192:195], a[160:163]
s_waitcnt lgkmcnt(7)
v_mfma_f32_16x16x32_bf16 a[192:195], a[32:35], v[196:199], a[192:195]
ds_read_b128 a[32:35], v244 offset:2048
v_mfma_f32_16x16x32_bf16 a[164:167], a[36:39], v[192:195], a[164:167]
v_mfma_f32_16x16x32_bf16 a[196:199], a[36:39], v[196:199], a[196:199]
ds_read_b128 a[36:39], v244 offset:2304
v_mfma_f32_16x16x32_bf16 a[168:171], a[40:43], v[192:195], a[168:171]
v_mfma_f32_16x16x32_bf16 a[200:203], a[40:43], v[196:199], a[200:203]
v_mfma_f32_16x16x32_bf16 a[172:175], a[44:47], v[192:195], a[172:175]
v_mfma_f32_16x16x32_bf16 a[204:207], a[44:47], v[196:199], a[204:207]
v_mfma_f32_16x16x32_bf16 a[176:179], a[48:51], v[192:195], a[176:179]
v_mfma_f32_16x16x32_bf16 a[208:211], a[48:51], v[196:199], a[208:211]
s_waitcnt vmcnt(5)
buffer_load_dwordx4 v249, s[12:15], s46 offen offset:1024 nt lds
v_mfma_f32_16x16x32_bf16 a[180:183], a[52:55], v[192:195], a[180:183]
v_mfma_f32_16x16x32_bf16 a[212:215], a[52:55], v[196:199], a[212:215]
v_mfma_f32_16x16x32_bf16 a[184:187], a[56:59], v[192:195], a[184:187]
v_mfma_f32_16x16x32_bf16 a[216:219], a[56:59], v[196:199], a[216:219]
v_mfma_f32_16x16x32_bf16 a[188:191], a[60:63], v[192:195], a[188:191]
v_mfma_f32_16x16x32_bf16 a[220:223], a[60:63], v[196:199], a[220:223]
ds_read_b128 a[40:43], v244 offset:2560
v_mfma_f32_16x16x32_bf16 v[160:163], a[0:3], v[0:3], v[200:203]
ds_read_b128 a[44:47], v244 offset:2816
s_waitcnt lgkmcnt(10)
v_mfma_f32_16x16x32_bf16 v[160:163], a[4:7], v[8:11], v[160:163]
ds_read_b128 a[48:51], v245 offset:2048
s_waitcnt lgkmcnt(10)
v_mfma_f32_16x16x32_bf16 v[160:163], a[8:11], v[16:19], v[160:163]
ds_read_b128 a[52:55], v245 offset:2304
s_waitcnt lgkmcnt(10)
v_mfma_f32_16x16x32_bf16 v[160:163], a[12:15], v[24:27], v[160:163]
s_waitcnt lgkmcnt(9)
v_mfma_f32_16x16x32_bf16 v[160:163], a[16:19], a[64:67], v[160:163]
s_waitcnt vmcnt(5)
buffer_load_dwordx4 v248, s[12:15], s46 offen offset:2048 nt lds
s_waitcnt lgkmcnt(8)
v_mfma_f32_16x16x32_bf16 v[160:163], a[20:23], a[84:87], v[160:163]
ds_read_b128 a[56:59], v245 offset:2560
s_waitcnt lgkmcnt(8)
v_mfma_f32_16x16x32_bf16 v[160:163], a[24:27], a[104:107], v[160:163]
ds_read_b128 a[60:63], v245 offset:2816
s_waitcnt lgkmcnt(8)
v_mfma_f32_16x16x32_bf16 v[160:163], a[28:31], a[124:127], v[160:163]
v_mfma_f32_16x16x32_bf16 v[164:167], a[0:3], v[32:35], v[204:207]
v_mfma_f32_16x16x32_bf16 v[164:167], a[4:7], v[40:43], v[164:167]
v_mfma_f32_16x16x32_bf16 v[164:167], a[8:11], v[48:51], v[164:167]
v_mfma_f32_16x16x32_bf16 v[164:167], a[12:15], v[56:59], v[164:167]
v_mfma_f32_16x16x32_bf16 v[164:167], a[16:19], a[68:71], v[164:167]
v_mfma_f32_16x16x32_bf16 v[164:167], a[20:23], a[88:91], v[164:167]
v_mfma_f32_16x16x32_bf16 v[164:167], a[24:27], a[108:111], v[164:167]
v_mfma_f32_16x16x32_bf16 v[164:167], a[28:31], a[128:131], v[164:167]
v_mfma_f32_16x16x32_bf16 v[168:171], a[0:3], v[64:67], v[208:211]
s_waitcnt vmcnt(5)
buffer_load_dwordx4 v249, s[12:15], s46 offen offset:3072 nt lds
v_mfma_f32_16x16x32_bf16 v[168:171], a[4:7], v[72:75], v[168:171]
v_mfma_f32_16x16x32_bf16 v[168:171], a[8:11], v[80:83], v[168:171]
v_mfma_f32_16x16x32_bf16 v[168:171], a[12:15], v[88:91], v[168:171]
v_mfma_f32_16x16x32_bf16 v[168:171], a[16:19], a[72:75], v[168:171]
v_mfma_f32_16x16x32_bf16 v[168:171], a[20:23], a[92:95], v[168:171]
v_mfma_f32_16x16x32_bf16 v[168:171], a[24:27], a[112:115], v[168:171]
v_mfma_f32_16x16x32_bf16 v[168:171], a[28:31], a[132:135], v[168:171]
s_waitcnt lgkmcnt(0)
v_mfma_f32_16x16x32_bf16 v[172:175], a[32:35], v[0:3], v[200:203]
v_mfma_f32_16x16x32_bf16 v[172:175], a[36:39], v[8:11], v[172:175]
v_exp_f32 v160, v160
v_mfma_f32_16x16x32_bf16 v[172:175], a[40:43], v[16:19], v[172:175]
s_mov_b32 s45, 327680
s_add_u32 m0, s29, 0
v_mfma_f32_16x16x32_bf16 v[172:175], a[44:47], v[24:27], v[172:175]
s_waitcnt vmcnt(5)
buffer_load_dwordx4 v248, s[8:11], s45 offen offset:0 nt lds
v_exp_f32 v161, v161
v_mfma_f32_16x16x32_bf16 v[172:175], a[48:51], a[64:67], v[172:175]
v_exp_f32 v162, v162
v_mfma_f32_16x16x32_bf16 v[172:175], a[52:55], a[84:87], v[172:175]
v_cvt_pk_bf16_f32 v160, v160, v161
v_mfma_f32_16x16x32_bf16 v[172:175], a[56:59], a[104:107], v[172:175]
v_exp_f32 v163, v163
v_mfma_f32_16x16x32_bf16 v[172:175], a[60:63], a[124:127], v[172:175]
v_exp_f32 v164, v164
v_mfma_f32_16x16x32_bf16 v[176:179], a[32:35], v[32:35], v[204:207]
v_cvt_pk_bf16_f32 v161, v162, v163
v_mfma_f32_16x16x32_bf16 v[176:179], a[36:39], v[40:43], v[176:179]
v_exp_f32 v165, v165
v_mfma_f32_16x16x32_bf16 v[176:179], a[40:43], v[48:51], v[176:179]
v_exp_f32 v166, v166
v_mfma_f32_16x16x32_bf16 v[176:179], a[44:47], v[56:59], v[176:179]
v_cvt_pk_bf16_f32 v164, v164, v165
v_mfma_f32_16x16x32_bf16 v[176:179], a[48:51], a[68:71], v[176:179]
v_exp_f32 v167, v167
v_mfma_f32_16x16x32_bf16 v[176:179], a[52:55], a[88:91], v[176:179]
v_exp_f32 v168, v168
v_mfma_f32_16x16x32_bf16 v[176:179], a[56:59], a[108:111], v[176:179]
s_waitcnt vmcnt(5)
buffer_load_dwordx4 v249, s[8:11], s45 offen offset:1024 nt lds
v_mfma_f32_16x16x32_bf16 v[176:179], a[60:63], a[128:131], v[176:179]
v_cvt_pk_bf16_f32 v165, v166, v167
v_mfma_f32_16x16x32_bf16 v[180:183], a[32:35], v[64:67], v[208:211]
v_exp_f32 v169, v169
v_mfma_f32_16x16x32_bf16 v[180:183], a[36:39], v[72:75], v[180:183]
v_exp_f32 v170, v170
v_mfma_f32_16x16x32_bf16 v[180:183], a[40:43], v[80:83], v[180:183]
v_cvt_pk_bf16_f32 v168, v168, v169
v_mfma_f32_16x16x32_bf16 v[180:183], a[44:47], v[88:91], v[180:183]
v_exp_f32 v171, v171
v_mfma_f32_16x16x32_bf16 v[180:183], a[48:51], a[72:75], v[180:183]
v_cvt_pk_bf16_f32 v169, v170, v171
v_mfma_f32_16x16x32_bf16 v[180:183], a[52:55], a[92:95], v[180:183]
v_mfma_f32_16x16x32_bf16 v[180:183], a[56:59], a[112:115], v[180:183]
v_mfma_f32_16x16x32_bf16 v[180:183], a[60:63], a[132:135], v[180:183]
v_mfma_f32_16x16x32_bf16 v[184:187], a[0:3], v[96:99], v[212:215]
v_mfma_f32_16x16x32_bf16 v[184:187], a[4:7], v[104:107], v[184:187]
s_waitcnt vmcnt(5)
buffer_load_dwordx4 v248, s[8:11], s45 offen offset:2048 nt lds
v_exp_f32 v172, v172
v_exp_f32 v173, v173
v_exp_f32 v174, v174
v_cvt_pk_bf16_f32 v162, v172, v173
v_mfma_f32_16x16x32_bf16 v[184:187], a[8:11], v[112:115], v[184:187]
v_exp_f32 v175, v175
v_mfma_f32_16x16x32_bf16 v[184:187], a[12:15], v[120:123], v[184:187]
v_exp_f32 v176, v176
v_mfma_f32_16x16x32_bf16 v[184:187], a[16:19], a[76:79], v[184:187]
v_cvt_pk_bf16_f32 v163, v174, v175
v_mfma_f32_16x16x32_bf16 v[184:187], a[20:23], a[96:99], v[184:187]
v_exp_f32 v177, v177
v_mfma_f32_16x16x32_bf16 v[184:187], a[24:27], a[116:119], v[184:187]
v_add_u32 v251, 0xfffe8000, v251
ds_write_b128 v251, v[160:163] offset:5120
v_mfma_f32_16x16x32_bf16 v[184:187], a[28:31], a[136:139], v[184:187]
v_exp_f32 v178, v178
v_mfma_f32_16x16x32_bf16 v[188:191], a[0:3], v[128:131], v[216:219]
v_cvt_pk_bf16_f32 v166, v176, v177
v_mfma_f32_16x16x32_bf16 v[188:191], a[4:7], v[136:139], v[188:191]
v_exp_f32 v179, v179
v_mfma_f32_16x16x32_bf16 v[188:191], a[8:11], v[144:147], v[188:191]
v_exp_f32 v180, v180
v_mfma_f32_16x16x32_bf16 v[188:191], a[12:15], v[152:155], v[188:191]
v_cvt_pk_bf16_f32 v167, v178, v179
v_mfma_f32_16x16x32_bf16 v[188:191], a[16:19], a[80:83], v[188:191]
s_waitcnt vmcnt(5)
buffer_load_dwordx4 v249, s[8:11], s45 offen offset:3072 nt lds
v_mfma_f32_16x16x32_bf16 v[188:191], a[20:23], a[100:103], v[188:191]
v_exp_f32 v181, v181
v_mfma_f32_16x16x32_bf16 v[188:191], a[24:27], a[120:123], v[188:191]
ds_write_b128 v251, v[164:167] offset:6144
v_mfma_f32_16x16x32_bf16 v[188:191], a[28:31], a[140:143], v[188:191]
v_exp_f32 v182, v182
v_mfma_f32_16x16x32_bf16 v[192:195], a[32:35], v[96:99], v[212:215]
v_cvt_pk_bf16_f32 v170, v180, v181
v_mfma_f32_16x16x32_bf16 v[192:195], a[36:39], v[104:107], v[192:195]
v_exp_f32 v183, v183
v_mfma_f32_16x16x32_bf16 v[192:195], a[40:43], v[112:115], v[192:195]
v_cvt_pk_bf16_f32 v171, v182, v183
ds_write_b128 v251, v[168:171] offset:7168
v_mfma_f32_16x16x32_bf16 v[192:195], a[44:47], v[120:123], v[192:195]
v_mfma_f32_16x16x32_bf16 v[192:195], a[48:51], a[76:79], v[192:195]
s_waitcnt lgkmcnt(0)
s_barrier
v_add_u32 v246, s34, v246
ds_read_b64_tr_b16 a[0:1], v246 offset:0
v_mfma_f32_16x16x32_bf16 v[192:195], a[52:55], a[96:99], v[192:195]
ds_read_b64_tr_b16 a[2:3], v246 offset:2048
v_mfma_f32_16x16x32_bf16 v[192:195], a[56:59], a[116:119], v[192:195]
s_mov_b32 s45, 331776
s_add_u32 m0, s29, 4096
v_mfma_f32_16x16x32_bf16 v[192:195], a[60:63], a[136:139], v[192:195]
s_waitcnt vmcnt(5)
buffer_load_dwordx4 v248, s[8:11], s45 offen offset:0 nt lds
v_mfma_f32_16x16x32_bf16 v[196:199], a[32:35], v[128:131], v[216:219]
v_add_u32 v247, s34, v247
ds_read_b64_tr_b16 a[4:5], v247 offset:0
v_mfma_f32_16x16x32_bf16 v[196:199], a[36:39], v[136:139], v[196:199]
ds_read_b64_tr_b16 a[6:7], v247 offset:2048
ds_read_b64_tr_b16 a[8:9], v246 offset:256
v_mfma_f32_16x16x32_bf16 v[196:199], a[40:43], v[144:147], v[196:199]
ds_read_b64_tr_b16 a[10:11], v246 offset:2304
ds_read_b64_tr_b16 a[12:13], v247 offset:256
v_mfma_f32_16x16x32_bf16 v[196:199], a[44:47], v[152:155], v[196:199]
ds_read_b64_tr_b16 a[14:15], v247 offset:2304
ds_read_b64_tr_b16 a[16:17], v246 offset:512
v_mfma_f32_16x16x32_bf16 v[196:199], a[48:51], a[80:83], v[196:199]
ds_read_b64_tr_b16 a[18:19], v246 offset:2560
ds_read_b64_tr_b16 a[20:21], v247 offset:512
v_mfma_f32_16x16x32_bf16 v[196:199], a[52:55], a[100:103], v[196:199]
ds_read_b64_tr_b16 a[22:23], v247 offset:2560
v_mfma_f32_16x16x32_bf16 v[196:199], a[56:59], a[120:123], v[196:199]
v_mfma_f32_16x16x32_bf16 v[196:199], a[60:63], a[140:143], v[196:199]
v_exp_f32 v184, v184
v_mfma_f32_16x16x32_bf16 a[224:227], a[244:247], v[160:163], a[224:227]
v_exp_f32 v185, v185
v_mfma_f32_16x16x32_bf16 a[228:231], a[244:247], v[164:167], a[228:231]
ds_read_b64_tr_b16 a[24:25], v246 offset:768
v_mfma_f32_16x16x32_bf16 a[232:235], a[244:247], v[168:171], a[232:235]
v_add_u32 v250, 0xfffe8000, v250
ds_read_b128 v[172:175], v250 offset:5120
s_waitcnt vmcnt(5)
buffer_load_dwordx4 v[220:223], v249, s[8:11], s45 offen offset:1024 nt
s_waitcnt lgkmcnt(6)
v_mfma_f32_16x16x32_bf16 v[4:7], a[0:3], v[160:163], v[4:7]
v_exp_f32 v186, v186
v_mfma_f32_16x16x32_bf16 v[68:71], a[0:3], v[164:167], v[68:71]
ds_read_b128 v[176:179], v250 offset:6144
v_add_u32 v250, 0x18000, v250
ds_write_b128 v250, v[240:243] offset:5120
v_mfma_f32_16x16x32_bf16 v[132:135], a[0:3], v[168:171], v[132:135]
v_cvt_pk_bf16_f32 v184, v184, v185
ds_read_b64_tr_b16 a[26:27], v246 offset:2816
v_mfma_f32_16x16x32_bf16 v[12:15], a[4:7], v[160:163], v[12:15]
v_add_u32 v250, 0xfffe8000, v250
ds_read_b128 v[180:183], v250 offset:7168
ds_read_b64_tr_b16 a[28:29], v247 offset:768
v_mfma_f32_16x16x32_bf16 v[76:79], a[4:7], v[164:167], v[76:79]
v_exp_f32 v187, v187
v_mfma_f32_16x16x32_bf16 v[140:143], a[4:7], v[168:171], v[140:143]
v_exp_f32 v188, v188
v_mfma_f32_16x16x32_bf16 v[20:23], a[8:11], v[160:163], v[20:23]
v_cvt_pk_bf16_f32 v185, v186, v187
ds_read_b64_tr_b16 a[30:31], v247 offset:2816
v_mfma_f32_16x16x32_bf16 v[84:87], a[8:11], v[164:167], v[84:87]
v_exp_f32 v189, v189
v_mfma_f32_16x16x32_bf16 v[148:151], a[8:11], v[168:171], v[148:151]
v_add_u32 v246, s33, v246
ds_read_b64_tr_b16 a[32:33], v246 offset:0
v_mfma_f32_16x16x32_bf16 v[28:31], a[12:15], v[160:163], v[28:31]
v_exp_f32 v190, v190
v_mfma_f32_16x16x32_bf16 v[92:95], a[12:15], v[164:167], v[92:95]
s_waitcnt lgkmcnt(6)
v_cvt_pk_bf16_f32 v188, v188, v189
v_mfma_f32_16x16x32_bf16 v[156:159], a[12:15], v[168:171], v[156:159]
s_waitcnt vmcnt(5)
buffer_load_dwordx4 v248, s[8:11], s45 offen offset:2048 nt lds
s_waitcnt lgkmcnt(2)
v_mfma_f32_16x16x32_bf16 v[36:39], a[16:19], v[160:163], v[36:39]
v_add_u32 v250, 0x18000, v250
ds_write_b128 v250, a[248:251] offset:6144
v_mfma_f32_16x16x32_bf16 v[100:103], a[16:19], v[164:167], v[100:103]
ds_read_b64_tr_b16 a[34:35], v246 offset:2048
v_mfma_f32_16x16x32_bf16 a[144:147], a[16:19], v[168:171], a[144:147]
v_add_u32 v247, s33, v247
ds_read_b64_tr_b16 a[36:37], v247 offset:0
v_mfma_f32_16x16x32_bf16 v[44:47], a[20:23], v[160:163], v[44:47]
ds_read_b64_tr_b16 a[38:39], v247 offset:2048
ds_read_b64_tr_b16 a[40:41], v246 offset:256
v_mfma_f32_16x16x32_bf16 v[108:111], a[20:23], v[164:167], v[108:111]
v_exp_f32 v191, v191
v_mfma_f32_16x16x32_bf16 a[148:151], a[20:23], v[168:171], a[148:151]
v_cvt_pk_bf16_f32 v189, v190, v191
ds_read_b64_tr_b16 a[42:43], v246 offset:2304
v_mfma_f32_16x16x32_bf16 v[52:55], a[24:27], v[160:163], v[52:55]
v_exp_f32 v192, v192
v_mfma_f32_16x16x32_bf16 v[116:119], a[24:27], v[164:167], v[116:119]
ds_read_b64_tr_b16 a[44:45], v247 offset:256
ds_read_b64_tr_b16 a[46:47], v247 offset:2304
v_mfma_f32_16x16x32_bf16 a[152:155], a[24:27], v[168:171], a[152:155]
ds_read_b64_tr_b16 a[48:49], v246 offset:512
s_waitcnt lgkmcnt(7)
v_mfma_f32_16x16x32_bf16 v[60:63], a[28:31], v[160:163], v[60:63]
ds_write_b128 v250, a[252:255] offset:7168
v_mfma_f32_16x16x32_bf16 v[124:127], a[28:31], v[164:167], v[124:127]
s_waitcnt vmcnt(5)
buffer_load_dwordx4 v249, s[8:11], s45 offen offset:3072 nt lds
v_mfma_f32_16x16x32_bf16 a[156:159], a[28:31], v[168:171], a[156:159]
v_exp_f32 v193, v193
v_mfma_f32_16x16x32_bf16 v[4:7], a[32:35], v[172:175], v[4:7]
v_exp_f32 v194, v194
v_mfma_f32_16x16x32_bf16 v[68:71], a[32:35], v[176:179], v[68:71]
ds_read_b64_tr_b16 a[50:51], v246 offset:2560
v_cvt_pk_bf16_f32 v186, v192, v193
v_mfma_f32_16x16x32_bf16 v[132:135], a[32:35], v[180:183], v[132:135]
ds_read_b64_tr_b16 a[52:53], v247 offset:512
s_waitcnt lgkmcnt(4)
v_mfma_f32_16x16x32_bf16 v[12:15], a[36:39], v[172:175], v[12:15]
ds_read_b64_tr_b16 a[54:55], v247 offset:2560
ds_read_b64_tr_b16 a[56:57], v246 offset:768
v_mfma_f32_16x16x32_bf16 v[76:79], a[36:39], v[176:179], v[76:79]
v_exp_f32 v195, v195
v_mfma_f32_16x16x32_bf16 v[140:143], a[36:39], v[180:183], v[140:143]
v_exp_f32 v196, v196
v_mfma_f32_16x16x32_bf16 v[20:23], a[40:43], v[172:175], v[20:23]
ds_read_b64_tr_b16 a[58:59], v246 offset:2816
v_cvt_pk_bf16_f32 v187, v194, v195
v_mfma_f32_16x16x32_bf16 v[84:87], a[40:43], v[176:179], v[84:87]
ds_read_b64_tr_b16 a[60:61], v247 offset:768
ds_read_b64_tr_b16 a[62:63], v247 offset:2816
v_mfma_f32_16x16x32_bf16 v[148:151], a[40:43], v[180:183], v[148:151]
s_mov_b32 s46, 327680
s_add_u32 m0, s29, 32768
v_mfma_f32_16x16x32_bf16 v[28:31], a[44:47], v[172:175], v[28:31]
s_waitcnt vmcnt(5)
buffer_load_dwordx4 v248, s[12:15], s46 offen offset:0 nt lds
v_mfma_f32_16x16x32_bf16 v[92:95], a[44:47], v[176:179], v[92:95]
v_exp_f32 v197, v197
v_mfma_f32_16x16x32_bf16 v[156:159], a[44:47], v[180:183], v[156:159]
ds_write_b128 v251, v[184:187] offset:38912
s_waitcnt lgkmcnt(4)
v_mfma_f32_16x16x32_bf16 v[36:39], a[48:51], v[172:175], v[36:39]
v_exp_f32 v198, v198
v_mfma_f32_16x16x32_bf16 v[100:103], a[48:51], v[176:179], v[100:103]
v_cvt_pk_bf16_f32 v190, v196, v197
v_mfma_f32_16x16x32_bf16 a[144:147], a[48:51], v[180:183], a[144:147]
v_exp_f32 v199, v199
v_mfma_f32_16x16x32_bf16 v[44:47], a[52:55], v[172:175], v[44:47]
v_cvt_pk_bf16_f32 v191, v198, v199
ds_write_b128 v251, v[188:191] offset:39936
v_mfma_f32_16x16x32_bf16 v[108:111], a[52:55], v[176:179], v[108:111]
v_mfma_f32_16x16x32_bf16 a[148:151], a[52:55], v[180:183], a[148:151]
s_waitcnt lgkmcnt(2)
v_mfma_f32_16x16x32_bf16 v[52:55], a[56:59], v[172:175], v[52:55]
v_mfma_f32_16x16x32_bf16 v[116:119], a[56:59], v[176:179], v[116:119]
v_mfma_f32_16x16x32_bf16 a[152:155], a[56:59], v[180:183], a[152:155]
s_waitcnt vmcnt(5)
buffer_load_dwordx4 v249, s[12:15], s46 offen offset:1024 nt lds
v_mfma_f32_16x16x32_bf16 v[60:63], a[60:63], v[172:175], v[60:63]
v_mfma_f32_16x16x32_bf16 v[124:127], a[60:63], v[176:179], v[124:127]
v_mfma_f32_16x16x32_bf16 a[156:159], a[60:63], v[180:183], a[156:159]
v_mfma_f32_16x16x32_bf16 a[236:239], a[244:247], v[184:187], a[236:239]
v_mfma_f32_16x16x32_bf16 a[240:243], a[244:247], v[188:191], a[240:243]
v_mfma_f32_16x16x32_bf16 a[160:163], a[0:3], v[184:187], a[160:163]
v_mfma_f32_16x16x32_bf16 a[192:195], a[0:3], v[188:191], a[192:195]
s_waitcnt lgkmcnt(0)
s_barrier
v_add_u32 v244, 0x10000, v244
ds_read_b128 a[0:3], v244 offset:0
v_mfma_f32_16x16x32_bf16 a[164:167], a[4:7], v[184:187], a[164:167]
v_add_u32 v250, 0xffff0000, v250
ds_read_b128 v[192:195], v250 offset:6144
v_mfma_f32_16x16x32_bf16 a[196:199], a[4:7], v[188:191], a[196:199]
ds_read_b128 v[196:199], v250 offset:7168
ds_read_b128 a[4:7], v244 offset:256
v_mfma_f32_16x16x32_bf16 a[168:171], a[8:11], v[184:187], a[168:171]
v_mfma_f32_16x16x32_bf16 a[200:203], a[8:11], v[188:191], a[200:203]
s_waitcnt vmcnt(5)
buffer_load_dwordx4 v248, s[12:15], s46 offen offset:2048 nt lds
v_mfma_f32_16x16x32_bf16 a[172:175], a[12:15], v[184:187], a[172:175]
ds_read_b128 a[8:11], v244 offset:512
v_mfma_f32_16x16x32_bf16 a[204:207], a[12:15], v[188:191], a[204:207]
ds_read_b128 a[12:15], v244 offset:768
v_mfma_f32_16x16x32_bf16 a[176:179], a[16:19], v[184:187], a[176:179]
v_mfma_f32_16x16x32_bf16 a[208:211], a[16:19], v[188:191], a[208:211]
v_add_u32 v245, 0x10000, v245
ds_read_b128 a[16:19], v245 offset:0
v_mfma_f32_16x16x32_bf16 a[180:183], a[20:23], v[184:187], a[180:183]
v_mfma_f32_16x16x32_bf16 a[212:215], a[20:23], v[188:191], a[212:215]
ds_read_b128 a[20:23], v245 offset:256
v_mfma_f32_16x16x32_bf16 a[184:187], a[24:27], v[184:187], a[184:187]
v_mfma_f32_16x16x32_bf16 a[216:219], a[24:27], v[188:191], a[216:219]
ds_read_b128 a[24:27], v245 offset:512
v_mfma_f32_16x16x32_bf16 a[188:191], a[28:31], v[184:187], a[188:191]
v_mfma_f32_16x16x32_bf16 a[220:223], a[28:31], v[188:191], a[220:223]
ds_read_b128 a[28:31], v245 offset:768
s_waitcnt lgkmcnt(8)
v_mfma_f32_16x16x32_bf16 a[160:163], a[32:35], v[192:195], a[160:163]
s_waitcnt vmcnt(5)
buffer_load_dwordx4 v249, s[12:15], s46 offen offset:3072 nt lds
s_waitcnt lgkmcnt(7)
v_mfma_f32_16x16x32_bf16 a[192:195], a[32:35], v[196:199], a[192:195]
ds_read_b128 a[32:35], v244 offset:2048
v_mfma_f32_16x16x32_bf16 a[164:167], a[36:39], v[192:195], a[164:167]
v_mfma_f32_16x16x32_bf16 a[196:199], a[36:39], v[196:199], a[196:199]
ds_read_b128 a[36:39], v244 offset:2304
v_mfma_f32_16x16x32_bf16 a[168:171], a[40:43], v[192:195], a[168:171]
v_mfma_f32_16x16x32_bf16 a[200:203], a[40:43], v[196:199], a[200:203]
v_mfma_f32_16x16x32_bf16 a[172:175], a[44:47], v[192:195], a[172:175]
v_mfma_f32_16x16x32_bf16 a[204:207], a[44:47], v[196:199], a[204:207]
v_mfma_f32_16x16x32_bf16 a[176:179], a[48:51], v[192:195], a[176:179]
v_mfma_f32_16x16x32_bf16 a[208:211], a[48:51], v[196:199], a[208:211]
v_mfma_f32_16x16x32_bf16 a[180:183], a[52:55], v[192:195], a[180:183]
s_mov_b32 s46, 331776
s_add_u32 m0, s29, 36864
v_mfma_f32_16x16x32_bf16 a[212:215], a[52:55], v[196:199], a[212:215]
s_waitcnt vmcnt(5)
buffer_load_dwordx4 v248, s[12:15], s46 offen offset:0 nt lds
v_mfma_f32_16x16x32_bf16 a[184:187], a[56:59], v[192:195], a[184:187]
v_mfma_f32_16x16x32_bf16 a[216:219], a[56:59], v[196:199], a[216:219]
v_mfma_f32_16x16x32_bf16 a[188:191], a[60:63], v[192:195], a[188:191]
v_mfma_f32_16x16x32_bf16 a[220:223], a[60:63], v[196:199], a[220:223]
ds_read_b128 a[40:43], v244 offset:2560
v_mfma_f32_16x16x32_bf16 v[160:163], a[0:3], v[0:3], v[200:203]
ds_read_b128 a[44:47], v244 offset:2816
s_waitcnt lgkmcnt(10)
v_mfma_f32_16x16x32_bf16 v[160:163], a[4:7], v[8:11], v[160:163]
ds_read_b128 a[48:51], v245 offset:2048
s_waitcnt lgkmcnt(10)
v_mfma_f32_16x16x32_bf16 v[160:163], a[8:11], v[16:19], v[160:163]
ds_read_b128 a[52:55], v245 offset:2304
s_waitcnt lgkmcnt(10)
v_mfma_f32_16x16x32_bf16 v[160:163], a[12:15], v[24:27], v[160:163]
ds_read_b128 a[56:59], v245 offset:2560
s_waitcnt lgkmcnt(10)
v_mfma_f32_16x16x32_bf16 v[160:163], a[16:19], a[64:67], v[160:163]
ds_read_b128 a[60:63], v245 offset:2816
s_waitcnt lgkmcnt(10)
v_mfma_f32_16x16x32_bf16 v[160:163], a[20:23], a[84:87], v[160:163]
s_waitcnt lgkmcnt(9)
v_mfma_f32_16x16x32_bf16 v[160:163], a[24:27], a[104:107], v[160:163]
s_waitcnt vmcnt(5)
buffer_load_dwordx4 v249, s[12:15], s46 offen offset:1024 nt lds
s_waitcnt lgkmcnt(8)
v_mfma_f32_16x16x32_bf16 v[160:163], a[28:31], a[124:127], v[160:163]
v_mfma_f32_16x16x32_bf16 v[164:167], a[0:3], v[32:35], v[204:207]
v_mfma_f32_16x16x32_bf16 v[164:167], a[4:7], v[40:43], v[164:167]
v_mfma_f32_16x16x32_bf16 v[164:167], a[8:11], v[48:51], v[164:167]
v_mfma_f32_16x16x32_bf16 v[164:167], a[12:15], v[56:59], v[164:167]
v_mfma_f32_16x16x32_bf16 v[164:167], a[16:19], a[68:71], v[164:167]
v_mfma_f32_16x16x32_bf16 v[164:167], a[20:23], a[88:91], v[164:167]
v_mfma_f32_16x16x32_bf16 v[164:167], a[24:27], a[108:111], v[164:167]
v_mfma_f32_16x16x32_bf16 v[164:167], a[28:31], a[128:131], v[164:167]
v_mfma_f32_16x16x32_bf16 v[168:171], a[0:3], v[64:67], v[208:211]
v_mfma_f32_16x16x32_bf16 v[168:171], a[4:7], v[72:75], v[168:171]
v_mfma_f32_16x16x32_bf16 v[168:171], a[8:11], v[80:83], v[168:171]
s_waitcnt vmcnt(5)
buffer_load_dwordx4 v248, s[12:15], s46 offen offset:2048 nt lds
v_mfma_f32_16x16x32_bf16 v[168:171], a[12:15], v[88:91], v[168:171]
v_mfma_f32_16x16x32_bf16 v[168:171], a[16:19], a[72:75], v[168:171]
v_mfma_f32_16x16x32_bf16 v[168:171], a[20:23], a[92:95], v[168:171]
v_mfma_f32_16x16x32_bf16 v[168:171], a[24:27], a[112:115], v[168:171]
v_mfma_f32_16x16x32_bf16 v[168:171], a[28:31], a[132:135], v[168:171]
s_waitcnt lgkmcnt(0)
v_mfma_f32_16x16x32_bf16 v[172:175], a[32:35], v[0:3], v[200:203]
v_mfma_f32_16x16x32_bf16 v[172:175], a[36:39], v[8:11], v[172:175]
v_exp_f32 v160, v160
v_mfma_f32_16x16x32_bf16 v[172:175], a[40:43], v[16:19], v[172:175]
v_exp_f32 v161, v161
v_mfma_f32_16x16x32_bf16 v[172:175], a[44:47], v[24:27], v[172:175]
v_exp_f32 v162, v162
v_mfma_f32_16x16x32_bf16 v[172:175], a[48:51], a[64:67], v[172:175]
v_cvt_pk_bf16_f32 v160, v160, v161
v_mfma_f32_16x16x32_bf16 v[172:175], a[52:55], a[84:87], v[172:175]
s_waitcnt vmcnt(5)
buffer_load_dwordx4 v249, s[12:15], s46 offen offset:3072 nt lds
v_mfma_f32_16x16x32_bf16 v[172:175], a[56:59], a[104:107], v[172:175]
v_exp_f32 v163, v163
v_mfma_f32_16x16x32_bf16 v[172:175], a[60:63], a[124:127], v[172:175]
v_exp_f32 v164, v164
v_mfma_f32_16x16x32_bf16 v[176:179], a[32:35], v[32:35], v[204:207]
v_cvt_pk_bf16_f32 v161, v162, v163
v_mfma_f32_16x16x32_bf16 v[176:179], a[36:39], v[40:43], v[176:179]
v_exp_f32 v165, v165
v_mfma_f32_16x16x32_bf16 v[176:179], a[40:43], v[48:51], v[176:179]
v_exp_f32 v166, v166
v_mfma_f32_16x16x32_bf16 v[176:179], a[44:47], v[56:59], v[176:179]
v_cvt_pk_bf16_f32 v164, v164, v165
v_mfma_f32_16x16x32_bf16 v[176:179], a[48:51], a[68:71], v[176:179]
v_exp_f32 v167, v167
v_mfma_f32_16x16x32_bf16 v[176:179], a[52:55], a[88:91], v[176:179]
v_exp_f32 v168, v168
v_mfma_f32_16x16x32_bf16 v[176:179], a[56:59], a[108:111], v[176:179]
v_cvt_pk_bf16_f32 v165, v166, v167
v_mfma_f32_16x16x32_bf16 v[176:179], a[60:63], a[128:131], v[176:179]
s_mov_b32 s45, 360448
s_add_u32 m0, s29, 65536
v_mfma_f32_16x16x32_bf16 v[180:183], a[32:35], v[64:67], v[208:211]
s_waitcnt vmcnt(5)
buffer_load_dwordx4 v248, s[8:11], s45 offen offset:0 nt lds
v_exp_f32 v169, v169
v_mfma_f32_16x16x32_bf16 v[180:183], a[36:39], v[72:75], v[180:183]
v_exp_f32 v170, v170
v_mfma_f32_16x16x32_bf16 v[180:183], a[40:43], v[80:83], v[180:183]
v_cvt_pk_bf16_f32 v168, v168, v169
v_mfma_f32_16x16x32_bf16 v[180:183], a[44:47], v[88:91], v[180:183]
v_exp_f32 v171, v171
v_mfma_f32_16x16x32_bf16 v[180:183], a[48:51], a[72:75], v[180:183]
v_cvt_pk_bf16_f32 v169, v170, v171
v_mfma_f32_16x16x32_bf16 v[180:183], a[52:55], a[92:95], v[180:183]
v_mfma_f32_16x16x32_bf16 v[180:183], a[56:59], a[112:115], v[180:183]
v_mfma_f32_16x16x32_bf16 v[180:183], a[60:63], a[132:135], v[180:183]
v_mfma_f32_16x16x32_bf16 v[184:187], a[0:3], v[96:99], v[212:215]
v_mfma_f32_16x16x32_bf16 v[184:187], a[4:7], v[104:107], v[184:187]
v_exp_f32 v172, v172
v_exp_f32 v173, v173
v_exp_f32 v174, v174
v_cvt_pk_bf16_f32 v162, v172, v173
v_mfma_f32_16x16x32_bf16 v[184:187], a[8:11], v[112:115], v[184:187]
v_exp_f32 v175, v175
v_mfma_f32_16x16x32_bf16 v[184:187], a[12:15], v[120:123], v[184:187]
s_waitcnt vmcnt(5)
buffer_load_dwordx4 v249, s[8:11], s45 offen offset:1024 nt lds
v_mfma_f32_16x16x32_bf16 v[184:187], a[16:19], a[76:79], v[184:187]
v_exp_f32 v176, v176
v_cvt_pk_bf16_f32 v163, v174, v175
v_mfma_f32_16x16x32_bf16 v[184:187], a[20:23], a[96:99], v[184:187]
v_exp_f32 v177, v177
v_mfma_f32_16x16x32_bf16 v[184:187], a[24:27], a[116:119], v[184:187]
v_add_u32 v251, 0x10000, v251
ds_write_b128 v251, v[160:163] offset:5120
v_mfma_f32_16x16x32_bf16 v[184:187], a[28:31], a[136:139], v[184:187]
v_exp_f32 v178, v178
v_mfma_f32_16x16x32_bf16 v[188:191], a[0:3], v[128:131], v[216:219]
v_cvt_pk_bf16_f32 v166, v176, v177
v_mfma_f32_16x16x32_bf16 v[188:191], a[4:7], v[136:139], v[188:191]
v_exp_f32 v179, v179
v_mfma_f32_16x16x32_bf16 v[188:191], a[8:11], v[144:147], v[188:191]
v_exp_f32 v180, v180
v_mfma_f32_16x16x32_bf16 v[188:191], a[12:15], v[152:155], v[188:191]
v_cvt_pk_bf16_f32 v167, v178, v179
v_mfma_f32_16x16x32_bf16 v[188:191], a[16:19], a[80:83], v[188:191]
v_exp_f32 v181, v181
v_mfma_f32_16x16x32_bf16 v[188:191], a[20:23], a[100:103], v[188:191]
ds_write_b128 v251, v[164:167] offset:6144
v_mfma_f32_16x16x32_bf16 v[188:191], a[24:27], a[120:123], v[188:191]
s_waitcnt vmcnt(5)
buffer_load_dwordx4 v248, s[8:11], s45 offen offset:2048 nt lds
v_mfma_f32_16x16x32_bf16 v[188:191], a[28:31], a[140:143], v[188:191]
v_exp_f32 v182, v182
v_mfma_f32_16x16x32_bf16 v[192:195], a[32:35], v[96:99], v[212:215]
v_cvt_pk_bf16_f32 v170, v180, v181
v_mfma_f32_16x16x32_bf16 v[192:195], a[36:39], v[104:107], v[192:195]
v_exp_f32 v183, v183
v_mfma_f32_16x16x32_bf16 v[192:195], a[40:43], v[112:115], v[192:195]
v_cvt_pk_bf16_f32 v171, v182, v183
ds_write_b128 v251, v[168:171] offset:7168
v_mfma_f32_16x16x32_bf16 v[192:195], a[44:47], v[120:123], v[192:195]
v_mfma_f32_16x16x32_bf16 v[192:195], a[48:51], a[76:79], v[192:195]
s_waitcnt lgkmcnt(0)
s_barrier
v_add_u32 v246, s34, v246
ds_read_b64_tr_b16 a[0:1], v246 offset:0
v_mfma_f32_16x16x32_bf16 v[192:195], a[52:55], a[96:99], v[192:195]
ds_read_b64_tr_b16 a[2:3], v246 offset:2048
v_mfma_f32_16x16x32_bf16 v[192:195], a[56:59], a[116:119], v[192:195]
v_add_u32 v247, s34, v247
ds_read_b64_tr_b16 a[4:5], v247 offset:0
v_mfma_f32_16x16x32_bf16 v[192:195], a[60:63], a[136:139], v[192:195]
ds_read_b64_tr_b16 a[6:7], v247 offset:2048
ds_read_b64_tr_b16 a[8:9], v246 offset:256
v_mfma_f32_16x16x32_bf16 v[196:199], a[32:35], v[128:131], v[216:219]
ds_read_b64_tr_b16 a[10:11], v246 offset:2304
ds_read_b64_tr_b16 a[12:13], v247 offset:256
v_mfma_f32_16x16x32_bf16 v[196:199], a[36:39], v[136:139], v[196:199]
s_waitcnt vmcnt(5)
buffer_load_dwordx4 v249, s[8:11], s45 offen offset:3072 nt lds
v_mfma_f32_16x16x32_bf16 v[196:199], a[40:43], v[144:147], v[196:199]
ds_read_b64_tr_b16 a[14:15], v247 offset:2304
ds_read_b64_tr_b16 a[16:17], v246 offset:512
v_mfma_f32_16x16x32_bf16 v[196:199], a[44:47], v[152:155], v[196:199]
ds_read_b64_tr_b16 a[18:19], v246 offset:2560
ds_read_b64_tr_b16 a[20:21], v247 offset:512
v_mfma_f32_16x16x32_bf16 v[196:199], a[48:51], a[80:83], v[196:199]
ds_read_b64_tr_b16 a[22:23], v247 offset:2560
v_mfma_f32_16x16x32_bf16 v[196:199], a[52:55], a[100:103], v[196:199]
v_mfma_f32_16x16x32_bf16 v[196:199], a[56:59], a[120:123], v[196:199]
v_mfma_f32_16x16x32_bf16 v[196:199], a[60:63], a[140:143], v[196:199]
v_exp_f32 v184, v184
v_mfma_f32_16x16x32_bf16 a[224:227], a[244:247], v[160:163], a[224:227]
v_exp_f32 v185, v185
v_mfma_f32_16x16x32_bf16 a[228:231], a[244:247], v[164:167], a[228:231]
v_exp_f32 v186, v186
v_mfma_f32_16x16x32_bf16 a[232:235], a[244:247], v[168:171], a[232:235]
ds_read_b128 v[172:175], v250 offset:37888
s_waitcnt lgkmcnt(5)
v_mfma_f32_16x16x32_bf16 v[4:7], a[0:3], v[160:163], v[4:7]
s_mov_b32 s45, 364544
s_add_u32 m0, s29, 69632
v_mfma_f32_16x16x32_bf16 v[68:71], a[0:3], v[164:167], v[68:71]
ds_read_b128 v[176:179], v250 offset:38912
s_waitcnt vmcnt(5)
buffer_load_dwordx4 v248, s[8:11], s45 offen offset:0 nt lds
v_mfma_f32_16x16x32_bf16 v[132:135], a[0:3], v[168:171], v[132:135]
v_cvt_pk_bf16_f32 v184, v184, v185
ds_read_b64_tr_b16 a[24:25], v246 offset:768
v_mfma_f32_16x16x32_bf16 v[12:15], a[4:7], v[160:163], v[12:15]
ds_read_b128 v[180:183], v250 offset:39936
ds_read_b64_tr_b16 a[26:27], v246 offset:2816
v_mfma_f32_16x16x32_bf16 v[76:79], a[4:7], v[164:167], v[76:79]
v_exp_f32 v187, v187
v_mfma_f32_16x16x32_bf16 v[140:143], a[4:7], v[168:171], v[140:143]
v_exp_f32 v188, v188
v_mfma_f32_16x16x32_bf16 v[20:23], a[8:11], v[160:163], v[20:23]
v_cvt_pk_bf16_f32 v185, v186, v187
ds_read_b64_tr_b16 a[28:29], v247 offset:768
v_mfma_f32_16x16x32_bf16 v[84:87], a[8:11], v[164:167], v[84:87]
ds_read_b64_tr_b16 a[30:31], v247 offset:2816
v_mfma_f32_16x16x32_bf16 v[148:151], a[8:11], v[168:171], v[148:151]
v_exp_f32 v189, v189
v_mfma_f32_16x16x32_bf16 v[28:31], a[12:15], v[160:163], v[28:31]
v_add_u32 v246, s33, v246
ds_read_b64_tr_b16 a[32:33], v246 offset:0
v_mfma_f32_16x16x32_bf16 v[92:95], a[12:15], v[164:167], v[92:95]
ds_read_b64_tr_b16 a[34:35], v246 offset:2048
v_mfma_f32_16x16x32_bf16 v[156:159], a[12:15], v[168:171], v[156:159]
s_waitcnt lgkmcnt(4)
v_mfma_f32_16x16x32_bf16 v[36:39], a[16:19], v[160:163], v[36:39]
v_mfma_f32_16x16x32_bf16 v[100:103], a[16:19], v[164:167], v[100:103]
s_waitcnt vmcnt(5)
buffer_load_dwordx4 v249, s[8:11], s45 offen offset:1024 nt lds
v_mfma_f32_16x16x32_bf16 a[144:147], a[16:19], v[168:171], a[144:147]
v_add_u32 v250, 0xffff8000, v250
ds_write_b128 v250, v[220:223] offset:5120
v_mfma_f32_16x16x32_bf16 v[44:47], a[20:23], v[160:163], v[44:47]
v_exp_f32 v190, v190
v_mfma_f32_16x16x32_bf16 v[108:111], a[20:23], v[164:167], v[108:111]
v_cvt_pk_bf16_f32 v188, v188, v189
v_mfma_f32_16x16x32_bf16 a[148:151], a[20:23], v[168:171], a[148:151]
v_add_u32 v247, s33, v247
ds_read_b64_tr_b16 a[36:37], v247 offset:0
v_mfma_f32_16x16x32_bf16 v[52:55], a[24:27], v[160:163], v[52:55]
ds_read_b64_tr_b16 a[38:39], v247 offset:2048
ds_read_b64_tr_b16 a[40:41], v246 offset:256
v_mfma_f32_16x16x32_bf16 v[116:119], a[24:27], v[164:167], v[116:119]
v_exp_f32 v191, v191
v_mfma_f32_16x16x32_bf16 a[152:155], a[24:27], v[168:171], a[152:155]
v_cvt_pk_bf16_f32 v189, v190, v191
s_waitcnt lgkmcnt(4)
v_mfma_f32_16x16x32_bf16 v[60:63], a[28:31], v[160:163], v[60:63]
ds_read_b64_tr_b16 a[42:43], v246 offset:2304
ds_read_b64_tr_b16 a[44:45], v247 offset:256
v_mfma_f32_16x16x32_bf16 v[124:127], a[28:31], v[164:167], v[124:127]
v_exp_f32 v192, v192
v_mfma_f32_16x16x32_bf16 a[156:159], a[28:31], v[168:171], a[156:159]
ds_read_b64_tr_b16 a[46:47], v247 offset:2304
v_mfma_f32_16x16x32_bf16 v[4:7], a[32:35], v[172:175], v[4:7]
s_waitcnt vmcnt(5)
buffer_load_dwordx4 v248, s[8:11], s45 offen offset:2048 nt lds
v_mfma_f32_16x16x32_bf16 v[68:71], a[32:35], v[176:179], v[68:71]
v_exp_f32 v193, v193
v_mfma_f32_16x16x32_bf16 v[132:135], a[32:35], v[180:183], v[132:135]
ds_read_b64_tr_b16 a[48:49], v246 offset:512
s_waitcnt lgkmcnt(4)
v_mfma_f32_16x16x32_bf16 v[12:15], a[36:39], v[172:175], v[12:15]
v_exp_f32 v194, v194
v_mfma_f32_16x16x32_bf16 v[76:79], a[36:39], v[176:179], v[76:79]
ds_read_b64_tr_b16 a[50:51], v246 offset:2560
v_cvt_pk_bf16_f32 v186, v192, v193
v_mfma_f32_16x16x32_bf16 v[140:143], a[36:39], v[180:183], v[140:143]
ds_read_b64_tr_b16 a[52:53], v247 offset:512
s_waitcnt lgkmcnt(4)
v_mfma_f32_16x16x32_bf16 v[20:23], a[40:43], v[172:175], v[20:23]
ds_read_b64_tr_b16 a[54:55], v247 offset:2560
ds_read_b64_tr_b16 a[56:57], v246 offset:768
v_mfma_f32_16x16x32_bf16 v[84:87], a[40:43], v[176:179], v[84:87]
v_exp_f32 v195, v195
v_mfma_f32_16x16x32_bf16 v[148:151], a[40:43], v[180:183], v[148:151]
ds_read_b64_tr_b16 a[58:59], v246 offset:2816
s_waitcnt lgkmcnt(6)
v_mfma_f32_16x16x32_bf16 v[28:31], a[44:47], v[172:175], v[28:31]
v_exp_f32 v196, v196
v_mfma_f32_16x16x32_bf16 v[92:95], a[44:47], v[176:179], v[92:95]
v_cvt_pk_bf16_f32 v187, v194, v195
v_mfma_f32_16x16x32_bf16 v[156:159], a[44:47], v[180:183], v[156:159]
s_waitcnt vmcnt(5)
buffer_load_dwordx4 v249, s[8:11], s45 offen offset:3072 nt lds
s_waitcnt lgkmcnt(4)
v_mfma_f32_16x16x32_bf16 v[36:39], a[48:51], v[172:175], v[36:39]
ds_read_b64_tr_b16 a[60:61], v247 offset:768
ds_read_b64_tr_b16 a[62:63], v247 offset:2816
v_mfma_f32_16x16x32_bf16 v[100:103], a[48:51], v[176:179], v[100:103]
v_exp_f32 v197, v197
v_mfma_f32_16x16x32_bf16 a[144:147], a[48:51], v[180:183], a[144:147]
ds_write_b128 v251, v[184:187] offset:38912
s_waitcnt lgkmcnt(4)
v_mfma_f32_16x16x32_bf16 v[44:47], a[52:55], v[172:175], v[44:47]
v_exp_f32 v198, v198
v_mfma_f32_16x16x32_bf16 v[108:111], a[52:55], v[176:179], v[108:111]
v_cvt_pk_bf16_f32 v190, v196, v197
v_mfma_f32_16x16x32_bf16 a[148:151], a[52:55], v[180:183], a[148:151]
s_waitcnt lgkmcnt(3)
v_mfma_f32_16x16x32_bf16 v[52:55], a[56:59], v[172:175], v[52:55]
v_exp_f32 v199, v199
v_mfma_f32_16x16x32_bf16 v[116:119], a[56:59], v[176:179], v[116:119]
v_cvt_pk_bf16_f32 v191, v198, v199
ds_write_b128 v251, v[188:191] offset:39936
v_mfma_f32_16x16x32_bf16 a[152:155], a[56:59], v[180:183], a[152:155]
s_waitcnt lgkmcnt(2)
v_mfma_f32_16x16x32_bf16 v[60:63], a[60:63], v[172:175], v[60:63]
s_mov_b32 s46, 360448
s_add_u32 m0, s29, 98304
v_mfma_f32_16x16x32_bf16 v[124:127], a[60:63], v[176:179], v[124:127]
s_waitcnt vmcnt(5)
buffer_load_dwordx4 v248, s[12:15], s46 offen offset:0 nt lds
v_mfma_f32_16x16x32_bf16 a[156:159], a[60:63], v[180:183], a[156:159]
v_mfma_f32_16x16x32_bf16 a[236:239], a[244:247], v[184:187], a[236:239]
v_mfma_f32_16x16x32_bf16 a[240:243], a[244:247], v[188:191], a[240:243]
v_mfma_f32_16x16x32_bf16 a[160:163], a[0:3], v[184:187], a[160:163]
v_mfma_f32_16x16x32_bf16 a[192:195], a[0:3], v[188:191], a[192:195]
s_waitcnt lgkmcnt(0)
s_barrier
v_add_u32 v244, 0xfffe8000, v244
ds_read_b128 a[0:3], v244 offset:0
v_mfma_f32_16x16x32_bf16 a[164:167], a[4:7], v[184:187], a[164:167]
v_add_u32 v250, 0x18000, v250
ds_read_b128 v[192:195], v250 offset:6144
v_mfma_f32_16x16x32_bf16 a[196:199], a[4:7], v[188:191], a[196:199]
ds_read_b128 v[196:199], v250 offset:7168
ds_read_b128 a[4:7], v244 offset:256
v_mfma_f32_16x16x32_bf16 a[168:171], a[8:11], v[184:187], a[168:171]
v_mfma_f32_16x16x32_bf16 a[200:203], a[8:11], v[188:191], a[200:203]
ds_read_b128 a[8:11], v244 offset:512
v_mfma_f32_16x16x32_bf16 a[172:175], a[12:15], v[184:187], a[172:175]
v_mfma_f32_16x16x32_bf16 a[204:207], a[12:15], v[188:191], a[204:207]
s_waitcnt vmcnt(5)
buffer_load_dwordx4 v249, s[12:15], s46 offen offset:1024 nt lds
v_mfma_f32_16x16x32_bf16 a[176:179], a[16:19], v[184:187], a[176:179]
ds_read_b128 a[12:15], v244 offset:768
v_mfma_f32_16x16x32_bf16 a[208:211], a[16:19], v[188:191], a[208:211]
v_add_u32 v245, 0xfffe8000, v245
ds_read_b128 a[16:19], v245 offset:0
v_mfma_f32_16x16x32_bf16 a[180:183], a[20:23], v[184:187], a[180:183]
v_mfma_f32_16x16x32_bf16 a[212:215], a[20:23], v[188:191], a[212:215]
ds_read_b128 a[20:23], v245 offset:256
v_mfma_f32_16x16x32_bf16 a[184:187], a[24:27], v[184:187], a[184:187]
v_mfma_f32_16x16x32_bf16 a[216:219], a[24:27], v[188:191], a[216:219]
ds_read_b128 a[24:27], v245 offset:512
v_mfma_f32_16x16x32_bf16 a[188:191], a[28:31], v[184:187], a[188:191]
v_mfma_f32_16x16x32_bf16 a[220:223], a[28:31], v[188:191], a[220:223]
ds_read_b128 a[28:31], v245 offset:768
s_waitcnt lgkmcnt(8)
v_mfma_f32_16x16x32_bf16 a[160:163], a[32:35], v[192:195], a[160:163]
s_waitcnt lgkmcnt(7)
v_mfma_f32_16x16x32_bf16 a[192:195], a[32:35], v[196:199], a[192:195]
ds_read_b128 a[32:35], v244 offset:2048
v_mfma_f32_16x16x32_bf16 a[164:167], a[36:39], v[192:195], a[164:167]
s_waitcnt vmcnt(5)
buffer_load_dwordx4 v248, s[12:15], s46 offen offset:2048 nt lds
v_mfma_f32_16x16x32_bf16 a[196:199], a[36:39], v[196:199], a[196:199]
ds_read_b128 a[36:39], v244 offset:2304
v_mfma_f32_16x16x32_bf16 a[168:171], a[40:43], v[192:195], a[168:171]
v_mfma_f32_16x16x32_bf16 a[200:203], a[40:43], v[196:199], a[200:203]
v_mfma_f32_16x16x32_bf16 a[172:175], a[44:47], v[192:195], a[172:175]
v_mfma_f32_16x16x32_bf16 a[204:207], a[44:47], v[196:199], a[204:207]
v_mfma_f32_16x16x32_bf16 a[176:179], a[48:51], v[192:195], a[176:179]
v_mfma_f32_16x16x32_bf16 a[208:211], a[48:51], v[196:199], a[208:211]
v_mfma_f32_16x16x32_bf16 a[180:183], a[52:55], v[192:195], a[180:183]
v_mfma_f32_16x16x32_bf16 a[212:215], a[52:55], v[196:199], a[212:215]
v_mfma_f32_16x16x32_bf16 a[184:187], a[56:59], v[192:195], a[184:187]
v_mfma_f32_16x16x32_bf16 a[216:219], a[56:59], v[196:199], a[216:219]
s_waitcnt vmcnt(5)
buffer_load_dwordx4 v249, s[12:15], s46 offen offset:3072 nt lds
v_mfma_f32_16x16x32_bf16 a[188:191], a[60:63], v[192:195], a[188:191]
v_mfma_f32_16x16x32_bf16 a[220:223], a[60:63], v[196:199], a[220:223]
ds_read_b128 a[40:43], v244 offset:2560
v_mfma_f32_16x16x32_bf16 v[160:163], a[0:3], v[0:3], v[200:203]
ds_read_b128 a[44:47], v244 offset:2816
s_waitcnt lgkmcnt(10)
v_mfma_f32_16x16x32_bf16 v[160:163], a[4:7], v[8:11], v[160:163]
ds_read_b128 a[48:51], v245 offset:2048
s_waitcnt lgkmcnt(10)
v_mfma_f32_16x16x32_bf16 v[160:163], a[8:11], v[16:19], v[160:163]
ds_read_b128 a[52:55], v245 offset:2304
s_waitcnt lgkmcnt(10)
v_mfma_f32_16x16x32_bf16 v[160:163], a[12:15], v[24:27], v[160:163]
ds_read_b128 a[56:59], v245 offset:2560
s_waitcnt lgkmcnt(10)
v_mfma_f32_16x16x32_bf16 v[160:163], a[16:19], a[64:67], v[160:163]
ds_read_b128 a[60:63], v245 offset:2816
s_waitcnt lgkmcnt(10)
v_mfma_f32_16x16x32_bf16 v[160:163], a[20:23], a[84:87], v[160:163]
s_waitcnt lgkmcnt(9)
v_mfma_f32_16x16x32_bf16 v[160:163], a[24:27], a[104:107], v[160:163]
s_waitcnt lgkmcnt(8)
v_mfma_f32_16x16x32_bf16 v[160:163], a[28:31], a[124:127], v[160:163]
v_mfma_f32_16x16x32_bf16 v[164:167], a[0:3], v[32:35], v[204:207]
s_mov_b32 s46, 364544
s_add_u32 m0, s29, 102400
v_mfma_f32_16x16x32_bf16 v[164:167], a[4:7], v[40:43], v[164:167]
s_waitcnt vmcnt(5)
buffer_load_dwordx4 v248, s[12:15], s46 offen offset:0 nt lds
v_mfma_f32_16x16x32_bf16 v[164:167], a[8:11], v[48:51], v[164:167]
v_mfma_f32_16x16x32_bf16 v[164:167], a[12:15], v[56:59], v[164:167]
v_mfma_f32_16x16x32_bf16 v[164:167], a[16:19], a[68:71], v[164:167]
v_mfma_f32_16x16x32_bf16 v[164:167], a[20:23], a[88:91], v[164:167]
v_mfma_f32_16x16x32_bf16 v[164:167], a[24:27], a[108:111], v[164:167]
v_mfma_f32_16x16x32_bf16 v[164:167], a[28:31], a[128:131], v[164:167]
v_mfma_f32_16x16x32_bf16 v[168:171], a[0:3], v[64:67], v[208:211]
v_mfma_f32_16x16x32_bf16 v[168:171], a[4:7], v[72:75], v[168:171]
v_mfma_f32_16x16x32_bf16 v[168:171], a[8:11], v[80:83], v[168:171]
v_mfma_f32_16x16x32_bf16 v[168:171], a[12:15], v[88:91], v[168:171]
v_mfma_f32_16x16x32_bf16 v[168:171], a[16:19], a[72:75], v[168:171]
s_waitcnt vmcnt(5)
buffer_load_dwordx4 v249, s[12:15], s46 offen offset:1024 nt lds
v_mfma_f32_16x16x32_bf16 v[168:171], a[20:23], a[92:95], v[168:171]
v_mfma_f32_16x16x32_bf16 v[168:171], a[24:27], a[112:115], v[168:171]
v_mfma_f32_16x16x32_bf16 v[168:171], a[28:31], a[132:135], v[168:171]
s_waitcnt lgkmcnt(0)
v_mfma_f32_16x16x32_bf16 v[172:175], a[32:35], v[0:3], v[200:203]
v_mfma_f32_16x16x32_bf16 v[172:175], a[36:39], v[8:11], v[172:175]
v_exp_f32 v160, v160
v_mfma_f32_16x16x32_bf16 v[172:175], a[40:43], v[16:19], v[172:175]
v_exp_f32 v161, v161
v_mfma_f32_16x16x32_bf16 v[172:175], a[44:47], v[24:27], v[172:175]
v_exp_f32 v162, v162
v_mfma_f32_16x16x32_bf16 v[172:175], a[48:51], a[64:67], v[172:175]
v_cvt_pk_bf16_f32 v160, v160, v161
v_mfma_f32_16x16x32_bf16 v[172:175], a[52:55], a[84:87], v[172:175]
v_exp_f32 v163, v163
v_mfma_f32_16x16x32_bf16 v[172:175], a[56:59], a[104:107], v[172:175]
v_mfma_f32_16x16x32_bf16 v[172:175], a[60:63], a[124:127], v[172:175]
s_waitcnt vmcnt(5)
buffer_load_dwordx4 v248, s[12:15], s46 offen offset:2048 nt lds
v_mfma_f32_16x16x32_bf16 v[176:179], a[32:35], v[32:35], v[204:207]
v_exp_f32 v164, v164
v_cvt_pk_bf16_f32 v161, v162, v163
v_mfma_f32_16x16x32_bf16 v[176:179], a[36:39], v[40:43], v[176:179]
v_exp_f32 v165, v165
v_mfma_f32_16x16x32_bf16 v[176:179], a[40:43], v[48:51], v[176:179]
v_exp_f32 v166, v166
v_mfma_f32_16x16x32_bf16 v[176:179], a[44:47], v[56:59], v[176:179]
v_cvt_pk_bf16_f32 v164, v164, v165
v_mfma_f32_16x16x32_bf16 v[176:179], a[48:51], a[68:71], v[176:179]
v_exp_f32 v167, v167
v_mfma_f32_16x16x32_bf16 v[176:179], a[52:55], a[88:91], v[176:179]
v_exp_f32 v168, v168
v_mfma_f32_16x16x32_bf16 v[176:179], a[56:59], a[108:111], v[176:179]
v_cvt_pk_bf16_f32 v165, v166, v167
v_mfma_f32_16x16x32_bf16 v[176:179], a[60:63], a[128:131], v[176:179]
v_exp_f32 v169, v169
v_mfma_f32_16x16x32_bf16 v[180:183], a[32:35], v[64:67], v[208:211]
v_exp_f32 v170, v170
v_mfma_f32_16x16x32_bf16 v[180:183], a[36:39], v[72:75], v[180:183]
v_cvt_pk_bf16_f32 v168, v168, v169
v_mfma_f32_16x16x32_bf16 v[180:183], a[40:43], v[80:83], v[180:183]
s_waitcnt vmcnt(5)
buffer_load_dwordx4 v249, s[12:15], s46 offen offset:3072 nt lds
v_mfma_f32_16x16x32_bf16 v[180:183], a[44:47], v[88:91], v[180:183]
v_exp_f32 v171, v171
v_mfma_f32_16x16x32_bf16 v[180:183], a[48:51], a[72:75], v[180:183]
v_cvt_pk_bf16_f32 v169, v170, v171
v_mfma_f32_16x16x32_bf16 v[180:183], a[52:55], a[92:95], v[180:183]
v_mfma_f32_16x16x32_bf16 v[180:183], a[56:59], a[112:115], v[180:183]
v_mfma_f32_16x16x32_bf16 v[180:183], a[60:63], a[132:135], v[180:183]
v_mfma_f32_16x16x32_bf16 v[184:187], a[0:3], v[96:99], v[212:215]
v_mfma_f32_16x16x32_bf16 v[184:187], a[4:7], v[104:107], v[184:187]
v_exp_f32 v172, v172
v_exp_f32 v173, v173
v_exp_f32 v174, v174
v_cvt_pk_bf16_f32 v162, v172, v173
v_mfma_f32_16x16x32_bf16 v[184:187], a[8:11], v[112:115], v[184:187]
v_exp_f32 v175, v175
v_mfma_f32_16x16x32_bf16 v[184:187], a[12:15], v[120:123], v[184:187]
v_exp_f32 v176, v176
v_mfma_f32_16x16x32_bf16 v[184:187], a[16:19], a[76:79], v[184:187]
s_mov_b32 s45, 393216
s_add_u32 m0, s29, 131072
v_cvt_pk_bf16_f32 v163, v174, v175
v_mfma_f32_16x16x32_bf16 v[184:187], a[20:23], a[96:99], v[184:187]
s_waitcnt vmcnt(5)
buffer_load_dwordx4 v248, s[8:11], s45 offen offset:0 nt lds
v_mfma_f32_16x16x32_bf16 v[184:187], a[24:27], a[116:119], v[184:187]
v_exp_f32 v177, v177
v_add_u32 v251, 0x8000, v251
ds_write_b128 v251, v[160:163] offset:37888
v_mfma_f32_16x16x32_bf16 v[184:187], a[28:31], a[136:139], v[184:187]
v_exp_f32 v178, v178
v_mfma_f32_16x16x32_bf16 v[188:191], a[0:3], v[128:131], v[216:219]
v_cvt_pk_bf16_f32 v166, v176, v177
v_mfma_f32_16x16x32_bf16 v[188:191], a[4:7], v[136:139], v[188:191]
v_exp_f32 v179, v179
v_mfma_f32_16x16x32_bf16 v[188:191], a[8:11], v[144:147], v[188:191]
v_exp_f32 v180, v180
v_mfma_f32_16x16x32_bf16 v[188:191], a[12:15], v[152:155], v[188:191]
v_cvt_pk_bf16_f32 v167, v178, v179
v_mfma_f32_16x16x32_bf16 v[188:191], a[16:19], a[80:83], v[188:191]
v_exp_f32 v181, v181
v_mfma_f32_16x16x32_bf16 v[188:191], a[20:23], a[100:103], v[188:191]
ds_write_b128 v251, v[164:167] offset:38912
v_mfma_f32_16x16x32_bf16 v[188:191], a[24:27], a[120:123], v[188:191]
v_exp_f32 v182, v182
v_mfma_f32_16x16x32_bf16 v[188:191], a[28:31], a[140:143], v[188:191]
v_cvt_pk_bf16_f32 v170, v180, v181
v_mfma_f32_16x16x32_bf16 v[192:195], a[32:35], v[96:99], v[212:215]
s_waitcnt vmcnt(5)
buffer_load_dwordx4 v249, s[8:11], s45 offen offset:1024 nt lds
v_mfma_f32_16x16x32_bf16 v[192:195], a[36:39], v[104:107], v[192:195]
v_exp_f32 v183, v183
v_mfma_f32_16x16x32_bf16 v[192:195], a[40:43], v[112:115], v[192:195]
v_cvt_pk_bf16_f32 v171, v182, v183
ds_write_b128 v251, v[168:171] offset:39936
v_mfma_f32_16x16x32_bf16 v[192:195], a[44:47], v[120:123], v[192:195]
v_mfma_f32_16x16x32_bf16 v[192:195], a[48:51], a[76:79], v[192:195]
s_waitcnt lgkmcnt(0)
s_barrier
v_add_u32 v246, s35, v246
ds_read_b64_tr_b16 a[0:1], v246 offset:0
v_mfma_f32_16x16x32_bf16 v[192:195], a[52:55], a[96:99], v[192:195]
ds_read_b64_tr_b16 a[2:3], v246 offset:2048
v_mfma_f32_16x16x32_bf16 v[192:195], a[56:59], a[116:119], v[192:195]
v_add_u32 v247, s35, v247
ds_read_b64_tr_b16 a[4:5], v247 offset:0
v_mfma_f32_16x16x32_bf16 v[192:195], a[60:63], a[136:139], v[192:195]
ds_read_b64_tr_b16 a[6:7], v247 offset:2048
ds_read_b64_tr_b16 a[8:9], v246 offset:256
v_mfma_f32_16x16x32_bf16 v[196:199], a[32:35], v[128:131], v[216:219]
ds_read_b64_tr_b16 a[10:11], v246 offset:2304
ds_read_b64_tr_b16 a[12:13], v247 offset:256
v_mfma_f32_16x16x32_bf16 v[196:199], a[36:39], v[136:139], v[196:199]
ds_read_b64_tr_b16 a[14:15], v247 offset:2304
ds_read_b64_tr_b16 a[16:17], v246 offset:512
v_mfma_f32_16x16x32_bf16 v[196:199], a[40:43], v[144:147], v[196:199]
ds_read_b64_tr_b16 a[18:19], v246 offset:2560
ds_read_b64_tr_b16 a[20:21], v247 offset:512
v_mfma_f32_16x16x32_bf16 v[196:199], a[44:47], v[152:155], v[196:199]
s_waitcnt vmcnt(5)
buffer_load_dwordx4 v248, s[8:11], s45 offen offset:2048 nt lds
v_mfma_f32_16x16x32_bf16 v[196:199], a[48:51], a[80:83], v[196:199]
ds_read_b64_tr_b16 a[22:23], v247 offset:2560
v_mfma_f32_16x16x32_bf16 v[196:199], a[52:55], a[100:103], v[196:199]
v_mfma_f32_16x16x32_bf16 v[196:199], a[56:59], a[120:123], v[196:199]
v_mfma_f32_16x16x32_bf16 v[196:199], a[60:63], a[140:143], v[196:199]
v_exp_f32 v184, v184
v_mfma_f32_16x16x32_bf16 a[224:227], a[244:247], v[160:163], a[224:227]
v_exp_f32 v185, v185
v_mfma_f32_16x16x32_bf16 a[228:231], a[244:247], v[164:167], a[228:231]
v_exp_f32 v186, v186
v_mfma_f32_16x16x32_bf16 a[232:235], a[244:247], v[168:171], a[232:235]
ds_read_b128 v[172:175], v250 offset:37888
s_waitcnt lgkmcnt(5)
v_mfma_f32_16x16x32_bf16 v[4:7], a[0:3], v[160:163], v[4:7]
v_cvt_pk_bf16_f32 v184, v184, v185
ds_read_b64_tr_b16 a[24:25], v246 offset:768
v_mfma_f32_16x16x32_bf16 v[68:71], a[0:3], v[164:167], v[68:71]
ds_read_b128 v[176:179], v250 offset:38912
ds_read_b64_tr_b16 a[26:27], v246 offset:2816
v_mfma_f32_16x16x32_bf16 v[132:135], a[0:3], v[168:171], v[132:135]
v_exp_f32 v187, v187
v_mfma_f32_16x16x32_bf16 v[12:15], a[4:7], v[160:163], v[12:15]
ds_read_b128 v[180:183], v250 offset:39936
s_waitcnt vmcnt(5)
buffer_load_dwordx4 v249, s[8:11], s45 offen offset:3072 nt lds
v_mfma_f32_16x16x32_bf16 v[76:79], a[4:7], v[164:167], v[76:79]
v_exp_f32 v188, v188
v_mfma_f32_16x16x32_bf16 v[140:143], a[4:7], v[168:171], v[140:143]
v_cvt_pk_bf16_f32 v185, v186, v187
ds_read_b64_tr_b16 a[28:29], v247 offset:768
v_mfma_f32_16x16x32_bf16 v[20:23], a[8:11], v[160:163], v[20:23]
ds_read_b64_tr_b16 a[30:31], v247 offset:2816
v_mfma_f32_16x16x32_bf16 v[84:87], a[8:11], v[164:167], v[84:87]
v_exp_f32 v189, v189
v_mfma_f32_16x16x32_bf16 v[148:151], a[8:11], v[168:171], v[148:151]
v_add_u32 v246, s33, v246
ds_read_b64_tr_b16 a[32:33], v246 offset:0
v_mfma_f32_16x16x32_bf16 v[28:31], a[12:15], v[160:163], v[28:31]
ds_read_b64_tr_b16 a[34:35], v246 offset:2048
v_mfma_f32_16x16x32_bf16 v[92:95], a[12:15], v[164:167], v[92:95]
v_exp_f32 v190, v190
v_mfma_f32_16x16x32_bf16 v[156:159], a[12:15], v[168:171], v[156:159]
v_cvt_pk_bf16_f32 v188, v188, v189
s_waitcnt lgkmcnt(4)
v_mfma_f32_16x16x32_bf16 v[36:39], a[16:19], v[160:163], v[36:39]
v_add_u32 v247, s33, v247
ds_read_b64_tr_b16 a[36:37], v247 offset:0
v_mfma_f32_16x16x32_bf16 v[100:103], a[16:19], v[164:167], v[100:103]
ds_read_b64_tr_b16 a[38:39], v247 offset:2048
ds_read_b64_tr_b16 a[40:41], v246 offset:256
v_mfma_f32_16x16x32_bf16 a[144:147], a[16:19], v[168:171], a[144:147]
s_mov_b32 s45, 397312
s_add_u32 m0, s29, 135168
v_mfma_f32_16x16x32_bf16 v[44:47], a[20:23], v[160:163], v[44:47]
s_waitcnt vmcnt(5)
buffer_load_dwordx4 v248, s[8:11], s45 offen offset:0 nt lds
v_mfma_f32_16x16x32_bf16 v[108:111], a[20:23], v[164:167], v[108:111]
v_exp_f32 v191, v191
v_mfma_f32_16x16x32_bf16 a[148:151], a[20:23], v[168:171], a[148:151]
v_cvt_pk_bf16_f32 v189, v190, v191
ds_read_b64_tr_b16 a[42:43], v246 offset:2304
v_mfma_f32_16x16x32_bf16 v[52:55], a[24:27], v[160:163], v[52:55]
v_exp_f32 v192, v192
v_mfma_f32_16x16x32_bf16 v[116:119], a[24:27], v[164:167], v[116:119]
ds_read_b64_tr_b16 a[44:45], v247 offset:256
ds_read_b64_tr_b16 a[46:47], v247 offset:2304
v_mfma_f32_16x16x32_bf16 a[152:155], a[24:27], v[168:171], a[152:155]
ds_read_b64_tr_b16 a[48:49], v246 offset:512
s_waitcnt lgkmcnt(4)
v_mfma_f32_16x16x32_bf16 v[60:63], a[28:31], v[160:163], v[60:63]
v_exp_f32 v193, v193
v_mfma_f32_16x16x32_bf16 v[124:127], a[28:31], v[164:167], v[124:127]
v_exp_f32 v194, v194
v_mfma_f32_16x16x32_bf16 a[156:159], a[28:31], v[168:171], a[156:159]
ds_read_b64_tr_b16 a[50:51], v246 offset:2560
v_cvt_pk_bf16_f32 v186, v192, v193
v_mfma_f32_16x16x32_bf16 v[4:7], a[32:35], v[172:175], v[4:7]
ds_read_b64_tr_b16 a[52:53], v247 offset:512
ds_read_b64_tr_b16 a[54:55], v247 offset:2560
v_mfma_f32_16x16x32_bf16 v[68:71], a[32:35], v[176:179], v[68:71]
ds_read_b64_tr_b16 a[56:57], v246 offset:768
v_mfma_f32_16x16x32_bf16 v[132:135], a[32:35], v[180:183], v[132:135]
s_waitcnt vmcnt(5)
buffer_load_dwordx4 v249, s[8:11], s45 offen offset:1024 nt lds
v_mfma_f32_16x16x32_bf16 v[12:15], a[36:39], v[172:175], v[12:15]
v_exp_f32 v195, v195
v_mfma_f32_16x16x32_bf16 v[76:79], a[36:39], v[176:179], v[76:79]
v_exp_f32 v196, v196
v_mfma_f32_16x16x32_bf16 v[140:143], a[36:39], v[180:183], v[140:143]
ds_read_b64_tr_b16 a[58:59], v246 offset:2816
s_waitcnt lgkmcnt(5)
v_mfma_f32_16x16x32_bf16 v[20:23], a[40:43], v[172:175], v[20:23]
v_cvt_pk_bf16_f32 v187, v194, v195
ds_read_b64_tr_b16 a[60:61], v247 offset:768
v_mfma_f32_16x16x32_bf16 v[84:87], a[40:43], v[176:179], v[84:87]
ds_read_b64_tr_b16 a[62:63], v247 offset:2816
v_mfma_f32_16x16x32_bf16 v[148:151], a[40:43], v[180:183], v[148:151]
v_exp_f32 v197, v197
v_mfma_f32_16x16x32_bf16 v[28:31], a[44:47], v[172:175], v[28:31]
v_add_u32 v251, 0xfffe8000, v251
ds_write_b128 v251, v[184:187] offset:6144
v_mfma_f32_16x16x32_bf16 v[92:95], a[44:47], v[176:179], v[92:95]
v_exp_f32 v198, v198
v_mfma_f32_16x16x32_bf16 v[156:159], a[44:47], v[180:183], v[156:159]
v_cvt_pk_bf16_f32 v190, v196, v197
s_waitcnt lgkmcnt(4)
v_mfma_f32_16x16x32_bf16 v[36:39], a[48:51], v[172:175], v[36:39]
v_mfma_f32_16x16x32_bf16 v[100:103], a[48:51], v[176:179], v[100:103]
s_waitcnt vmcnt(5)
buffer_load_dwordx4 v248, s[8:11], s45 offen offset:2048 nt lds
v_mfma_f32_16x16x32_bf16 a[144:147], a[48:51], v[180:183], a[144:147]
v_exp_f32 v199, v199
v_mfma_f32_16x16x32_bf16 v[44:47], a[52:55], v[172:175], v[44:47]
v_cvt_pk_bf16_f32 v191, v198, v199
ds_write_b128 v251, v[188:191] offset:7168
v_mfma_f32_16x16x32_bf16 v[108:111], a[52:55], v[176:179], v[108:111]
v_mfma_f32_16x16x32_bf16 a[148:151], a[52:55], v[180:183], a[148:151]
s_waitcnt lgkmcnt(1)
v_mfma_f32_16x16x32_bf16 v[52:55], a[56:59], v[172:175], v[52:55]
v_mfma_f32_16x16x32_bf16 v[116:119], a[56:59], v[176:179], v[116:119]
v_mfma_f32_16x16x32_bf16 a[152:155], a[56:59], v[180:183], a[152:155]
v_mfma_f32_16x16x32_bf16 v[60:63], a[60:63], v[172:175], v[60:63]
v_mfma_f32_16x16x32_bf16 v[124:127], a[60:63], v[176:179], v[124:127]
v_mfma_f32_16x16x32_bf16 a[156:159], a[60:63], v[180:183], a[156:159]
v_mfma_f32_16x16x32_bf16 a[236:239], a[244:247], v[184:187], a[236:239]
s_waitcnt vmcnt(5)
buffer_load_dwordx4 v249, s[8:11], s45 offen offset:3072 nt lds
v_mfma_f32_16x16x32_bf16 a[240:243], a[244:247], v[188:191], a[240:243]
v_mfma_f32_16x16x32_bf16 a[160:163], a[0:3], v[184:187], a[160:163]
v_mfma_f32_16x16x32_bf16 a[192:195], a[0:3], v[188:191], a[192:195]
s_waitcnt lgkmcnt(0)
s_barrier
v_add_u32 v244, 0x10000, v244
ds_read_b128 a[0:3], v244 offset:0
v_mfma_f32_16x16x32_bf16 a[164:167], a[4:7], v[184:187], a[164:167]
v_add_u32 v250, 0xfffe8000, v250
ds_read_b128 v[192:195], v250 offset:6144
v_mfma_f32_16x16x32_bf16 a[196:199], a[4:7], v[188:191], a[196:199]
ds_read_b128 v[196:199], v250 offset:7168
ds_read_b128 a[4:7], v244 offset:256
v_mfma_f32_16x16x32_bf16 a[168:171], a[8:11], v[184:187], a[168:171]
v_mfma_f32_16x16x32_bf16 a[200:203], a[8:11], v[188:191], a[200:203]
ds_read_b128 a[8:11], v244 offset:512
v_mfma_f32_16x16x32_bf16 a[172:175], a[12:15], v[184:187], a[172:175]
v_mfma_f32_16x16x32_bf16 a[204:207], a[12:15], v[188:191], a[204:207]
ds_read_b128 a[12:15], v244 offset:768
v_mfma_f32_16x16x32_bf16 a[176:179], a[16:19], v[184:187], a[176:179]
s_mov_b32 s46, 393216
s_add_u32 m0, s29, 0
v_mfma_f32_16x16x32_bf16 a[208:211], a[16:19], v[188:191], a[208:211]
s_waitcnt vmcnt(5)
buffer_load_dwordx4 v248, s[12:15], s46 offen offset:0 nt lds
v_mfma_f32_16x16x32_bf16 a[180:183], a[20:23], v[184:187], a[180:183]
v_add_u32 v245, 0x10000, v245
ds_read_b128 a[16:19], v245 offset:0
v_mfma_f32_16x16x32_bf16 a[212:215], a[20:23], v[188:191], a[212:215]
ds_read_b128 a[20:23], v245 offset:256
v_mfma_f32_16x16x32_bf16 a[184:187], a[24:27], v[184:187], a[184:187]
v_mfma_f32_16x16x32_bf16 a[216:219], a[24:27], v[188:191], a[216:219]
ds_read_b128 a[24:27], v245 offset:512
v_mfma_f32_16x16x32_bf16 a[188:191], a[28:31], v[184:187], a[188:191]
v_mfma_f32_16x16x32_bf16 a[220:223], a[28:31], v[188:191], a[220:223]
ds_read_b128 a[28:31], v245 offset:768
s_waitcnt lgkmcnt(8)
v_mfma_f32_16x16x32_bf16 a[160:163], a[32:35], v[192:195], a[160:163]
s_waitcnt lgkmcnt(7)
v_mfma_f32_16x16x32_bf16 a[192:195], a[32:35], v[196:199], a[192:195]
ds_read_b128 a[32:35], v244 offset:2048
v_mfma_f32_16x16x32_bf16 a[164:167], a[36:39], v[192:195], a[164:167]
v_mfma_f32_16x16x32_bf16 a[196:199], a[36:39], v[196:199], a[196:199]
ds_read_b128 a[36:39], v244 offset:2304
v_mfma_f32_16x16x32_bf16 a[168:171], a[40:43], v[192:195], a[168:171]
s_waitcnt vmcnt(5)
buffer_load_dwordx4 v249, s[12:15], s46 offen offset:1024 nt lds
v_mfma_f32_16x16x32_bf16 a[200:203], a[40:43], v[196:199], a[200:203]
v_mfma_f32_16x16x32_bf16 a[172:175], a[44:47], v[192:195], a[172:175]
v_mfma_f32_16x16x32_bf16 a[204:207], a[44:47], v[196:199], a[204:207]
v_mfma_f32_16x16x32_bf16 a[176:179], a[48:51], v[192:195], a[176:179]
v_mfma_f32_16x16x32_bf16 a[208:211], a[48:51], v[196:199], a[208:211]
v_mfma_f32_16x16x32_bf16 a[180:183], a[52:55], v[192:195], a[180:183]
v_mfma_f32_16x16x32_bf16 a[212:215], a[52:55], v[196:199], a[212:215]
v_mfma_f32_16x16x32_bf16 a[184:187], a[56:59], v[192:195], a[184:187]
v_mfma_f32_16x16x32_bf16 a[216:219], a[56:59], v[196:199], a[216:219]
v_mfma_f32_16x16x32_bf16 a[188:191], a[60:63], v[192:195], a[188:191]
v_mfma_f32_16x16x32_bf16 a[220:223], a[60:63], v[196:199], a[220:223]
s_waitcnt vmcnt(5)
buffer_load_dwordx4 v248, s[12:15], s46 offen offset:2048 nt lds
v_mfma_f32_16x16x32_bf16 v[160:163], a[0:3], v[0:3], v[200:203]
s_getpc_b64 s[16:17]
Lcw_2:
s_waitcnt lgkmcnt(8)
v_mfma_f32_16x16x32_bf16 v[160:163], a[4:7], v[8:11], v[160:163]
v_mbcnt_lo_u32_b32 v252, -1, 0
s_waitcnt lgkmcnt(7)
v_mfma_f32_16x16x32_bf16 v[160:163], a[8:11], v[16:19], v[160:163]
v_mbcnt_hi_u32_b32 v252, -1, v252
s_waitcnt lgkmcnt(6)
v_mfma_f32_16x16x32_bf16 v[160:163], a[12:15], v[24:27], v[160:163]
v_lshlrev_b32 v252, 14, v252
s_waitcnt lgkmcnt(5)
v_mfma_f32_16x16x32_bf16 v[160:163], a[16:19], a[64:67], v[160:163]
s_lshr_b32 s48, s2, 3
s_waitcnt lgkmcnt(4)
v_mfma_f32_16x16x32_bf16 v[160:163], a[20:23], a[84:87], v[160:163]
s_lshl_b32 s48, s48, 9
s_waitcnt lgkmcnt(3)
v_mfma_f32_16x16x32_bf16 v[160:163], a[24:27], a[104:107], v[160:163]
s_lshl_b32 s49, s28, 7
s_waitcnt lgkmcnt(2)
v_mfma_f32_16x16x32_bf16 v[160:163], a[28:31], a[124:127], v[160:163]
s_add_u32 s48, s48, s49
v_add_u32 v252, s48, v252
v_mfma_f32_16x16x32_bf16 v[164:167], a[0:3], v[32:35], v[204:207]
v_min_u32 v252, L_code_end-Lcw_2-4, v252
v_mov_b32 v253, s17
v_mfma_f32_16x16x32_bf16 v[164:167], a[4:7], v[40:43], v[164:167]
ds_read_b128 a[40:43], v244 offset:2560
ds_read_b128 a[44:47], v244 offset:2816
v_mfma_f32_16x16x32_bf16 v[164:167], a[8:11], v[48:51], v[164:167]
ds_read_b128 a[48:51], v245 offset:2048
ds_read_b128 a[52:55], v245 offset:2304
v_mfma_f32_16x16x32_bf16 v[164:167], a[12:15], v[56:59], v[164:167]
s_waitcnt vmcnt(5)
buffer_load_dwordx4 v249, s[12:15], s46 offen offset:3072 nt lds
v_mfma_f32_16x16x32_bf16 v[164:167], a[16:19], a[68:71], v[164:167]
v_add_co_u32 v252, vcc, s16, v252
s_nop 1
v_addc_co_u32 v253, vcc, 0, v253, vcc
v_mfma_f32_16x16x32_bf16 v[164:167], a[20:23], a[88:91], v[164:167]
ds_read_b128 a[56:59], v245 offset:2560
global_load_dword v252, v[252:253], off
v_mfma_f32_16x16x32_bf16 v[164:167], a[24:27], a[108:111], v[164:167]
ds_read_b128 a[60:63], v245 offset:2816
v_mfma_f32_16x16x32_bf16 v[164:167], a[28:31], a[128:131], v[164:167]
v_mfma_f32_16x16x32_bf16 v[168:171], a[0:3], v[64:67], v[208:211]
v_mfma_f32_16x16x32_bf16 v[168:171], a[4:7], v[72:75], v[168:171]
v_mfma_f32_16x16x32_bf16 v[168:171], a[8:11], v[80:83], v[168:171]
v_mfma_f32_16x16x32_bf16 v[168:171], a[12:15], v[88:91], v[168:171]
v_mfma_f32_16x16x32_bf16 v[168:171], a[16:19], a[72:75], v[168:171]
v_mfma_f32_16x16x32_bf16 v[168:171], a[20:23], a[92:95], v[168:171]
s_mov_b32 s46, 397312
s_add_u32 m0, s29, 4096
v_mfma_f32_16x16x32_bf16 v[168:171], a[24:27], a[112:115], v[168:171]
s_waitcnt vmcnt(5)
buffer_load_dwordx4 v248, s[12:15], s46 offen offset:0 nt lds
v_mfma_f32_16x16x32_bf16 v[168:171], a[28:31], a[132:135], v[168:171]
s_waitcnt lgkmcnt(0)
v_mfma_f32_16x16x32_bf16 v[172:175], a[32:35], v[0:3], v[200:203]
v_mfma_f32_16x16x32_bf16 v[172:175], a[36:39], v[8:11], v[172:175]
v_exp_f32 v160, v160
v_mfma_f32_16x16x32_bf16 v[172:175], a[40:43], v[16:19], v[172:175]
v_exp_f32 v161, v161
v_mfma_f32_16x16x32_bf16 v[172:175], a[44:47], v[24:27], v[172:175]
v_exp_f32 v162, v162
v_mfma_f32_16x16x32_bf16 v[172:175], a[48:51], a[64:67], v[172:175]
v_cvt_pk_bf16_f32 v160, v160, v161
v_mfma_f32_16x16x32_bf16 v[172:175], a[52:55], a[84:87], v[172:175]
v_exp_f32 v163, v163
v_mfma_f32_16x16x32_bf16 v[172:175], a[56:59], a[104:107], v[172:175]
v_exp_f32 v164, v164
v_mfma_f32_16x16x32_bf16 v[172:175], a[60:63], a[124:127], v[172:175]
v_cvt_pk_bf16_f32 v161, v162, v163
v_mfma_f32_16x16x32_bf16 v[176:179], a[32:35], v[32:35], v[204:207]
v_exp_f32 v165, v165
v_mfma_f32_16x16x32_bf16 v[176:179], a[36:39], v[40:43], v[176:179]
s_waitcnt vmcnt(5)
buffer_load_dwordx4 v249, s[12:15], s46 offen offset:1024 nt lds
v_mfma_f32_16x16x32_bf16 v[176:179], a[40:43], v[48:51], v[176:179]
v_exp_f32 v166, v166
v_mfma_f32_16x16x32_bf16 v[176:179], a[44:47], v[56:59], v[176:179]
v_cvt_pk_bf16_f32 v164, v164, v165
v_mfma_f32_16x16x32_bf16 v[176:179], a[48:51], a[68:71], v[176:179]
v_exp_f32 v167, v167
v_mfma_f32_16x16x32_bf16 v[176:179], a[52:55], a[88:91], v[176:179]
v_exp_f32 v168, v168
v_mfma_f32_16x16x32_bf16 v[176:179], a[56:59], a[108:111], v[176:179]
v_cvt_pk_bf16_f32 v165, v166, v167
v_mfma_f32_16x16x32_bf16 v[176:179], a[60:63], a[128:131], v[176:179]
v_exp_f32 v169, v169
v_mfma_f32_16x16x32_bf16 v[180:183], a[32:35], v[64:67], v[208:211]
v_exp_f32 v170, v170
v_mfma_f32_16x16x32_bf16 v[180:183], a[36:39], v[72:75], v[180:183]
v_cvt_pk_bf16_f32 v168, v168, v169
v_mfma_f32_16x16x32_bf16 v[180:183], a[40:43], v[80:83], v[180:183]
v_exp_f32 v171, v171
v_mfma_f32_16x16x32_bf16 v[180:183], a[44:47], v[88:91], v[180:183]
v_cvt_pk_bf16_f32 v169, v170, v171
v_mfma_f32_16x16x32_bf16 v[180:183], a[48:51], a[72:75], v[180:183]
s_waitcnt vmcnt(5)
buffer_load_dwordx4 v248, s[12:15], s46 offen offset:2048 nt lds
v_mfma_f32_16x16x32_bf16 v[180:183], a[52:55], a[92:95], v[180:183]
v_mfma_f32_16x16x32_bf16 v[180:183], a[56:59], a[112:115], v[180:183]
v_mfma_f32_16x16x32_bf16 v[180:183], a[60:63], a[132:135], v[180:183]
v_mfma_f32_16x16x32_bf16 v[184:187], a[0:3], v[96:99], v[212:215]
v_mfma_f32_16x16x32_bf16 v[184:187], a[4:7], v[104:107], v[184:187]
v_exp_f32 v172, v172
v_exp_f32 v173, v173
v_exp_f32 v174, v174
v_cvt_pk_bf16_f32 v162, v172, v173
v_mfma_f32_16x16x32_bf16 v[184:187], a[8:11], v[112:115], v[184:187]
v_exp_f32 v175, v175
v_mfma_f32_16x16x32_bf16 v[184:187], a[12:15], v[120:123], v[184:187]
v_exp_f32 v176, v176
v_mfma_f32_16x16x32_bf16 v[184:187], a[16:19], a[76:79], v[184:187]
v_cvt_pk_bf16_f32 v163, v174, v175
v_mfma_f32_16x16x32_bf16 v[184:187], a[20:23], a[96:99], v[184:187]
v_exp_f32 v177, v177
v_mfma_f32_16x16x32_bf16 v[184:187], a[24:27], a[116:119], v[184:187]
ds_write_b128 v251, v[160:163] offset:37888
v_mfma_f32_16x16x32_bf16 v[184:187], a[28:31], a[136:139], v[184:187]
s_waitcnt vmcnt(5)
buffer_load_dwordx4 v249, s[12:15], s46 offen offset:3072 nt lds
v_mfma_f32_16x16x32_bf16 v[188:191], a[0:3], v[128:131], v[216:219]
v_exp_f32 v178, v178
v_cvt_pk_bf16_f32 v166, v176, v177
v_mfma_f32_16x16x32_bf16 v[188:191], a[4:7], v[136:139], v[188:191]
v_exp_f32 v179, v179
v_mfma_f32_16x16x32_bf16 v[188:191], a[8:11], v[144:147], v[188:191]
v_exp_f32 v180, v180
v_mfma_f32_16x16x32_bf16 v[188:191], a[12:15], v[152:155], v[188:191]
v_cvt_pk_bf16_f32 v167, v178, v179
v_mfma_f32_16x16x32_bf16 v[188:191], a[16:19], a[80:83], v[188:191]
v_exp_f32 v181, v181
v_mfma_f32_16x16x32_bf16 v[188:191], a[20:23], a[100:103], v[188:191]
ds_write_b128 v251, v[164:167] offset:38912
v_mfma_f32_16x16x32_bf16 v[188:191], a[24:27], a[120:123], v[188:191]
v_exp_f32 v182, v182
v_mfma_f32_16x16x32_bf16 v[188:191], a[28:31], a[140:143], v[188:191]
v_cvt_pk_bf16_f32 v170, v180, v181
v_mfma_f32_16x16x32_bf16 v[192:195], a[32:35], v[96:99], v[212:215]
v_exp_f32 v183, v183
v_mfma_f32_16x16x32_bf16 v[192:195], a[36:39], v[104:107], v[192:195]
s_mov_b32 s45, 425984
s_add_u32 m0, s29, 32768
v_mfma_f32_16x16x32_bf16 v[192:195], a[40:43], v[112:115], v[192:195]
s_waitcnt vmcnt(5)
buffer_load_dwordx4 v248, s[8:11], s45 offen offset:0 nt lds
v_cvt_pk_bf16_f32 v171, v182, v183
ds_write_b128 v251, v[168:171] offset:39936
v_mfma_f32_16x16x32_bf16 v[192:195], a[44:47], v[120:123], v[192:195]
v_mfma_f32_16x16x32_bf16 v[192:195], a[48:51], a[76:79], v[192:195]
s_waitcnt lgkmcnt(0)
s_barrier
v_add_u32 v246, s34, v246
ds_read_b64_tr_b16 a[0:1], v246 offset:0
v_mfma_f32_16x16x32_bf16 v[192:195], a[52:55], a[96:99], v[192:195]
ds_read_b64_tr_b16 a[2:3], v246 offset:2048
v_mfma_f32_16x16x32_bf16 v[192:195], a[56:59], a[116:119], v[192:195]
v_add_u32 v247, s34, v247
ds_read_b64_tr_b16 a[4:5], v247 offset:0
v_mfma_f32_16x16x32_bf16 v[192:195], a[60:63], a[136:139], v[192:195]
ds_read_b64_tr_b16 a[6:7], v247 offset:2048
ds_read_b64_tr_b16 a[8:9], v246 offset:256
v_mfma_f32_16x16x32_bf16 v[196:199], a[32:35], v[128:131], v[216:219]
ds_read_b64_tr_b16 a[10:11], v246 offset:2304
ds_read_b64_tr_b16 a[12:13], v247 offset:256
v_mfma_f32_16x16x32_bf16 v[196:199], a[36:39], v[136:139], v[196:199]
ds_read_b64_tr_b16 a[14:15], v247 offset:2304
ds_read_b64_tr_b16 a[16:17], v246 offset:512
v_mfma_f32_16x16x32_bf16 v[196:199], a[40:43], v[144:147], v[196:199]
ds_read_b64_tr_b16 a[18:19], v246 offset:2560
ds_read_b64_tr_b16 a[20:21], v247 offset:512
v_mfma_f32_16x16x32_bf16 v[196:199], a[44:47], v[152:155], v[196:199]
ds_read_b64_tr_b16 a[22:23], v247 offset:2560
v_mfma_f32_16x16x32_bf16 v[196:199], a[48:51], a[80:83], v[196:199]
v_mfma_f32_16x16x32_bf16 v[196:199], a[52:55], a[100:103], v[196:199]
s_waitcnt vmcnt(5)
buffer_load_dwordx4 v249, s[8:11], s45 offen offset:1024 nt lds
v_mfma_f32_16x16x32_bf16 v[196:199], a[56:59], a[120:123], v[196:199]
v_mfma_f32_16x16x32_bf16 v[196:199], a[60:63], a[140:143], v[196:199]
v_exp_f32 v184, v184
v_mfma_f32_16x16x32_bf16 a[224:227], a[244:247], v[160:163], a[224:227]
v_exp_f32 v185, v185
v_mfma_f32_16x16x32_bf16 a[228:231], a[244:247], v[164:167], a[228:231]
v_exp_f32 v186, v186
v_mfma_f32_16x16x32_bf16 a[232:235], a[244:247], v[168:171], a[232:235]
ds_read_b128 v[172:175], v250 offset:37888
s_waitcnt lgkmcnt(5)
v_mfma_f32_16x16x32_bf16 v[4:7], a[0:3], v[160:163], v[4:7]
v_cvt_pk_bf16_f32 v184, v184, v185
ds_read_b64_tr_b16 a[24:25], v246 offset:768
v_mfma_f32_16x16x32_bf16 v[68:71], a[0:3], v[164:167], v[68:71]
ds_read_b128 v[176:179], v250 offset:38912
ds_read_b64_tr_b16 a[26:27], v246 offset:2816
v_mfma_f32_16x16x32_bf16 v[132:135], a[0:3], v[168:171], v[132:135]
v_exp_f32 v187, v187
v_mfma_f32_16x16x32_bf16 v[12:15], a[4:7], v[160:163], v[12:15]
ds_read_b128 v[180:183], v250 offset:39936
ds_read_b64_tr_b16 a[28:29], v247 offset:768
v_mfma_f32_16x16x32_bf16 v[76:79], a[4:7], v[164:167], v[76:79]
v_exp_f32 v188, v188
v_mfma_f32_16x16x32_bf16 v[140:143], a[4:7], v[168:171], v[140:143]
s_waitcnt vmcnt(5)
buffer_load_dwordx4 v248, s[8:11], s45 offen offset:2048 nt lds
v_mfma_f32_16x16x32_bf16 v[20:23], a[8:11], v[160:163], v[20:23]
v_cvt_pk_bf16_f32 v185, v186, v187
ds_read_b64_tr_b16 a[30:31], v247 offset:2816
v_mfma_f32_16x16x32_bf16 v[84:87], a[8:11], v[164:167], v[84:87]
v_exp_f32 v189, v189
v_mfma_f32_16x16x32_bf16 v[148:151], a[8:11], v[168:171], v[148:151]
v_add_u32 v246, s33, v246
ds_read_b64_tr_b16 a[32:33], v246 offset:0
v_mfma_f32_16x16x32_bf16 v[28:31], a[12:15], v[160:163], v[28:31]
ds_read_b64_tr_b16 a[34:35], v246 offset:2048
v_mfma_f32_16x16x32_bf16 v[92:95], a[12:15], v[164:167], v[92:95]
v_exp_f32 v190, v190
v_mfma_f32_16x16x32_bf16 v[156:159], a[12:15], v[168:171], v[156:159]
v_cvt_pk_bf16_f32 v188, v188, v189
s_waitcnt lgkmcnt(3)
v_mfma_f32_16x16x32_bf16 v[36:39], a[16:19], v[160:163], v[36:39]
v_add_u32 v247, s33, v247
ds_read_b64_tr_b16 a[36:37], v247 offset:0
v_mfma_f32_16x16x32_bf16 v[100:103], a[16:19], v[164:167], v[100:103]
ds_read_b64_tr_b16 a[38:39], v247 offset:2048
ds_read_b64_tr_b16 a[40:41], v246 offset:256
v_mfma_f32_16x16x32_bf16 a[144:147], a[16:19], v[168:171], a[144:147]
v_exp_f32 v191, v191
v_mfma_f32_16x16x32_bf16 v[44:47], a[20:23], v[160:163], v[44:47]
v_cvt_pk_bf16_f32 v189, v190, v191
ds_read_b64_tr_b16 a[42:43], v246 offset:2304
v_mfma_f32_16x16x32_bf16 v[108:111], a[20:23], v[164:167], v[108:111]
v_exp_f32 v192, v192
v_mfma_f32_16x16x32_bf16 a[148:151], a[20:23], v[168:171], a[148:151]
s_waitcnt vmcnt(5)
buffer_load_dwordx4 v249, s[8:11], s45 offen offset:3072 nt lds
v_mfma_f32_16x16x32_bf16 v[52:55], a[24:27], v[160:163], v[52:55]
ds_read_b64_tr_b16 a[44:45], v247 offset:256
ds_read_b64_tr_b16 a[46:47], v247 offset:2304
v_mfma_f32_16x16x32_bf16 v[116:119], a[24:27], v[164:167], v[116:119]
v_exp_f32 v193, v193
v_mfma_f32_16x16x32_bf16 a[152:155], a[24:27], v[168:171], a[152:155]
ds_read_b64_tr_b16 a[48:49], v246 offset:512
s_waitcnt lgkmcnt(4)
v_mfma_f32_16x16x32_bf16 v[60:63], a[28:31], v[160:163], v[60:63]
v_exp_f32 v194, v194
v_mfma_f32_16x16x32_bf16 v[124:127], a[28:31], v[164:167], v[124:127]
ds_read_b64_tr_b16 a[50:51], v246 offset:2560
v_cvt_pk_bf16_f32 v186, v192, v193
v_mfma_f32_16x16x32_bf16 a[156:159], a[28:31], v[168:171], a[156:159]
ds_read_b64_tr_b16 a[52:53], v247 offset:512
ds_read_b64_tr_b16 a[54:55], v247 offset:2560
v_mfma_f32_16x16x32_bf16 v[4:7], a[32:35], v[172:175], v[4:7]
v_exp_f32 v195, v195
v_mfma_f32_16x16x32_bf16 v[68:71], a[32:35], v[176:179], v[68:71]
ds_read_b64_tr_b16 a[56:57], v246 offset:768
ds_read_b64_tr_b16 a[58:59], v246 offset:2816
v_mfma_f32_16x16x32_bf16 v[132:135], a[32:35], v[180:183], v[132:135]
v_exp_f32 v196, v196
v_mfma_f32_16x16x32_bf16 v[12:15], a[36:39], v[172:175], v[12:15]
s_mov_b32 s45, 430080
s_add_u32 m0, s29, 36864
v_mfma_f32_16x16x32_bf16 v[76:79], a[36:39], v[176:179], v[76:79]
s_waitcnt vmcnt(5)
buffer_load_dwordx4 v248, s[8:11], s45 offen offset:0 nt lds
v_mfma_f32_16x16x32_bf16 v[140:143], a[36:39], v[180:183], v[140:143]
v_cvt_pk_bf16_f32 v187, v194, v195
s_waitcnt lgkmcnt(4)
v_mfma_f32_16x16x32_bf16 v[20:23], a[40:43], v[172:175], v[20:23]
ds_read_b64_tr_b16 a[60:61], v247 offset:768
ds_read_b64_tr_b16 a[62:63], v247 offset:2816
v_mfma_f32_16x16x32_bf16 v[84:87], a[40:43], v[176:179], v[84:87]
v_exp_f32 v197, v197
v_mfma_f32_16x16x32_bf16 v[148:151], a[40:43], v[180:183], v[148:151]
v_add_u32 v251, 0x10000, v251
ds_write_b128 v251, v[184:187] offset:6144
v_mfma_f32_16x16x32_bf16 v[28:31], a[44:47], v[172:175], v[28:31]
v_exp_f32 v198, v198
v_mfma_f32_16x16x32_bf16 v[92:95], a[44:47], v[176:179], v[92:95]
v_cvt_pk_bf16_f32 v190, v196, v197
v_mfma_f32_16x16x32_bf16 v[156:159], a[44:47], v[180:183], v[156:159]
v_exp_f32 v199, v199
v_mfma_f32_16x16x32_bf16 v[36:39], a[48:51], v[172:175], v[36:39]
v_cvt_pk_bf16_f32 v191, v198, v199
ds_write_b128 v251, v[188:191] offset:7168
v_mfma_f32_16x16x32_bf16 v[100:103], a[48:51], v[176:179], v[100:103]
v_mfma_f32_16x16x32_bf16 a[144:147], a[48:51], v[180:183], a[144:147]
s_waitcnt lgkmcnt(2)
v_mfma_f32_16x16x32_bf16 v[44:47], a[52:55], v[172:175], v[44:47]
s_waitcnt vmcnt(5)
buffer_load_dwordx4 v249, s[8:11], s45 offen offset:1024 nt lds
v_mfma_f32_16x16x32_bf16 v[108:111], a[52:55], v[176:179], v[108:111]
v_mfma_f32_16x16x32_bf16 a[148:151], a[52:55], v[180:183], a[148:151]
v_mfma_f32_16x16x32_bf16 v[52:55], a[56:59], v[172:175], v[52:55]
v_mfma_f32_16x16x32_bf16 v[116:119], a[56:59], v[176:179], v[116:119]
v_mfma_f32_16x16x32_bf16 a[152:155], a[56:59], v[180:183], a[152:155]
v_mfma_f32_16x16x32_bf16 v[60:63], a[60:63], v[172:175], v[60:63]
v_mfma_f32_16x16x32_bf16 v[124:127], a[60:63], v[176:179], v[124:127]
v_mfma_f32_16x16x32_bf16 a[156:159], a[60:63], v[180:183], a[156:159]
v_mfma_f32_16x16x32_bf16 a[236:239], a[244:247], v[184:187], a[236:239]
v_mfma_f32_16x16x32_bf16 a[240:243], a[244:247], v[188:191], a[240:243]
v_mfma_f32_16x16x32_bf16 a[160:163], a[0:3], v[184:187], a[160:163]
s_waitcnt vmcnt(5)
buffer_load_dwordx4 v248, s[8:11], s45 offen offset:2048 nt lds
v_mfma_f32_16x16x32_bf16 a[192:195], a[0:3], v[188:191], a[192:195]
s_waitcnt lgkmcnt(0)
s_barrier
v_add_u32 v244, 0x10000, v244
ds_read_b128 a[0:3], v244 offset:0
v_mfma_f32_16x16x32_bf16 a[164:167], a[4:7], v[184:187], a[164:167]
v_add_u32 v250, 0x10000, v250
ds_read_b128 v[192:195], v250 offset:6144
v_mfma_f32_16x16x32_bf16 a[196:199], a[4:7], v[188:191], a[196:199]
ds_read_b128 v[196:199], v250 offset:7168
ds_read_b128 a[4:7], v244 offset:256
v_mfma_f32_16x16x32_bf16 a[168:171], a[8:11], v[184:187], a[168:171]
v_mfma_f32_16x16x32_bf16 a[200:203], a[8:11], v[188:191], a[200:203]
ds_read_b128 a[8:11], v244 offset:512
v_mfma_f32_16x16x32_bf16 a[172:175], a[12:15], v[184:187], a[172:175]
v_mfma_f32_16x16x32_bf16 a[204:207], a[12:15], v[188:191], a[204:207]
ds_read_b128 a[12:15], v244 offset:768
v_mfma_f32_16x16x32_bf16 a[176:179], a[16:19], v[184:187], a[176:179]
v_mfma_f32_16x16x32_bf16 a[208:211], a[16:19], v[188:191], a[208:211]
v_add_u32 v245, 0x10000, v245
ds_read_b128 a[16:19], v245 offset:0
v_mfma_f32_16x16x32_bf16 a[180:183], a[20:23], v[184:187], a[180:183]
v_mfma_f32_16x16x32_bf16 a[212:215], a[20:23], v[188:191], a[212:215]
s_waitcnt vmcnt(5)
buffer_load_dwordx4 v249, s[8:11], s45 offen offset:3072 nt lds
v_mfma_f32_16x16x32_bf16 a[184:187], a[24:27], v[184:187], a[184:187]
ds_read_b128 a[20:23], v245 offset:256
v_mfma_f32_16x16x32_bf16 a[216:219], a[24:27], v[188:191], a[216:219]
ds_read_b128 a[24:27], v245 offset:512
v_mfma_f32_16x16x32_bf16 a[188:191], a[28:31], v[184:187], a[188:191]
v_mfma_f32_16x16x32_bf16 a[220:223], a[28:31], v[188:191], a[220:223]
ds_read_b128 a[28:31], v245 offset:768
s_waitcnt lgkmcnt(8)
v_mfma_f32_16x16x32_bf16 a[160:163], a[32:35], v[192:195], a[160:163]
s_waitcnt lgkmcnt(7)
v_mfma_f32_16x16x32_bf16 a[192:195], a[32:35], v[196:199], a[192:195]
ds_read_b128 a[32:35], v244 offset:2048
v_mfma_f32_16x16x32_bf16 a[164:167], a[36:39], v[192:195], a[164:167]
v_mfma_f32_16x16x32_bf16 a[196:199], a[36:39], v[196:199], a[196:199]
ds_read_b128 a[36:39], v244 offset:2304
v_mfma_f32_16x16x32_bf16 a[168:171], a[40:43], v[192:195], a[168:171]
v_mfma_f32_16x16x32_bf16 a[200:203], a[40:43], v[196:199], a[200:203]
s_mov_b32 s46, 425984
s_add_u32 m0, s29, 65536
v_mfma_f32_16x16x32_bf16 a[172:175], a[44:47], v[192:195], a[172:175]
s_waitcnt vmcnt(5)
buffer_load_dwordx4 v248, s[12:15], s46 offen offset:0 nt lds
v_mfma_f32_16x16x32_bf16 a[204:207], a[44:47], v[196:199], a[204:207]
v_mfma_f32_16x16x32_bf16 a[176:179], a[48:51], v[192:195], a[176:179]
v_mfma_f32_16x16x32_bf16 a[208:211], a[48:51], v[196:199], a[208:211]
v_mfma_f32_16x16x32_bf16 a[180:183], a[52:55], v[192:195], a[180:183]
v_mfma_f32_16x16x32_bf16 a[212:215], a[52:55], v[196:199], a[212:215]
v_mfma_f32_16x16x32_bf16 a[184:187], a[56:59], v[192:195], a[184:187]
v_mfma_f32_16x16x32_bf16 a[216:219], a[56:59], v[196:199], a[216:219]
v_mfma_f32_16x16x32_bf16 a[188:191], a[60:63], v[192:195], a[188:191]
v_mfma_f32_16x16x32_bf16 a[220:223], a[60:63], v[196:199], a[220:223]
ds_read_b128 a[40:43], v244 offset:2560
v_mfma_f32_16x16x32_bf16 v[160:163], a[0:3], v[0:3], v[200:203]
ds_read_b128 a[44:47], v244 offset:2816
s_waitcnt lgkmcnt(10)
v_mfma_f32_16x16x32_bf16 v[160:163], a[4:7], v[8:11], v[160:163]
s_waitcnt vmcnt(5)
buffer_load_dwordx4 v249, s[12:15], s46 offen offset:1024 nt lds
s_waitcnt lgkmcnt(9)
v_mfma_f32_16x16x32_bf16 v[160:163], a[8:11], v[16:19], v[160:163]
ds_read_b128 a[48:51], v245 offset:2048
s_waitcnt lgkmcnt(9)
v_mfma_f32_16x16x32_bf16 v[160:163], a[12:15], v[24:27], v[160:163]
ds_read_b128 a[52:55], v245 offset:2304
s_waitcnt lgkmcnt(9)
v_mfma_f32_16x16x32_bf16 v[160:163], a[16:19], a[64:67], v[160:163]
ds_read_b128 a[56:59], v245 offset:2560
s_waitcnt lgkmcnt(9)
v_mfma_f32_16x16x32_bf16 v[160:163], a[20:23], a[84:87], v[160:163]
ds_read_b128 a[60:63], v245 offset:2816
s_waitcnt lgkmcnt(9)
v_mfma_f32_16x16x32_bf16 v[160:163], a[24:27], a[104:107], v[160:163]
s_waitcnt lgkmcnt(8)
v_mfma_f32_16x16x32_bf16 v[160:163], a[28:31], a[124:127], v[160:163]
v_mfma_f32_16x16x32_bf16 v[164:167], a[0:3], v[32:35], v[204:207]
v_mfma_f32_16x16x32_bf16 v[164:167], a[4:7], v[40:43], v[164:167]
v_mfma_f32_16x16x32_bf16 v[164:167], a[8:11], v[48:51], v[164:167]
v_mfma_f32_16x16x32_bf16 v[164:167], a[12:15], v[56:59], v[164:167]
v_mfma_f32_16x16x32_bf16 v[164:167], a[16:19], a[68:71], v[164:167]
v_mfma_f32_16x16x32_bf16 v[164:167], a[20:23], a[88:91], v[164:167]
s_waitcnt vmcnt(5)
buffer_load_dwordx4 v248, s[12:15], s46 offen offset:2048 nt lds
v_mfma_f32_16x16x32_bf16 v[164:167], a[24:27], a[108:111], v[164:167]
v_mfma_f32_16x16x32_bf16 v[164:167], a[28:31], a[128:131], v[164:167]
v_mfma_f32_16x16x32_bf16 v[168:171], a[0:3], v[64:67], v[208:211]
v_mfma_f32_16x16x32_bf16 v[168:171], a[4:7], v[72:75], v[168:171]
v_mfma_f32_16x16x32_bf16 v[168:171], a[8:11], v[80:83], v[168:171]
v_mfma_f32_16x16x32_bf16 v[168:171], a[12:15], v[88:91], v[168:171]
v_mfma_f32_16x16x32_bf16 v[168:171], a[16:19], a[72:75], v[168:171]
v_mfma_f32_16x16x32_bf16 v[168:171], a[20:23], a[92:95], v[168:171]
v_mfma_f32_16x16x32_bf16 v[168:171], a[24:27], a[112:115], v[168:171]
v_mfma_f32_16x16x32_bf16 v[168:171], a[28:31], a[132:135], v[168:171]
s_waitcnt lgkmcnt(0)
v_mfma_f32_16x16x32_bf16 v[172:175], a[32:35], v[0:3], v[200:203]
s_waitcnt vmcnt(5)
buffer_load_dwordx4 v249, s[12:15], s46 offen offset:3072 nt lds
v_mfma_f32_16x16x32_bf16 v[172:175], a[36:39], v[8:11], v[172:175]
v_exp_f32 v160, v160
v_mfma_f32_16x16x32_bf16 v[172:175], a[40:43], v[16:19], v[172:175]
v_exp_f32 v161, v161
v_mfma_f32_16x16x32_bf16 v[172:175], a[44:47], v[24:27], v[172:175]
v_exp_f32 v162, v162
v_mfma_f32_16x16x32_bf16 v[172:175], a[48:51], a[64:67], v[172:175]
v_cvt_pk_bf16_f32 v160, v160, v161
v_mfma_f32_16x16x32_bf16 v[172:175], a[52:55], a[84:87], v[172:175]
v_exp_f32 v163, v163
v_mfma_f32_16x16x32_bf16 v[172:175], a[56:59], a[104:107], v[172:175]
v_exp_f32 v164, v164
v_mfma_f32_16x16x32_bf16 v[172:175], a[60:63], a[124:127], v[172:175]
v_cvt_pk_bf16_f32 v161, v162, v163
v_mfma_f32_16x16x32_bf16 v[176:179], a[32:35], v[32:35], v[204:207]
v_exp_f32 v165, v165
v_mfma_f32_16x16x32_bf16 v[176:179], a[36:39], v[40:43], v[176:179]
v_exp_f32 v166, v166
v_mfma_f32_16x16x32_bf16 v[176:179], a[40:43], v[48:51], v[176:179]
s_mov_b32 s46, 430080
s_add_u32 m0, s29, 69632
v_mfma_f32_16x16x32_bf16 v[176:179], a[44:47], v[56:59], v[176:179]
s_waitcnt vmcnt(5)
buffer_load_dwordx4 v248, s[12:15], s46 offen offset:0 nt lds
v_mfma_f32_16x16x32_bf16 v[176:179], a[48:51], a[68:71], v[176:179]
v_cvt_pk_bf16_f32 v164, v164, v165
v_mfma_f32_16x16x32_bf16 v[176:179], a[52:55], a[88:91], v[176:179]
v_exp_f32 v167, v167
v_mfma_f32_16x16x32_bf16 v[176:179], a[56:59], a[108:111], v[176:179]
v_exp_f32 v168, v168
v_mfma_f32_16x16x32_bf16 v[176:179], a[60:63], a[128:131], v[176:179]
v_cvt_pk_bf16_f32 v165, v166, v167
v_mfma_f32_16x16x32_bf16 v[180:183], a[32:35], v[64:67], v[208:211]
v_exp_f32 v169, v169
v_mfma_f32_16x16x32_bf16 v[180:183], a[36:39], v[72:75], v[180:183]
v_exp_f32 v170, v170
v_mfma_f32_16x16x32_bf16 v[180:183], a[40:43], v[80:83], v[180:183]
v_cvt_pk_bf16_f32 v168, v168, v169
v_mfma_f32_16x16x32_bf16 v[180:183], a[44:47], v[88:91], v[180:183]
v_exp_f32 v171, v171
v_mfma_f32_16x16x32_bf16 v[180:183], a[48:51], a[72:75], v[180:183]
v_cvt_pk_bf16_f32 v169, v170, v171
v_mfma_f32_16x16x32_bf16 v[180:183], a[52:55], a[92:95], v[180:183]
v_mfma_f32_16x16x32_bf16 v[180:183], a[56:59], a[112:115], v[180:183]
s_waitcnt vmcnt(5)
buffer_load_dwordx4 v249, s[12:15], s46 offen offset:1024 nt lds
v_mfma_f32_16x16x32_bf16 v[180:183], a[60:63], a[132:135], v[180:183]
v_mfma_f32_16x16x32_bf16 v[184:187], a[0:3], v[96:99], v[212:215]
v_mfma_f32_16x16x32_bf16 v[184:187], a[4:7], v[104:107], v[184:187]
v_exp_f32 v172, v172
v_exp_f32 v173, v173
v_exp_f32 v174, v174
v_cvt_pk_bf16_f32 v162, v172, v173
v_mfma_f32_16x16x32_bf16 v[184:187], a[8:11], v[112:115], v[184:187]
v_exp_f32 v175, v175
v_mfma_f32_16x16x32_bf16 v[184:187], a[12:15], v[120:123], v[184:187]
v_exp_f32 v176, v176
v_mfma_f32_16x16x32_bf16 v[184:187], a[16:19], a[76:79], v[184:187]
v_cvt_pk_bf16_f32 v163, v174, v175
v_mfma_f32_16x16x32_bf16 v[184:187], a[20:23], a[96:99], v[184:187]
v_exp_f32 v177, v177
v_mfma_f32_16x16x32_bf16 v[184:187], a[24:27], a[116:119], v[184:187]
ds_write_b128 v251, v[160:163] offset:37888
v_mfma_f32_16x16x32_bf16 v[184:187], a[28:31], a[136:139], v[184:187]
v_exp_f32 v178, v178
v_mfma_f32_16x16x32_bf16 v[188:191], a[0:3], v[128:131], v[216:219]
v_cvt_pk_bf16_f32 v166, v176, v177
v_mfma_f32_16x16x32_bf16 v[188:191], a[4:7], v[136:139], v[188:191]
s_waitcnt vmcnt(5)
buffer_load_dwordx4 v248, s[12:15], s46 offen offset:2048 nt lds
v_mfma_f32_16x16x32_bf16 v[188:191], a[8:11], v[144:147], v[188:191]
v_exp_f32 v179, v179
v_mfma_f32_16x16x32_bf16 v[188:191], a[12:15], v[152:155], v[188:191]
v_exp_f32 v180, v180
v_mfma_f32_16x16x32_bf16 v[188:191], a[16:19], a[80:83], v[188:191]
v_cvt_pk_bf16_f32 v167, v178, v179
v_mfma_f32_16x16x32_bf16 v[188:191], a[20:23], a[100:103], v[188:191]
v_exp_f32 v181, v181
v_mfma_f32_16x16x32_bf16 v[188:191], a[24:27], a[120:123], v[188:191]
ds_write_b128 v251, v[164:167] offset:38912
v_mfma_f32_16x16x32_bf16 v[188:191], a[28:31], a[140:143], v[188:191]
v_exp_f32 v182, v182
v_mfma_f32_16x16x32_bf16 v[192:195], a[32:35], v[96:99], v[212:215]
v_cvt_pk_bf16_f32 v170, v180, v181
v_mfma_f32_16x16x32_bf16 v[192:195], a[36:39], v[104:107], v[192:195]
v_exp_f32 v183, v183
v_mfma_f32_16x16x32_bf16 v[192:195], a[40:43], v[112:115], v[192:195]
v_cvt_pk_bf16_f32 v171, v182, v183
ds_write_b128 v251, v[168:171] offset:39936
v_mfma_f32_16x16x32_bf16 v[192:195], a[44:47], v[120:123], v[192:195]
v_mfma_f32_16x16x32_bf16 v[192:195], a[48:51], a[76:79], v[192:195]
s_waitcnt vmcnt(5)
buffer_load_dwordx4 v249, s[12:15], s46 offen offset:3072 nt lds
s_waitcnt lgkmcnt(0)
s_barrier
v_add_u32 v246, s35, v246
ds_read_b64_tr_b16 a[0:1], v246 offset:0
v_mfma_f32_16x16x32_bf16 v[192:195], a[52:55], a[96:99], v[192:195]
ds_read_b64_tr_b16 a[2:3], v246 offset:2048
v_mfma_f32_16x16x32_bf16 v[192:195], a[56:59], a[116:119], v[192:195]
v_add_u32 v247, s35, v247
ds_read_b64_tr_b16 a[4:5], v247 offset:0
v_mfma_f32_16x16x32_bf16 v[192:195], a[60:63], a[136:139], v[192:195]
ds_read_b64_tr_b16 a[6:7], v247 offset:2048
ds_read_b64_tr_b16 a[8:9], v246 offset:256
v_mfma_f32_16x16x32_bf16 v[196:199], a[32:35], v[128:131], v[216:219]
ds_read_b64_tr_b16 a[10:11], v246 offset:2304
ds_read_b64_tr_b16 a[12:13], v247 offset:256
v_mfma_f32_16x16x32_bf16 v[196:199], a[36:39], v[136:139], v[196:199]
ds_read_b64_tr_b16 a[14:15], v247 offset:2304
ds_read_b64_tr_b16 a[16:17], v246 offset:512
v_mfma_f32_16x16x32_bf16 v[196:199], a[40:43], v[144:147], v[196:199]
ds_read_b64_tr_b16 a[18:19], v246 offset:2560
ds_read_b64_tr_b16 a[20:21], v247 offset:512
v_mfma_f32_16x16x32_bf16 v[196:199], a[44:47], v[152:155], v[196:199]
ds_read_b64_tr_b16 a[22:23], v247 offset:2560
v_mfma_f32_16x16x32_bf16 v[196:199], a[48:51], a[80:83], v[196:199]
v_mfma_f32_16x16x32_bf16 v[196:199], a[52:55], a[100:103], v[196:199]
v_mfma_f32_16x16x32_bf16 v[196:199], a[56:59], a[120:123], v[196:199]
s_mov_b32 s45, 458752
s_add_u32 m0, s29, 98304
v_mfma_f32_16x16x32_bf16 v[196:199], a[60:63], a[140:143], v[196:199]
s_waitcnt vmcnt(5)
buffer_load_dwordx4 v248, s[8:11], s45 offen offset:0 nt lds
v_mfma_f32_16x16x32_bf16 a[224:227], a[244:247], v[160:163], a[224:227]
v_exp_f32 v184, v184
v_mfma_f32_16x16x32_bf16 a[228:231], a[244:247], v[164:167], a[228:231]
v_exp_f32 v185, v185
v_mfma_f32_16x16x32_bf16 a[232:235], a[244:247], v[168:171], a[232:235]
ds_read_b128 v[172:175], v250 offset:37888
s_waitcnt lgkmcnt(5)
v_mfma_f32_16x16x32_bf16 v[4:7], a[0:3], v[160:163], v[4:7]
v_exp_f32 v186, v186
v_mfma_f32_16x16x32_bf16 v[68:71], a[0:3], v[164:167], v[68:71]
ds_read_b128 v[176:179], v250 offset:38912
v_cvt_pk_bf16_f32 v184, v184, v185
v_mfma_f32_16x16x32_bf16 v[132:135], a[0:3], v[168:171], v[132:135]
v_exp_f32 v187, v187
v_mfma_f32_16x16x32_bf16 v[12:15], a[4:7], v[160:163], v[12:15]
ds_read_b128 v[180:183], v250 offset:39936
ds_read_b64_tr_b16 a[24:25], v246 offset:768
v_mfma_f32_16x16x32_bf16 v[76:79], a[4:7], v[164:167], v[76:79]
ds_read_b64_tr_b16 a[26:27], v246 offset:2816
ds_read_b64_tr_b16 a[28:29], v247 offset:768
v_mfma_f32_16x16x32_bf16 v[140:143], a[4:7], v[168:171], v[140:143]
v_exp_f32 v188, v188
v_mfma_f32_16x16x32_bf16 v[20:23], a[8:11], v[160:163], v[20:23]
v_cvt_pk_bf16_f32 v185, v186, v187
ds_read_b64_tr_b16 a[30:31], v247 offset:2816
v_mfma_f32_16x16x32_bf16 v[84:87], a[8:11], v[164:167], v[84:87]
s_waitcnt vmcnt(5)
buffer_load_dwordx4 v249, s[8:11], s45 offen offset:1024 nt lds
v_mfma_f32_16x16x32_bf16 v[148:151], a[8:11], v[168:171], v[148:151]
v_exp_f32 v189, v189
v_mfma_f32_16x16x32_bf16 v[28:31], a[12:15], v[160:163], v[28:31]
v_add_u32 v246, s33, v246
ds_read_b64_tr_b16 a[32:33], v246 offset:0
v_mfma_f32_16x16x32_bf16 v[92:95], a[12:15], v[164:167], v[92:95]
ds_read_b64_tr_b16 a[34:35], v246 offset:2048
v_mfma_f32_16x16x32_bf16 v[156:159], a[12:15], v[168:171], v[156:159]
s_waitcnt lgkmcnt(3)
v_mfma_f32_16x16x32_bf16 v[36:39], a[16:19], v[160:163], v[36:39]
v_exp_f32 v190, v190
v_mfma_f32_16x16x32_bf16 v[100:103], a[16:19], v[164:167], v[100:103]
v_cvt_pk_bf16_f32 v188, v188, v189
v_mfma_f32_16x16x32_bf16 a[144:147], a[16:19], v[168:171], a[144:147]
v_add_u32 v247, s33, v247
ds_read_b64_tr_b16 a[36:37], v247 offset:0
v_mfma_f32_16x16x32_bf16 v[44:47], a[20:23], v[160:163], v[44:47]
ds_read_b64_tr_b16 a[38:39], v247 offset:2048
ds_read_b64_tr_b16 a[40:41], v246 offset:256
v_mfma_f32_16x16x32_bf16 v[108:111], a[20:23], v[164:167], v[108:111]
v_exp_f32 v191, v191
v_mfma_f32_16x16x32_bf16 a[148:151], a[20:23], v[168:171], a[148:151]
v_cvt_pk_bf16_f32 v189, v190, v191
ds_read_b64_tr_b16 a[42:43], v246 offset:2304
v_mfma_f32_16x16x32_bf16 v[52:55], a[24:27], v[160:163], v[52:55]
v_exp_f32 v192, v192
v_mfma_f32_16x16x32_bf16 v[116:119], a[24:27], v[164:167], v[116:119]
s_waitcnt vmcnt(5)
buffer_load_dwordx4 v248, s[8:11], s45 offen offset:2048 nt lds
v_mfma_f32_16x16x32_bf16 a[152:155], a[24:27], v[168:171], a[152:155]
ds_read_b64_tr_b16 a[44:45], v247 offset:256
s_waitcnt lgkmcnt(5)
v_mfma_f32_16x16x32_bf16 v[60:63], a[28:31], v[160:163], v[60:63]
ds_read_b64_tr_b16 a[46:47], v247 offset:2304
ds_read_b64_tr_b16 a[48:49], v246 offset:512
v_mfma_f32_16x16x32_bf16 v[124:127], a[28:31], v[164:167], v[124:127]
v_exp_f32 v193, v193
v_mfma_f32_16x16x32_bf16 a[156:159], a[28:31], v[168:171], a[156:159]
v_exp_f32 v194, v194
v_mfma_f32_16x16x32_bf16 v[4:7], a[32:35], v[172:175], v[4:7]
ds_read_b64_tr_b16 a[50:51], v246 offset:2560
v_cvt_pk_bf16_f32 v186, v192, v193
v_mfma_f32_16x16x32_bf16 v[68:71], a[32:35], v[176:179], v[68:71]
ds_read_b64_tr_b16 a[52:53], v247 offset:512
ds_read_b64_tr_b16 a[54:55], v247 offset:2560
v_mfma_f32_16x16x32_bf16 v[132:135], a[32:35], v[180:183], v[132:135]
ds_read_b64_tr_b16 a[56:57], v246 offset:768
s_waitcnt lgkmcnt(7)
v_mfma_f32_16x16x32_bf16 v[12:15], a[36:39], v[172:175], v[12:15]
v_exp_f32 v195, v195
v_mfma_f32_16x16x32_bf16 v[76:79], a[36:39], v[176:179], v[76:79]
v_exp_f32 v196, v196
v_mfma_f32_16x16x32_bf16 v[140:143], a[36:39], v[180:183], v[140:143]
ds_read_b64_tr_b16 a[58:59], v246 offset:2816
v_cvt_pk_bf16_f32 v187, v194, v195
v_mfma_f32_16x16x32_bf16 v[20:23], a[40:43], v[172:175], v[20:23]
s_waitcnt vmcnt(5)
buffer_load_dwordx4 v249, s[8:11], s45 offen offset:3072 nt lds
v_mfma_f32_16x16x32_bf16 v[84:87], a[40:43], v[176:179], v[84:87]
ds_read_b64_tr_b16 a[60:61], v247 offset:768
ds_read_b64_tr_b16 a[62:63], v247 offset:2816
v_mfma_f32_16x16x32_bf16 v[148:151], a[40:43], v[180:183], v[148:151]
s_waitcnt lgkmcnt(4)
v_mfma_f32_16x16x32_bf16 v[28:31], a[44:47], v[172:175], v[28:31]
v_exp_f32 v197, v197
v_mfma_f32_16x16x32_bf16 v[92:95], a[44:47], v[176:179], v[92:95]
v_add_u32 v251, 0x8000, v251
ds_write_b128 v251, v[184:187] offset:38912
v_mfma_f32_16x16x32_bf16 v[156:159], a[44:47], v[180:183], v[156:159]
v_exp_f32 v198, v198
v_mfma_f32_16x16x32_bf16 v[36:39], a[48:51], v[172:175], v[36:39]
v_cvt_pk_bf16_f32 v190, v196, v197
v_mfma_f32_16x16x32_bf16 v[100:103], a[48:51], v[176:179], v[100:103]
v_exp_f32 v199, v199
v_mfma_f32_16x16x32_bf16 a[144:147], a[48:51], v[180:183], a[144:147]
v_cvt_pk_bf16_f32 v191, v198, v199
ds_write_b128 v251, v[188:191] offset:39936
v_mfma_f32_16x16x32_bf16 v[44:47], a[52:55], v[172:175], v[44:47]
v_mfma_f32_16x16x32_bf16 v[108:111], a[52:55], v[176:179], v[108:111]
s_mov_b32 s45, 462848
s_add_u32 m0, s29, 102400
v_mfma_f32_16x16x32_bf16 a[148:151], a[52:55], v[180:183], a[148:151]
s_waitcnt vmcnt(5)
buffer_load_dwordx4 v248, s[8:11], s45 offen offset:0 nt lds
s_waitcnt lgkmcnt(1)
v_mfma_f32_16x16x32_bf16 v[52:55], a[56:59], v[172:175], v[52:55]
v_mfma_f32_16x16x32_bf16 v[116:119], a[56:59], v[176:179], v[116:119]
v_mfma_f32_16x16x32_bf16 a[152:155], a[56:59], v[180:183], a[152:155]
v_mfma_f32_16x16x32_bf16 v[60:63], a[60:63], v[172:175], v[60:63]
v_mfma_f32_16x16x32_bf16 v[124:127], a[60:63], v[176:179], v[124:127]
v_mfma_f32_16x16x32_bf16 a[156:159], a[60:63], v[180:183], a[156:159]
v_mfma_f32_16x16x32_bf16 a[236:239], a[244:247], v[184:187], a[236:239]
v_mfma_f32_16x16x32_bf16 a[240:243], a[244:247], v[188:191], a[240:243]
v_mfma_f32_16x16x32_bf16 a[160:163], a[0:3], v[184:187], a[160:163]
v_mfma_f32_16x16x32_bf16 a[192:195], a[0:3], v[188:191], a[192:195]
s_waitcnt lgkmcnt(0)
s_barrier
v_add_u32 v244, 0xfffe8000, v244
ds_read_b128 a[0:3], v244 offset:0
v_mfma_f32_16x16x32_bf16 a[164:167], a[4:7], v[184:187], a[164:167]
v_add_u32 v250, 0x8000, v250
ds_read_b128 v[192:195], v250 offset:38912
s_waitcnt vmcnt(5)
buffer_load_dwordx4 v249, s[8:11], s45 offen offset:1024 nt lds
v_mfma_f32_16x16x32_bf16 a[196:199], a[4:7], v[188:191], a[196:199]
ds_read_b128 v[196:199], v250 offset:39936
ds_read_b128 a[4:7], v244 offset:256
v_mfma_f32_16x16x32_bf16 a[168:171], a[8:11], v[184:187], a[168:171]
v_mfma_f32_16x16x32_bf16 a[200:203], a[8:11], v[188:191], a[200:203]
ds_read_b128 a[8:11], v244 offset:512
v_mfma_f32_16x16x32_bf16 a[172:175], a[12:15], v[184:187], a[172:175]
v_mfma_f32_16x16x32_bf16 a[204:207], a[12:15], v[188:191], a[204:207]
ds_read_b128 a[12:15], v244 offset:768
v_mfma_f32_16x16x32_bf16 a[176:179], a[16:19], v[184:187], a[176:179]
v_mfma_f32_16x16x32_bf16 a[208:211], a[16:19], v[188:191], a[208:211]
v_add_u32 v245, 0xfffe8000, v245
ds_read_b128 a[16:19], v245 offset:0
v_mfma_f32_16x16x32_bf16 a[180:183], a[20:23], v[184:187], a[180:183]
v_mfma_f32_16x16x32_bf16 a[212:215], a[20:23], v[188:191], a[212:215]
ds_read_b128 a[20:23], v245 offset:256
v_mfma_f32_16x16x32_bf16 a[184:187], a[24:27], v[184:187], a[184:187]
v_mfma_f32_16x16x32_bf16 a[216:219], a[24:27], v[188:191], a[216:219]
s_waitcnt vmcnt(5)
buffer_load_dwordx4 v248, s[8:11], s45 offen offset:2048 nt lds
v_mfma_f32_16x16x32_bf16 a[188:191], a[28:31], v[184:187], a[188:191]
ds_read_b128 a[24:27], v245 offset:512
v_mfma_f32_16x16x32_bf16 a[220:223], a[28:31], v[188:191], a[220:223]
ds_read_b128 a[28:31], v245 offset:768
s_waitcnt lgkmcnt(8)
v_mfma_f32_16x16x32_bf16 a[160:163], a[32:35], v[192:195], a[160:163]
s_waitcnt lgkmcnt(7)
v_mfma_f32_16x16x32_bf16 a[192:195], a[32:35], v[196:199], a[192:195]
ds_read_b128 a[32:35], v244 offset:2048
v_mfma_f32_16x16x32_bf16 a[164:167], a[36:39], v[192:195], a[164:167]
v_mfma_f32_16x16x32_bf16 a[196:199], a[36:39], v[196:199], a[196:199]
ds_read_b128 a[36:39], v244 offset:2304
v_mfma_f32_16x16x32_bf16 a[168:171], a[40:43], v[192:195], a[168:171]
v_mfma_f32_16x16x32_bf16 a[200:203], a[40:43], v[196:199], a[200:203]
v_mfma_f32_16x16x32_bf16 a[172:175], a[44:47], v[192:195], a[172:175]
v_mfma_f32_16x16x32_bf16 a[204:207], a[44:47], v[196:199], a[204:207]
v_mfma_f32_16x16x32_bf16 a[176:179], a[48:51], v[192:195], a[176:179]
s_waitcnt vmcnt(5)
buffer_load_dwordx4 v249, s[8:11], s45 offen offset:3072 nt lds
v_mfma_f32_16x16x32_bf16 a[208:211], a[48:51], v[196:199], a[208:211]
v_mfma_f32_16x16x32_bf16 a[180:183], a[52:55], v[192:195], a[180:183]
v_mfma_f32_16x16x32_bf16 a[212:215], a[52:55], v[196:199], a[212:215]
v_mfma_f32_16x16x32_bf16 a[184:187], a[56:59], v[192:195], a[184:187]
v_mfma_f32_16x16x32_bf16 a[216:219], a[56:59], v[196:199], a[216:219]
v_mfma_f32_16x16x32_bf16 a[188:191], a[60:63], v[192:195], a[188:191]
v_mfma_f32_16x16x32_bf16 a[220:223], a[60:63], v[196:199], a[220:223]
ds_read_b128 a[40:43], v244 offset:2560
v_mfma_f32_16x16x32_bf16 v[160:163], a[0:3], v[0:3], v[200:203]
ds_read_b128 a[44:47], v244 offset:2816
s_waitcnt lgkmcnt(10)
v_mfma_f32_16x16x32_bf16 v[160:163], a[4:7], v[8:11], v[160:163]
ds_read_b128 a[48:51], v245 offset:2048
s_waitcnt lgkmcnt(10)
v_mfma_f32_16x16x32_bf16 v[160:163], a[8:11], v[16:19], v[160:163]
s_mov_b32 s46, 458752
s_add_u32 m0, s29, 131072
s_waitcnt lgkmcnt(9)
v_mfma_f32_16x16x32_bf16 v[160:163], a[12:15], v[24:27], v[160:163]
s_waitcnt vmcnt(5)
buffer_load_dwordx4 v248, s[12:15], s46 offen offset:0 nt lds
s_waitcnt lgkmcnt(8)
v_mfma_f32_16x16x32_bf16 v[160:163], a[16:19], a[64:67], v[160:163]
ds_read_b128 a[52:55], v245 offset:2304
s_waitcnt lgkmcnt(8)
v_mfma_f32_16x16x32_bf16 v[160:163], a[20:23], a[84:87], v[160:163]
ds_read_b128 a[56:59], v245 offset:2560
s_waitcnt lgkmcnt(8)
v_mfma_f32_16x16x32_bf16 v[160:163], a[24:27], a[104:107], v[160:163]
ds_read_b128 a[60:63], v245 offset:2816
s_waitcnt lgkmcnt(8)
v_mfma_f32_16x16x32_bf16 v[160:163], a[28:31], a[124:127], v[160:163]
v_mfma_f32_16x16x32_bf16 v[164:167], a[0:3], v[32:35], v[204:207]
v_mfma_f32_16x16x32_bf16 v[164:167], a[4:7], v[40:43], v[164:167]
v_mfma_f32_16x16x32_bf16 v[164:167], a[8:11], v[48:51], v[164:167]
v_mfma_f32_16x16x32_bf16 v[164:167], a[12:15], v[56:59], v[164:167]
v_mfma_f32_16x16x32_bf16 v[164:167], a[16:19], a[68:71], v[164:167]
v_mfma_f32_16x16x32_bf16 v[164:167], a[20:23], a[88:91], v[164:167]
v_mfma_f32_16x16x32_bf16 v[164:167], a[24:27], a[108:111], v[164:167]
v_mfma_f32_16x16x32_bf16 v[164:167], a[28:31], a[128:131], v[164:167]
s_waitcnt vmcnt(5)
buffer_load_dwordx4 v249, s[12:15], s46 offen offset:1024 nt lds
v_mfma_f32_16x16x32_bf16 v[168:171], a[0:3], v[64:67], v[208:211]
v_mfma_f32_16x16x32_bf16 v[168:171], a[4:7], v[72:75], v[168:171]
v_mfma_f32_16x16x32_bf16 v[168:171], a[8:11], v[80:83], v[168:171]
v_mfma_f32_16x16x32_bf16 v[168:171], a[12:15], v[88:91], v[168:171]
v_mfma_f32_16x16x32_bf16 v[168:171], a[16:19], a[72:75], v[168:171]
v_mfma_f32_16x16x32_bf16 v[168:171], a[20:23], a[92:95], v[168:171]
v_mfma_f32_16x16x32_bf16 v[168:171], a[24:27], a[112:115], v[168:171]
v_mfma_f32_16x16x32_bf16 v[168:171], a[28:31], a[132:135], v[168:171]
s_waitcnt lgkmcnt(0)
v_mfma_f32_16x16x32_bf16 v[172:175], a[32:35], v[0:3], v[200:203]
v_mfma_f32_16x16x32_bf16 v[172:175], a[36:39], v[8:11], v[172:175]
v_exp_f32 v160, v160
v_mfma_f32_16x16x32_bf16 v[172:175], a[40:43], v[16:19], v[172:175]
s_waitcnt vmcnt(5)
buffer_load_dwordx4 v248, s[12:15], s46 offen offset:2048 nt lds
v_mfma_f32_16x16x32_bf16 v[172:175], a[44:47], v[24:27], v[172:175]
v_exp_f32 v161, v161
v_mfma_f32_16x16x32_bf16 v[172:175], a[48:51], a[64:67], v[172:175]
v_exp_f32 v162, v162
v_mfma_f32_16x16x32_bf16 v[172:175], a[52:55], a[84:87], v[172:175]
v_cvt_pk_bf16_f32 v160, v160, v161
v_mfma_f32_16x16x32_bf16 v[172:175], a[56:59], a[104:107], v[172:175]
v_exp_f32 v163, v163
v_mfma_f32_16x16x32_bf16 v[172:175], a[60:63], a[124:127], v[172:175]
v_exp_f32 v164, v164
v_mfma_f32_16x16x32_bf16 v[176:179], a[32:35], v[32:35], v[204:207]
v_cvt_pk_bf16_f32 v161, v162, v163
v_mfma_f32_16x16x32_bf16 v[176:179], a[36:39], v[40:43], v[176:179]
v_exp_f32 v165, v165
v_mfma_f32_16x16x32_bf16 v[176:179], a[40:43], v[48:51], v[176:179]
v_exp_f32 v166, v166
v_mfma_f32_16x16x32_bf16 v[176:179], a[44:47], v[56:59], v[176:179]
v_cvt_pk_bf16_f32 v164, v164, v165
v_mfma_f32_16x16x32_bf16 v[176:179], a[48:51], a[68:71], v[176:179]
v_exp_f32 v167, v167
v_mfma_f32_16x16x32_bf16 v[176:179], a[52:55], a[88:91], v[176:179]
s_waitcnt vmcnt(5)
buffer_load_dwordx4 v249, s[12:15], s46 offen offset:3072 nt lds
v_mfma_f32_16x16x32_bf16 v[176:179], a[56:59], a[108:111], v[176:179]
v_exp_f32 v168, v168
v_mfma_f32_16x16x32_bf16 v[176:179], a[60:63], a[128:131], v[176:179]
v_cvt_pk_bf16_f32 v165, v166, v167
v_mfma_f32_16x16x32_bf16 v[180:183], a[32:35], v[64:67], v[208:211]
v_exp_f32 v169, v169
v_mfma_f32_16x16x32_bf16 v[180:183], a[36:39], v[72:75], v[180:183]
v_exp_f32 v170, v170
v_mfma_f32_16x16x32_bf16 v[180:183], a[40:43], v[80:83], v[180:183]
v_cvt_pk_bf16_f32 v168, v168, v169
v_mfma_f32_16x16x32_bf16 v[180:183], a[44:47], v[88:91], v[180:183]
v_exp_f32 v171, v171
v_mfma_f32_16x16x32_bf16 v[180:183], a[48:51], a[72:75], v[180:183]
v_cvt_pk_bf16_f32 v169, v170, v171
v_mfma_f32_16x16x32_bf16 v[180:183], a[52:55], a[92:95], v[180:183]
v_mfma_f32_16x16x32_bf16 v[180:183], a[56:59], a[112:115], v[180:183]
v_mfma_f32_16x16x32_bf16 v[180:183], a[60:63], a[132:135], v[180:183]
s_mov_b32 s46, 462848
s_add_u32 m0, s29, 135168
v_mfma_f32_16x16x32_bf16 v[184:187], a[0:3], v[96:99], v[212:215]
s_waitcnt vmcnt(5)
buffer_load_dwordx4 v248, s[12:15], s46 offen offset:0 nt lds
v_mfma_f32_16x16x32_bf16 v[184:187], a[4:7], v[104:107], v[184:187]
v_exp_f32 v172, v172
v_exp_f32 v173, v173
v_exp_f32 v174, v174
v_cvt_pk_bf16_f32 v162, v172, v173
v_mfma_f32_16x16x32_bf16 v[184:187], a[8:11], v[112:115], v[184:187]
v_exp_f32 v175, v175
v_mfma_f32_16x16x32_bf16 v[184:187], a[12:15], v[120:123], v[184:187]
v_exp_f32 v176, v176
v_mfma_f32_16x16x32_bf16 v[184:187], a[16:19], a[76:79], v[184:187]
v_cvt_pk_bf16_f32 v163, v174, v175
v_mfma_f32_16x16x32_bf16 v[184:187], a[20:23], a[96:99], v[184:187]
v_exp_f32 v177, v177
v_mfma_f32_16x16x32_bf16 v[184:187], a[24:27], a[116:119], v[184:187]
v_add_u32 v251, 0xfffe8000, v251
ds_write_b128 v251, v[160:163] offset:5120
v_mfma_f32_16x16x32_bf16 v[184:187], a[28:31], a[136:139], v[184:187]
v_exp_f32 v178, v178
v_mfma_f32_16x16x32_bf16 v[188:191], a[0:3], v[128:131], v[216:219]
v_cvt_pk_bf16_f32 v166, v176, v177
v_mfma_f32_16x16x32_bf16 v[188:191], a[4:7], v[136:139], v[188:191]
v_exp_f32 v179, v179
v_mfma_f32_16x16x32_bf16 v[188:191], a[8:11], v[144:147], v[188:191]
v_exp_f32 v180, v180
v_mfma_f32_16x16x32_bf16 v[188:191], a[12:15], v[152:155], v[188:191]
s_waitcnt vmcnt(5)
buffer_load_dwordx4 v249, s[12:15], s46 offen offset:1024 nt lds
v_mfma_f32_16x16x32_bf16 v[188:191], a[16:19], a[80:83], v[188:191]
v_cvt_pk_bf16_f32 v167, v178, v179
v_mfma_f32_16x16x32_bf16 v[188:191], a[20:23], a[100:103], v[188:191]
v_exp_f32 v181, v181
v_mfma_f32_16x16x32_bf16 v[188:191], a[24:27], a[120:123], v[188:191]
ds_write_b128 v251, v[164:167] offset:6144
v_mfma_f32_16x16x32_bf16 v[188:191], a[28:31], a[140:143], v[188:191]
v_exp_f32 v182, v182
v_mfma_f32_16x16x32_bf16 v[192:195], a[32:35], v[96:99], v[212:215]
v_cvt_pk_bf16_f32 v170, v180, v181
v_mfma_f32_16x16x32_bf16 v[192:195], a[36:39], v[104:107], v[192:195]
v_exp_f32 v183, v183
v_mfma_f32_16x16x32_bf16 v[192:195], a[40:43], v[112:115], v[192:195]
v_cvt_pk_bf16_f32 v171, v182, v183
ds_write_b128 v251, v[168:171] offset:7168
v_mfma_f32_16x16x32_bf16 v[192:195], a[44:47], v[120:123], v[192:195]
v_mfma_f32_16x16x32_bf16 v[192:195], a[48:51], a[76:79], v[192:195]
s_waitcnt lgkmcnt(0)
s_barrier
v_add_u32 v246, s34, v246
ds_read_b64_tr_b16 a[0:1], v246 offset:0
v_mfma_f32_16x16x32_bf16 v[192:195], a[52:55], a[96:99], v[192:195]
ds_read_b64_tr_b16 a[2:3], v246 offset:2048
v_mfma_f32_16x16x32_bf16 v[192:195], a[56:59], a[116:119], v[192:195]
s_waitcnt vmcnt(5)
buffer_load_dwordx4 v248, s[12:15], s46 offen offset:2048 nt lds
v_mfma_f32_16x16x32_bf16 v[192:195], a[60:63], a[136:139], v[192:195]
v_add_u32 v247, s34, v247
ds_read_b64_tr_b16 a[4:5], v247 offset:0
v_mfma_f32_16x16x32_bf16 v[196:199], a[32:35], v[128:131], v[216:219]
ds_read_b64_tr_b16 a[6:7], v247 offset:2048
ds_read_b64_tr_b16 a[8:9], v246 offset:256
v_mfma_f32_16x16x32_bf16 v[196:199], a[36:39], v[136:139], v[196:199]
ds_read_b64_tr_b16 a[10:11], v246 offset:2304
ds_read_b64_tr_b16 a[12:13], v247 offset:256
v_mfma_f32_16x16x32_bf16 v[196:199], a[40:43], v[144:147], v[196:199]
ds_read_b64_tr_b16 a[14:15], v247 offset:2304
ds_read_b64_tr_b16 a[16:17], v246 offset:512
v_mfma_f32_16x16x32_bf16 v[196:199], a[44:47], v[152:155], v[196:199]
ds_read_b64_tr_b16 a[18:19], v246 offset:2560
ds_read_b64_tr_b16 a[20:21], v247 offset:512
v_mfma_f32_16x16x32_bf16 v[196:199], a[48:51], a[80:83], v[196:199]
ds_read_b64_tr_b16 a[22:23], v247 offset:2560
v_mfma_f32_16x16x32_bf16 v[196:199], a[52:55], a[100:103], v[196:199]
v_mfma_f32_16x16x32_bf16 v[196:199], a[56:59], a[120:123], v[196:199]
v_mfma_f32_16x16x32_bf16 v[196:199], a[60:63], a[140:143], v[196:199]
v_exp_f32 v184, v184
v_mfma_f32_16x16x32_bf16 a[224:227], a[244:247], v[160:163], a[224:227]
ds_read_b64_tr_b16 a[24:25], v246 offset:768
v_mfma_f32_16x16x32_bf16 a[228:231], a[244:247], v[164:167], a[228:231]
s_waitcnt vmcnt(5)
buffer_load_dwordx4 v249, s[12:15], s46 offen offset:3072 nt lds
v_mfma_f32_16x16x32_bf16 a[232:235], a[244:247], v[168:171], a[232:235]
v_add_u32 v250, 0xfffe8000, v250
ds_read_b128 v[172:175], v250 offset:5120
s_waitcnt lgkmcnt(6)
v_mfma_f32_16x16x32_bf16 v[4:7], a[0:3], v[160:163], v[4:7]
v_exp_f32 v185, v185
v_mfma_f32_16x16x32_bf16 v[68:71], a[0:3], v[164:167], v[68:71]
ds_read_b128 v[176:179], v250 offset:6144
ds_read_b64_tr_b16 a[26:27], v246 offset:2816
v_mfma_f32_16x16x32_bf16 v[132:135], a[0:3], v[168:171], v[132:135]
v_exp_f32 v186, v186
v_mfma_f32_16x16x32_bf16 v[12:15], a[4:7], v[160:163], v[12:15]
ds_read_b128 v[180:183], v250 offset:7168
v_cvt_pk_bf16_f32 v184, v184, v185
v_mfma_f32_16x16x32_bf16 v[76:79], a[4:7], v[164:167], v[76:79]
v_exp_f32 v187, v187
v_mfma_f32_16x16x32_bf16 v[140:143], a[4:7], v[168:171], v[140:143]
v_exp_f32 v188, v188
v_mfma_f32_16x16x32_bf16 v[20:23], a[8:11], v[160:163], v[20:23]
v_cvt_pk_bf16_f32 v185, v186, v187
ds_read_b64_tr_b16 a[28:29], v247 offset:768
v_mfma_f32_16x16x32_bf16 v[84:87], a[8:11], v[164:167], v[84:87]
ds_read_b64_tr_b16 a[30:31], v247 offset:2816
v_mfma_f32_16x16x32_bf16 v[148:151], a[8:11], v[168:171], v[148:151]
s_mov_b32 s45, 491520
s_add_u32 m0, s29, 0
v_mfma_f32_16x16x32_bf16 v[28:31], a[12:15], v[160:163], v[28:31]
s_waitcnt vmcnt(5)
buffer_load_dwordx4 v248, s[8:11], s45 offen offset:0 nt lds
v_mfma_f32_16x16x32_bf16 v[92:95], a[12:15], v[164:167], v[92:95]
v_exp_f32 v189, v189
v_mfma_f32_16x16x32_bf16 v[156:159], a[12:15], v[168:171], v[156:159]
s_waitcnt lgkmcnt(2)
v_mfma_f32_16x16x32_bf16 v[36:39], a[16:19], v[160:163], v[36:39]
v_add_u32 v246, s33, v246
ds_read_b64_tr_b16 a[32:33], v246 offset:0
v_mfma_f32_16x16x32_bf16 v[100:103], a[16:19], v[164:167], v[100:103]
ds_read_b64_tr_b16 a[34:35], v246 offset:2048
v_mfma_f32_16x16x32_bf16 a[144:147], a[16:19], v[168:171], a[144:147]
v_exp_f32 v190, v190
v_mfma_f32_16x16x32_bf16 v[44:47], a[20:23], v[160:163], v[44:47]
v_cvt_pk_bf16_f32 v188, v188, v189
v_mfma_f32_16x16x32_bf16 v[108:111], a[20:23], v[164:167], v[108:111]
v_add_u32 v247, s33, v247
ds_read_b64_tr_b16 a[36:37], v247 offset:0
v_mfma_f32_16x16x32_bf16 a[148:151], a[20:23], v[168:171], a[148:151]
ds_read_b64_tr_b16 a[38:39], v247 offset:2048
ds_read_b64_tr_b16 a[40:41], v246 offset:256
v_mfma_f32_16x16x32_bf16 v[52:55], a[24:27], v[160:163], v[52:55]
v_exp_f32 v191, v191
v_mfma_f32_16x16x32_bf16 v[116:119], a[24:27], v[164:167], v[116:119]
v_cvt_pk_bf16_f32 v189, v190, v191
ds_read_b64_tr_b16 a[42:43], v246 offset:2304
v_mfma_f32_16x16x32_bf16 a[152:155], a[24:27], v[168:171], a[152:155]
ds_read_b64_tr_b16 a[44:45], v247 offset:256
s_waitcnt lgkmcnt(5)
v_mfma_f32_16x16x32_bf16 v[60:63], a[28:31], v[160:163], v[60:63]
s_waitcnt vmcnt(5)
buffer_load_dwordx4 v249, s[8:11], s45 offen offset:1024 nt lds
v_mfma_f32_16x16x32_bf16 v[124:127], a[28:31], v[164:167], v[124:127]
v_exp_f32 v192, v192
v_mfma_f32_16x16x32_bf16 a[156:159], a[28:31], v[168:171], a[156:159]
ds_read_b64_tr_b16 a[46:47], v247 offset:2304
ds_read_b64_tr_b16 a[48:49], v246 offset:512
v_mfma_f32_16x16x32_bf16 v[4:7], a[32:35], v[172:175], v[4:7]
v_exp_f32 v193, v193
v_mfma_f32_16x16x32_bf16 v[68:71], a[32:35], v[176:179], v[68:71]
v_exp_f32 v194, v194
v_mfma_f32_16x16x32_bf16 v[132:135], a[32:35], v[180:183], v[132:135]
ds_read_b64_tr_b16 a[50:51], v246 offset:2560
s_waitcnt lgkmcnt(4)
v_mfma_f32_16x16x32_bf16 v[12:15], a[36:39], v[172:175], v[12:15]
v_cvt_pk_bf16_f32 v186, v192, v193
ds_read_b64_tr_b16 a[52:53], v247 offset:512
v_mfma_f32_16x16x32_bf16 v[76:79], a[36:39], v[176:179], v[76:79]
ds_read_b64_tr_b16 a[54:55], v247 offset:2560
ds_read_b64_tr_b16 a[56:57], v246 offset:768
v_mfma_f32_16x16x32_bf16 v[140:143], a[36:39], v[180:183], v[140:143]
v_exp_f32 v195, v195
v_mfma_f32_16x16x32_bf16 v[20:23], a[40:43], v[172:175], v[20:23]
v_exp_f32 v196, v196
v_mfma_f32_16x16x32_bf16 v[84:87], a[40:43], v[176:179], v[84:87]
ds_read_b64_tr_b16 a[58:59], v246 offset:2816
v_cvt_pk_bf16_f32 v187, v194, v195
v_mfma_f32_16x16x32_bf16 v[148:151], a[40:43], v[180:183], v[148:151]
s_waitcnt vmcnt(5)
buffer_load_dwordx4 v248, s[8:11], s45 offen offset:2048 nt lds
s_waitcnt lgkmcnt(5)
v_mfma_f32_16x16x32_bf16 v[28:31], a[44:47], v[172:175], v[28:31]
ds_read_b64_tr_b16 a[60:61], v247 offset:768
ds_read_b64_tr_b16 a[62:63], v247 offset:2816
v_mfma_f32_16x16x32_bf16 v[92:95], a[44:47], v[176:179], v[92:95]
v_exp_f32 v197, v197
v_mfma_f32_16x16x32_bf16 v[156:159], a[44:47], v[180:183], v[156:159]
ds_write_b128 v251, v[184:187] offset:38912
s_waitcnt lgkmcnt(4)
v_mfma_f32_16x16x32_bf16 v[36:39], a[48:51], v[172:175], v[36:39]
v_exp_f32 v198, v198
v_mfma_f32_16x16x32_bf16 v[100:103], a[48:51], v[176:179], v[100:103]
v_cvt_pk_bf16_f32 v190, v196, v197
v_mfma_f32_16x16x32_bf16 a[144:147], a[48:51], v[180:183], a[144:147]
v_exp_f32 v199, v199
v_mfma_f32_16x16x32_bf16 v[44:47], a[52:55], v[172:175], v[44:47]
v_cvt_pk_bf16_f32 v191, v198, v199
ds_write_b128 v251, v[188:191] offset:39936
v_mfma_f32_16x16x32_bf16 v[108:111], a[52:55], v[176:179], v[108:111]
v_mfma_f32_16x16x32_bf16 a[148:151], a[52:55], v[180:183], a[148:151]
s_waitcnt lgkmcnt(2)
v_mfma_f32_16x16x32_bf16 v[52:55], a[56:59], v[172:175], v[52:55]
v_mfma_f32_16x16x32_bf16 v[116:119], a[56:59], v[176:179], v[116:119]
s_waitcnt vmcnt(5)
buffer_load_dwordx4 v249, s[8:11], s45 offen offset:3072 nt lds
v_mfma_f32_16x16x32_bf16 a[152:155], a[56:59], v[180:183], a[152:155]
v_mfma_f32_16x16x32_bf16 v[60:63], a[60:63], v[172:175], v[60:63]
v_mfma_f32_16x16x32_bf16 v[124:127], a[60:63], v[176:179], v[124:127]
v_mfma_f32_16x16x32_bf16 a[156:159], a[60:63], v[180:183], a[156:159]
v_mfma_f32_16x16x32_bf16 a[236:239], a[244:247], v[184:187], a[236:239]
v_mfma_f32_16x16x32_bf16 a[240:243], a[244:247], v[188:191], a[240:243]
v_mfma_f32_16x16x32_bf16 a[160:163], a[0:3], v[184:187], a[160:163]
v_mfma_f32_16x16x32_bf16 a[192:195], a[0:3], v[188:191], a[192:195]
s_waitcnt lgkmcnt(0)
s_barrier
v_add_u32 v244, 0x10000, v244
ds_read_b128 a[0:3], v244 offset:0
v_mfma_f32_16x16x32_bf16 a[164:167], a[4:7], v[184:187], a[164:167]
ds_read_b128 v[192:195], v250 offset:38912
v_mfma_f32_16x16x32_bf16 a[196:199], a[4:7], v[188:191], a[196:199]
ds_read_b128 v[196:199], v250 offset:39936
s_mov_b32 s45, 495616
s_add_u32 m0, s29, 4096
v_mfma_f32_16x16x32_bf16 a[168:171], a[8:11], v[184:187], a[168:171]
s_waitcnt vmcnt(5)
buffer_load_dwordx4 v248, s[8:11], s45 offen offset:0 nt lds
v_mfma_f32_16x16x32_bf16 a[200:203], a[8:11], v[188:191], a[200:203]
ds_read_b128 a[4:7], v244 offset:256
ds_read_b128 a[8:11], v244 offset:512
v_mfma_f32_16x16x32_bf16 a[172:175], a[12:15], v[184:187], a[172:175]
v_mfma_f32_16x16x32_bf16 a[204:207], a[12:15], v[188:191], a[204:207]
ds_read_b128 a[12:15], v244 offset:768
v_mfma_f32_16x16x32_bf16 a[176:179], a[16:19], v[184:187], a[176:179]
v_mfma_f32_16x16x32_bf16 a[208:211], a[16:19], v[188:191], a[208:211]
v_add_u32 v245, 0x10000, v245
ds_read_b128 a[16:19], v245 offset:0
v_mfma_f32_16x16x32_bf16 a[180:183], a[20:23], v[184:187], a[180:183]
v_mfma_f32_16x16x32_bf16 a[212:215], a[20:23], v[188:191], a[212:215]
ds_read_b128 a[20:23], v245 offset:256
v_mfma_f32_16x16x32_bf16 a[184:187], a[24:27], v[184:187], a[184:187]
v_mfma_f32_16x16x32_bf16 a[216:219], a[24:27], v[188:191], a[216:219]
ds_read_b128 a[24:27], v245 offset:512
v_mfma_f32_16x16x32_bf16 a[188:191], a[28:31], v[184:187], a[188:191]
v_mfma_f32_16x16x32_bf16 a[220:223], a[28:31], v[188:191], a[220:223]
s_waitcnt vmcnt(5)
buffer_load_dwordx4 v249, s[8:11], s45 offen offset:1024 nt lds
s_waitcnt lgkmcnt(7)
v_mfma_f32_16x16x32_bf16 a[160:163], a[32:35], v[192:195], a[160:163]
ds_read_b128 a[28:31], v245 offset:768
s_waitcnt lgkmcnt(7)
v_mfma_f32_16x16x32_bf16 a[192:195], a[32:35], v[196:199], a[192:195]
ds_read_b128 a[32:35], v244 offset:2048
v_mfma_f32_16x16x32_bf16 a[164:167], a[36:39], v[192:195], a[164:167]
v_mfma_f32_16x16x32_bf16 a[196:199], a[36:39], v[196:199], a[196:199]
ds_read_b128 a[36:39], v244 offset:2304
v_mfma_f32_16x16x32_bf16 a[168:171], a[40:43], v[192:195], a[168:171]
v_mfma_f32_16x16x32_bf16 a[200:203], a[40:43], v[196:199], a[200:203]
v_mfma_f32_16x16x32_bf16 a[172:175], a[44:47], v[192:195], a[172:175]
v_mfma_f32_16x16x32_bf16 a[204:207], a[44:47], v[196:199], a[204:207]
v_mfma_f32_16x16x32_bf16 a[176:179], a[48:51], v[192:195], a[176:179]
v_mfma_f32_16x16x32_bf16 a[208:211], a[48:51], v[196:199], a[208:211]
v_mfma_f32_16x16x32_bf16 a[180:183], a[52:55], v[192:195], a[180:183]
s_waitcnt vmcnt(5)
buffer_load_dwordx4 v248, s[8:11], s45 offen offset:2048 nt lds
v_mfma_f32_16x16x32_bf16 a[212:215], a[52:55], v[196:199], a[212:215]
v_mfma_f32_16x16x32_bf16 a[184:187], a[56:59], v[192:195], a[184:187]
v_mfma_f32_16x16x32_bf16 a[216:219], a[56:59], v[196:199], a[216:219]
v_mfma_f32_16x16x32_bf16 a[188:191], a[60:63], v[192:195], a[188:191]
v_mfma_f32_16x16x32_bf16 a[220:223], a[60:63], v[196:199], a[220:223]
ds_read_b128 a[40:43], v244 offset:2560
v_mfma_f32_16x16x32_bf16 v[160:163], a[0:3], v[0:3], v[200:203]
ds_read_b128 a[44:47], v244 offset:2816
s_waitcnt lgkmcnt(10)
v_mfma_f32_16x16x32_bf16 v[160:163], a[4:7], v[8:11], v[160:163]
ds_read_b128 a[48:51], v245 offset:2048
s_waitcnt lgkmcnt(10)
v_mfma_f32_16x16x32_bf16 v[160:163], a[8:11], v[16:19], v[160:163]
ds_read_b128 a[52:55], v245 offset:2304
s_waitcnt lgkmcnt(10)
v_mfma_f32_16x16x32_bf16 v[160:163], a[12:15], v[24:27], v[160:163]
ds_read_b128 a[56:59], v245 offset:2560
s_waitcnt lgkmcnt(10)
v_mfma_f32_16x16x32_bf16 v[160:163], a[16:19], a[64:67], v[160:163]
s_waitcnt lgkmcnt(9)
v_mfma_f32_16x16x32_bf16 v[160:163], a[20:23], a[84:87], v[160:163]
s_waitcnt vmcnt(5)
buffer_load_dwordx4 v249, s[8:11], s45 offen offset:3072 nt lds
s_waitcnt lgkmcnt(8)
v_mfma_f32_16x16x32_bf16 v[160:163], a[24:27], a[104:107], v[160:163]
ds_read_b128 a[60:63], v245 offset:2816
s_waitcnt lgkmcnt(8)
v_mfma_f32_16x16x32_bf16 v[160:163], a[28:31], a[124:127], v[160:163]
v_mfma_f32_16x16x32_bf16 v[164:167], a[0:3], v[32:35], v[204:207]
v_mfma_f32_16x16x32_bf16 v[164:167], a[4:7], v[40:43], v[164:167]
v_mfma_f32_16x16x32_bf16 v[164:167], a[8:11], v[48:51], v[164:167]
v_mfma_f32_16x16x32_bf16 v[164:167], a[12:15], v[56:59], v[164:167]
v_mfma_f32_16x16x32_bf16 v[164:167], a[16:19], a[68:71], v[164:167]
v_mfma_f32_16x16x32_bf16 v[164:167], a[20:23], a[88:91], v[164:167]
v_mfma_f32_16x16x32_bf16 v[164:167], a[24:27], a[108:111], v[164:167]
v_mfma_f32_16x16x32_bf16 v[164:167], a[28:31], a[128:131], v[164:167]
v_mfma_f32_16x16x32_bf16 v[168:171], a[0:3], v[64:67], v[208:211]
s_mov_b32 s46, 491520
s_add_u32 m0, s29, 32768
v_mfma_f32_16x16x32_bf16 v[168:171], a[4:7], v[72:75], v[168:171]
s_waitcnt vmcnt(5)
buffer_load_dwordx4 v248, s[12:15], s46 offen offset:0 nt lds
v_mfma_f32_16x16x32_bf16 v[168:171], a[8:11], v[80:83], v[168:171]
v_mfma_f32_16x16x32_bf16 v[168:171], a[12:15], v[88:91], v[168:171]
v_mfma_f32_16x16x32_bf16 v[168:171], a[16:19], a[72:75], v[168:171]
v_mfma_f32_16x16x32_bf16 v[168:171], a[20:23], a[92:95], v[168:171]
v_mfma_f32_16x16x32_bf16 v[168:171], a[24:27], a[112:115], v[168:171]
v_mfma_f32_16x16x32_bf16 v[168:171], a[28:31], a[132:135], v[168:171]
s_waitcnt lgkmcnt(0)
v_mfma_f32_16x16x32_bf16 v[172:175], a[32:35], v[0:3], v[200:203]
v_mfma_f32_16x16x32_bf16 v[172:175], a[36:39], v[8:11], v[172:175]
v_exp_f32 v160, v160
v_mfma_f32_16x16x32_bf16 v[172:175], a[40:43], v[16:19], v[172:175]
v_exp_f32 v161, v161
v_mfma_f32_16x16x32_bf16 v[172:175], a[44:47], v[24:27], v[172:175]
v_exp_f32 v162, v162
v_mfma_f32_16x16x32_bf16 v[172:175], a[48:51], a[64:67], v[172:175]
s_waitcnt vmcnt(5)
buffer_load_dwordx4 v249, s[12:15], s46 offen offset:1024 nt lds
v_mfma_f32_16x16x32_bf16 v[172:175], a[52:55], a[84:87], v[172:175]
v_cvt_pk_bf16_f32 v160, v160, v161
v_mfma_f32_16x16x32_bf16 v[172:175], a[56:59], a[104:107], v[172:175]
v_exp_f32 v163, v163
v_mfma_f32_16x16x32_bf16 v[172:175], a[60:63], a[124:127], v[172:175]
v_exp_f32 v164, v164
v_mfma_f32_16x16x32_bf16 v[176:179], a[32:35], v[32:35], v[204:207]
v_cvt_pk_bf16_f32 v161, v162, v163
v_mfma_f32_16x16x32_bf16 v[176:179], a[36:39], v[40:43], v[176:179]
v_exp_f32 v165, v165
v_mfma_f32_16x16x32_bf16 v[176:179], a[40:43], v[48:51], v[176:179]
v_exp_f32 v166, v166
v_mfma_f32_16x16x32_bf16 v[176:179], a[44:47], v[56:59], v[176:179]
v_cvt_pk_bf16_f32 v164, v164, v165
v_mfma_f32_16x16x32_bf16 v[176:179], a[48:51], a[68:71], v[176:179]
v_exp_f32 v167, v167
v_mfma_f32_16x16x32_bf16 v[176:179], a[52:55], a[88:91], v[176:179]
v_exp_f32 v168, v168
v_mfma_f32_16x16x32_bf16 v[176:179], a[56:59], a[108:111], v[176:179]
v_cvt_pk_bf16_f32 v165, v166, v167
v_mfma_f32_16x16x32_bf16 v[176:179], a[60:63], a[128:131], v[176:179]
s_waitcnt vmcnt(5)
buffer_load_dwordx4 v248, s[12:15], s46 offen offset:2048 nt lds
v_mfma_f32_16x16x32_bf16 v[180:183], a[32:35], v[64:67], v[208:211]
v_exp_f32 v169, v169
v_mfma_f32_16x16x32_bf16 v[180:183], a[36:39], v[72:75], v[180:183]
v_exp_f32 v170, v170
v_mfma_f32_16x16x32_bf16 v[180:183], a[40:43], v[80:83], v[180:183]
v_cvt_pk_bf16_f32 v168, v168, v169
v_mfma_f32_16x16x32_bf16 v[180:183], a[44:47], v[88:91], v[180:183]
v_exp_f32 v171, v171
v_mfma_f32_16x16x32_bf16 v[180:183], a[48:51], a[72:75], v[180:183]
v_cvt_pk_bf16_f32 v169, v170, v171
v_mfma_f32_16x16x32_bf16 v[180:183], a[52:55], a[92:95], v[180:183]
v_mfma_f32_16x16x32_bf16 v[180:183], a[56:59], a[112:115], v[180:183]
v_mfma_f32_16x16x32_bf16 v[180:183], a[60:63], a[132:135], v[180:183]
v_mfma_f32_16x16x32_bf16 v[184:187], a[0:3], v[96:99], v[212:215]
v_mfma_f32_16x16x32_bf16 v[184:187], a[4:7], v[104:107], v[184:187]
v_exp_f32 v172, v172
v_exp_f32 v173, v173
v_exp_f32 v174, v174
v_cvt_pk_bf16_f32 v162, v172, v173
v_mfma_f32_16x16x32_bf16 v[184:187], a[8:11], v[112:115], v[184:187]
s_waitcnt vmcnt(5)
buffer_load_dwordx4 v249, s[12:15], s46 offen offset:3072 nt lds
v_exp_f32 v175, v175
v_mfma_f32_16x16x32_bf16 v[184:187], a[12:15], v[120:123], v[184:187]
v_exp_f32 v176, v176
v_mfma_f32_16x16x32_bf16 v[184:187], a[16:19], a[76:79], v[184:187]
v_cvt_pk_bf16_f32 v163, v174, v175
v_mfma_f32_16x16x32_bf16 v[184:187], a[20:23], a[96:99], v[184:187]
v_exp_f32 v177, v177
v_mfma_f32_16x16x32_bf16 v[184:187], a[24:27], a[116:119], v[184:187]
v_add_u32 v251, 0x10000, v251
ds_write_b128 v251, v[160:163] offset:5120
v_mfma_f32_16x16x32_bf16 v[184:187], a[28:31], a[136:139], v[184:187]
v_exp_f32 v178, v178
v_mfma_f32_16x16x32_bf16 v[188:191], a[0:3], v[128:131], v[216:219]
v_cvt_pk_bf16_f32 v166, v176, v177
v_mfma_f32_16x16x32_bf16 v[188:191], a[4:7], v[136:139], v[188:191]
v_exp_f32 v179, v179
v_mfma_f32_16x16x32_bf16 v[188:191], a[8:11], v[144:147], v[188:191]
v_exp_f32 v180, v180
v_mfma_f32_16x16x32_bf16 v[188:191], a[12:15], v[152:155], v[188:191]
v_cvt_pk_bf16_f32 v167, v178, v179
v_mfma_f32_16x16x32_bf16 v[188:191], a[16:19], a[80:83], v[188:191]
s_mov_b32 s46, 495616
s_add_u32 m0, s29, 36864
v_mfma_f32_16x16x32_bf16 v[188:191], a[20:23], a[100:103], v[188:191]
s_waitcnt vmcnt(5)
buffer_load_dwordx4 v248, s[12:15], s46 offen offset:0 nt lds
v_exp_f32 v181, v181
v_mfma_f32_16x16x32_bf16 v[188:191], a[24:27], a[120:123], v[188:191]
ds_write_b128 v251, v[164:167] offset:6144
v_mfma_f32_16x16x32_bf16 v[188:191], a[28:31], a[140:143], v[188:191]
v_exp_f32 v182, v182
v_mfma_f32_16x16x32_bf16 v[192:195], a[32:35], v[96:99], v[212:215]
v_cvt_pk_bf16_f32 v170, v180, v181
v_mfma_f32_16x16x32_bf16 v[192:195], a[36:39], v[104:107], v[192:195]
v_exp_f32 v183, v183
v_mfma_f32_16x16x32_bf16 v[192:195], a[40:43], v[112:115], v[192:195]
v_cvt_pk_bf16_f32 v171, v182, v183
ds_write_b128 v251, v[168:171] offset:7168
v_mfma_f32_16x16x32_bf16 v[192:195], a[44:47], v[120:123], v[192:195]
v_mfma_f32_16x16x32_bf16 v[192:195], a[48:51], a[76:79], v[192:195]
s_waitcnt lgkmcnt(0)
s_barrier
v_add_u32 v246, s34, v246
ds_read_b64_tr_b16 a[0:1], v246 offset:0
v_mfma_f32_16x16x32_bf16 v[192:195], a[52:55], a[96:99], v[192:195]
ds_read_b64_tr_b16 a[2:3], v246 offset:2048
v_mfma_f32_16x16x32_bf16 v[192:195], a[56:59], a[116:119], v[192:195]
v_add_u32 v247, s34, v247
ds_read_b64_tr_b16 a[4:5], v247 offset:0
v_mfma_f32_16x16x32_bf16 v[192:195], a[60:63], a[136:139], v[192:195]
ds_read_b64_tr_b16 a[6:7], v247 offset:2048
ds_read_b64_tr_b16 a[8:9], v246 offset:256
v_mfma_f32_16x16x32_bf16 v[196:199], a[32:35], v[128:131], v[216:219]
s_waitcnt vmcnt(5)
buffer_load_dwordx4 v249, s[12:15], s46 offen offset:1024 nt lds
v_mfma_f32_16x16x32_bf16 v[196:199], a[36:39], v[136:139], v[196:199]
ds_read_b64_tr_b16 a[10:11], v246 offset:2304
ds_read_b64_tr_b16 a[12:13], v247 offset:256
v_mfma_f32_16x16x32_bf16 v[196:199], a[40:43], v[144:147], v[196:199]
ds_read_b64_tr_b16 a[14:15], v247 offset:2304
ds_read_b64_tr_b16 a[16:17], v246 offset:512
v_mfma_f32_16x16x32_bf16 v[196:199], a[44:47], v[152:155], v[196:199]
ds_read_b64_tr_b16 a[18:19], v246 offset:2560
ds_read_b64_tr_b16 a[20:21], v247 offset:512
v_mfma_f32_16x16x32_bf16 v[196:199], a[48:51], a[80:83], v[196:199]
ds_read_b64_tr_b16 a[22:23], v247 offset:2560
v_mfma_f32_16x16x32_bf16 v[196:199], a[52:55], a[100:103], v[196:199]
v_mfma_f32_16x16x32_bf16 v[196:199], a[56:59], a[120:123], v[196:199]
v_mfma_f32_16x16x32_bf16 v[196:199], a[60:63], a[140:143], v[196:199]
v_exp_f32 v184, v184
v_mfma_f32_16x16x32_bf16 a[224:227], a[244:247], v[160:163], a[224:227]
v_exp_f32 v185, v185
v_mfma_f32_16x16x32_bf16 a[228:231], a[244:247], v[164:167], a[228:231]
v_exp_f32 v186, v186
v_mfma_f32_16x16x32_bf16 a[232:235], a[244:247], v[168:171], a[232:235]
v_add_u32 v250, 0x10000, v250
ds_read_b128 v[172:175], v250 offset:5120
s_waitcnt lgkmcnt(5)
v_mfma_f32_16x16x32_bf16 v[4:7], a[0:3], v[160:163], v[4:7]
s_waitcnt vmcnt(5)
buffer_load_dwordx4 v248, s[12:15], s46 offen offset:2048 nt lds
v_mfma_f32_16x16x32_bf16 v[68:71], a[0:3], v[164:167], v[68:71]
ds_read_b128 v[176:179], v250 offset:6144
v_cvt_pk_bf16_f32 v184, v184, v185
v_mfma_f32_16x16x32_bf16 v[132:135], a[0:3], v[168:171], v[132:135]
v_exp_f32 v187, v187
v_mfma_f32_16x16x32_bf16 v[12:15], a[4:7], v[160:163], v[12:15]
ds_read_b128 v[180:183], v250 offset:7168
ds_read_b64_tr_b16 a[24:25], v246 offset:768
v_mfma_f32_16x16x32_bf16 v[76:79], a[4:7], v[164:167], v[76:79]
ds_read_b64_tr_b16 a[26:27], v246 offset:2816
ds_read_b64_tr_b16 a[28:29], v247 offset:768
v_mfma_f32_16x16x32_bf16 v[140:143], a[4:7], v[168:171], v[140:143]
v_exp_f32 v188, v188
v_mfma_f32_16x16x32_bf16 v[20:23], a[8:11], v[160:163], v[20:23]
v_cvt_pk_bf16_f32 v185, v186, v187
ds_read_b64_tr_b16 a[30:31], v247 offset:2816
v_mfma_f32_16x16x32_bf16 v[84:87], a[8:11], v[164:167], v[84:87]
v_exp_f32 v189, v189
v_mfma_f32_16x16x32_bf16 v[148:151], a[8:11], v[168:171], v[148:151]
v_add_u32 v246, s33, v246
ds_read_b64_tr_b16 a[32:33], v246 offset:0
v_mfma_f32_16x16x32_bf16 v[28:31], a[12:15], v[160:163], v[28:31]
ds_read_b64_tr_b16 a[34:35], v246 offset:2048
v_mfma_f32_16x16x32_bf16 v[92:95], a[12:15], v[164:167], v[92:95]
v_exp_f32 v190, v190
v_mfma_f32_16x16x32_bf16 v[156:159], a[12:15], v[168:171], v[156:159]
s_waitcnt lgkmcnt(3)
v_mfma_f32_16x16x32_bf16 v[36:39], a[16:19], v[160:163], v[36:39]
s_waitcnt vmcnt(5)
buffer_load_dwordx4 v249, s[12:15], s46 offen offset:3072 nt lds
v_mfma_f32_16x16x32_bf16 v[100:103], a[16:19], v[164:167], v[100:103]
v_cvt_pk_bf16_f32 v188, v188, v189
v_mfma_f32_16x16x32_bf16 a[144:147], a[16:19], v[168:171], a[144:147]
v_add_u32 v247, s33, v247
ds_read_b64_tr_b16 a[36:37], v247 offset:0
v_mfma_f32_16x16x32_bf16 v[44:47], a[20:23], v[160:163], v[44:47]
ds_read_b64_tr_b16 a[38:39], v247 offset:2048
ds_read_b64_tr_b16 a[40:41], v246 offset:256
v_mfma_f32_16x16x32_bf16 v[108:111], a[20:23], v[164:167], v[108:111]
v_exp_f32 v191, v191
v_mfma_f32_16x16x32_bf16 a[148:151], a[20:23], v[168:171], a[148:151]
v_cvt_pk_bf16_f32 v189, v190, v191
ds_read_b64_tr_b16 a[42:43], v246 offset:2304
v_mfma_f32_16x16x32_bf16 v[52:55], a[24:27], v[160:163], v[52:55]
v_exp_f32 v192, v192
v_mfma_f32_16x16x32_bf16 v[116:119], a[24:27], v[164:167], v[116:119]
ds_read_b64_tr_b16 a[44:45], v247 offset:256
ds_read_b64_tr_b16 a[46:47], v247 offset:2304
v_mfma_f32_16x16x32_bf16 a[152:155], a[24:27], v[168:171], a[152:155]
ds_read_b64_tr_b16 a[48:49], v246 offset:512
s_waitcnt lgkmcnt(7)
v_mfma_f32_16x16x32_bf16 v[60:63], a[28:31], v[160:163], v[60:63]
v_exp_f32 v193, v193
v_mfma_f32_16x16x32_bf16 v[124:127], a[28:31], v[164:167], v[124:127]
v_exp_f32 v194, v194
v_mfma_f32_16x16x32_bf16 a[156:159], a[28:31], v[168:171], a[156:159]
ds_read_b64_tr_b16 a[50:51], v246 offset:2560
v_cvt_pk_bf16_f32 v186, v192, v193
v_mfma_f32_16x16x32_bf16 v[4:7], a[32:35], v[172:175], v[4:7]
ds_read_b64_tr_b16 a[52:53], v247 offset:512
ds_read_b64_tr_b16 a[54:55], v247 offset:2560
v_mfma_f32_16x16x32_bf16 v[68:71], a[32:35], v[176:179], v[68:71]
v_exp_f32 v195, v195
v_mfma_f32_16x16x32_bf16 v[132:135], a[32:35], v[180:183], v[132:135]
ds_read_b64_tr_b16 a[56:57], v246 offset:768
s_waitcnt lgkmcnt(5)
v_mfma_f32_16x16x32_bf16 v[12:15], a[36:39], v[172:175], v[12:15]
v_exp_f32 v196, v196
v_mfma_f32_16x16x32_bf16 v[76:79], a[36:39], v[176:179], v[76:79]
ds_read_b64_tr_b16 a[58:59], v246 offset:2816
v_cvt_pk_bf16_f32 v187, v194, v195
v_mfma_f32_16x16x32_bf16 v[140:143], a[36:39], v[180:183], v[140:143]
ds_read_b64_tr_b16 a[60:61], v247 offset:768
ds_read_b64_tr_b16 a[62:63], v247 offset:2816
v_mfma_f32_16x16x32_bf16 v[20:23], a[40:43], v[172:175], v[20:23]
v_exp_f32 v197, v197
v_mfma_f32_16x16x32_bf16 v[84:87], a[40:43], v[176:179], v[84:87]
ds_write_b128 v251, v[184:187] offset:38912
v_mfma_f32_16x16x32_bf16 v[148:151], a[40:43], v[180:183], v[148:151]
v_exp_f32 v198, v198
v_mfma_f32_16x16x32_bf16 v[28:31], a[44:47], v[172:175], v[28:31]
v_cvt_pk_bf16_f32 v190, v196, v197
v_mfma_f32_16x16x32_bf16 v[92:95], a[44:47], v[176:179], v[92:95]
v_exp_f32 v199, v199
v_mfma_f32_16x16x32_bf16 v[156:159], a[44:47], v[180:183], v[156:159]
v_cvt_pk_bf16_f32 v191, v198, v199
s_waitcnt lgkmcnt(3)
v_mfma_f32_16x16x32_bf16 v[36:39], a[48:51], v[172:175], v[36:39]
ds_write_b128 v251, v[188:191] offset:39936
v_mfma_f32_16x16x32_bf16 v[100:103], a[48:51], v[176:179], v[100:103]
v_mfma_f32_16x16x32_bf16 a[144:147], a[48:51], v[180:183], a[144:147]
v_mfma_f32_16x16x32_bf16 v[44:47], a[52:55], v[172:175], v[44:47]
v_mfma_f32_16x16x32_bf16 v[108:111], a[52:55], v[176:179], v[108:111]
v_mfma_f32_16x16x32_bf16 a[148:151], a[52:55], v[180:183], a[148:151]
v_mfma_f32_16x16x32_bf16 v[52:55], a[56:59], v[172:175], v[52:55]
v_mfma_f32_16x16x32_bf16 v[116:119], a[56:59], v[176:179], v[116:119]
v_mfma_f32_16x16x32_bf16 a[152:155], a[56:59], v[180:183], a[152:155]
s_waitcnt lgkmcnt(0)
v_mfma_f32_16x16x32_bf16 v[60:63], a[60:63], v[172:175], v[60:63]
v_mfma_f32_16x16x32_bf16 v[124:127], a[60:63], v[176:179], v[124:127]
v_mfma_f32_16x16x32_bf16 a[156:159], a[60:63], v[180:183], a[156:159]
v_mfma_f32_16x16x32_bf16 a[236:239], a[244:247], v[184:187], a[236:239]
v_mfma_f32_16x16x32_bf16 a[240:243], a[244:247], v[188:191], a[240:243]
v_mfma_f32_16x16x32_bf16 a[160:163], a[0:3], v[184:187], a[160:163]
v_mfma_f32_16x16x32_bf16 a[192:195], a[0:3], v[188:191], a[192:195]
s_waitcnt lgkmcnt(0)
s_barrier
v_add_u32 v244, 0xfffe8000, v244
ds_read_b128 a[0:3], v244 offset:0
v_mfma_f32_16x16x32_bf16 a[164:167], a[4:7], v[184:187], a[164:167]
ds_read_b128 v[192:195], v250 offset:38912
v_mfma_f32_16x16x32_bf16 a[196:199], a[4:7], v[188:191], a[196:199]
ds_read_b128 v[196:199], v250 offset:39936
ds_read_b128 a[4:7], v244 offset:256
v_mfma_f32_16x16x32_bf16 a[168:171], a[8:11], v[184:187], a[168:171]
v_mfma_f32_16x16x32_bf16 a[200:203], a[8:11], v[188:191], a[200:203]
ds_read_b128 a[8:11], v244 offset:512
v_mfma_f32_16x16x32_bf16 a[172:175], a[12:15], v[184:187], a[172:175]
v_mfma_f32_16x16x32_bf16 a[204:207], a[12:15], v[188:191], a[204:207]
ds_read_b128 a[12:15], v244 offset:768
v_mfma_f32_16x16x32_bf16 a[176:179], a[16:19], v[184:187], a[176:179]
v_mfma_f32_16x16x32_bf16 a[208:211], a[16:19], v[188:191], a[208:211]
v_add_u32 v245, 0xfffe8000, v245
ds_read_b128 a[16:19], v245 offset:0
v_mfma_f32_16x16x32_bf16 a[180:183], a[20:23], v[184:187], a[180:183]
v_mfma_f32_16x16x32_bf16 a[212:215], a[20:23], v[188:191], a[212:215]
ds_read_b128 a[20:23], v245 offset:256
v_mfma_f32_16x16x32_bf16 a[184:187], a[24:27], v[184:187], a[184:187]
v_mfma_f32_16x16x32_bf16 a[216:219], a[24:27], v[188:191], a[216:219]
ds_read_b128 a[24:27], v245 offset:512
v_mfma_f32_16x16x32_bf16 a[188:191], a[28:31], v[184:187], a[188:191]
v_mfma_f32_16x16x32_bf16 a[220:223], a[28:31], v[188:191], a[220:223]
ds_read_b128 a[28:31], v245 offset:768
s_waitcnt lgkmcnt(8)
v_mfma_f32_16x16x32_bf16 a[160:163], a[32:35], v[192:195], a[160:163]
s_waitcnt lgkmcnt(7)
v_mfma_f32_16x16x32_bf16 a[192:195], a[32:35], v[196:199], a[192:195]
ds_read_b128 a[32:35], v244 offset:2048
v_mfma_f32_16x16x32_bf16 a[164:167], a[36:39], v[192:195], a[164:167]
v_mfma_f32_16x16x32_bf16 a[196:199], a[36:39], v[196:199], a[196:199]
ds_read_b128 a[36:39], v244 offset:2304
v_mfma_f32_16x16x32_bf16 a[168:171], a[40:43], v[192:195], a[168:171]
v_mfma_f32_16x16x32_bf16 a[200:203], a[40:43], v[196:199], a[200:203]
v_mfma_f32_16x16x32_bf16 a[172:175], a[44:47], v[192:195], a[172:175]
v_mfma_f32_16x16x32_bf16 a[204:207], a[44:47], v[196:199], a[204:207]
v_mfma_f32_16x16x32_bf16 a[176:179], a[48:51], v[192:195], a[176:179]
v_mfma_f32_16x16x32_bf16 a[208:211], a[48:51], v[196:199], a[208:211]
v_mfma_f32_16x16x32_bf16 a[180:183], a[52:55], v[192:195], a[180:183]
v_mfma_f32_16x16x32_bf16 a[212:215], a[52:55], v[196:199], a[212:215]
v_mfma_f32_16x16x32_bf16 a[184:187], a[56:59], v[192:195], a[184:187]
v_mfma_f32_16x16x32_bf16 a[216:219], a[56:59], v[196:199], a[216:219]
v_mfma_f32_16x16x32_bf16 a[188:191], a[60:63], v[192:195], a[188:191]
v_mfma_f32_16x16x32_bf16 a[220:223], a[60:63], v[196:199], a[220:223]
ds_read_b128 a[40:43], v244 offset:2560
v_mfma_f32_16x16x32_bf16 v[160:163], a[0:3], v[0:3], v[200:203]
s_mul_i32 s47, s53, 229376
s_waitcnt lgkmcnt(9)
v_mfma_f32_16x16x32_bf16 v[160:163], a[4:7], v[8:11], v[160:163]
s_add_u32 s20, s60, s47
s_addc_u32 s21, s61, 0
s_waitcnt lgkmcnt(8)
v_mfma_f32_16x16x32_bf16 v[160:163], a[8:11], v[16:19], v[160:163]
s_mov_b32 s22, 229376
v_mbcnt_lo_u32_b32 v223, -1, 0
s_waitcnt lgkmcnt(7)
v_mfma_f32_16x16x32_bf16 v[160:163], a[12:15], v[24:27], v[160:163]
v_mbcnt_hi_u32_b32 v223, -1, v223
s_waitcnt lgkmcnt(6)
v_mfma_f32_16x16x32_bf16 v[160:163], a[16:19], a[64:67], v[160:163]
v_bfe_u32 v220, v223, 2, 3
v_mul_u32_u24 v220, 896, v220
s_waitcnt lgkmcnt(5)
v_mfma_f32_16x16x32_bf16 v[160:163], a[20:23], a[84:87], v[160:163]
v_lshrrev_b32 v221, 5, v223
v_lshl_add_u32 v220, v221, 6, v220
s_waitcnt lgkmcnt(4)
v_mfma_f32_16x16x32_bf16 v[160:163], a[24:27], a[104:107], v[160:163]
v_lshrrev_b32 v221, 3, v223
v_and_b32 v221, 2, v221
s_waitcnt lgkmcnt(3)
v_mfma_f32_16x16x32_bf16 v[160:163], a[28:31], a[124:127], v[160:163]
v_and_b32 v222, 3, v223
v_xor_b32 v221, v221, v222
v_mfma_f32_16x16x32_bf16 v[164:167], a[0:3], v[32:35], v[204:207]
v_lshl_add_u32 v220, v221, 4, v220
s_mul_i32 s47, s28, 57344
v_mfma_f32_16x16x32_bf16 v[164:167], a[4:7], v[40:43], v[164:167]
v_add_u32 v220, s47, v220
v_add_u32 v221, 6144, v220
v_mfma_f32_16x16x32_bf16 v[164:167], a[8:11], v[48:51], v[164:167]
v_add_u32 v222, 12288, v220
v_add_u32 v223, 18432, v220
v_mfma_f32_16x16x32_bf16 v[164:167], a[12:15], v[56:59], v[164:167]
s_lshl_b32 s64, s54, 7
s_mul_i32 s74, s64, 160
v_mfma_f32_16x16x32_bf16 v[164:167], a[16:19], a[68:71], v[164:167]
s_add_u32 s65, s64, 128
s_cmp_eq_u32 s65, 896
s_cselect_b32 s65, 0, s65
v_mfma_f32_16x16x32_bf16 v[164:167], a[20:23], a[88:91], v[164:167]
s_mul_i32 s75, s65, 160
ds_read_b128 a[44:47], v244 offset:2816
v_mfma_f32_16x16x32_bf16 v[164:167], a[24:27], a[108:111], v[164:167]
s_add_u32 s66, s65, 128
s_cmp_eq_u32 s66, 896
s_cselect_b32 s66, 0, s66
v_mfma_f32_16x16x32_bf16 v[164:167], a[28:31], a[128:131], v[164:167]
s_mul_i32 s76, s66, 160
ds_read_b128 a[48:51], v245 offset:2048
v_mfma_f32_16x16x32_bf16 v[168:171], a[0:3], v[64:67], v[208:211]
s_add_u32 s67, s66, 128
s_cmp_eq_u32 s67, 896
s_cselect_b32 s67, 0, s67
v_mfma_f32_16x16x32_bf16 v[168:171], a[4:7], v[72:75], v[168:171]
s_mul_i32 s77, s67, 160
ds_read_b128 a[52:55], v245 offset:2304
v_mfma_f32_16x16x32_bf16 v[168:171], a[8:11], v[80:83], v[168:171]
ds_read_b128 a[56:59], v245 offset:2560
ds_read_b128 a[60:63], v245 offset:2816
v_mfma_f32_16x16x32_bf16 v[168:171], a[12:15], v[88:91], v[168:171]
s_add_u32 s68, s67, 128
s_cmp_eq_u32 s68, 896
s_cselect_b32 s68, 0, s68
v_mfma_f32_16x16x32_bf16 v[168:171], a[16:19], a[72:75], v[168:171]
s_mul_i32 s78, s68, 160
v_mfma_f32_16x16x32_bf16 v[168:171], a[20:23], a[92:95], v[168:171]
s_add_u32 s69, s68, 128
s_cmp_eq_u32 s69, 896
s_cselect_b32 s69, 0, s69
v_mfma_f32_16x16x32_bf16 v[168:171], a[24:27], a[112:115], v[168:171]
s_mul_i32 s79, s69, 160
v_mfma_f32_16x16x32_bf16 v[168:171], a[28:31], a[132:135], v[168:171]
s_waitcnt lgkmcnt(3)
v_mfma_f32_16x16x32_bf16 v[172:175], a[32:35], v[0:3], v[200:203]
s_add_u32 s70, s69, 128
s_cmp_eq_u32 s70, 896
s_cselect_b32 s70, 0, s70
v_mfma_f32_16x16x32_bf16 v[172:175], a[36:39], v[8:11], v[172:175]
v_exp_f32 v160, v160
v_mfma_f32_16x16x32_bf16 v[172:175], a[40:43], v[16:19], v[172:175]
s_mul_i32 s80, s70, 160
v_mbcnt_lo_u32_b32 v233, -1, 0
v_mfma_f32_16x16x32_bf16 v[172:175], a[44:47], v[24:27], v[172:175]
v_exp_f32 v161, v161
v_mbcnt_hi_u32_b32 v233, -1, v233
v_mfma_f32_16x16x32_bf16 v[172:175], a[48:51], a[64:67], v[172:175]
v_lshrrev_b32 v224, 5, v233
v_bfe_u32 v225, v233, 2, 3
v_exp_f32 v162, v162
s_waitcnt lgkmcnt(0)
v_mfma_f32_16x16x32_bf16 v[172:175], a[52:55], a[84:87], v[172:175]
v_lshlrev_b32 v225, 6, v225
v_cvt_pk_bf16_f32 v160, v160, v161
v_lshl_add_u32 v224, v224, 10, v225
v_mfma_f32_16x16x32_bf16 v[172:175], a[56:59], a[104:107], v[172:175]
v_and_b32 v225, 3, v233
v_exp_f32 v163, v163
v_mfma_f32_16x16x32_bf16 v[172:175], a[60:63], a[124:127], v[172:175]
v_lshl_add_u32 v224, v225, 3, v224
v_and_b32 v225, 16, v233
v_mfma_f32_16x16x32_bf16 v[176:179], a[32:35], v[32:35], v[204:207]
v_lshl_add_u32 v224, v225, 1, v224
v_exp_f32 v164, v164
s_and_b32 s48, s28, 1
v_cvt_pk_bf16_f32 v161, v162, v163
v_mfma_f32_16x16x32_bf16 v[176:179], a[36:39], v[40:43], v[176:179]
s_mul_i32 s49, s48, 16416
v_xor_b32 v224, s49, v224
v_mfma_f32_16x16x32_bf16 v[176:179], a[40:43], v[48:51], v[176:179]
v_exp_f32 v165, v165
v_xor_b32 v225, 0x4000, v224
v_mfma_f32_16x16x32_bf16 v[176:179], a[44:47], v[56:59], v[176:179]
v_add_u32 v226, 65536, v224
v_exp_f32 v166, v166
v_add_u32 v227, 65536, v225
v_mfma_f32_16x16x32_bf16 v[176:179], a[48:51], a[68:71], v[176:179]
v_cvt_pk_bf16_f32 v164, v164, v165
v_add_u32 v228, 131072, v224
v_add_u32 v229, 131072, v225
v_mfma_f32_16x16x32_bf16 v[176:179], a[52:55], a[88:91], v[176:179]
v_lshlrev_b32 v233, 4, v233
v_exp_f32 v167, v167
v_mfma_f32_16x16x32_bf16 v[176:179], a[56:59], a[108:111], v[176:179]
s_lshl_b32 s48, s48, 10
s_lshr_b32 s49, s28, 1
v_exp_f32 v168, v168
v_mfma_f32_16x16x32_bf16 v[176:179], a[60:63], a[128:131], v[176:179]
s_lshl_b32 s49, s49, 13
v_cvt_pk_bf16_f32 v165, v166, v167
s_add_u32 s49, s49, s48
v_mfma_f32_16x16x32_bf16 v[180:183], a[32:35], v[64:67], v[208:211]
v_add_u32 v230, s49, v233
v_add_u32 v231, 4096, v230
v_exp_f32 v169, v169
v_mfma_f32_16x16x32_bf16 v[180:183], a[36:39], v[72:75], v[180:183]
s_lshl_b32 s49, s28, 10
s_add_u32 s49, s49, 16384
v_mfma_f32_16x16x32_bf16 v[180:183], a[40:43], v[80:83], v[180:183]
v_exp_f32 v170, v170
v_add_u32 v232, s49, v233
v_cvt_pk_bf16_f32 v168, v168, v169
v_mfma_f32_16x16x32_bf16 v[180:183], a[44:47], v[88:91], v[180:183]
s_add_u32 s49, s29, 131072
v_add_u32 v234, s49, v233
v_mfma_f32_16x16x32_bf16 v[180:183], a[48:51], a[72:75], v[180:183]
v_exp_f32 v171, v171
v_xor_b32 v235, 0x2000, v234
v_cvt_pk_bf16_f32 v169, v170, v171
v_xor_b32 v236, 0x4000, v234
v_mfma_f32_16x16x32_bf16 v[180:183], a[52:55], a[92:95], v[180:183]
v_mfma_f32_16x16x32_bf16 v[180:183], a[56:59], a[112:115], v[180:183]
v_mfma_f32_16x16x32_bf16 v[180:183], a[60:63], a[132:135], v[180:183]
v_mfma_f32_16x16x32_bf16 v[184:187], a[0:3], v[96:99], v[212:215]
v_mfma_f32_16x16x32_bf16 v[184:187], a[4:7], v[104:107], v[184:187]
v_exp_f32 v172, v172
v_exp_f32 v173, v173
v_exp_f32 v174, v174
v_cvt_pk_bf16_f32 v162, v172, v173
v_mfma_f32_16x16x32_bf16 v[184:187], a[8:11], v[112:115], v[184:187]
v_accvgpr_read_b32 v32, a160
v_exp_f32 v175, v175
v_mfma_f32_16x16x32_bf16 v[184:187], a[12:15], v[120:123], v[184:187]
v_accvgpr_read_b32 v0, a144
v_accvgpr_read_b32 v33, a161
v_mfma_f32_16x16x32_bf16 v[184:187], a[16:19], a[76:79], v[184:187]
v_exp_f32 v176, v176
v_cvt_pk_bf16_f32 v163, v174, v175
v_mfma_f32_16x16x32_bf16 v[184:187], a[20:23], a[96:99], v[184:187]
v_accvgpr_read_b32 v34, a162
v_accvgpr_read_b32 v1, a145
v_mfma_f32_16x16x32_bf16 v[184:187], a[24:27], a[116:119], v[184:187]
v_accvgpr_read_b32 v35, a163
v_exp_f32 v177, v177
v_add_u32 v251, 0x8000, v251
ds_write_b128 v251, v[160:163] offset:37888
v_mfma_f32_16x16x32_bf16 v[184:187], a[28:31], a[136:139], v[184:187]
v_accvgpr_read_b32 v40, a164
v_accvgpr_read_b32 v2, a146
v_mfma_f32_16x16x32_bf16 v[188:191], a[0:3], v[128:131], v[216:219]
v_exp_f32 v178, v178
v_cvt_pk_bf16_f32 v166, v176, v177
v_mfma_f32_16x16x32_bf16 v[188:191], a[4:7], v[136:139], v[188:191]
s_add_u32 m0, s29, 65536
v_accvgpr_read_b32 v41, a165
v_mfma_f32_16x16x32_bf16 v[188:191], a[8:11], v[144:147], v[188:191]
buffer_load_dwordx4 v220, s[20:23], s64 offen offset:0 lds
v_accvgpr_read_b32 v42, a166
v_exp_f32 v179, v179
v_mfma_f32_16x16x32_bf16 v[188:191], a[12:15], v[152:155], v[188:191]
buffer_load_dwordx4 v221, s[20:23], s64 offen offset:1024 lds
v_accvgpr_read_b32 v3, a147
v_exp_f32 v180, v180
v_mfma_f32_16x16x32_bf16 v[188:191], a[16:19], a[80:83], v[188:191]
buffer_load_dwordx4 v222, s[20:23], s64 offen offset:2048 lds
v_accvgpr_read_b32 v43, a167
v_cvt_pk_bf16_f32 v167, v178, v179
v_mfma_f32_16x16x32_bf16 v[188:191], a[20:23], a[100:103], v[188:191]
buffer_load_dwordx4 v223, s[20:23], s64 offen offset:3072 lds
s_add_u32 m0, s29, 69632
s_add_u32 s47, s64, 28672
v_exp_f32 v181, v181
v_mfma_f32_16x16x32_bf16 v[188:191], a[24:27], a[120:123], v[188:191]
buffer_load_dwordx4 v220, s[20:23], s47 offen offset:0 lds
v_accvgpr_read_b32 v48, a168
ds_write_b128 v251, v[164:167] offset:38912
v_mfma_f32_16x16x32_bf16 v[188:191], a[28:31], a[140:143], v[188:191]
buffer_load_dwordx4 v221, s[20:23], s47 offen offset:1024 lds
v_accvgpr_read_b32 v8, a148
v_exp_f32 v182, v182
v_mfma_f32_16x16x32_bf16 v[192:195], a[32:35], v[96:99], v[212:215]
buffer_load_dwordx4 v222, s[20:23], s47 offen offset:2048 lds
v_accvgpr_read_b32 v49, a169
v_cvt_pk_bf16_f32 v170, v180, v181
v_mfma_f32_16x16x32_bf16 v[192:195], a[36:39], v[104:107], v[192:195]
buffer_load_dwordx4 v223, s[20:23], s47 offen offset:3072 lds
v_accvgpr_read_b32 v50, a170
v_exp_f32 v183, v183
v_mfma_f32_16x16x32_bf16 v[192:195], a[40:43], v[112:115], v[192:195]
v_accvgpr_read_b32 v9, a149
v_accvgpr_read_b32 v51, a171
v_cvt_pk_bf16_f32 v171, v182, v183
ds_write_b128 v251, v[168:171] offset:39936
v_mfma_f32_16x16x32_bf16 v[192:195], a[44:47], v[120:123], v[192:195]
v_accvgpr_read_b32 v56, a172
v_accvgpr_read_b32 v10, a150
v_mfma_f32_16x16x32_bf16 v[192:195], a[48:51], a[76:79], v[192:195]
s_waitcnt vmcnt(8) lgkmcnt(0)
s_barrier
v_accvgpr_read_b32 v57, a173
v_accvgpr_read_b32 v58, a174
v_mfma_f32_16x16x32_bf16 v[192:195], a[52:55], a[96:99], v[192:195]
v_accvgpr_read_b32 v11, a151
v_accvgpr_read_b32 v59, a175
v_mfma_f32_16x16x32_bf16 v[192:195], a[56:59], a[116:119], v[192:195]
v_accvgpr_read_b32 v64, a176
v_accvgpr_read_b32 v16, a152
v_mfma_f32_16x16x32_bf16 v[192:195], a[60:63], a[136:139], v[192:195]
v_accvgpr_read_b32 v65, a177
v_accvgpr_read_b32 v66, a178
v_mfma_f32_16x16x32_bf16 v[196:199], a[32:35], v[128:131], v[216:219]
v_add_u32 v246, s35, v246
ds_read_b64_tr_b16 a[0:1], v246 offset:0
v_mfma_f32_16x16x32_bf16 v[196:199], a[36:39], v[136:139], v[196:199]
ds_read_b64_tr_b16 a[2:3], v246 offset:2048
v_accvgpr_read_b32 v17, a153
v_mfma_f32_16x16x32_bf16 v[196:199], a[40:43], v[144:147], v[196:199]
v_accvgpr_read_b32 v67, a179
v_accvgpr_read_b32 v72, a180
v_mfma_f32_16x16x32_bf16 v[196:199], a[44:47], v[152:155], v[196:199]
v_add_u32 v247, s35, v247
ds_read_b64_tr_b16 a[4:5], v247 offset:0
v_mfma_f32_16x16x32_bf16 v[196:199], a[48:51], a[80:83], v[196:199]
v_accvgpr_read_b32 v18, a154
v_accvgpr_read_b32 v73, a181
v_mfma_f32_16x16x32_bf16 v[196:199], a[52:55], a[100:103], v[196:199]
ds_read_b64_tr_b16 a[6:7], v247 offset:2048
v_accvgpr_read_b32 v74, a182
v_mfma_f32_16x16x32_bf16 v[196:199], a[56:59], a[120:123], v[196:199]
v_accvgpr_read_b32 v19, a155
v_accvgpr_read_b32 v75, a183
v_mfma_f32_16x16x32_bf16 v[196:199], a[60:63], a[140:143], v[196:199]
ds_read_b64_tr_b16 a[8:9], v246 offset:256
ds_read_b64_tr_b16 a[10:11], v246 offset:2304
v_mfma_f32_16x16x32_bf16 a[224:227], a[244:247], v[160:163], a[224:227]
v_accvgpr_read_b32 v80, a184
v_accvgpr_read_b32 v24, a156
v_mfma_f32_16x16x32_bf16 a[228:231], a[244:247], v[164:167], a[228:231]
v_exp_f32 v184, v184
v_mfma_f32_16x16x32_bf16 a[232:235], a[244:247], v[168:171], a[232:235]
v_add_u32 v250, 0x8000, v250
ds_read_b128 v[172:175], v250 offset:37888
s_waitcnt lgkmcnt(4)
v_mfma_f32_16x16x32_bf16 v[4:7], a[0:3], v[160:163], v[4:7]
s_add_u32 m0, s29, 98304
v_accvgpr_read_b32 v81, a185
v_mfma_f32_16x16x32_bf16 v[68:71], a[0:3], v[164:167], v[68:71]
ds_read_b128 v[176:179], v250 offset:38912
buffer_load_dwordx4 v220, s[20:23], s65 offen offset:0 lds
v_mfma_f32_16x16x32_bf16 v[132:135], a[0:3], v[168:171], v[132:135]
ds_read_b64_tr_b16 a[12:13], v247 offset:256
s_waitcnt lgkmcnt(5)
v_mfma_f32_16x16x32_bf16 v[12:15], a[4:7], v[160:163], v[12:15]
ds_read_b128 v[180:183], v250 offset:39936
ds_read_b64_tr_b16 a[14:15], v247 offset:2304
v_mfma_f32_16x16x32_bf16 v[76:79], a[4:7], v[164:167], v[76:79]
v_accvgpr_read_b32 v82, a186
v_accvgpr_read_b32 v25, a157
v_mfma_f32_16x16x32_bf16 v[140:143], a[4:7], v[168:171], v[140:143]
v_accvgpr_read_b32 v83, a187
v_accvgpr_read_b32 v26, a158
v_accvgpr_read_b32 v27, a159
s_waitcnt lgkmcnt(5)
v_mfma_f32_16x16x32_bf16 v[20:23], a[8:11], v[160:163], v[20:23]
buffer_load_dwordx4 v221, s[20:23], s65 offen offset:1024 lds
ds_read_b64_tr_b16 a[16:17], v246 offset:512
v_mfma_f32_16x16x32_bf16 v[84:87], a[8:11], v[164:167], v[84:87]
v_exp_f32 v185, v185
v_mfma_f32_16x16x32_bf16 v[148:151], a[8:11], v[168:171], v[148:151]
v_accvgpr_read_b32 v88, a188
ds_read_b64_tr_b16 a[18:19], v246 offset:2560
s_waitcnt lgkmcnt(2)
v_mfma_f32_16x16x32_bf16 v[28:31], a[12:15], v[160:163], v[28:31]
v_exp_f32 v186, v186
v_mfma_f32_16x16x32_bf16 v[92:95], a[12:15], v[164:167], v[92:95]
v_accvgpr_read_b32 v89, a189
v_cvt_pk_bf16_f32 v184, v184, v185
v_mfma_f32_16x16x32_bf16 v[156:159], a[12:15], v[168:171], v[156:159]
buffer_load_dwordx4 v222, s[20:23], s65 offen offset:2048 lds
ds_read_b64_tr_b16 a[20:21], v247 offset:512
ds_read_b64_tr_b16 a[22:23], v247 offset:2560
s_waitcnt lgkmcnt(2)
v_mfma_f32_16x16x32_bf16 v[36:39], a[16:19], v[160:163], v[36:39]
v_accvgpr_read_b32 v90, a190
v_accvgpr_read_b32 v91, a191
v_mfma_f32_16x16x32_bf16 v[100:103], a[16:19], v[164:167], v[100:103]
v_exp_f32 v187, v187
v_mfma_f32_16x16x32_bf16 v[0:3], a[16:19], v[168:171], v[0:3]
v_accvgpr_read_b32 v96, a192
ds_read_b64_tr_b16 a[24:25], v246 offset:768
ds_read_b64_tr_b16 a[26:27], v246 offset:2816
s_waitcnt lgkmcnt(2)
v_mfma_f32_16x16x32_bf16 v[44:47], a[20:23], v[160:163], v[44:47]
v_accvgpr_read_b32 v97, a193
v_accvgpr_read_b32 v98, a194
v_mfma_f32_16x16x32_bf16 v[108:111], a[20:23], v[164:167], v[108:111]
buffer_load_dwordx4 v223, s[20:23], s65 offen offset:3072 lds
ds_read_b64_tr_b16 a[28:29], v247 offset:768
v_mfma_f32_16x16x32_bf16 v[8:11], a[20:23], v[168:171], v[8:11]
v_accvgpr_read_b32 v99, a195
ds_read_b64_tr_b16 a[30:31], v247 offset:2816
s_waitcnt lgkmcnt(2)
v_mfma_f32_16x16x32_bf16 v[52:55], a[24:27], v[160:163], v[52:55]
v_exp_f32 v188, v188
v_mfma_f32_16x16x32_bf16 v[116:119], a[24:27], v[164:167], v[116:119]
v_cvt_pk_bf16_f32 v185, v186, v187
v_accvgpr_read_b32 v104, a196
v_mfma_f32_16x16x32_bf16 v[16:19], a[24:27], v[168:171], v[16:19]
s_add_u32 m0, s29, 102400
s_add_u32 s47, s65, 28672
v_add_u32 v246, s33, v246
ds_read_b64_tr_b16 a[32:33], v246 offset:0
ds_read_b64_tr_b16 a[34:35], v246 offset:2048
s_waitcnt lgkmcnt(2)
v_mfma_f32_16x16x32_bf16 v[60:63], a[28:31], v[160:163], v[60:63]
buffer_load_dwordx4 v220, s[20:23], s47 offen offset:0 lds
v_accvgpr_read_b32 v105, a197
v_mfma_f32_16x16x32_bf16 v[124:127], a[28:31], v[164:167], v[124:127]
v_exp_f32 v189, v189
v_mfma_f32_16x16x32_bf16 v[24:27], a[28:31], v[168:171], v[24:27]
v_accvgpr_read_b32 v106, a198
v_add_u32 v247, s33, v247
ds_read_b64_tr_b16 a[36:37], v247 offset:0
ds_read_b64_tr_b16 a[38:39], v247 offset:2048
s_waitcnt lgkmcnt(2)
v_mfma_f32_16x16x32_bf16 v[4:7], a[32:35], v[172:175], v[4:7]
v_exp_f32 v190, v190
v_mfma_f32_16x16x32_bf16 v[68:71], a[32:35], v[176:179], v[68:71]
v_cvt_pk_bf16_f32 v188, v188, v189
v_accvgpr_read_b32 v107, a199
v_mfma_f32_16x16x32_bf16 v[132:135], a[32:35], v[180:183], v[132:135]
buffer_load_dwordx4 v221, s[20:23], s47 offen offset:1024 lds
ds_read_b64_tr_b16 a[40:41], v246 offset:256
ds_read_b64_tr_b16 a[42:43], v246 offset:2304
s_waitcnt lgkmcnt(2)
v_mfma_f32_16x16x32_bf16 v[12:15], a[36:39], v[172:175], v[12:15]
v_accvgpr_read_b32 v112, a200
v_accvgpr_read_b32 v113, a201
v_mfma_f32_16x16x32_bf16 v[76:79], a[36:39], v[176:179], v[76:79]
v_exp_f32 v191, v191
v_mfma_f32_16x16x32_bf16 v[140:143], a[36:39], v[180:183], v[140:143]
v_cvt_pk_bf16_f32 v189, v190, v191
ds_read_b64_tr_b16 a[44:45], v247 offset:256
ds_read_b64_tr_b16 a[46:47], v247 offset:2304
s_waitcnt lgkmcnt(2)
v_mfma_f32_16x16x32_bf16 v[20:23], a[40:43], v[172:175], v[20:23]
v_accvgpr_read_b32 v114, a202
v_accvgpr_read_b32 v115, a203
v_mfma_f32_16x16x32_bf16 v[84:87], a[40:43], v[176:179], v[84:87]
buffer_load_dwordx4 v222, s[20:23], s47 offen offset:2048 lds
v_accvgpr_read_b32 v120, a204
v_mfma_f32_16x16x32_bf16 v[148:151], a[40:43], v[180:183], v[148:151]
v_exp_f32 v192, v192
ds_read_b64_tr_b16 a[48:49], v246 offset:512
ds_read_b64_tr_b16 a[50:51], v246 offset:2560
s_waitcnt lgkmcnt(2)
v_mfma_f32_16x16x32_bf16 v[28:31], a[44:47], v[172:175], v[28:31]
v_accvgpr_read_b32 v121, a205
v_exp_f32 v193, v193
v_mfma_f32_16x16x32_bf16 v[92:95], a[44:47], v[176:179], v[92:95]
v_accvgpr_read_b32 v122, a206
v_accvgpr_read_b32 v123, a207
v_mfma_f32_16x16x32_bf16 v[156:159], a[44:47], v[180:183], v[156:159]
v_exp_f32 v194, v194
v_cvt_pk_bf16_f32 v186, v192, v193
ds_read_b64_tr_b16 a[52:53], v247 offset:512
ds_read_b64_tr_b16 a[54:55], v247 offset:2560
s_waitcnt lgkmcnt(2)
v_mfma_f32_16x16x32_bf16 v[36:39], a[48:51], v[172:175], v[36:39]
buffer_load_dwordx4 v223, s[20:23], s47 offen offset:3072 lds
v_accvgpr_read_b32 v128, a208
v_mfma_f32_16x16x32_bf16 v[100:103], a[48:51], v[176:179], v[100:103]
v_accvgpr_read_b32 v129, a209
v_exp_f32 v195, v195
v_mfma_f32_16x16x32_bf16 v[0:3], a[48:51], v[180:183], v[0:3]
v_accvgpr_read_b32 v130, a210
v_accvgpr_read_b32 v131, a211
ds_read_b64_tr_b16 a[56:57], v246 offset:768
v_exp_f32 v196, v196
ds_read_b64_tr_b16 a[58:59], v246 offset:2816
s_waitcnt lgkmcnt(2)
v_mfma_f32_16x16x32_bf16 v[44:47], a[52:55], v[172:175], v[44:47]
v_accvgpr_read_b32 v136, a212
v_cvt_pk_bf16_f32 v4, v4, v5
v_cvt_pk_bf16_f32 v187, v194, v195
v_mfma_f32_16x16x32_bf16 v[108:111], a[52:55], v[176:179], v[108:111]
v_accvgpr_read_b32 v137, a213
ds_read_b64_tr_b16 a[60:61], v247 offset:768
v_accvgpr_read_b32 v138, a214
v_exp_f32 v197, v197
v_mfma_f32_16x16x32_bf16 v[8:11], a[52:55], v[180:183], v[8:11]
ds_read_b64_tr_b16 a[62:63], v247 offset:2816
v_accvgpr_read_b32 v139, a215
v_add_u32 v251, 0xfffe8000, v251
ds_write_b128 v251, v[184:187] offset:6144
s_waitcnt lgkmcnt(3)
v_mfma_f32_16x16x32_bf16 v[52:55], a[56:59], v[172:175], v[52:55]
v_cvt_pk_bf16_f32 v5, v6, v7
v_accvgpr_read_b32 v144, a216
v_accvgpr_read_b32 v145, a217
v_exp_f32 v198, v198
v_mfma_f32_16x16x32_bf16 v[116:119], a[56:59], v[176:179], v[116:119]
v_cvt_pk_bf16_f32 v6, v12, v13
v_cvt_pk_bf16_f32 v20, v20, v21
v_accvgpr_read_b32 v146, a218
v_cvt_pk_bf16_f32 v190, v196, v197
v_mfma_f32_16x16x32_bf16 v[16:19], a[56:59], v[180:183], v[16:19]
v_cvt_pk_bf16_f32 v7, v14, v15
v_accvgpr_read_b32 v147, a219
v_accvgpr_read_b32 v152, a220
v_exp_f32 v199, v199
s_waitcnt lgkmcnt(1)
v_mfma_f32_16x16x32_bf16 v[60:63], a[60:63], v[172:175], v[60:63]
v_cvt_pk_bf16_f32 v21, v22, v23
v_cvt_pk_bf16_f32 v68, v68, v69
v_accvgpr_read_b32 v153, a221
v_cvt_pk_bf16_f32 v191, v198, v199
ds_write_b128 v251, v[188:191] offset:7168
v_mfma_f32_16x16x32_bf16 v[124:127], a[60:63], v[176:179], v[124:127]
v_cvt_pk_bf16_f32 v22, v28, v29
v_cvt_pk_bf16_f32 v36, v36, v37
v_accvgpr_read_b32 v154, a222
v_accvgpr_read_b32 v155, a223
v_mfma_f32_16x16x32_bf16 v[24:27], a[60:63], v[180:183], v[24:27]
v_cvt_pk_bf16_f32 v69, v70, v71
v_cvt_pk_bf16_f32 v23, v30, v31
v_mfma_f32_16x16x32_bf16 a[236:239], a[244:247], v[184:187], a[236:239]
v_cvt_pk_bf16_f32 v37, v38, v39
v_cvt_pk_bf16_f32 v70, v76, v77
v_mfma_f32_16x16x32_bf16 a[240:243], a[244:247], v[188:191], a[240:243]
v_cvt_pk_bf16_f32 v84, v84, v85
v_cvt_pk_bf16_f32 v38, v44, v45
v_mfma_f32_16x16x32_bf16 v[32:35], a[0:3], v[184:187], v[32:35]
v_cvt_pk_bf16_f32 v52, v52, v53
v_cvt_pk_bf16_f32 v71, v78, v79
v_mfma_f32_16x16x32_bf16 v[96:99], a[0:3], v[188:191], v[96:99]
s_waitcnt lgkmcnt(0)
s_barrier
v_cvt_pk_bf16_f32 v85, v86, v87
v_cvt_pk_bf16_f32 v39, v46, v47
v_mfma_f32_16x16x32_bf16 v[40:43], a[4:7], v[184:187], v[40:43]
v_add_u32 v250, 0xfffe8000, v250
ds_read_b128 v[192:195], v250 offset:6144
v_cvt_pk_bf16_f32 v53, v54, v55
v_mfma_f32_16x16x32_bf16 v[104:107], a[4:7], v[188:191], v[104:107]
ds_read_b128 v[196:199], v250 offset:7168
v_cvt_pk_bf16_f32 v132, v132, v133
v_mfma_f32_16x16x32_bf16 v[48:51], a[8:11], v[184:187], v[48:51]
ds_write_b32 v251, a224 offset:4096
v_cvt_pk_bf16_f32 v86, v92, v93
v_mfma_f32_16x16x32_bf16 v[112:115], a[8:11], v[188:191], v[112:115]
v_cvt_pk_bf16_f32 v100, v100, v101
v_cvt_pk_bf16_f32 v54, v60, v61
v_mfma_f32_16x16x32_bf16 v[56:59], a[12:15], v[184:187], v[56:59]
v_cvt_pk_bf16_f32 v133, v134, v135
v_cvt_pk_bf16_f32 v87, v94, v95
v_mfma_f32_16x16x32_bf16 v[120:123], a[12:15], v[188:191], v[120:123]
ds_write_b32 v251, a228 offset:4100
v_cvt_pk_bf16_f32 v101, v102, v103
v_mfma_f32_16x16x32_bf16 v[64:67], a[16:19], v[184:187], v[64:67]
v_cvt_pk_bf16_f32 v55, v62, v63
v_cvt_pk_bf16_f32 v134, v140, v141
v_mfma_f32_16x16x32_bf16 v[128:131], a[16:19], v[188:191], v[128:131]
v_cvt_pk_bf16_f32 v148, v148, v149
ds_write_b32 v251, a232 offset:4104
v_mfma_f32_16x16x32_bf16 v[72:75], a[20:23], v[184:187], v[72:75]
v_cvt_pk_bf16_f32 v102, v108, v109
v_cvt_pk_bf16_f32 v116, v116, v117
v_mfma_f32_16x16x32_bf16 v[136:139], a[20:23], v[188:191], v[136:139]
v_cvt_pk_bf16_f32 v135, v142, v143
v_cvt_pk_bf16_f32 v149, v150, v151
v_mfma_f32_16x16x32_bf16 v[80:83], a[24:27], v[184:187], v[80:83]
v_cvt_pk_bf16_f32 v103, v110, v111
ds_write_b32 v251, a236 offset:4108
v_mfma_f32_16x16x32_bf16 v[144:147], a[24:27], v[188:191], v[144:147]
v_cvt_pk_bf16_f32 v117, v118, v119
v_cvt_pk_bf16_f32 v150, v156, v157
v_mfma_f32_16x16x32_bf16 v[88:91], a[28:31], v[184:187], v[88:91]
v_cvt_pk_bf16_f32 v0, v0, v1
ds_write_b32 v251, a240 offset:5120
v_mfma_f32_16x16x32_bf16 v[152:155], a[28:31], v[188:191], v[152:155]
v_cvt_pk_bf16_f32 v118, v124, v125
v_cvt_pk_bf16_f32 v151, v158, v159
s_waitcnt lgkmcnt(6)
v_mfma_f32_16x16x32_bf16 v[32:35], a[32:35], v[192:195], v[32:35]
v_cvt_pk_bf16_f32 v1, v2, v3
v_cvt_pk_bf16_f32 v119, v126, v127
s_waitcnt lgkmcnt(5)
v_mfma_f32_16x16x32_bf16 v[96:99], a[32:35], v[196:199], v[96:99]
ds_write_b128 v235, v[4:7] offset:0
v_cvt_pk_bf16_f32 v2, v8, v9
v_mfma_f32_16x16x32_bf16 v[40:43], a[36:39], v[192:195], v[40:43]
v_cvt_pk_bf16_f32 v16, v16, v17
ds_write_b128 v235, v[68:71] offset:4096
v_mfma_f32_16x16x32_bf16 v[104:107], a[36:39], v[196:199], v[104:107]
s_waitcnt vmcnt(8)
s_barrier
ds_read_b64_tr_b16 a[0:1], v226 offset:0
ds_read_b64_tr_b16 a[2:3], v226 offset:2048
v_mfma_f32_16x16x32_bf16 v[48:51], a[40:43], v[192:195], v[48:51]
v_cvt_pk_bf16_f32 v3, v10, v11
v_cvt_pk_bf16_f32 v17, v18, v19
v_mfma_f32_16x16x32_bf16 v[112:115], a[40:43], v[196:199], v[112:115]
v_cvt_pk_bf16_f32 v32, v32, v33
ds_read_b64_tr_b16 a[4:5], v226 offset:512
v_mfma_f32_16x16x32_bf16 v[56:59], a[44:47], v[192:195], v[56:59]
ds_read_b64_tr_b16 a[6:7], v226 offset:2560
ds_write_b128 v251, v[132:135] offset:0
v_mfma_f32_16x16x32_bf16 v[120:123], a[44:47], v[196:199], v[120:123]
v_cvt_pk_bf16_f32 v18, v24, v25
v_cvt_pk_bf16_f32 v33, v34, v35
v_mfma_f32_16x16x32_bf16 v[64:67], a[48:51], v[192:195], v[64:67]
v_cvt_pk_bf16_f32 v19, v26, v27
v_cvt_pk_bf16_f32 v34, v40, v41
v_mfma_f32_16x16x32_bf16 v[128:131], a[48:51], v[196:199], v[128:131]
v_cvt_pk_bf16_f32 v48, v48, v49
v_cvt_pk_bf16_f32 v49, v50, v51
v_mfma_f32_16x16x32_bf16 v[72:75], a[52:55], v[192:195], v[72:75]
v_cvt_pk_bf16_f32 v35, v42, v43
v_cvt_pk_bf16_f32 v50, v56, v57
v_mfma_f32_16x16x32_bf16 v[136:139], a[52:55], v[196:199], v[136:139]
v_cvt_pk_bf16_f32 v96, v96, v97
v_cvt_pk_bf16_f32 v51, v58, v59
v_mfma_f32_16x16x32_bf16 v[80:83], a[56:59], v[192:195], v[80:83]
v_cvt_pk_bf16_f32 v97, v98, v99
v_cvt_pk_bf16_f32 v112, v112, v113
v_mfma_f32_16x16x32_bf16 v[144:147], a[56:59], v[196:199], v[144:147]
v_cvt_pk_bf16_f32 v64, v64, v65
v_cvt_pk_bf16_f32 v65, v66, v67
v_mfma_f32_16x16x32_bf16 v[88:91], a[60:63], v[192:195], v[88:91]
v_cvt_pk_bf16_f32 v66, v72, v73
v_cvt_pk_bf16_f32 v67, v74, v75
v_mfma_f32_16x16x32_bf16 v[152:155], a[60:63], v[196:199], v[152:155]
v_cvt_pk_bf16_f32 v98, v104, v105
s_waitcnt lgkmcnt(0)
v_mfma_f32_16x16x32_bf16 v[160:163], a[0:3], v[4:7], 0
ds_read_b64_tr_b16 a[8:9], v226 offset:4096
ds_read_b64_tr_b16 a[10:11], v226 offset:6144
v_mfma_f32_16x16x32_bf16 v[168:171], a[0:3], v[68:71], 0
ds_write_b128 v235, v[20:23] offset:1024
ds_read_b64_tr_b16 a[12:13], v226 offset:4608
v_mfma_f32_16x16x32_bf16 v[176:179], a[0:3], v[132:135], 0
ds_read_b64_tr_b16 a[14:15], v226 offset:6656
ds_write_b128 v235, v[84:87] offset:5120
v_mfma_f32_16x16x32_bf16 v[164:167], a[4:7], v[4:7], 0
ds_read_b64_tr_b16 a[16:17], v226 offset:8192
ds_read_b64_tr_b16 a[18:19], v226 offset:10240
v_mfma_f32_16x16x32_bf16 v[172:175], a[4:7], v[68:71], 0
ds_write_b128 v251, v[148:151] offset:1024
v_cvt_pk_bf16_f32 v80, v80, v81
v_mfma_f32_16x16x32_bf16 v[180:183], a[4:7], v[132:135], 0
ds_read_b64_tr_b16 a[20:21], v226 offset:8704
s_waitcnt lgkmcnt(8)
v_mfma_f32_16x16x32_bf16 v[160:163], a[8:11], v[20:23], v[160:163]
ds_read_b64_tr_b16 a[22:23], v226 offset:10752
ds_write_b128 v235, v[36:39] offset:2048
v_mfma_f32_16x16x32_bf16 v[168:171], a[8:11], v[84:87], v[168:171]
ds_read_b64_tr_b16 a[24:25], v226 offset:12288
v_cvt_pk_bf16_f32 v81, v82, v83
v_mfma_f32_16x16x32_bf16 v[176:179], a[8:11], v[148:151], v[176:179]
ds_read_b64_tr_b16 a[26:27], v226 offset:14336
s_waitcnt lgkmcnt(9)
v_mfma_f32_16x16x32_bf16 v[164:167], a[12:15], v[20:23], v[164:167]
ds_write_b128 v235, v[100:103] offset:6144
ds_read_b64_tr_b16 a[28:29], v226 offset:12800
v_mfma_f32_16x16x32_bf16 v[172:175], a[12:15], v[84:87], v[172:175]
ds_read_b64_tr_b16 a[30:31], v226 offset:14848
ds_write_b128 v251, v[0:3] offset:2048
v_mfma_f32_16x16x32_bf16 v[180:183], a[12:15], v[148:151], v[180:183]
v_cvt_pk_bf16_f32 v82, v88, v89
s_waitcnt lgkmcnt(9)
v_mfma_f32_16x16x32_bf16 v[160:163], a[16:19], v[36:39], v[160:163]
ds_write_b128 v235, v[52:55] offset:3072
v_cvt_pk_bf16_f32 v113, v114, v115
v_mfma_f32_16x16x32_bf16 v[168:171], a[16:19], v[100:103], v[168:171]
v_cvt_pk_bf16_f32 v128, v128, v129
v_cvt_pk_bf16_f32 v83, v90, v91
v_mfma_f32_16x16x32_bf16 v[176:179], a[16:19], v[0:3], v[176:179]
ds_write_b128 v235, v[116:119] offset:7168
s_waitcnt lgkmcnt(7)
v_mfma_f32_16x16x32_bf16 v[164:167], a[20:23], v[36:39], v[164:167]
v_cvt_pk_bf16_f32 v99, v106, v107
v_cvt_pk_bf16_f32 v114, v120, v121
v_mfma_f32_16x16x32_bf16 v[172:175], a[20:23], v[100:103], v[172:175]
v_cvt_pk_bf16_f32 v129, v130, v131
v_cvt_pk_bf16_f32 v144, v144, v145
v_mfma_f32_16x16x32_bf16 v[180:183], a[20:23], v[0:3], v[180:183]
ds_write_b128 v251, v[16:19] offset:3072
s_waitcnt lgkmcnt(3)
v_mfma_f32_16x16x32_bf16 v[160:163], a[24:27], v[52:55], v[160:163]
v_cvt_pk_bf16_f32 v115, v122, v123
v_cvt_pk_bf16_f32 v130, v136, v137
v_mfma_f32_16x16x32_bf16 v[168:171], a[24:27], v[116:119], v[168:171]
v_cvt_pk_bf16_f32 v145, v146, v147
v_cvt_pk_bf16_f32 v131, v138, v139
v_mfma_f32_16x16x32_bf16 v[176:179], a[24:27], v[16:19], v[176:179]
ds_write_b128 v251, v[32:35] offset:32768
ds_write_b128 v251, v[96:99] offset:36864
v_mfma_f32_16x16x32_bf16 v[164:167], a[28:31], v[52:55], v[164:167]
v_cvt_pk_bf16_f32 v146, v152, v153
ds_read_b64_tr_b16 a[32:33], v227 offset:0
v_mfma_f32_16x16x32_bf16 v[172:175], a[28:31], v[116:119], v[172:175]
s_waitcnt lgkmcnt(1)
s_barrier
ds_read_b128 a[64:67], v234 offset:0
ds_read_b128 a[68:71], v234 offset:4096
v_mfma_f32_16x16x32_bf16 v[180:183], a[28:31], v[16:19], v[180:183]
ds_read_b128 a[72:75], v250 offset:0
ds_read_b128 v[208:211], v250 offset:4096
v_mfma_f32_16x16x32_bf16 v[184:187], a[0:3], v[32:35], 0
ds_read_b128 a[84:87], v234 offset:1024
ds_read_b128 a[88:91], v234 offset:5120
v_mfma_f32_16x16x32_bf16 v[192:195], a[0:3], v[96:99], 0
ds_read_b128 a[92:95], v250 offset:1024
ds_read_b32 v212, v250 offset:5120
v_mfma_f32_16x16x32_bf16 v[188:191], a[4:7], v[32:35], 0
v_accvgpr_read_b32 v200, a224
v_accvgpr_read_b32 v201, a228
v_mfma_f32_16x16x32_bf16 v[196:199], a[4:7], v[96:99], 0
v_accvgpr_read_b32 v202, a232
v_cvt_pk_bf16_f32 v147, v154, v155
v_mfma_f32_16x16x32_bf16 v[184:187], a[8:11], v[48:51], v[184:187]
v_accvgpr_read_b32 v203, a236
v_accvgpr_read_b32 v204, a240
v_mfma_f32_16x16x32_bf16 v[192:195], a[8:11], v[112:115], v[192:195]
s_waitcnt lgkmcnt(4)
v_add_f32 v200, v200, v208
v_add_f32 v201, v201, v209
v_mfma_f32_16x16x32_bf16 v[188:191], a[12:15], v[48:51], v[188:191]
v_add_f32 v202, v202, v210
v_add_f32 v203, v203, v211
v_mfma_f32_16x16x32_bf16 v[196:199], a[12:15], v[112:115], v[196:199]
ds_read_b128 a[104:107], v234 offset:2048
ds_read_b128 a[108:111], v234 offset:6144
ds_read_b128 a[112:115], v250 offset:2048
v_mfma_f32_16x16x32_bf16 v[184:187], a[16:19], v[64:67], v[184:187]
ds_read_b128 a[124:127], v234 offset:3072
ds_read_b128 a[128:131], v234 offset:7168
ds_read_b128 a[132:135], v250 offset:3072
v_mfma_f32_16x16x32_bf16 v[192:195], a[16:19], v[128:131], v[192:195]
s_waitcnt lgkmcnt(6)
v_add_f32 v204, v204, v212
v_add_f32 v208, v200, v201
v_mfma_f32_16x16x32_bf16 v[188:191], a[20:23], v[64:67], v[188:191]
v_add_f32 v209, v202, v203
v_add_f32 v208, v208, v204
v_mfma_f32_16x16x32_bf16 v[196:199], a[20:23], v[128:131], v[196:199]
v_add_f32 v208, v208, v209
v_mfma_f32_16x16x32_bf16 v[184:187], a[24:27], v[80:83], v[184:187]
s_waitcnt lgkmcnt(1)
ds_read_b64_tr_b16 a[34:35], v227 offset:2048
v_mfma_f32_16x16x32_bf16 v[192:195], a[24:27], v[144:147], v[192:195]
s_add_u32 m0, s29, 131072
v_mfma_f32_16x16x32_bf16 v[188:191], a[28:31], v[80:83], v[188:191]
buffer_load_dwordx4 v220, s[20:23], s66 offen offset:0 lds
v_mfma_f32_16x16x32_bf16 v[196:199], a[28:31], v[144:147], v[196:199]
ds_read_b64_tr_b16 a[36:37], v227 offset:512
ds_read_b64_tr_b16 a[38:39], v227 offset:2560
s_waitcnt lgkmcnt(2)
v_mfma_f32_16x16x32_bf16 v[160:163], a[32:35], a[64:67], v[160:163]
ds_write_b128 v251, v[48:51] offset:33792
ds_write_b128 v251, v[112:115] offset:37888
v_mfma_f32_16x16x32_bf16 v[168:171], a[32:35], a[68:71], v[168:171]
buffer_load_dwordx4 v221, s[20:23], s66 offen offset:1024 lds
ds_read_b64_tr_b16 a[40:41], v227 offset:4096
v_mfma_f32_16x16x32_bf16 v[176:179], a[32:35], a[72:75], v[176:179]
ds_read_b64_tr_b16 a[42:43], v227 offset:6144
s_waitcnt lgkmcnt(4)
v_mfma_f32_16x16x32_bf16 v[164:167], a[36:39], a[64:67], v[164:167]
ds_write_b128 v251, v[64:67] offset:34816
ds_read_b64_tr_b16 a[44:45], v227 offset:4608
v_mfma_f32_16x16x32_bf16 v[172:175], a[36:39], a[68:71], v[172:175]
buffer_load_dwordx4 v222, s[20:23], s66 offen offset:2048 lds
ds_read_b64_tr_b16 a[46:47], v227 offset:6656
v_mfma_f32_16x16x32_bf16 v[180:183], a[36:39], a[72:75], v[180:183]
ds_write_b128 v251, v[128:131] offset:38912
s_waitcnt lgkmcnt(4)
v_mfma_f32_16x16x32_bf16 v[160:163], a[40:43], a[84:87], v[160:163]
ds_read_b64_tr_b16 a[48:49], v227 offset:8192
ds_read_b64_tr_b16 a[50:51], v227 offset:10240
v_mfma_f32_16x16x32_bf16 v[168:171], a[40:43], a[88:91], v[168:171]
buffer_load_dwordx4 v223, s[20:23], s66 offen offset:3072 lds
ds_write_b128 v251, v[80:83] offset:35840
v_mfma_f32_16x16x32_bf16 v[176:179], a[40:43], a[92:95], v[176:179]
ds_read_b64_tr_b16 a[52:53], v227 offset:8704
ds_write_b128 v251, v[144:147] offset:39936
s_waitcnt lgkmcnt(6)
v_mfma_f32_16x16x32_bf16 v[164:167], a[44:47], a[84:87], v[164:167]
s_add_u32 m0, s29, 135168
s_add_u32 s47, s66, 28672
v_mfma_f32_16x16x32_bf16 v[172:175], a[44:47], a[88:91], v[172:175]
buffer_load_dwordx4 v220, s[20:23], s47 offen offset:0 lds
s_waitcnt lgkmcnt(0)
s_waitcnt vmcnt(5)
s_barrier
ds_read_b64_tr_b16 a[54:55], v227 offset:10752
ds_read_b64_tr_b16 a[56:57], v227 offset:12288
v_mfma_f32_16x16x32_bf16 v[180:183], a[44:47], a[92:95], v[180:183]
ds_read_b64_tr_b16 a[58:59], v227 offset:14336
v_mfma_f32_16x16x32_bf16 v[160:163], a[48:51], a[104:107], v[160:163]
v_rcp_f32 v200, v200
v_mfma_f32_16x16x32_bf16 v[168:171], a[48:51], a[108:111], v[168:171]
buffer_load_dwordx4 v221, s[20:23], s47 offen offset:1024 lds
ds_read_b64_tr_b16 a[60:61], v227 offset:12800
v_mfma_f32_16x16x32_bf16 v[176:179], a[48:51], a[112:115], v[176:179]
ds_read_b128 a[76:79], v250 offset:32768
s_waitcnt lgkmcnt(4)
v_mfma_f32_16x16x32_bf16 v[164:167], a[52:55], a[104:107], v[164:167]
ds_read_b64_tr_b16 a[62:63], v227 offset:14848
ds_read_b128 a[80:83], v250 offset:36864
v_mfma_f32_16x16x32_bf16 v[172:175], a[52:55], a[108:111], v[172:175]
buffer_load_dwordx4 v222, s[20:23], s47 offen offset:2048 lds
ds_read_b128 a[96:99], v250 offset:33792
v_mfma_f32_16x16x32_bf16 v[180:183], a[52:55], a[112:115], v[180:183]
ds_read_b128 a[100:103], v250 offset:37888
ds_read_b128 a[116:119], v250 offset:34816
s_waitcnt lgkmcnt(7)
v_mfma_f32_16x16x32_bf16 v[160:163], a[56:59], a[124:127], v[160:163]
ds_read_b128 a[120:123], v250 offset:38912
ds_read_b128 a[136:139], v250 offset:35840
ds_read_b128 a[140:143], v250 offset:39936
v_mfma_f32_16x16x32_bf16 v[168:171], a[56:59], a[128:131], v[168:171]
buffer_load_dwordx4 v223, s[20:23], s47 offen offset:3072 lds
v_rcp_f32 v201, v201
v_mfma_f32_16x16x32_bf16 v[176:179], a[56:59], a[132:135], v[176:179]
ds_read_b64_tr_b16 a[0:1], v226 offset:32768
s_waitcnt lgkmcnt(8)
v_mfma_f32_16x16x32_bf16 v[164:167], a[60:63], a[124:127], v[164:167]
v_rcp_f32 v202, v202
v_mfma_f32_16x16x32_bf16 v[172:175], a[60:63], a[128:131], v[172:175]
v_rcp_f32 v203, v203
v_mfma_f32_16x16x32_bf16 v[180:183], a[60:63], a[132:135], v[180:183]
s_add_u32 m0, s29, 0
v_rcp_f32 v204, v204
v_mfma_f32_16x16x32_bf16 v[184:187], a[32:35], a[76:79], v[184:187]
buffer_load_dwordx4 v220, s[20:23], s67 offen offset:0 lds
s_waitcnt lgkmcnt(4)
v_mfma_f32_16x16x32_bf16 v[192:195], a[32:35], a[80:83], v[192:195]
v_mul_f32 v160, v160, v200
v_mul_f32 v161, v161, v200
v_mfma_f32_16x16x32_bf16 v[188:191], a[36:39], a[76:79], v[188:191]
v_mul_f32 v162, v162, v200
v_mul_f32 v163, v163, v200
v_mfma_f32_16x16x32_bf16 v[196:199], a[36:39], a[80:83], v[196:199]
v_cvt_pk_bf16_f32 v160, v160, v161
v_cvt_pk_bf16_f32 v161, v162, v163
v_mfma_f32_16x16x32_bf16 v[184:187], a[40:43], a[96:99], v[184:187]
buffer_load_dwordx4 v221, s[20:23], s67 offen offset:1024 lds
v_mul_f32 v164, v164, v200
v_mfma_f32_16x16x32_bf16 v[192:195], a[40:43], a[100:103], v[192:195]
ds_read_b64_tr_b16 a[2:3], v226 offset:34816
ds_read_b64_tr_b16 a[4:5], v226 offset:36864
v_mfma_f32_16x16x32_bf16 v[188:191], a[44:47], a[96:99], v[188:191]
v_mul_f32 v165, v165, v200
ds_read_b64_tr_b16 a[6:7], v226 offset:38912
v_mfma_f32_16x16x32_bf16 v[196:199], a[44:47], a[100:103], v[196:199]
ds_read_b64_tr_b16 a[8:9], v226 offset:40960
v_mul_f32 v166, v166, v200
v_mfma_f32_16x16x32_bf16 v[184:187], a[48:51], a[116:119], v[184:187]
buffer_load_dwordx4 v222, s[20:23], s67 offen offset:2048 lds
s_waitcnt lgkmcnt(4)
v_mfma_f32_16x16x32_bf16 v[192:195], a[48:51], a[120:123], v[192:195]
ds_read_b64_tr_b16 a[10:11], v226 offset:43008
v_mul_f32 v167, v167, v200
v_mfma_f32_16x16x32_bf16 v[188:191], a[52:55], a[116:119], v[188:191]
ds_read_b64_tr_b16 a[12:13], v226 offset:45056
v_mul_f32 v168, v168, v201
v_cvt_pk_bf16_f32 v162, v164, v165
v_cvt_pk_bf16_f32 v163, v166, v167
v_mfma_f32_16x16x32_bf16 v[196:199], a[52:55], a[120:123], v[196:199]
buffer_store_dwordx4 v[160:163], v230, s[24:27], s74 offen offset:0 sc1
ds_read_b64_tr_b16 a[14:15], v226 offset:47104
v_mfma_f32_16x16x32_bf16 v[184:187], a[56:59], a[136:139], v[184:187]
buffer_load_dwordx4 v223, s[20:23], s67 offen offset:3072 lds
ds_read_b64_tr_b16 a[16:17], v227 offset:32768
v_mul_f32 v169, v169, v201
v_mul_f32 v170, v170, v201
v_mfma_f32_16x16x32_bf16 v[192:195], a[56:59], a[140:143], v[192:195]
ds_read_b64_tr_b16 a[18:19], v227 offset:34816
ds_read_b64_tr_b16 a[20:21], v227 offset:36864
v_mul_f32 v171, v171, v201
v_mfma_f32_16x16x32_bf16 v[188:191], a[60:63], a[136:139], v[188:191]
ds_read_b64_tr_b16 a[22:23], v227 offset:38912
ds_read_b64_tr_b16 a[24:25], v227 offset:40960
v_cvt_pk_bf16_f32 v168, v168, v169
v_cvt_pk_bf16_f32 v169, v170, v171
v_mfma_f32_16x16x32_bf16 v[196:199], a[60:63], a[140:143], v[196:199]
s_add_u32 m0, s29, 4096
s_add_u32 s47, s67, 28672
v_mul_f32 v172, v172, v201
s_waitcnt lgkmcnt(8)
v_mfma_f32_16x16x32_bf16 v[12:15], a[0:3], v[4:7], 0
buffer_load_dwordx4 v220, s[20:23], s47 offen offset:0 lds
ds_read_b64_tr_b16 a[26:27], v227 offset:43008
v_mul_f32 v173, v173, v201
v_mul_f32 v174, v174, v201
v_mfma_f32_16x16x32_bf16 v[12:15], a[4:7], v[20:23], v[12:15]
ds_read_b64_tr_b16 a[28:29], v227 offset:45056
v_mul_f32 v175, v175, v201
s_waitcnt lgkmcnt(8)
v_mfma_f32_16x16x32_bf16 v[12:15], a[8:11], v[36:39], v[12:15]
ds_read_b64_tr_b16 a[30:31], v227 offset:47104
v_cvt_pk_bf16_f32 v170, v172, v173
v_cvt_pk_bf16_f32 v171, v174, v175
s_waitcnt lgkmcnt(8)
v_mfma_f32_16x16x32_bf16 v[12:15], a[12:15], v[52:55], v[12:15]
buffer_store_dwordx4 v[168:171], v230, s[24:27], s74 offen offset:2048 sc1
v_mul_f32 v176, v176, v202
s_waitcnt lgkmcnt(6)
v_mfma_f32_16x16x32_bf16 v[12:15], a[16:19], a[64:67], v[12:15]
buffer_load_dwordx4 v221, s[20:23], s47 offen offset:1024 lds
v_mul_f32 v177, v177, v202
v_mul_f32 v178, v178, v202
s_waitcnt lgkmcnt(4)
v_mfma_f32_16x16x32_bf16 v[12:15], a[20:23], a[84:87], v[12:15]
v_mul_f32 v179, v179, v202
s_waitcnt lgkmcnt(2)
v_mfma_f32_16x16x32_bf16 v[12:15], a[24:27], a[104:107], v[12:15]
v_cvt_pk_bf16_f32 v176, v176, v177
v_cvt_pk_bf16_f32 v177, v178, v179
s_waitcnt lgkmcnt(0)
v_mfma_f32_16x16x32_bf16 v[12:15], a[28:31], a[124:127], v[12:15]
v_mul_f32 v180, v180, v202
v_mul_f32 v181, v181, v202
v_mfma_f32_16x16x32_bf16 v[44:47], a[0:3], v[68:71], 0
buffer_load_dwordx4 v222, s[20:23], s47 offen offset:2048 lds
v_mul_f32 v182, v182, v202
v_mfma_f32_16x16x32_bf16 v[44:47], a[4:7], v[84:87], v[44:47]
v_mul_f32 v183, v183, v202
v_mul_f32 v184, v184, v203
v_mfma_f32_16x16x32_bf16 v[44:47], a[8:11], v[100:103], v[44:47]
v_cvt_pk_bf16_f32 v178, v180, v181
v_mul_f32 v185, v185, v203
v_cvt_pk_bf16_f32 v179, v182, v183
v_mfma_f32_16x16x32_bf16 v[44:47], a[12:15], v[116:119], v[44:47]
buffer_store_dwordx4 v[176:179], v231, s[24:27], s74 offen offset:0 sc1
v_mul_f32 v186, v186, v203
v_mfma_f32_16x16x32_bf16 v[44:47], a[16:19], a[68:71], v[44:47]
buffer_load_dwordx4 v223, s[20:23], s47 offen offset:3072 lds
v_mul_f32 v187, v187, v203
v_mfma_f32_16x16x32_bf16 v[44:47], a[20:23], a[88:91], v[44:47]
v_cvt_pk_bf16_f32 v184, v184, v185
v_cvt_pk_bf16_f32 v185, v186, v187
v_mfma_f32_16x16x32_bf16 v[44:47], a[24:27], a[108:111], v[44:47]
v_mul_f32 v188, v188, v203
v_mul_f32 v189, v189, v203
v_mfma_f32_16x16x32_bf16 v[44:47], a[28:31], a[128:131], v[44:47]
v_mul_f32 v190, v190, v203
v_mul_f32 v191, v191, v203
v_mfma_f32_16x16x32_bf16 v[76:79], a[0:3], v[132:135], 0
v_cvt_pk_bf16_f32 v186, v188, v189
v_mfma_f32_16x16x32_bf16 v[76:79], a[4:7], v[148:151], v[76:79]
s_add_u32 m0, s29, 32768
v_mul_f32 v192, v192, v204
v_mfma_f32_16x16x32_bf16 v[76:79], a[8:11], v[0:3], v[76:79]
buffer_load_dwordx4 v220, s[20:23], s68 offen offset:0 lds
v_mul_f32 v193, v193, v204
v_cvt_pk_bf16_f32 v187, v190, v191
v_mfma_f32_16x16x32_bf16 v[76:79], a[12:15], v[16:19], v[76:79]
buffer_store_dwordx4 v[184:187], v231, s[24:27], s74 offen offset:2048 sc1
v_mul_f32 v194, v194, v204
v_mfma_f32_16x16x32_bf16 v[76:79], a[16:19], a[72:75], v[76:79]
v_mul_f32 v195, v195, v204
v_cvt_pk_bf16_f32 v192, v192, v193
v_mfma_f32_16x16x32_bf16 v[76:79], a[20:23], a[92:95], v[76:79]
v_cvt_pk_bf16_f32 v193, v194, v195
v_mul_f32 v196, v196, v204
v_mfma_f32_16x16x32_bf16 v[76:79], a[24:27], a[112:115], v[76:79]
v_mul_f32 v197, v197, v204
v_mul_f32 v198, v198, v204
v_mfma_f32_16x16x32_bf16 v[76:79], a[28:31], a[132:135], v[76:79]
buffer_load_dwordx4 v221, s[20:23], s68 offen offset:1024 lds
v_mul_f32 v199, v199, v204
v_mfma_f32_16x16x32_bf16 v[108:111], a[0:3], v[32:35], 0
v_cvt_pk_bf16_f32 v194, v196, v197
v_cvt_pk_bf16_f32 v195, v198, v199
v_mfma_f32_16x16x32_bf16 v[108:111], a[4:7], v[48:51], v[108:111]
ds_read_b64_tr_b16 a[32:33], v226 offset:33280
ds_read_b64_tr_b16 a[34:35], v226 offset:35328
v_mfma_f32_16x16x32_bf16 v[108:111], a[8:11], v[64:67], v[108:111]
ds_read_b64_tr_b16 a[36:37], v226 offset:37376
ds_read_b64_tr_b16 a[38:39], v226 offset:39424
v_mfma_f32_16x16x32_bf16 v[108:111], a[12:15], v[80:83], v[108:111]
buffer_store_dwordx4 v[192:195], v232, s[24:27], s74 offen offset:0 sc1
ds_read_b64_tr_b16 a[40:41], v226 offset:41472
v_mfma_f32_16x16x32_bf16 v[108:111], a[16:19], a[76:79], v[108:111]
buffer_load_dwordx4 v222, s[20:23], s68 offen offset:2048 lds
ds_read_b64_tr_b16 a[42:43], v226 offset:43520
v_mfma_f32_16x16x32_bf16 v[108:111], a[20:23], a[96:99], v[108:111]
ds_read_b64_tr_b16 a[44:45], v226 offset:45568
ds_read_b64_tr_b16 a[46:47], v226 offset:47616
v_mfma_f32_16x16x32_bf16 v[108:111], a[24:27], a[116:119], v[108:111]
ds_read_b64_tr_b16 a[48:49], v227 offset:33280
ds_read_b64_tr_b16 a[50:51], v227 offset:35328
v_mfma_f32_16x16x32_bf16 v[108:111], a[28:31], a[136:139], v[108:111]
ds_read_b64_tr_b16 a[52:53], v227 offset:37376
ds_read_b64_tr_b16 a[54:55], v227 offset:39424
v_mfma_f32_16x16x32_bf16 v[140:143], a[0:3], v[96:99], 0
ds_read_b64_tr_b16 a[56:57], v227 offset:41472
v_mfma_f32_16x16x32_bf16 v[140:143], a[4:7], v[112:115], v[140:143]
buffer_load_dwordx4 v223, s[20:23], s68 offen offset:3072 lds
v_mfma_f32_16x16x32_bf16 v[140:143], a[8:11], v[128:131], v[140:143]
v_mfma_f32_16x16x32_bf16 v[140:143], a[12:15], v[144:147], v[140:143]
v_mfma_f32_16x16x32_bf16 v[140:143], a[16:19], a[80:83], v[140:143]
v_mfma_f32_16x16x32_bf16 v[140:143], a[20:23], a[100:103], v[140:143]
s_add_u32 m0, s29, 36864
s_add_u32 s47, s68, 28672
v_mfma_f32_16x16x32_bf16 v[140:143], a[24:27], a[120:123], v[140:143]
buffer_load_dwordx4 v220, s[20:23], s47 offen offset:0 lds
v_mfma_f32_16x16x32_bf16 v[140:143], a[28:31], a[140:143], v[140:143]
s_waitcnt lgkmcnt(0)
v_mfma_f32_16x16x32_bf16 v[28:31], a[32:35], v[4:7], 0
ds_read_b64_tr_b16 a[58:59], v227 offset:43520
ds_read_b64_tr_b16 a[60:61], v227 offset:45568
v_mfma_f32_16x16x32_bf16 v[28:31], a[36:39], v[20:23], v[28:31]
ds_read_b64_tr_b16 a[62:63], v227 offset:47616
v_mfma_f32_16x16x32_bf16 v[28:31], a[40:43], v[36:39], v[28:31]
v_mfma_f32_16x16x32_bf16 v[28:31], a[44:47], v[52:55], v[28:31]
buffer_load_dwordx4 v221, s[20:23], s47 offen offset:1024 lds
v_mfma_f32_16x16x32_bf16 v[28:31], a[48:51], a[64:67], v[28:31]
v_mfma_f32_16x16x32_bf16 v[28:31], a[52:55], a[84:87], v[28:31]
s_waitcnt lgkmcnt(2)
v_mfma_f32_16x16x32_bf16 v[28:31], a[56:59], a[104:107], v[28:31]
s_waitcnt lgkmcnt(0)
v_mfma_f32_16x16x32_bf16 v[28:31], a[60:63], a[124:127], v[28:31]
v_mfma_f32_16x16x32_bf16 v[60:63], a[32:35], v[68:71], 0
buffer_load_dwordx4 v222, s[20:23], s47 offen offset:2048 lds
v_mfma_f32_16x16x32_bf16 v[60:63], a[36:39], v[84:87], v[60:63]
v_mfma_f32_16x16x32_bf16 v[60:63], a[40:43], v[100:103], v[60:63]
v_mfma_f32_16x16x32_bf16 v[60:63], a[44:47], v[116:119], v[60:63]
v_mfma_f32_16x16x32_bf16 v[60:63], a[48:51], a[68:71], v[60:63]
v_mfma_f32_16x16x32_bf16 v[60:63], a[52:55], a[88:91], v[60:63]
buffer_load_dwordx4 v223, s[20:23], s47 offen offset:3072 lds
v_mul_f32 v12, v12, v200
v_mfma_f32_16x16x32_bf16 v[60:63], a[56:59], a[108:111], v[60:63]
v_mul_f32 v13, v13, v200
v_mul_f32 v14, v14, v200
v_mfma_f32_16x16x32_bf16 v[60:63], a[60:63], a[128:131], v[60:63]
v_mul_f32 v15, v15, v200
v_cvt_pk_bf16_f32 v12, v12, v13
v_mfma_f32_16x16x32_bf16 v[92:95], a[32:35], v[132:135], 0
v_cvt_pk_bf16_f32 v13, v14, v15
v_mfma_f32_16x16x32_bf16 v[92:95], a[36:39], v[148:151], v[92:95]
v_mul_f32 v44, v44, v201
v_mul_f32 v45, v45, v201
v_mfma_f32_16x16x32_bf16 v[92:95], a[40:43], v[0:3], v[92:95]
v_mul_f32 v46, v46, v201
v_mul_f32 v47, v47, v201
v_mfma_f32_16x16x32_bf16 v[92:95], a[44:47], v[16:19], v[92:95]
v_cvt_pk_bf16_f32 v44, v44, v45
v_cvt_pk_bf16_f32 v45, v46, v47
v_mfma_f32_16x16x32_bf16 v[92:95], a[48:51], a[72:75], v[92:95]
v_mfma_f32_16x16x32_bf16 v[92:95], a[52:55], a[92:95], v[92:95]
v_mul_f32 v76, v76, v202
v_mul_f32 v77, v77, v202
v_mfma_f32_16x16x32_bf16 v[92:95], a[56:59], a[112:115], v[92:95]
v_mul_f32 v78, v78, v202
v_mul_f32 v79, v79, v202
v_mfma_f32_16x16x32_bf16 v[92:95], a[60:63], a[132:135], v[92:95]
v_cvt_pk_bf16_f32 v76, v76, v77
v_cvt_pk_bf16_f32 v77, v78, v79
v_mfma_f32_16x16x32_bf16 v[124:127], a[32:35], v[32:35], 0
v_mfma_f32_16x16x32_bf16 v[124:127], a[36:39], v[48:51], v[124:127]
v_mul_f32 v108, v108, v203
v_mul_f32 v109, v109, v203
v_mfma_f32_16x16x32_bf16 v[124:127], a[40:43], v[64:67], v[124:127]
v_mul_f32 v110, v110, v203
v_mul_f32 v111, v111, v203
v_mfma_f32_16x16x32_bf16 v[124:127], a[44:47], v[80:83], v[124:127]
s_waitcnt vmcnt(10) lgkmcnt(0)
s_barrier
v_cvt_pk_bf16_f32 v108, v108, v109
ds_read_b64_tr_b16 a[0:1], v228 offset:0
v_mfma_f32_16x16x32_bf16 v[124:127], a[48:51], a[76:79], v[124:127]
ds_read_b64_tr_b16 a[2:3], v228 offset:2048
v_cvt_pk_bf16_f32 v109, v110, v111
v_mfma_f32_16x16x32_bf16 v[124:127], a[52:55], a[96:99], v[124:127]
s_add_u32 m0, s29, 65536
v_mul_f32 v140, v140, v204
v_mfma_f32_16x16x32_bf16 v[124:127], a[56:59], a[116:119], v[124:127]
buffer_load_dwordx4 v220, s[20:23], s69 offen offset:0 lds
v_mul_f32 v141, v141, v204
v_mfma_f32_16x16x32_bf16 v[124:127], a[60:63], a[136:139], v[124:127]
ds_read_b64_tr_b16 a[4:5], v228 offset:4096
ds_read_b64_tr_b16 a[6:7], v228 offset:6144
v_mfma_f32_16x16x32_bf16 v[156:159], a[32:35], v[96:99], 0
v_mul_f32 v142, v142, v204
ds_read_b64_tr_b16 a[8:9], v228 offset:8192
v_mfma_f32_16x16x32_bf16 v[156:159], a[36:39], v[112:115], v[156:159]
ds_read_b64_tr_b16 a[10:11], v228 offset:10240
v_mul_f32 v143, v143, v204
v_mfma_f32_16x16x32_bf16 v[156:159], a[40:43], v[128:131], v[156:159]
ds_read_b64_tr_b16 a[12:13], v228 offset:12288
ds_read_b64_tr_b16 a[14:15], v228 offset:14336
v_cvt_pk_bf16_f32 v140, v140, v141
v_cvt_pk_bf16_f32 v141, v142, v143
v_mfma_f32_16x16x32_bf16 v[156:159], a[44:47], v[144:147], v[156:159]
buffer_load_dwordx4 v221, s[20:23], s69 offen offset:1024 lds
ds_read_b64_tr_b16 a[16:17], v229 offset:0
v_mfma_f32_16x16x32_bf16 v[156:159], a[48:51], a[80:83], v[156:159]
ds_read_b64_tr_b16 a[18:19], v229 offset:2048
ds_read_b64_tr_b16 a[20:21], v229 offset:4096
v_mfma_f32_16x16x32_bf16 v[156:159], a[52:55], a[100:103], v[156:159]
ds_read_b64_tr_b16 a[22:23], v229 offset:6144
ds_read_b64_tr_b16 a[24:25], v229 offset:8192
v_mfma_f32_16x16x32_bf16 v[156:159], a[56:59], a[120:123], v[156:159]
v_mfma_f32_16x16x32_bf16 v[156:159], a[60:63], a[140:143], v[156:159]
s_waitcnt lgkmcnt(8)
v_mfma_f32_16x16x32_bf16 v[8:11], a[0:3], v[4:7], 0
buffer_load_dwordx4 v222, s[20:23], s69 offen offset:2048 lds
ds_read_b64_tr_b16 a[26:27], v229 offset:10240
v_mfma_f32_16x16x32_bf16 v[8:11], a[4:7], v[20:23], v[8:11]
ds_read_b64_tr_b16 a[28:29], v229 offset:12288
s_waitcnt lgkmcnt(7)
v_mfma_f32_16x16x32_bf16 v[8:11], a[8:11], v[36:39], v[8:11]
ds_read_b64_tr_b16 a[30:31], v229 offset:14336
v_mul_f32 v28, v28, v200
v_mfma_f32_16x16x32_bf16 v[8:11], a[12:15], v[52:55], v[8:11]
v_mul_f32 v29, v29, v200
s_waitcnt lgkmcnt(5)
v_mfma_f32_16x16x32_bf16 v[8:11], a[16:19], a[64:67], v[8:11]
v_mul_f32 v30, v30, v200
s_waitcnt lgkmcnt(3)
v_mfma_f32_16x16x32_bf16 v[8:11], a[20:23], a[84:87], v[8:11]
buffer_load_dwordx4 v223, s[20:23], s69 offen offset:3072 lds
v_mul_f32 v31, v31, v200
s_waitcnt lgkmcnt(2)
v_mfma_f32_16x16x32_bf16 v[8:11], a[24:27], a[104:107], v[8:11]
v_cvt_pk_bf16_f32 v14, v28, v29
v_cvt_pk_bf16_f32 v15, v30, v31
s_waitcnt lgkmcnt(0)
v_mfma_f32_16x16x32_bf16 v[8:11], a[28:31], a[124:127], v[8:11]
buffer_store_dwordx4 v[12:15], v230, s[24:27], s75 offen offset:0 sc1
v_mul_f32 v60, v60, v201
v_mfma_f32_16x16x32_bf16 v[40:43], a[0:3], v[68:71], 0
v_mul_f32 v61, v61, v201
v_mul_f32 v62, v62, v201
v_mfma_f32_16x16x32_bf16 v[40:43], a[4:7], v[84:87], v[40:43]
s_add_u32 m0, s29, 69632
s_add_u32 s47, s69, 28672
v_mul_f32 v63, v63, v201
v_mfma_f32_16x16x32_bf16 v[40:43], a[8:11], v[100:103], v[40:43]
buffer_load_dwordx4 v220, s[20:23], s47 offen offset:0 lds
v_cvt_pk_bf16_f32 v46, v60, v61
v_cvt_pk_bf16_f32 v47, v62, v63
v_mfma_f32_16x16x32_bf16 v[40:43], a[12:15], v[116:119], v[40:43]
buffer_store_dwordx4 v[44:47], v230, s[24:27], s75 offen offset:2048 sc1
v_mul_f32 v92, v92, v202
v_mfma_f32_16x16x32_bf16 v[40:43], a[16:19], a[68:71], v[40:43]
v_mul_f32 v93, v93, v202
v_mul_f32 v94, v94, v202
v_mfma_f32_16x16x32_bf16 v[40:43], a[20:23], a[88:91], v[40:43]
v_mul_f32 v95, v95, v202
v_cvt_pk_bf16_f32 v78, v92, v93
v_mfma_f32_16x16x32_bf16 v[40:43], a[24:27], a[108:111], v[40:43]
v_mul_f32 v124, v124, v203
v_cvt_pk_bf16_f32 v79, v94, v95
v_mfma_f32_16x16x32_bf16 v[40:43], a[28:31], a[128:131], v[40:43]
buffer_load_dwordx4 v221, s[20:23], s47 offen offset:1024 lds
v_mul_f32 v125, v125, v203
v_mfma_f32_16x16x32_bf16 v[72:75], a[0:3], v[132:135], 0
buffer_store_dwordx4 v[76:79], v231, s[24:27], s75 offen offset:0 sc1
v_mul_f32 v126, v126, v203
v_mfma_f32_16x16x32_bf16 v[72:75], a[4:7], v[148:151], v[72:75]
v_mul_f32 v127, v127, v203
v_cvt_pk_bf16_f32 v110, v124, v125
v_mfma_f32_16x16x32_bf16 v[72:75], a[8:11], v[0:3], v[72:75]
v_mul_f32 v156, v156, v204
v_cvt_pk_bf16_f32 v111, v126, v127
v_mfma_f32_16x16x32_bf16 v[72:75], a[12:15], v[16:19], v[72:75]
buffer_store_dwordx4 v[108:111], v231, s[24:27], s75 offen offset:2048 sc1
v_mul_f32 v157, v157, v204
v_mfma_f32_16x16x32_bf16 v[72:75], a[16:19], a[72:75], v[72:75]
buffer_load_dwordx4 v222, s[20:23], s47 offen offset:2048 lds
v_mul_f32 v158, v158, v204
v_mfma_f32_16x16x32_bf16 v[72:75], a[20:23], a[92:95], v[72:75]
v_mul_f32 v159, v159, v204
v_cvt_pk_bf16_f32 v142, v156, v157
v_mfma_f32_16x16x32_bf16 v[72:75], a[24:27], a[112:115], v[72:75]
v_cvt_pk_bf16_f32 v143, v158, v159
ds_read_b64_tr_b16 a[32:33], v228 offset:512
v_mfma_f32_16x16x32_bf16 v[72:75], a[28:31], a[132:135], v[72:75]
buffer_store_dwordx4 v[140:143], v232, s[24:27], s75 offen offset:0 sc1
ds_read_b64_tr_b16 a[34:35], v228 offset:2560
v_mfma_f32_16x16x32_bf16 v[104:107], a[0:3], v[32:35], 0
ds_read_b64_tr_b16 a[36:37], v228 offset:4608
ds_read_b64_tr_b16 a[38:39], v228 offset:6656
v_mfma_f32_16x16x32_bf16 v[104:107], a[4:7], v[48:51], v[104:107]
buffer_load_dwordx4 v223, s[20:23], s47 offen offset:3072 lds
ds_read_b64_tr_b16 a[40:41], v228 offset:8704
v_mfma_f32_16x16x32_bf16 v[104:107], a[8:11], v[64:67], v[104:107]
ds_read_b64_tr_b16 a[42:43], v228 offset:10752
ds_read_b64_tr_b16 a[44:45], v228 offset:12800
v_mfma_f32_16x16x32_bf16 v[104:107], a[12:15], v[80:83], v[104:107]
ds_read_b64_tr_b16 a[46:47], v228 offset:14848
ds_read_b64_tr_b16 a[48:49], v229 offset:512
v_mfma_f32_16x16x32_bf16 v[104:107], a[16:19], a[76:79], v[104:107]
ds_read_b64_tr_b16 a[50:51], v229 offset:2560
ds_read_b64_tr_b16 a[52:53], v229 offset:4608
v_mfma_f32_16x16x32_bf16 v[104:107], a[20:23], a[96:99], v[104:107]
ds_read_b64_tr_b16 a[54:55], v229 offset:6656
ds_read_b64_tr_b16 a[56:57], v229 offset:8704
v_mfma_f32_16x16x32_bf16 v[104:107], a[24:27], a[116:119], v[104:107]
s_add_u32 m0, s29, 98304
v_mfma_f32_16x16x32_bf16 v[104:107], a[28:31], a[136:139], v[104:107]
buffer_load_dwordx4 v220, s[20:23], s70 offen offset:0 lds
v_mfma_f32_16x16x32_bf16 v[136:139], a[0:3], v[96:99], 0
v_mfma_f32_16x16x32_bf16 v[136:139], a[4:7], v[112:115], v[136:139]
v_mfma_f32_16x16x32_bf16 v[136:139], a[8:11], v[128:131], v[136:139]
v_mfma_f32_16x16x32_bf16 v[136:139], a[12:15], v[144:147], v[136:139]
v_mfma_f32_16x16x32_bf16 v[136:139], a[16:19], a[80:83], v[136:139]
buffer_load_dwordx4 v221, s[20:23], s70 offen offset:1024 lds
v_mfma_f32_16x16x32_bf16 v[136:139], a[20:23], a[100:103], v[136:139]
v_mfma_f32_16x16x32_bf16 v[136:139], a[24:27], a[120:123], v[136:139]
v_mfma_f32_16x16x32_bf16 v[136:139], a[28:31], a[140:143], v[136:139]
s_waitcnt lgkmcnt(0)
v_mfma_f32_16x16x32_bf16 v[24:27], a[32:35], v[4:7], 0
ds_read_b64_tr_b16 a[58:59], v229 offset:10752
ds_read_b64_tr_b16 a[60:61], v229 offset:12800
v_mfma_f32_16x16x32_bf16 v[24:27], a[36:39], v[20:23], v[24:27]
buffer_load_dwordx4 v222, s[20:23], s70 offen offset:2048 lds
ds_read_b64_tr_b16 a[62:63], v229 offset:14848
v_mfma_f32_16x16x32_bf16 v[24:27], a[40:43], v[36:39], v[24:27]
v_mul_f32 v8, v8, v200
v_mul_f32 v9, v9, v200
v_mfma_f32_16x16x32_bf16 v[24:27], a[44:47], v[52:55], v[24:27]
v_mul_f32 v10, v10, v200
v_mul_f32 v11, v11, v200
v_mfma_f32_16x16x32_bf16 v[24:27], a[48:51], a[64:67], v[24:27]
v_cvt_pk_bf16_f32 v8, v8, v9
v_cvt_pk_bf16_f32 v9, v10, v11
v_mfma_f32_16x16x32_bf16 v[24:27], a[52:55], a[84:87], v[24:27]
v_mul_f32 v40, v40, v201
s_waitcnt lgkmcnt(2)
v_mfma_f32_16x16x32_bf16 v[24:27], a[56:59], a[104:107], v[24:27]
buffer_load_dwordx4 v223, s[20:23], s70 offen offset:3072 lds
s_waitcnt lgkmcnt(0)
v_mfma_f32_16x16x32_bf16 v[24:27], a[60:63], a[124:127], v[24:27]
v_mul_f32 v41, v41, v201
v_mul_f32 v42, v42, v201
v_mfma_f32_16x16x32_bf16 v[56:59], a[32:35], v[68:71], 0
v_mul_f32 v43, v43, v201
v_cvt_pk_bf16_f32 v40, v40, v41
v_mfma_f32_16x16x32_bf16 v[56:59], a[36:39], v[84:87], v[56:59]
v_mul_f32 v72, v72, v202
v_cvt_pk_bf16_f32 v41, v42, v43
v_mfma_f32_16x16x32_bf16 v[56:59], a[40:43], v[100:103], v[56:59]
s_add_u32 m0, s29, 102400
s_add_u32 s47, s70, 28672
v_mfma_f32_16x16x32_bf16 v[56:59], a[44:47], v[116:119], v[56:59]
buffer_load_dwordx4 v220, s[20:23], s47 offen offset:0 lds
v_mul_f32 v73, v73, v202
v_mfma_f32_16x16x32_bf16 v[56:59], a[48:51], a[68:71], v[56:59]
v_mul_f32 v74, v74, v202
v_mul_f32 v75, v75, v202
v_mfma_f32_16x16x32_bf16 v[56:59], a[52:55], a[88:91], v[56:59]
v_cvt_pk_bf16_f32 v72, v72, v73
v_mul_f32 v104, v104, v203
v_mfma_f32_16x16x32_bf16 v[56:59], a[56:59], a[108:111], v[56:59]
v_cvt_pk_bf16_f32 v73, v74, v75
v_mul_f32 v105, v105, v203
v_mfma_f32_16x16x32_bf16 v[56:59], a[60:63], a[128:131], v[56:59]
v_mul_f32 v106, v106, v203
v_mul_f32 v107, v107, v203
v_mfma_f32_16x16x32_bf16 v[88:91], a[32:35], v[132:135], 0
buffer_load_dwordx4 v221, s[20:23], s47 offen offset:1024 lds
v_cvt_pk_bf16_f32 v104, v104, v105
v_mfma_f32_16x16x32_bf16 v[88:91], a[36:39], v[148:151], v[88:91]
v_mul_f32 v136, v136, v204
v_cvt_pk_bf16_f32 v105, v106, v107
v_mfma_f32_16x16x32_bf16 v[88:91], a[40:43], v[0:3], v[88:91]
v_mul_f32 v137, v137, v204
v_mul_f32 v138, v138, v204
v_mfma_f32_16x16x32_bf16 v[88:91], a[44:47], v[16:19], v[88:91]
v_mul_f32 v139, v139, v204
v_cvt_pk_bf16_f32 v136, v136, v137
v_mfma_f32_16x16x32_bf16 v[88:91], a[48:51], a[72:75], v[88:91]
v_cvt_pk_bf16_f32 v137, v138, v139
ds_read_b64_tr_b16 a[0:1], v224 offset:0
v_mfma_f32_16x16x32_bf16 v[88:91], a[52:55], a[92:95], v[88:91]
buffer_load_dwordx4 v222, s[20:23], s47 offen offset:2048 lds
ds_read_b64_tr_b16 a[2:3], v224 offset:2048
v_mfma_f32_16x16x32_bf16 v[88:91], a[56:59], a[112:115], v[88:91]
ds_read_b64_tr_b16 a[4:5], v224 offset:4096
ds_read_b64_tr_b16 a[6:7], v224 offset:6144
v_mfma_f32_16x16x32_bf16 v[88:91], a[60:63], a[132:135], v[88:91]
ds_read_b64_tr_b16 a[8:9], v224 offset:8192
ds_read_b64_tr_b16 a[10:11], v224 offset:10240
v_mfma_f32_16x16x32_bf16 v[120:123], a[32:35], v[32:35], 0
ds_read_b64_tr_b16 a[12:13], v224 offset:12288
ds_read_b64_tr_b16 a[14:15], v224 offset:14336
v_mfma_f32_16x16x32_bf16 v[120:123], a[36:39], v[48:51], v[120:123]
ds_read_b64_tr_b16 a[16:17], v225 offset:0
ds_read_b64_tr_b16 a[18:19], v225 offset:2048
v_mfma_f32_16x16x32_bf16 v[120:123], a[40:43], v[64:67], v[120:123]
buffer_load_dwordx4 v223, s[20:23], s47 offen offset:3072 lds
ds_read_b64_tr_b16 a[20:21], v225 offset:4096
v_mfma_f32_16x16x32_bf16 v[120:123], a[44:47], v[80:83], v[120:123]
ds_read_b64_tr_b16 a[22:23], v225 offset:6144
ds_read_b64_tr_b16 a[24:25], v225 offset:8192
v_mfma_f32_16x16x32_bf16 v[120:123], a[48:51], a[76:79], v[120:123]
v_mfma_f32_16x16x32_bf16 v[120:123], a[52:55], a[96:99], v[120:123]
v_mfma_f32_16x16x32_bf16 v[120:123], a[56:59], a[116:119], v[120:123]
v_mfma_f32_16x16x32_bf16 v[120:123], a[60:63], a[136:139], v[120:123]
v_mfma_f32_16x16x32_bf16 v[152:155], a[32:35], v[96:99], 0
v_mfma_f32_16x16x32_bf16 v[152:155], a[36:39], v[112:115], v[152:155]
v_mfma_f32_16x16x32_bf16 v[152:155], a[40:43], v[128:131], v[152:155]
v_mfma_f32_16x16x32_bf16 v[152:155], a[44:47], v[144:147], v[152:155]
v_mfma_f32_16x16x32_bf16 v[152:155], a[48:51], a[80:83], v[152:155]
v_mfma_f32_16x16x32_bf16 v[152:155], a[52:55], a[100:103], v[152:155]
v_mfma_f32_16x16x32_bf16 v[152:155], a[56:59], a[120:123], v[152:155]
v_mfma_f32_16x16x32_bf16 v[152:155], a[60:63], a[140:143], v[152:155]
s_waitcnt lgkmcnt(0)
v_mfma_f32_16x16x32_bf16 v[160:163], a[0:3], v[4:7], 0
ds_read_b64_tr_b16 a[26:27], v225 offset:10240
ds_read_b64_tr_b16 a[28:29], v225 offset:12288
v_mfma_f32_16x16x32_bf16 v[160:163], a[4:7], v[20:23], v[160:163]
ds_read_b64_tr_b16 a[30:31], v225 offset:14336
v_mul_f32 v24, v24, v200
v_mfma_f32_16x16x32_bf16 v[160:163], a[8:11], v[36:39], v[160:163]
v_mul_f32 v25, v25, v200
v_mul_f32 v26, v26, v200
v_mfma_f32_16x16x32_bf16 v[160:163], a[12:15], v[52:55], v[160:163]
v_mul_f32 v27, v27, v200
v_cvt_pk_bf16_f32 v10, v24, v25
v_mfma_f32_16x16x32_bf16 v[160:163], a[16:19], a[64:67], v[160:163]
v_cvt_pk_bf16_f32 v11, v26, v27
ds_read_b64_tr_b16 a[32:33], v224 offset:512
v_mfma_f32_16x16x32_bf16 v[160:163], a[20:23], a[84:87], v[160:163]
v_mul_f32 v56, v56, v201
s_waitcnt lgkmcnt(3)
v_mfma_f32_16x16x32_bf16 v[160:163], a[24:27], a[104:107], v[160:163]
v_mul_f32 v57, v57, v201
s_waitcnt lgkmcnt(1)
v_mfma_f32_16x16x32_bf16 v[160:163], a[28:31], a[124:127], v[160:163]
buffer_store_dwordx4 v[8:11], v230, s[24:27], s76 offen offset:0 sc1
v_mul_f32 v58, v58, v201
v_mfma_f32_16x16x32_bf16 v[168:171], a[0:3], v[68:71], 0
v_mul_f32 v59, v59, v201
v_cvt_pk_bf16_f32 v42, v56, v57
v_mfma_f32_16x16x32_bf16 v[168:171], a[4:7], v[84:87], v[168:171]
v_mul_f32 v88, v88, v202
v_cvt_pk_bf16_f32 v43, v58, v59
v_mfma_f32_16x16x32_bf16 v[168:171], a[8:11], v[100:103], v[168:171]
v_mul_f32 v89, v89, v202
v_mul_f32 v90, v90, v202
v_mfma_f32_16x16x32_bf16 v[168:171], a[12:15], v[116:119], v[168:171]
buffer_store_dwordx4 v[40:43], v230, s[24:27], s76 offen offset:2048 sc1
v_mul_f32 v91, v91, v202
v_mfma_f32_16x16x32_bf16 v[168:171], a[16:19], a[68:71], v[168:171]
v_cvt_pk_bf16_f32 v74, v88, v89
v_cvt_pk_bf16_f32 v75, v90, v91
v_mfma_f32_16x16x32_bf16 v[168:171], a[20:23], a[88:91], v[168:171]
v_mul_f32 v120, v120, v203
v_mul_f32 v121, v121, v203
v_mfma_f32_16x16x32_bf16 v[168:171], a[24:27], a[108:111], v[168:171]
v_mul_f32 v122, v122, v203
v_mul_f32 v123, v123, v203
v_mfma_f32_16x16x32_bf16 v[168:171], a[28:31], a[128:131], v[168:171]
buffer_store_dwordx4 v[72:75], v231, s[24:27], s76 offen offset:0 sc1
v_cvt_pk_bf16_f32 v106, v120, v121
v_mfma_f32_16x16x32_bf16 v[176:179], a[0:3], v[132:135], 0
v_cvt_pk_bf16_f32 v107, v122, v123
ds_read_b64_tr_b16 a[34:35], v224 offset:2560
v_mfma_f32_16x16x32_bf16 v[176:179], a[4:7], v[148:151], v[176:179]
v_mul_f32 v152, v152, v204
v_mul_f32 v153, v153, v204
v_mfma_f32_16x16x32_bf16 v[176:179], a[8:11], v[0:3], v[176:179]
v_mul_f32 v154, v154, v204
v_mul_f32 v155, v155, v204
v_mfma_f32_16x16x32_bf16 v[176:179], a[12:15], v[16:19], v[176:179]
buffer_store_dwordx4 v[104:107], v231, s[24:27], s76 offen offset:2048 sc1
v_cvt_pk_bf16_f32 v138, v152, v153
v_mfma_f32_16x16x32_bf16 v[176:179], a[16:19], a[72:75], v[176:179]
v_cvt_pk_bf16_f32 v139, v154, v155
ds_read_b64_tr_b16 a[36:37], v224 offset:4608
v_mfma_f32_16x16x32_bf16 v[176:179], a[20:23], a[92:95], v[176:179]
ds_read_b64_tr_b16 a[38:39], v224 offset:6656
ds_read_b64_tr_b16 a[40:41], v224 offset:8704
v_mfma_f32_16x16x32_bf16 v[176:179], a[24:27], a[112:115], v[176:179]
ds_read_b64_tr_b16 a[42:43], v224 offset:10752
ds_read_b64_tr_b16 a[44:45], v224 offset:12800
v_mfma_f32_16x16x32_bf16 v[176:179], a[28:31], a[132:135], v[176:179]
buffer_store_dwordx4 v[136:139], v232, s[24:27], s76 offen offset:0 sc1
ds_read_b64_tr_b16 a[46:47], v224 offset:14848
v_mfma_f32_16x16x32_bf16 v[184:187], a[0:3], v[32:35], 0
ds_read_b64_tr_b16 a[48:49], v225 offset:512
ds_read_b64_tr_b16 a[50:51], v225 offset:2560
v_mfma_f32_16x16x32_bf16 v[184:187], a[4:7], v[48:51], v[184:187]
ds_read_b64_tr_b16 a[52:53], v225 offset:4608
ds_read_b64_tr_b16 a[54:55], v225 offset:6656
v_mfma_f32_16x16x32_bf16 v[184:187], a[8:11], v[64:67], v[184:187]
ds_read_b64_tr_b16 a[56:57], v225 offset:8704
v_mfma_f32_16x16x32_bf16 v[184:187], a[12:15], v[80:83], v[184:187]
v_mfma_f32_16x16x32_bf16 v[184:187], a[16:19], a[76:79], v[184:187]
v_mfma_f32_16x16x32_bf16 v[184:187], a[20:23], a[96:99], v[184:187]
v_mfma_f32_16x16x32_bf16 v[184:187], a[24:27], a[116:119], v[184:187]
v_mfma_f32_16x16x32_bf16 v[184:187], a[28:31], a[136:139], v[184:187]
v_mfma_f32_16x16x32_bf16 v[192:195], a[0:3], v[96:99], 0
v_mfma_f32_16x16x32_bf16 v[192:195], a[4:7], v[112:115], v[192:195]
v_mfma_f32_16x16x32_bf16 v[192:195], a[8:11], v[128:131], v[192:195]
v_mfma_f32_16x16x32_bf16 v[192:195], a[12:15], v[144:147], v[192:195]
v_mfma_f32_16x16x32_bf16 v[192:195], a[16:19], a[80:83], v[192:195]
v_mfma_f32_16x16x32_bf16 v[192:195], a[20:23], a[100:103], v[192:195]
v_mfma_f32_16x16x32_bf16 v[192:195], a[24:27], a[120:123], v[192:195]
v_mfma_f32_16x16x32_bf16 v[192:195], a[28:31], a[140:143], v[192:195]
s_waitcnt lgkmcnt(0)
v_mfma_f32_16x16x32_bf16 v[164:167], a[32:35], v[4:7], 0
ds_read_b64_tr_b16 a[58:59], v225 offset:10752
ds_read_b64_tr_b16 a[60:61], v225 offset:12800
v_mfma_f32_16x16x32_bf16 v[164:167], a[36:39], v[20:23], v[164:167]
ds_read_b64_tr_b16 a[62:63], v225 offset:14848
v_mul_f32 v160, v160, v200
v_mfma_f32_16x16x32_bf16 v[164:167], a[40:43], v[36:39], v[164:167]
v_mul_f32 v161, v161, v200
v_mul_f32 v162, v162, v200
v_mfma_f32_16x16x32_bf16 v[164:167], a[44:47], v[52:55], v[164:167]
v_mul_f32 v163, v163, v200
v_cvt_pk_bf16_f32 v160, v160, v161
v_mfma_f32_16x16x32_bf16 v[164:167], a[48:51], a[64:67], v[164:167]
v_cvt_pk_bf16_f32 v161, v162, v163
v_mfma_f32_16x16x32_bf16 v[164:167], a[52:55], a[84:87], v[164:167]
v_mul_f32 v168, v168, v201
s_waitcnt lgkmcnt(2)
v_mfma_f32_16x16x32_bf16 v[164:167], a[56:59], a[104:107], v[164:167]
v_mul_f32 v169, v169, v201
s_waitcnt lgkmcnt(0)
v_mfma_f32_16x16x32_bf16 v[164:167], a[60:63], a[124:127], v[164:167]
v_mul_f32 v170, v170, v201
v_mul_f32 v171, v171, v201
v_mfma_f32_16x16x32_bf16 v[172:175], a[32:35], v[68:71], 0
v_cvt_pk_bf16_f32 v168, v168, v169
v_cvt_pk_bf16_f32 v169, v170, v171
v_mfma_f32_16x16x32_bf16 v[172:175], a[36:39], v[84:87], v[172:175]
v_mul_f32 v176, v176, v202
v_mul_f32 v177, v177, v202
v_mfma_f32_16x16x32_bf16 v[172:175], a[40:43], v[100:103], v[172:175]
v_mul_f32 v178, v178, v202
v_mul_f32 v179, v179, v202
v_mfma_f32_16x16x32_bf16 v[172:175], a[44:47], v[116:119], v[172:175]
v_cvt_pk_bf16_f32 v176, v176, v177
v_cvt_pk_bf16_f32 v177, v178, v179
v_mfma_f32_16x16x32_bf16 v[172:175], a[48:51], a[68:71], v[172:175]
v_mfma_f32_16x16x32_bf16 v[172:175], a[52:55], a[88:91], v[172:175]
v_mul_f32 v184, v184, v203
v_mul_f32 v185, v185, v203
v_mfma_f32_16x16x32_bf16 v[172:175], a[56:59], a[108:111], v[172:175]
v_mul_f32 v186, v186, v203
v_mul_f32 v187, v187, v203
v_mfma_f32_16x16x32_bf16 v[172:175], a[60:63], a[128:131], v[172:175]
v_cvt_pk_bf16_f32 v184, v184, v185
v_cvt_pk_bf16_f32 v185, v186, v187
v_mfma_f32_16x16x32_bf16 v[180:183], a[32:35], v[132:135], 0
v_mfma_f32_16x16x32_bf16 v[180:183], a[36:39], v[148:151], v[180:183]
v_mul_f32 v192, v192, v204
v_mul_f32 v193, v193, v204
v_mfma_f32_16x16x32_bf16 v[180:183], a[40:43], v[0:3], v[180:183]
v_mul_f32 v194, v194, v204
v_mul_f32 v195, v195, v204
v_mfma_f32_16x16x32_bf16 v[180:183], a[44:47], v[16:19], v[180:183]
v_cvt_pk_bf16_f32 v192, v192, v193
v_cvt_pk_bf16_f32 v193, v194, v195
v_mfma_f32_16x16x32_bf16 v[180:183], a[48:51], a[72:75], v[180:183]
v_mfma_f32_16x16x32_bf16 v[180:183], a[52:55], a[92:95], v[180:183]
v_mfma_f32_16x16x32_bf16 v[180:183], a[56:59], a[112:115], v[180:183]
v_mfma_f32_16x16x32_bf16 v[180:183], a[60:63], a[132:135], v[180:183]
v_mfma_f32_16x16x32_bf16 v[188:191], a[32:35], v[32:35], 0
v_mfma_f32_16x16x32_bf16 v[188:191], a[36:39], v[48:51], v[188:191]
v_mfma_f32_16x16x32_bf16 v[188:191], a[40:43], v[64:67], v[188:191]
v_mfma_f32_16x16x32_bf16 v[188:191], a[44:47], v[80:83], v[188:191]
s_waitcnt vmcnt(26)
s_barrier
ds_read_b64_tr_b16 a[0:1], v224 offset:32768
ds_read_b64_tr_b16 a[2:3], v224 offset:34816
v_mfma_f32_16x16x32_bf16 v[188:191], a[48:51], a[76:79], v[188:191]
ds_read_b64_tr_b16 a[4:5], v224 offset:36864
ds_read_b64_tr_b16 a[6:7], v224 offset:38912
v_mfma_f32_16x16x32_bf16 v[188:191], a[52:55], a[96:99], v[188:191]
ds_read_b64_tr_b16 a[8:9], v224 offset:40960
ds_read_b64_tr_b16 a[10:11], v224 offset:43008
v_mfma_f32_16x16x32_bf16 v[188:191], a[56:59], a[116:119], v[188:191]
ds_read_b64_tr_b16 a[12:13], v224 offset:45056
ds_read_b64_tr_b16 a[14:15], v224 offset:47104
v_mfma_f32_16x16x32_bf16 v[188:191], a[60:63], a[136:139], v[188:191]
ds_read_b64_tr_b16 a[16:17], v225 offset:32768
ds_read_b64_tr_b16 a[18:19], v225 offset:34816
v_mfma_f32_16x16x32_bf16 v[196:199], a[32:35], v[96:99], 0
ds_read_b64_tr_b16 a[20:21], v225 offset:36864
ds_read_b64_tr_b16 a[22:23], v225 offset:38912
v_mfma_f32_16x16x32_bf16 v[196:199], a[36:39], v[112:115], v[196:199]
ds_read_b64_tr_b16 a[24:25], v225 offset:40960
ds_write_b32 v234, v208
v_mfma_f32_16x16x32_bf16 v[196:199], a[40:43], v[128:131], v[196:199]
v_mfma_f32_16x16x32_bf16 v[196:199], a[44:47], v[144:147], v[196:199]
v_mfma_f32_16x16x32_bf16 v[196:199], a[48:51], a[80:83], v[196:199]
v_mfma_f32_16x16x32_bf16 v[196:199], a[52:55], a[100:103], v[196:199]
v_mfma_f32_16x16x32_bf16 v[196:199], a[56:59], a[120:123], v[196:199]
v_mfma_f32_16x16x32_bf16 v[196:199], a[60:63], a[140:143], v[196:199]
s_waitcnt lgkmcnt(2)
v_mfma_f32_16x16x32_bf16 v[12:15], a[0:3], v[4:7], 0
ds_read_b64_tr_b16 a[26:27], v225 offset:43008
ds_read_b64_tr_b16 a[28:29], v225 offset:45056
v_mfma_f32_16x16x32_bf16 v[12:15], a[4:7], v[20:23], v[12:15]
ds_read_b64_tr_b16 a[30:31], v225 offset:47104
v_mul_f32 v164, v164, v200
v_mfma_f32_16x16x32_bf16 v[12:15], a[8:11], v[36:39], v[12:15]
v_mul_f32 v165, v165, v200
v_mul_f32 v166, v166, v200
v_mfma_f32_16x16x32_bf16 v[12:15], a[12:15], v[52:55], v[12:15]
v_mul_f32 v167, v167, v200
v_cvt_pk_bf16_f32 v162, v164, v165
v_mfma_f32_16x16x32_bf16 v[12:15], a[16:19], a[64:67], v[12:15]
v_cvt_pk_bf16_f32 v163, v166, v167
ds_read_b64_tr_b16 a[32:33], v224 offset:33280
v_mfma_f32_16x16x32_bf16 v[12:15], a[20:23], a[84:87], v[12:15]
v_mul_f32 v172, v172, v201
s_waitcnt lgkmcnt(3)
v_mfma_f32_16x16x32_bf16 v[12:15], a[24:27], a[104:107], v[12:15]
v_mul_f32 v173, v173, v201
s_waitcnt lgkmcnt(1)
v_mfma_f32_16x16x32_bf16 v[12:15], a[28:31], a[124:127], v[12:15]
buffer_store_dwordx4 v[160:163], v230, s[24:27], s77 offen offset:0 sc1
v_mul_f32 v174, v174, v201
v_mfma_f32_16x16x32_bf16 v[44:47], a[0:3], v[68:71], 0
v_mul_f32 v175, v175, v201
v_cvt_pk_bf16_f32 v170, v172, v173
v_mfma_f32_16x16x32_bf16 v[44:47], a[4:7], v[84:87], v[44:47]
v_mul_f32 v180, v180, v202
v_cvt_pk_bf16_f32 v171, v174, v175
v_mfma_f32_16x16x32_bf16 v[44:47], a[8:11], v[100:103], v[44:47]
v_mul_f32 v181, v181, v202
v_mul_f32 v182, v182, v202
v_mfma_f32_16x16x32_bf16 v[44:47], a[12:15], v[116:119], v[44:47]
buffer_store_dwordx4 v[168:171], v230, s[24:27], s77 offen offset:2048 sc1
v_mul_f32 v183, v183, v202
v_mfma_f32_16x16x32_bf16 v[44:47], a[16:19], a[68:71], v[44:47]
v_cvt_pk_bf16_f32 v178, v180, v181
v_cvt_pk_bf16_f32 v179, v182, v183
v_mfma_f32_16x16x32_bf16 v[44:47], a[20:23], a[88:91], v[44:47]
v_mul_f32 v188, v188, v203
v_mul_f32 v189, v189, v203
v_mfma_f32_16x16x32_bf16 v[44:47], a[24:27], a[108:111], v[44:47]
v_mul_f32 v190, v190, v203
v_mul_f32 v191, v191, v203
v_mfma_f32_16x16x32_bf16 v[44:47], a[28:31], a[128:131], v[44:47]
buffer_store_dwordx4 v[176:179], v231, s[24:27], s77 offen offset:0 sc1
v_cvt_pk_bf16_f32 v186, v188, v189
v_mfma_f32_16x16x32_bf16 v[76:79], a[0:3], v[132:135], 0
v_cvt_pk_bf16_f32 v187, v190, v191
ds_read_b64_tr_b16 a[34:35], v224 offset:35328
v_mfma_f32_16x16x32_bf16 v[76:79], a[4:7], v[148:151], v[76:79]
v_mul_f32 v196, v196, v204
v_mul_f32 v197, v197, v204
v_mfma_f32_16x16x32_bf16 v[76:79], a[8:11], v[0:3], v[76:79]
v_mul_f32 v198, v198, v204
v_mul_f32 v199, v199, v204
v_mfma_f32_16x16x32_bf16 v[76:79], a[12:15], v[16:19], v[76:79]
buffer_store_dwordx4 v[184:187], v231, s[24:27], s77 offen offset:2048 sc1
v_cvt_pk_bf16_f32 v194, v196, v197
v_mfma_f32_16x16x32_bf16 v[76:79], a[16:19], a[72:75], v[76:79]
v_cvt_pk_bf16_f32 v195, v198, v199
ds_read_b64_tr_b16 a[36:37], v224 offset:37376
v_mfma_f32_16x16x32_bf16 v[76:79], a[20:23], a[92:95], v[76:79]
ds_read_b64_tr_b16 a[38:39], v224 offset:39424
ds_read_b64_tr_b16 a[40:41], v224 offset:41472
v_mfma_f32_16x16x32_bf16 v[76:79], a[24:27], a[112:115], v[76:79]
ds_read_b64_tr_b16 a[42:43], v224 offset:43520
ds_read_b64_tr_b16 a[44:45], v224 offset:45568
v_mfma_f32_16x16x32_bf16 v[76:79], a[28:31], a[132:135], v[76:79]
buffer_store_dwordx4 v[192:195], v232, s[24:27], s77 offen offset:0 sc1
ds_read_b64_tr_b16 a[46:47], v224 offset:47616
v_mfma_f32_16x16x32_bf16 v[108:111], a[0:3], v[32:35], 0
ds_read_b64_tr_b16 a[48:49], v225 offset:33280
ds_read_b64_tr_b16 a[50:51], v225 offset:35328
v_mfma_f32_16x16x32_bf16 v[108:111], a[4:7], v[48:51], v[108:111]
ds_read_b64_tr_b16 a[52:53], v225 offset:37376
ds_read_b64_tr_b16 a[54:55], v225 offset:39424
v_mfma_f32_16x16x32_bf16 v[108:111], a[8:11], v[64:67], v[108:111]
ds_read_b64_tr_b16 a[56:57], v225 offset:41472
v_mfma_f32_16x16x32_bf16 v[108:111], a[12:15], v[80:83], v[108:111]
v_mfma_f32_16x16x32_bf16 v[108:111], a[16:19], a[76:79], v[108:111]
v_mfma_f32_16x16x32_bf16 v[108:111], a[20:23], a[96:99], v[108:111]
v_mfma_f32_16x16x32_bf16 v[108:111], a[24:27], a[116:119], v[108:111]
v_mfma_f32_16x16x32_bf16 v[108:111], a[28:31], a[136:139], v[108:111]
v_mfma_f32_16x16x32_bf16 v[140:143], a[0:3], v[96:99], 0
v_mfma_f32_16x16x32_bf16 v[140:143], a[4:7], v[112:115], v[140:143]
v_mfma_f32_16x16x32_bf16 v[140:143], a[8:11], v[128:131], v[140:143]
v_mfma_f32_16x16x32_bf16 v[140:143], a[12:15], v[144:147], v[140:143]
v_mfma_f32_16x16x32_bf16 v[140:143], a[16:19], a[80:83], v[140:143]
v_mfma_f32_16x16x32_bf16 v[140:143], a[20:23], a[100:103], v[140:143]
v_mfma_f32_16x16x32_bf16 v[140:143], a[24:27], a[120:123], v[140:143]
v_mfma_f32_16x16x32_bf16 v[140:143], a[28:31], a[140:143], v[140:143]
s_waitcnt lgkmcnt(0)
v_mfma_f32_16x16x32_bf16 v[28:31], a[32:35], v[4:7], 0
ds_read_b64_tr_b16 a[58:59], v225 offset:43520
ds_read_b64_tr_b16 a[60:61], v225 offset:45568
v_mfma_f32_16x16x32_bf16 v[28:31], a[36:39], v[20:23], v[28:31]
ds_read_b64_tr_b16 a[62:63], v225 offset:47616
v_mul_f32 v12, v12, v200
v_mfma_f32_16x16x32_bf16 v[28:31], a[40:43], v[36:39], v[28:31]
v_mul_f32 v13, v13, v200
v_mul_f32 v14, v14, v200
v_mfma_f32_16x16x32_bf16 v[28:31], a[44:47], v[52:55], v[28:31]
v_mul_f32 v15, v15, v200
v_cvt_pk_bf16_f32 v12, v12, v13
v_mfma_f32_16x16x32_bf16 v[28:31], a[48:51], a[64:67], v[28:31]
v_cvt_pk_bf16_f32 v13, v14, v15
v_mfma_f32_16x16x32_bf16 v[28:31], a[52:55], a[84:87], v[28:31]
v_mul_f32 v44, v44, v201
s_waitcnt lgkmcnt(2)
v_mfma_f32_16x16x32_bf16 v[28:31], a[56:59], a[104:107], v[28:31]
v_mul_f32 v45, v45, v201
s_waitcnt lgkmcnt(0)
v_mfma_f32_16x16x32_bf16 v[28:31], a[60:63], a[124:127], v[28:31]
v_mul_f32 v46, v46, v201
v_mul_f32 v47, v47, v201
v_mfma_f32_16x16x32_bf16 v[60:63], a[32:35], v[68:71], 0
v_cvt_pk_bf16_f32 v44, v44, v45
v_cvt_pk_bf16_f32 v45, v46, v47
v_mfma_f32_16x16x32_bf16 v[60:63], a[36:39], v[84:87], v[60:63]
v_mul_f32 v76, v76, v202
v_mul_f32 v77, v77, v202
v_mfma_f32_16x16x32_bf16 v[60:63], a[40:43], v[100:103], v[60:63]
v_mul_f32 v78, v78, v202
v_mul_f32 v79, v79, v202
v_mfma_f32_16x16x32_bf16 v[60:63], a[44:47], v[116:119], v[60:63]
v_cvt_pk_bf16_f32 v76, v76, v77
v_cvt_pk_bf16_f32 v77, v78, v79
v_mfma_f32_16x16x32_bf16 v[60:63], a[48:51], a[68:71], v[60:63]
v_mfma_f32_16x16x32_bf16 v[60:63], a[52:55], a[88:91], v[60:63]
v_mul_f32 v108, v108, v203
v_mul_f32 v109, v109, v203
v_mfma_f32_16x16x32_bf16 v[60:63], a[56:59], a[108:111], v[60:63]
v_mul_f32 v110, v110, v203
v_mul_f32 v111, v111, v203
v_mfma_f32_16x16x32_bf16 v[60:63], a[60:63], a[128:131], v[60:63]
v_cvt_pk_bf16_f32 v108, v108, v109
v_cvt_pk_bf16_f32 v109, v110, v111
v_mfma_f32_16x16x32_bf16 v[92:95], a[32:35], v[132:135], 0
v_mfma_f32_16x16x32_bf16 v[92:95], a[36:39], v[148:151], v[92:95]
v_mul_f32 v140, v140, v204
v_mul_f32 v141, v141, v204
v_mfma_f32_16x16x32_bf16 v[92:95], a[40:43], v[0:3], v[92:95]
v_mul_f32 v142, v142, v204
v_mul_f32 v143, v143, v204
v_mfma_f32_16x16x32_bf16 v[92:95], a[44:47], v[16:19], v[92:95]
v_cvt_pk_bf16_f32 v140, v140, v141
v_cvt_pk_bf16_f32 v141, v142, v143
v_mfma_f32_16x16x32_bf16 v[92:95], a[48:51], a[72:75], v[92:95]
v_mfma_f32_16x16x32_bf16 v[92:95], a[52:55], a[92:95], v[92:95]
v_mfma_f32_16x16x32_bf16 v[92:95], a[56:59], a[112:115], v[92:95]
v_mfma_f32_16x16x32_bf16 v[92:95], a[60:63], a[132:135], v[92:95]
v_mfma_f32_16x16x32_bf16 v[124:127], a[32:35], v[32:35], 0
v_mfma_f32_16x16x32_bf16 v[124:127], a[36:39], v[48:51], v[124:127]
v_mfma_f32_16x16x32_bf16 v[124:127], a[40:43], v[64:67], v[124:127]
v_mfma_f32_16x16x32_bf16 v[124:127], a[44:47], v[80:83], v[124:127]
s_waitcnt vmcnt(10)
s_barrier
ds_read_b64_tr_b16 a[0:1], v226 offset:0
ds_read_b64_tr_b16 a[2:3], v226 offset:2048
v_mfma_f32_16x16x32_bf16 v[124:127], a[48:51], a[76:79], v[124:127]
ds_read_b64_tr_b16 a[4:5], v226 offset:4096
ds_read_b64_tr_b16 a[6:7], v226 offset:6144
v_mfma_f32_16x16x32_bf16 v[124:127], a[52:55], a[96:99], v[124:127]
ds_read_b64_tr_b16 a[8:9], v226 offset:8192
ds_read_b64_tr_b16 a[10:11], v226 offset:10240
v_mfma_f32_16x16x32_bf16 v[124:127], a[56:59], a[116:119], v[124:127]
ds_read_b64_tr_b16 a[12:13], v226 offset:12288
ds_read_b64_tr_b16 a[14:15], v226 offset:14336
v_mfma_f32_16x16x32_bf16 v[124:127], a[60:63], a[136:139], v[124:127]
ds_read_b64_tr_b16 a[16:17], v227 offset:0
ds_read_b64_tr_b16 a[18:19], v227 offset:2048
v_mfma_f32_16x16x32_bf16 v[156:159], a[32:35], v[96:99], 0
ds_read_b64_tr_b16 a[20:21], v227 offset:4096
ds_read_b64_tr_b16 a[22:23], v227 offset:6144
v_mfma_f32_16x16x32_bf16 v[156:159], a[36:39], v[112:115], v[156:159]
ds_read_b64_tr_b16 a[24:25], v227 offset:8192
ds_read_b32 v209, v236
v_mfma_f32_16x16x32_bf16 v[156:159], a[40:43], v[128:131], v[156:159]
v_mfma_f32_16x16x32_bf16 v[156:159], a[44:47], v[144:147], v[156:159]
v_mfma_f32_16x16x32_bf16 v[156:159], a[48:51], a[80:83], v[156:159]
v_mfma_f32_16x16x32_bf16 v[156:159], a[52:55], a[100:103], v[156:159]
v_mfma_f32_16x16x32_bf16 v[156:159], a[56:59], a[120:123], v[156:159]
v_mfma_f32_16x16x32_bf16 v[156:159], a[60:63], a[140:143], v[156:159]
s_waitcnt lgkmcnt(2)
v_mfma_f32_16x16x32_bf16 v[8:11], a[0:3], v[4:7], 0
ds_read_b64_tr_b16 a[26:27], v227 offset:10240
ds_read_b64_tr_b16 a[28:29], v227 offset:12288
v_mfma_f32_16x16x32_bf16 v[8:11], a[4:7], v[20:23], v[8:11]
ds_read_b64_tr_b16 a[30:31], v227 offset:14336
v_mul_f32 v28, v28, v200
v_mfma_f32_16x16x32_bf16 v[8:11], a[8:11], v[36:39], v[8:11]
v_mul_f32 v29, v29, v200
v_mul_f32 v30, v30, v200
v_mfma_f32_16x16x32_bf16 v[8:11], a[12:15], v[52:55], v[8:11]
v_mul_f32 v31, v31, v200
v_cvt_pk_bf16_f32 v14, v28, v29
v_mfma_f32_16x16x32_bf16 v[8:11], a[16:19], a[64:67], v[8:11]
v_cvt_pk_bf16_f32 v15, v30, v31
ds_read_b64_tr_b16 a[32:33], v226 offset:512
v_mfma_f32_16x16x32_bf16 v[8:11], a[20:23], a[84:87], v[8:11]
v_mul_f32 v60, v60, v201
s_waitcnt lgkmcnt(3)
v_mfma_f32_16x16x32_bf16 v[8:11], a[24:27], a[104:107], v[8:11]
v_mul_f32 v61, v61, v201
s_waitcnt lgkmcnt(1)
v_mfma_f32_16x16x32_bf16 v[8:11], a[28:31], a[124:127], v[8:11]
buffer_store_dwordx4 v[12:15], v230, s[24:27], s78 offen offset:0 sc1
v_mul_f32 v62, v62, v201
v_mfma_f32_16x16x32_bf16 v[40:43], a[0:3], v[68:71], 0
v_mul_f32 v63, v63, v201
v_cvt_pk_bf16_f32 v46, v60, v61
v_mfma_f32_16x16x32_bf16 v[40:43], a[4:7], v[84:87], v[40:43]
v_mul_f32 v92, v92, v202
v_cvt_pk_bf16_f32 v47, v62, v63
v_mfma_f32_16x16x32_bf16 v[40:43], a[8:11], v[100:103], v[40:43]
v_mul_f32 v93, v93, v202
v_mul_f32 v94, v94, v202
v_mfma_f32_16x16x32_bf16 v[40:43], a[12:15], v[116:119], v[40:43]
buffer_store_dwordx4 v[44:47], v230, s[24:27], s78 offen offset:2048 sc1
v_mul_f32 v95, v95, v202
v_mfma_f32_16x16x32_bf16 v[40:43], a[16:19], a[68:71], v[40:43]
v_cvt_pk_bf16_f32 v78, v92, v93
v_cvt_pk_bf16_f32 v79, v94, v95
v_mfma_f32_16x16x32_bf16 v[40:43], a[20:23], a[88:91], v[40:43]
v_mul_f32 v124, v124, v203
v_mul_f32 v125, v125, v203
v_mfma_f32_16x16x32_bf16 v[40:43], a[24:27], a[108:111], v[40:43]
v_mul_f32 v126, v126, v203
v_mul_f32 v127, v127, v203
v_mfma_f32_16x16x32_bf16 v[40:43], a[28:31], a[128:131], v[40:43]
buffer_store_dwordx4 v[76:79], v231, s[24:27], s78 offen offset:0 sc1
v_cvt_pk_bf16_f32 v110, v124, v125
v_mfma_f32_16x16x32_bf16 v[72:75], a[0:3], v[132:135], 0
v_cvt_pk_bf16_f32 v111, v126, v127
ds_read_b64_tr_b16 a[34:35], v226 offset:2560
v_mfma_f32_16x16x32_bf16 v[72:75], a[4:7], v[148:151], v[72:75]
v_mul_f32 v156, v156, v204
v_mul_f32 v157, v157, v204
v_mfma_f32_16x16x32_bf16 v[72:75], a[8:11], v[0:3], v[72:75]
v_mul_f32 v158, v158, v204
v_mul_f32 v159, v159, v204
v_mfma_f32_16x16x32_bf16 v[72:75], a[12:15], v[16:19], v[72:75]
buffer_store_dwordx4 v[108:111], v231, s[24:27], s78 offen offset:2048 sc1
v_cvt_pk_bf16_f32 v142, v156, v157
v_mfma_f32_16x16x32_bf16 v[72:75], a[16:19], a[72:75], v[72:75]
v_cvt_pk_bf16_f32 v143, v158, v159
ds_read_b64_tr_b16 a[36:37], v226 offset:4608
v_mfma_f32_16x16x32_bf16 v[72:75], a[20:23], a[92:95], v[72:75]
ds_read_b64_tr_b16 a[38:39], v226 offset:6656
ds_read_b64_tr_b16 a[40:41], v226 offset:8704
v_mfma_f32_16x16x32_bf16 v[72:75], a[24:27], a[112:115], v[72:75]
ds_read_b64_tr_b16 a[42:43], v226 offset:10752
ds_read_b64_tr_b16 a[44:45], v226 offset:12800
v_mfma_f32_16x16x32_bf16 v[72:75], a[28:31], a[132:135], v[72:75]
buffer_store_dwordx4 v[140:143], v232, s[24:27], s78 offen offset:0 sc1
ds_read_b64_tr_b16 a[46:47], v226 offset:14848
v_mfma_f32_16x16x32_bf16 v[104:107], a[0:3], v[32:35], 0
v_add_f32 v208, v208, v209
ds_read_b64_tr_b16 a[48:49], v227 offset:512
v_mfma_f32_16x16x32_bf16 v[104:107], a[4:7], v[48:51], v[104:107]
ds_read_b64_tr_b16 a[50:51], v227 offset:2560
ds_read_b64_tr_b16 a[52:53], v227 offset:4608
v_mfma_f32_16x16x32_bf16 v[104:107], a[8:11], v[64:67], v[104:107]
ds_read_b64_tr_b16 a[54:55], v227 offset:6656
ds_read_b64_tr_b16 a[56:57], v227 offset:8704
v_mfma_f32_16x16x32_bf16 v[104:107], a[12:15], v[80:83], v[104:107]
v_cmp_nge_f32 vcc, s32, v208
s_cbranch_vccnz L_redo
L_redo_ret:
v_mfma_f32_16x16x32_bf16 v[104:107], a[16:19], a[76:79], v[104:107]
v_mfma_f32_16x16x32_bf16 v[104:107], a[20:23], a[96:99], v[104:107]
v_mfma_f32_16x16x32_bf16 v[104:107], a[24:27], a[116:119], v[104:107]
v_mfma_f32_16x16x32_bf16 v[104:107], a[28:31], a[136:139], v[104:107]
v_mfma_f32_16x16x32_bf16 v[136:139], a[0:3], v[96:99], 0
v_mfma_f32_16x16x32_bf16 v[136:139], a[4:7], v[112:115], v[136:139]
v_mfma_f32_16x16x32_bf16 v[136:139], a[8:11], v[128:131], v[136:139]
v_mfma_f32_16x16x32_bf16 v[136:139], a[12:15], v[144:147], v[136:139]
v_mfma_f32_16x16x32_bf16 v[136:139], a[16:19], a[80:83], v[136:139]
v_mfma_f32_16x16x32_bf16 v[136:139], a[20:23], a[100:103], v[136:139]
v_mfma_f32_16x16x32_bf16 v[136:139], a[24:27], a[120:123], v[136:139]
v_mfma_f32_16x16x32_bf16 v[136:139], a[28:31], a[140:143], v[136:139]
s_waitcnt lgkmcnt(0)
v_mfma_f32_16x16x32_bf16 v[24:27], a[32:35], v[4:7], 0
ds_read_b64_tr_b16 a[58:59], v227 offset:10752
ds_read_b64_tr_b16 a[60:61], v227 offset:12800
v_mfma_f32_16x16x32_bf16 v[24:27], a[36:39], v[20:23], v[24:27]
ds_read_b64_tr_b16 a[62:63], v227 offset:14848
v_mul_f32 v8, v8, v200
v_mfma_f32_16x16x32_bf16 v[24:27], a[40:43], v[36:39], v[24:27]
v_mul_f32 v9, v9, v200
v_mul_f32 v10, v10, v200
v_mfma_f32_16x16x32_bf16 v[24:27], a[44:47], v[52:55], v[24:27]
v_mul_f32 v11, v11, v200
v_cvt_pk_bf16_f32 v8, v8, v9
v_mfma_f32_16x16x32_bf16 v[24:27], a[48:51], a[64:67], v[24:27]
v_cvt_pk_bf16_f32 v9, v10, v11
ds_read_b64_tr_b16 a[0:1], v226 offset:32768
v_mfma_f32_16x16x32_bf16 v[24:27], a[52:55], a[84:87], v[24:27]
v_mul_f32 v40, v40, v201
s_waitcnt lgkmcnt(3)
v_mfma_f32_16x16x32_bf16 v[24:27], a[56:59], a[104:107], v[24:27]
v_mul_f32 v41, v41, v201
s_waitcnt lgkmcnt(1)
v_mfma_f32_16x16x32_bf16 v[24:27], a[60:63], a[124:127], v[24:27]
v_mul_f32 v42, v42, v201
v_mul_f32 v43, v43, v201
v_mfma_f32_16x16x32_bf16 v[56:59], a[32:35], v[68:71], 0
v_cvt_pk_bf16_f32 v40, v40, v41
v_cvt_pk_bf16_f32 v41, v42, v43
v_mfma_f32_16x16x32_bf16 v[56:59], a[36:39], v[84:87], v[56:59]
v_mul_f32 v72, v72, v202
v_mul_f32 v73, v73, v202
v_mfma_f32_16x16x32_bf16 v[56:59], a[40:43], v[100:103], v[56:59]
v_mul_f32 v74, v74, v202
v_mul_f32 v75, v75, v202
v_mfma_f32_16x16x32_bf16 v[56:59], a[44:47], v[116:119], v[56:59]
v_cvt_pk_bf16_f32 v72, v72, v73
v_cvt_pk_bf16_f32 v73, v74, v75
v_mfma_f32_16x16x32_bf16 v[56:59], a[48:51], a[68:71], v[56:59]
ds_read_b64_tr_b16 a[2:3], v226 offset:34816
ds_read_b64_tr_b16 a[4:5], v226 offset:36864
v_mfma_f32_16x16x32_bf16 v[56:59], a[52:55], a[88:91], v[56:59]
v_mul_f32 v104, v104, v203
v_mul_f32 v105, v105, v203
v_mfma_f32_16x16x32_bf16 v[56:59], a[56:59], a[108:111], v[56:59]
v_mul_f32 v106, v106, v203
v_mul_f32 v107, v107, v203
v_mfma_f32_16x16x32_bf16 v[56:59], a[60:63], a[128:131], v[56:59]
v_cvt_pk_bf16_f32 v104, v104, v105
v_cvt_pk_bf16_f32 v105, v106, v107
v_mfma_f32_16x16x32_bf16 v[88:91], a[32:35], v[132:135], 0
ds_read_b64_tr_b16 a[6:7], v226 offset:38912
ds_read_b64_tr_b16 a[8:9], v226 offset:40960
v_mfma_f32_16x16x32_bf16 v[88:91], a[36:39], v[148:151], v[88:91]
v_mul_f32 v136, v136, v204
v_mul_f32 v137, v137, v204
v_mfma_f32_16x16x32_bf16 v[88:91], a[40:43], v[0:3], v[88:91]
v_mul_f32 v138, v138, v204
v_mul_f32 v139, v139, v204
v_mfma_f32_16x16x32_bf16 v[88:91], a[44:47], v[16:19], v[88:91]
v_cvt_pk_bf16_f32 v136, v136, v137
v_cvt_pk_bf16_f32 v137, v138, v139
v_mfma_f32_16x16x32_bf16 v[88:91], a[48:51], a[72:75], v[88:91]
ds_read_b64_tr_b16 a[10:11], v226 offset:43008
ds_read_b64_tr_b16 a[12:13], v226 offset:45056
v_mfma_f32_16x16x32_bf16 v[88:91], a[52:55], a[92:95], v[88:91]
ds_read_b64_tr_b16 a[14:15], v226 offset:47104
ds_read_b64_tr_b16 a[16:17], v227 offset:32768
v_mfma_f32_16x16x32_bf16 v[88:91], a[56:59], a[112:115], v[88:91]
ds_read_b64_tr_b16 a[18:19], v227 offset:34816
ds_read_b64_tr_b16 a[20:21], v227 offset:36864
v_mfma_f32_16x16x32_bf16 v[88:91], a[60:63], a[132:135], v[88:91]
ds_read_b64_tr_b16 a[22:23], v227 offset:38912
ds_read_b64_tr_b16 a[24:25], v227 offset:40960
v_mfma_f32_16x16x32_bf16 v[120:123], a[32:35], v[32:35], 0
v_mfma_f32_16x16x32_bf16 v[120:123], a[36:39], v[48:51], v[120:123]
v_mfma_f32_16x16x32_bf16 v[120:123], a[40:43], v[64:67], v[120:123]
v_mfma_f32_16x16x32_bf16 v[120:123], a[44:47], v[80:83], v[120:123]
v_mfma_f32_16x16x32_bf16 v[120:123], a[48:51], a[76:79], v[120:123]
v_mfma_f32_16x16x32_bf16 v[120:123], a[52:55], a[96:99], v[120:123]
v_mfma_f32_16x16x32_bf16 v[120:123], a[56:59], a[116:119], v[120:123]
v_mfma_f32_16x16x32_bf16 v[120:123], a[60:63], a[136:139], v[120:123]
v_mfma_f32_16x16x32_bf16 v[152:155], a[32:35], v[96:99], 0
v_mfma_f32_16x16x32_bf16 v[152:155], a[36:39], v[112:115], v[152:155]
v_mfma_f32_16x16x32_bf16 v[152:155], a[40:43], v[128:131], v[152:155]
v_mfma_f32_16x16x32_bf16 v[152:155], a[44:47], v[144:147], v[152:155]
v_mfma_f32_16x16x32_bf16 v[152:155], a[48:51], a[80:83], v[152:155]
v_mfma_f32_16x16x32_bf16 v[152:155], a[52:55], a[100:103], v[152:155]
v_mfma_f32_16x16x32_bf16 v[152:155], a[56:59], a[120:123], v[152:155]
v_mfma_f32_16x16x32_bf16 v[152:155], a[60:63], a[140:143], v[152:155]
s_waitcnt lgkmcnt(0)
v_mfma_f32_16x16x32_bf16 v[160:163], a[0:3], v[4:7], 0
ds_read_b64_tr_b16 a[26:27], v227 offset:43008
ds_read_b64_tr_b16 a[28:29], v227 offset:45056
v_mfma_f32_16x16x32_bf16 v[160:163], a[4:7], v[20:23], v[160:163]
ds_read_b64_tr_b16 a[30:31], v227 offset:47104
v_mul_f32 v24, v24, v200
v_mfma_f32_16x16x32_bf16 v[160:163], a[8:11], v[36:39], v[160:163]
v_mul_f32 v25, v25, v200
v_mul_f32 v26, v26, v200
v_mfma_f32_16x16x32_bf16 v[160:163], a[12:15], v[52:55], v[160:163]
v_mul_f32 v27, v27, v200
v_cvt_pk_bf16_f32 v10, v24, v25
v_mfma_f32_16x16x32_bf16 v[160:163], a[16:19], a[64:67], v[160:163]
v_cvt_pk_bf16_f32 v11, v26, v27
ds_read_b64_tr_b16 a[32:33], v226 offset:33280
v_mfma_f32_16x16x32_bf16 v[160:163], a[20:23], a[84:87], v[160:163]
v_mul_f32 v56, v56, v201
s_waitcnt lgkmcnt(3)
v_mfma_f32_16x16x32_bf16 v[160:163], a[24:27], a[104:107], v[160:163]
v_mul_f32 v57, v57, v201
s_waitcnt lgkmcnt(1)
v_mfma_f32_16x16x32_bf16 v[160:163], a[28:31], a[124:127], v[160:163]
buffer_store_dwordx4 v[8:11], v230, s[24:27], s79 offen offset:0 sc1
v_mul_f32 v58, v58, v201
v_mfma_f32_16x16x32_bf16 v[168:171], a[0:3], v[68:71], 0
v_mul_f32 v59, v59, v201
v_cvt_pk_bf16_f32 v42, v56, v57
v_mfma_f32_16x16x32_bf16 v[168:171], a[4:7], v[84:87], v[168:171]
v_mul_f32 v88, v88, v202
v_cvt_pk_bf16_f32 v43, v58, v59
v_mfma_f32_16x16x32_bf16 v[168:171], a[8:11], v[100:103], v[168:171]
v_mul_f32 v89, v89, v202
v_mul_f32 v90, v90, v202
v_mfma_f32_16x16x32_bf16 v[168:171], a[12:15], v[116:119], v[168:171]
buffer_store_dwordx4 v[40:43], v230, s[24:27], s79 offen offset:2048 sc1
v_mul_f32 v91, v91, v202
v_mfma_f32_16x16x32_bf16 v[168:171], a[16:19], a[68:71], v[168:171]
v_cvt_pk_bf16_f32 v74, v88, v89
v_cvt_pk_bf16_f32 v75, v90, v91
v_mfma_f32_16x16x32_bf16 v[168:171], a[20:23], a[88:91], v[168:171]
v_mul_f32 v120, v120, v203
v_mul_f32 v121, v121, v203
v_mfma_f32_16x16x32_bf16 v[168:171], a[24:27], a[108:111], v[168:171]
v_mul_f32 v122, v122, v203
v_mul_f32 v123, v123, v203
v_mfma_f32_16x16x32_bf16 v[168:171], a[28:31], a[128:131], v[168:171]
buffer_store_dwordx4 v[72:75], v231, s[24:27], s79 offen offset:0 sc1
v_cvt_pk_bf16_f32 v106, v120, v121
v_mfma_f32_16x16x32_bf16 v[176:179], a[0:3], v[132:135], 0
v_cvt_pk_bf16_f32 v107, v122, v123
ds_read_b64_tr_b16 a[34:35], v226 offset:35328
v_mfma_f32_16x16x32_bf16 v[176:179], a[4:7], v[148:151], v[176:179]
v_mul_f32 v152, v152, v204
v_mul_f32 v153, v153, v204
v_mfma_f32_16x16x32_bf16 v[176:179], a[8:11], v[0:3], v[176:179]
v_mul_f32 v154, v154, v204
v_mul_f32 v155, v155, v204
v_mfma_f32_16x16x32_bf16 v[176:179], a[12:15], v[16:19], v[176:179]
buffer_store_dwordx4 v[104:107], v231, s[24:27], s79 offen offset:2048 sc1
v_cvt_pk_bf16_f32 v138, v152, v153
v_mfma_f32_16x16x32_bf16 v[176:179], a[16:19], a[72:75], v[176:179]
v_cvt_pk_bf16_f32 v139, v154, v155
ds_read_b64_tr_b16 a[36:37], v226 offset:37376
v_mfma_f32_16x16x32_bf16 v[176:179], a[20:23], a[92:95], v[176:179]
ds_read_b64_tr_b16 a[38:39], v226 offset:39424
ds_read_b64_tr_b16 a[40:41], v226 offset:41472
v_mfma_f32_16x16x32_bf16 v[176:179], a[24:27], a[112:115], v[176:179]
ds_read_b64_tr_b16 a[42:43], v226 offset:43520
ds_read_b64_tr_b16 a[44:45], v226 offset:45568
v_mfma_f32_16x16x32_bf16 v[176:179], a[28:31], a[132:135], v[176:179]
buffer_store_dwordx4 v[136:139], v232, s[24:27], s79 offen offset:0 sc1
ds_read_b64_tr_b16 a[46:47], v226 offset:47616
v_mfma_f32_16x16x32_bf16 v[184:187], a[0:3], v[32:35], 0
ds_read_b64_tr_b16 a[48:49], v227 offset:33280
ds_read_b64_tr_b16 a[50:51], v227 offset:35328
v_mfma_f32_16x16x32_bf16 v[184:187], a[4:7], v[48:51], v[184:187]
ds_read_b64_tr_b16 a[52:53], v227 offset:37376
ds_read_b64_tr_b16 a[54:55], v227 offset:39424
v_mfma_f32_16x16x32_bf16 v[184:187], a[8:11], v[64:67], v[184:187]
ds_read_b64_tr_b16 a[56:57], v227 offset:41472
v_mfma_f32_16x16x32_bf16 v[184:187], a[12:15], v[80:83], v[184:187]
v_mfma_f32_16x16x32_bf16 v[184:187], a[16:19], a[76:79], v[184:187]
v_mfma_f32_16x16x32_bf16 v[184:187], a[20:23], a[96:99], v[184:187]
v_mfma_f32_16x16x32_bf16 v[184:187], a[24:27], a[116:119], v[184:187]
v_mfma_f32_16x16x32_bf16 v[184:187], a[28:31], a[136:139], v[184:187]
v_mfma_f32_16x16x32_bf16 v[192:195], a[0:3], v[96:99], 0
v_mfma_f32_16x16x32_bf16 v[192:195], a[4:7], v[112:115], v[192:195]
v_mfma_f32_16x16x32_bf16 v[192:195], a[8:11], v[128:131], v[192:195]
v_mfma_f32_16x16x32_bf16 v[192:195], a[12:15], v[144:147], v[192:195]
v_mfma_f32_16x16x32_bf16 v[192:195], a[16:19], a[80:83], v[192:195]
v_mfma_f32_16x16x32_bf16 v[192:195], a[20:23], a[100:103], v[192:195]
v_mfma_f32_16x16x32_bf16 v[192:195], a[24:27], a[120:123], v[192:195]
v_mfma_f32_16x16x32_bf16 v[192:195], a[28:31], a[140:143], v[192:195]
s_waitcnt lgkmcnt(0)
v_mfma_f32_16x16x32_bf16 v[164:167], a[32:35], v[4:7], 0
ds_read_b64_tr_b16 a[58:59], v227 offset:43520
ds_read_b64_tr_b16 a[60:61], v227 offset:45568
v_mfma_f32_16x16x32_bf16 v[164:167], a[36:39], v[20:23], v[164:167]
ds_read_b64_tr_b16 a[62:63], v227 offset:47616
v_mul_f32 v160, v160, v200
v_mfma_f32_16x16x32_bf16 v[164:167], a[40:43], v[36:39], v[164:167]
v_mul_f32 v161, v161, v200
v_mul_f32 v162, v162, v200
v_mfma_f32_16x16x32_bf16 v[164:167], a[44:47], v[52:55], v[164:167]
v_mul_f32 v163, v163, v200
v_cvt_pk_bf16_f32 v160, v160, v161
v_mfma_f32_16x16x32_bf16 v[164:167], a[48:51], a[64:67], v[164:167]
v_cvt_pk_bf16_f32 v161, v162, v163
v_mfma_f32_16x16x32_bf16 v[164:167], a[52:55], a[84:87], v[164:167]
v_mul_f32 v168, v168, v201
s_waitcnt lgkmcnt(2)
v_mfma_f32_16x16x32_bf16 v[164:167], a[56:59], a[104:107], v[164:167]
v_mul_f32 v169, v169, v201
s_waitcnt lgkmcnt(0)
v_mfma_f32_16x16x32_bf16 v[164:167], a[60:63], a[124:127], v[164:167]
v_mul_f32 v170, v170, v201
v_mul_f32 v171, v171, v201
v_mfma_f32_16x16x32_bf16 v[172:175], a[32:35], v[68:71], 0
v_cvt_pk_bf16_f32 v168, v168, v169
v_cvt_pk_bf16_f32 v169, v170, v171
v_mfma_f32_16x16x32_bf16 v[172:175], a[36:39], v[84:87], v[172:175]
v_mul_f32 v176, v176, v202
v_mul_f32 v177, v177, v202
v_mfma_f32_16x16x32_bf16 v[172:175], a[40:43], v[100:103], v[172:175]
v_mul_f32 v178, v178, v202
v_mul_f32 v179, v179, v202
v_mfma_f32_16x16x32_bf16 v[172:175], a[44:47], v[116:119], v[172:175]
v_cvt_pk_bf16_f32 v176, v176, v177
v_cvt_pk_bf16_f32 v177, v178, v179
v_mfma_f32_16x16x32_bf16 v[172:175], a[48:51], a[68:71], v[172:175]
v_mfma_f32_16x16x32_bf16 v[172:175], a[52:55], a[88:91], v[172:175]
v_mul_f32 v184, v184, v203
v_mul_f32 v185, v185, v203
v_mfma_f32_16x16x32_bf16 v[172:175], a[56:59], a[108:111], v[172:175]
v_mul_f32 v186, v186, v203
v_mul_f32 v187, v187, v203
v_mfma_f32_16x16x32_bf16 v[172:175], a[60:63], a[128:131], v[172:175]
v_cvt_pk_bf16_f32 v184, v184, v185
v_cvt_pk_bf16_f32 v185, v186, v187
v_mfma_f32_16x16x32_bf16 v[180:183], a[32:35], v[132:135], 0
v_mfma_f32_16x16x32_bf16 v[180:183], a[36:39], v[148:151], v[180:183]
v_mul_f32 v192, v192, v204
v_mul_f32 v193, v193, v204
v_mfma_f32_16x16x32_bf16 v[180:183], a[40:43], v[0:3], v[180:183]
v_mul_f32 v194, v194, v204
v_mul_f32 v195, v195, v204
v_mfma_f32_16x16x32_bf16 v[180:183], a[44:47], v[16:19], v[180:183]
v_cvt_pk_bf16_f32 v192, v192, v193
v_cvt_pk_bf16_f32 v193, v194, v195
v_mfma_f32_16x16x32_bf16 v[180:183], a[48:51], a[72:75], v[180:183]
v_mfma_f32_16x16x32_bf16 v[180:183], a[52:55], a[92:95], v[180:183]
v_mfma_f32_16x16x32_bf16 v[180:183], a[56:59], a[112:115], v[180:183]
v_mfma_f32_16x16x32_bf16 v[180:183], a[60:63], a[132:135], v[180:183]
v_mfma_f32_16x16x32_bf16 v[188:191], a[32:35], v[32:35], 0
v_mfma_f32_16x16x32_bf16 v[188:191], a[36:39], v[48:51], v[188:191]
v_mfma_f32_16x16x32_bf16 v[188:191], a[40:43], v[64:67], v[188:191]
v_mfma_f32_16x16x32_bf16 v[188:191], a[44:47], v[80:83], v[188:191]
v_mfma_f32_16x16x32_bf16 v[188:191], a[48:51], a[76:79], v[188:191]
v_mfma_f32_16x16x32_bf16 v[188:191], a[52:55], a[96:99], v[188:191]
v_mfma_f32_16x16x32_bf16 v[188:191], a[56:59], a[116:119], v[188:191]
v_mfma_f32_16x16x32_bf16 v[188:191], a[60:63], a[136:139], v[188:191]
v_mfma_f32_16x16x32_bf16 v[196:199], a[32:35], v[96:99], 0
v_mfma_f32_16x16x32_bf16 v[196:199], a[36:39], v[112:115], v[196:199]
v_mfma_f32_16x16x32_bf16 v[196:199], a[40:43], v[128:131], v[196:199]
v_mfma_f32_16x16x32_bf16 v[196:199], a[44:47], v[144:147], v[196:199]
v_mfma_f32_16x16x32_bf16 v[196:199], a[48:51], a[80:83], v[196:199]
v_mfma_f32_16x16x32_bf16 v[196:199], a[52:55], a[100:103], v[196:199]
v_mfma_f32_16x16x32_bf16 v[196:199], a[56:59], a[120:123], v[196:199]
v_mfma_f32_16x16x32_bf16 v[196:199], a[60:63], a[140:143], v[196:199]
s_nop 7
v_mul_f32 v164, v164, v200
v_mul_f32 v165, v165, v200
v_mul_f32 v166, v166, v200
v_mul_f32 v167, v167, v200
v_cvt_pk_bf16_f32 v162, v164, v165
v_cvt_pk_bf16_f32 v163, v166, v167
buffer_store_dwordx4 v[160:163], v230, s[24:27], s80 offen offset:0 sc1
v_mul_f32 v172, v172, v201
v_mul_f32 v173, v173, v201
v_mul_f32 v174, v174, v201
v_mul_f32 v175, v175, v201
v_cvt_pk_bf16_f32 v170, v172, v173
v_cvt_pk_bf16_f32 v171, v174, v175
buffer_store_dwordx4 v[168:171], v230, s[24:27], s80 offen offset:2048 sc1
v_mul_f32 v180, v180, v202
v_mul_f32 v181, v181, v202
v_mul_f32 v182, v182, v202
v_mul_f32 v183, v183, v202
v_cvt_pk_bf16_f32 v178, v180, v181
v_cvt_pk_bf16_f32 v179, v182, v183
buffer_store_dwordx4 v[176:179], v231, s[24:27], s80 offen offset:0 sc1
v_mul_f32 v188, v188, v203
v_mul_f32 v189, v189, v203
v_mul_f32 v190, v190, v203
v_mul_f32 v191, v191, v203
v_cvt_pk_bf16_f32 v186, v188, v189
v_cvt_pk_bf16_f32 v187, v190, v191
buffer_store_dwordx4 v[184:187], v231, s[24:27], s80 offen offset:2048 sc1
v_mul_f32 v196, v196, v204
v_mul_f32 v197, v197, v204
v_mul_f32 v198, v198, v204
v_mul_f32 v199, v199, v204
v_cvt_pk_bf16_f32 v194, v196, v197
v_cvt_pk_bf16_f32 v195, v198, v199
buffer_store_dwordx4 v[192:195], v232, s[24:27], s80 offen offset:0 sc1
s_lshl_b32 s47, s51, 3
s_add_u32 s47, s47, s52
s_lshl_b32 s48, s47, 4
s_add_u32 s8, s94, s48
s_addc_u32 s9, s95, 0
s_mov_b32 s10, 4
s_mov_b32 s41, 2310144
s_mul_i32 s47, s47, s41
s_add_u32 s12, s72, s47
s_addc_u32 s13, s73, 0
s_mov_b32 s16, s92
s_mov_b32 s17, s93
s_mov_b32 s18, 2293760
s_mov_b32 s19, 0x20000
s_lshl_b32 s40, 1, s53
s_mov_b32 s38, 20000
s_mov_b32 s37, 0
v_mbcnt_lo_u32_b32 v236, -1, 0
v_mbcnt_hi_u32_b32 v236, -1, v236
v_lshlrev_b32 v237, 2, v236
v_and_b32 v240, 15, v236
v_mul_u32_u24 v238, 1792, v240
v_bfe_u32 v240, v236, 4, 1
v_lshl_add_u32 v238, v240, 6, v238
v_lshrrev_b32 v240, 5, v236
v_lshl_add_u32 v238, v240, 4, v238
v_mov_b32 v240, s40
v_mov_b32 v249, s40
s_mov_b32 s14, s41
v_mul_u32_u24 v247, 144384, v236
v_add_u32 v247, 144128, v247
v_lshlrev_b32 v248, 8, v236
v_add_u32 v248, 144128, v248
v_and_b32 v232, 1, v236
v_lshlrev_b32 v232, 4, v232
s_movk_i32 s47, 0x3f80
v_lshlrev_b32 v232, v232, s47
v_bfe_i32 v239, v236, 1, 1
v_and_b32 v233, v232, v239
v_xor_b32 v232, v232, v233
s_waitcnt vmcnt(0)
s_barrier
s_cmp_lg_u32 s28, 0
s_cbranch_scc1 L_f_b0
buffer_atomic_add v240, v237, s[8:11], 0 offen sc0
buffer_atomic_add v249, v247, s[12:15], 0 offen
s_waitcnt vmcnt(1)
ds_write_b32 v237, v240
s_waitcnt lgkmcnt(0)
L_f_b0:
s_barrier
ds_read_b32 v240, v237
s_waitcnt lgkmcnt(0)
v_readfirstlane_b32 s32, v240
s_and_b32 s34, s32, 0xffff
s_bcnt1_i32_b32 s33, s34
s_or_b32 s34, s34, s40
s_cmp_lg_u32 s33, 15
s_cbranch_scc1 L_f_share
s_lshr_b32 s37, s32, 16
L_f_next:
s_cmp_eq_u32 s37, 0
s_cbranch_scc1 L_f_end
s_ff1_i32_b32 s33, s37
s_bitset0_b32 s37, s33
L_f_share:
s_lshl_b32 s47, s33, 2
s_add_u32 s47, s47, s28
s_mul_i32 s48, s47, 26
s_lshr_b32 s48, s48, 8
s_mul_i32 s49, s48, 10
s_sub_u32 s47, s47, s49
s_lshl_b32 s48, s48, 2
s_lshr_b32 s49, 0xdb9630, s48
s_and_b32 s49, s49, 15
s_lshr_b32 s50, 0x122333, s48
s_and_b32 s50, s50, 15
s_cbranch_scc0 L_f_next
s_mul_i32 s42, s52, 10
s_add_u32 s42, s42, s47
s_mul_i32 s42, s42, 28672
s_mul_i32 s48, s51, 896
s_add_u32 s42, s42, s48
s_lshl_b32 s47, s47, 11
s_lshr_b32 s36, s49, 1
s_and_b32 s35, s49, 1
s_mul_i32 s32, s36, 20
s_add_u32 s32, s32, s35
s_lshl_b32 s32, s32, 10
s_add_u32 s32, s32, s47
s_lshl_b32 s36, s36, 2
s_add_u32 s36, s36, s35
s_lshl_b32 s36, s36, 5
s_add_u32 s36, s36, s42
v_lshl_add_u32 v241, v236, 4, s32
v_add_u32 v244, s36, v238
s_add_u32 s49, s49, 1
s_lshr_b32 s36, s49, 1
s_and_b32 s35, s49, 1
s_mul_i32 s32, s36, 20
s_add_u32 s32, s32, s35
s_lshl_b32 s32, s32, 10
s_add_u32 s32, s32, s47
s_lshl_b32 s36, s36, 2
s_add_u32 s36, s36, s35
s_lshl_b32 s36, s36, 5
s_add_u32 s36, s36, s42
v_lshl_add_u32 v242, v236, 4, s32
v_add_u32 v245, s36, v238
s_add_u32 s49, s49, 1
s_lshr_b32 s36, s49, 1
s_and_b32 s35, s49, 1
s_mul_i32 s32, s36, 20
s_add_u32 s32, s32, s35
s_lshl_b32 s32, s32, 10
s_add_u32 s32, s32, s47
s_lshl_b32 s36, s36, 2
s_add_u32 s36, s36, s35
s_lshl_b32 s36, s36, 5
s_add_u32 s36, s36, s42
v_lshl_add_u32 v243, v236, 4, s32
v_add_u32 v246, s36, v238
s_add_u32 s49, s49, 1
s_mov_b32 s36, s34
s_mov_b32 s35, s34
s_cmp_eq_u32 s50, 2
s_cbranch_scc1 L_f2_i
s_cmp_eq_u32 s50, 1
s_cbranch_scc1 L_f1_i
L_f3_i:
s_and_b32 s47, s36, 15
s_cbranch_scc0 L_f3_h3
s_bitcmp1_b32 s36, 0
s_cbranch_scc0 L_f3_h0
s_mov_b32 s42, 0
buffer_load_dwordx4 a[0:3], v241, s[12:15], s42 offen sc1
buffer_load_dwordx4 a[4:7], v242, s[12:15], s42 offen sc1
buffer_load_dwordx4 a[8:11], v243, s[12:15], s42 offen sc1
L_f3_h0:
s_bitcmp1_b32 s36, 1
s_cbranch_scc0 L_f3_h1
s_mov_b32 s42, 144384
buffer_load_dwordx4 a[12:15], v241, s[12:15], s42 offen sc1
buffer_load_dwordx4 a[16:19], v242, s[12:15], s42 offen sc1
buffer_load_dwordx4 a[20:23], v243, s[12:15], s42 offen sc1
L_f3_h1:
s_bitcmp1_b32 s36, 2
s_cbranch_scc0 L_f3_h2
s_mov_b32 s42, 288768
buffer_load_dwordx4 a[24:27], v241, s[12:15], s42 offen sc1
buffer_load_dwordx4 a[28:31], v242, s[12:15], s42 offen sc1
buffer_load_dwordx4 a[32:35], v243, s[12:15], s42 offen sc1
L_f3_h2:
s_bitcmp1_b32 s36, 3
s_cbranch_scc0 L_f3_h3
s_mov_b32 s42, 433152
buffer_load_dwordx4 a[36:39], v241, s[12:15], s42 offen sc1
buffer_load_dwordx4 a[40:43], v242, s[12:15], s42 offen sc1
buffer_load_dwordx4 a[44:47], v243, s[12:15], s42 offen sc1
L_f3_h3:
s_and_b32 s47, s36, 240
s_cbranch_scc0 L_f3_h7
s_bitcmp1_b32 s36, 4
s_cbranch_scc0 L_f3_h4
s_mov_b32 s42, 577536
buffer_load_dwordx4 a[48:51], v241, s[12:15], s42 offen sc1
buffer_load_dwordx4 a[52:55], v242, s[12:15], s42 offen sc1
buffer_load_dwordx4 a[56:59], v243, s[12:15], s42 offen sc1
L_f3_h4:
s_bitcmp1_b32 s36, 5
s_cbranch_scc0 L_f3_h5
s_mov_b32 s42, 721920
buffer_load_dwordx4 a[60:63], v241, s[12:15], s42 offen sc1
buffer_load_dwordx4 a[64:67], v242, s[12:15], s42 offen sc1
buffer_load_dwordx4 a[68:71], v243, s[12:15], s42 offen sc1
L_f3_h5:
s_bitcmp1_b32 s36, 6
s_cbranch_scc0 L_f3_h6
s_mov_b32 s42, 866304
buffer_load_dwordx4 a[72:75], v241, s[12:15], s42 offen sc1
buffer_load_dwordx4 a[76:79], v242, s[12:15], s42 offen sc1
buffer_load_dwordx4 a[80:83], v243, s[12:15], s42 offen sc1
L_f3_h6:
s_bitcmp1_b32 s36, 7
s_cbranch_scc0 L_f3_h7
s_mov_b32 s42, 1010688
buffer_load_dwordx4 a[84:87], v241, s[12:15], s42 offen sc1
buffer_load_dwordx4 a[88:91], v242, s[12:15], s42 offen sc1
buffer_load_dwordx4 a[92:95], v243, s[12:15], s42 offen sc1
L_f3_h7:
s_and_b32 s47, s36, 3840
s_cbranch_scc0 L_f3_h11
s_bitcmp1_b32 s36, 8
s_cbranch_scc0 L_f3_h8
s_mov_b32 s42, 1155072
buffer_load_dwordx4 a[96:99], v241, s[12:15], s42 offen sc1
buffer_load_dwordx4 a[100:103], v242, s[12:15], s42 offen sc1
buffer_load_dwordx4 a[104:107], v243, s[12:15], s42 offen sc1
L_f3_h8:
s_bitcmp1_b32 s36, 9
s_cbranch_scc0 L_f3_h9
s_mov_b32 s42, 1299456
buffer_load_dwordx4 a[108:111], v241, s[12:15], s42 offen sc1
buffer_load_dwordx4 a[112:115], v242, s[12:15], s42 offen sc1
buffer_load_dwordx4 a[116:119], v243, s[12:15], s42 offen sc1
L_f3_h9:
s_bitcmp1_b32 s36, 10
s_cbranch_scc0 L_f3_h10
s_mov_b32 s42, 1443840
buffer_load_dwordx4 a[120:123], v241, s[12:15], s42 offen sc1
buffer_load_dwordx4 a[124:127], v242, s[12:15], s42 offen sc1
buffer_load_dwordx4 a[128:131], v243, s[12:15], s42 offen sc1
L_f3_h10:
s_bitcmp1_b32 s36, 11
s_cbranch_scc0 L_f3_h11
s_mov_b32 s42, 1588224
buffer_load_dwordx4 a[132:135], v241, s[12:15], s42 offen sc1
buffer_load_dwordx4 a[136:139], v242, s[12:15], s42 offen sc1
buffer_load_dwordx4 a[140:143], v243, s[12:15], s42 offen sc1
L_f3_h11:
s_and_b32 s47, s36, 61440
s_cbranch_scc0 L_f3_h15
s_bitcmp1_b32 s36, 12
s_cbranch_scc0 L_f3_h12
s_mov_b32 s42, 1732608
buffer_load_dwordx4 a[144:147], v241, s[12:15], s42 offen sc1
buffer_load_dwordx4 a[148:151], v242, s[12:15], s42 offen sc1
buffer_load_dwordx4 a[152:155], v243, s[12:15], s42 offen sc1
L_f3_h12:
s_bitcmp1_b32 s36, 13
s_cbranch_scc0 L_f3_h13
s_mov_b32 s42, 1876992
buffer_load_dwordx4 a[156:159], v241, s[12:15], s42 offen sc1
buffer_load_dwordx4 a[160:163], v242, s[12:15], s42 offen sc1
buffer_load_dwordx4 a[164:167], v243, s[12:15], s42 offen sc1
L_f3_h13:
s_bitcmp1_b32 s36, 14
s_cbranch_scc0 L_f3_h14
s_mov_b32 s42, 2021376
buffer_load_dwordx4 a[168:171], v241, s[12:15], s42 offen sc1
buffer_load_dwordx4 a[172:175], v242, s[12:15], s42 offen sc1
buffer_load_dwordx4 a[176:179], v243, s[12:15], s42 offen sc1
L_f3_h14:
s_bitcmp1_b32 s36, 15
s_cbranch_scc0 L_f3_h15
s_mov_b32 s42, 2165760
buffer_load_dwordx4 a[180:183], v241, s[12:15], s42 offen sc1
buffer_load_dwordx4 a[184:187], v242, s[12:15], s42 offen sc1
buffer_load_dwordx4 a[188:191], v243, s[12:15], s42 offen sc1
L_f3_h15:
s_cmp_eq_u32 s35, 0xffff
s_cbranch_scc1 L_f3_sum
L_f3_spin:
buffer_load_dword v240, v248, s[24:27], 0 offen sc1
s_waitcnt vmcnt(0)
v_readfirstlane_b32 s34, v240
s_and_b32 s34, s34, 0xffff
s_andn2_b32 s36, s34, s35
s_cbranch_scc1 L_f3_got
s_sub_u32 s38, s38, 1
s_cbranch_scc0 L_f3_spin
s_lshl_b32 s47, 0x10000, s33
v_mov_b32 v240, s47
buffer_atomic_or v240, v237, s[8:11], 0 offen sc0
s_waitcnt vmcnt(0)
v_readfirstlane_b32 s34, v240
s_and_b32 s34, s34, 0xffff
s_cmp_lg_u32 s34, 0xffff
s_cbranch_scc1 L_f_end
s_andn2_b32 s36, s34, s35
L_f3_got:
s_or_b32 s35, s35, s36
s_branch L_f3_i
L_f3_sum:
s_waitcnt vmcnt(0)
v_mfma_f32_4x4x4_16b_bf16 v[0:3], v[232:233], a[0:1], 0
v_mfma_f32_4x4x4_16b_bf16 v[4:7], v[232:233], a[2:3], 0
v_mfma_f32_4x4x4_16b_bf16 v[8:11], v[232:233], a[4:5], 0
v_mfma_f32_4x4x4_16b_bf16 v[12:15], v[232:233], a[6:7], 0
v_mfma_f32_4x4x4_16b_bf16 v[16:19], v[232:233], a[8:9], 0
v_mfma_f32_4x4x4_16b_bf16 v[20:23], v[232:233], a[10:11], 0
v_mfma_f32_4x4x4_16b_bf16 v[0:3], v[232:233], a[12:13], v[0:3]
v_mfma_f32_4x4x4_16b_bf16 v[4:7], v[232:233], a[14:15], v[4:7]
v_mfma_f32_4x4x4_16b_bf16 v[8:11], v[232:233], a[16:17], v[8:11]
v_mfma_f32_4x4x4_16b_bf16 v[12:15], v[232:233], a[18:19], v[12:15]
v_mfma_f32_4x4x4_16b_bf16 v[16:19], v[232:233], a[20:21], v[16:19]
v_mfma_f32_4x4x4_16b_bf16 v[20:23], v[232:233], a[22:23], v[20:23]
v_mfma_f32_4x4x4_16b_bf16 v[0:3], v[232:233], a[24:25], v[0:3]
v_mfma_f32_4x4x4_16b_bf16 v[4:7], v[232:233], a[26:27], v[4:7]
v_mfma_f32_4x4x4_16b_bf16 v[8:11], v[232:233], a[28:29], v[8:11]
v_mfma_f32_4x4x4_16b_bf16 v[12:15], v[232:233], a[30:31], v[12:15]
v_mfma_f32_4x4x4_16b_bf16 v[16:19], v[232:233], a[32:33], v[16:19]
v_mfma_f32_4x4x4_16b_bf16 v[20:23], v[232:233], a[34:35], v[20:23]
v_mfma_f32_4x4x4_16b_bf16 v[0:3], v[232:233], a[36:37], v[0:3]
v_mfma_f32_4x4x4_16b_bf16 v[4:7], v[232:233], a[38:39], v[4:7]
v_mfma_f32_4x4x4_16b_bf16 v[8:11], v[232:233], a[40:41], v[8:11]
v_mfma_f32_4x4x4_16b_bf16 v[12:15], v[232:233], a[42:43], v[12:15]
v_mfma_f32_4x4x4_16b_bf16 v[16:19], v[232:233], a[44:45], v[16:19]
v_mfma_f32_4x4x4_16b_bf16 v[20:23], v[232:233], a[46:47], v[20:23]
v_mfma_f32_4x4x4_16b_bf16 v[0:3], v[232:233], a[48:49], v[0:3]
v_mfma_f32_4x4x4_16b_bf16 v[4:7], v[232:233], a[50:51], v[4:7]
v_mfma_f32_4x4x4_16b_bf16 v[8:11], v[232:233], a[52:53], v[8:11]
v_mfma_f32_4x4x4_16b_bf16 v[12:15], v[232:233], a[54:55], v[12:15]
v_mfma_f32_4x4x4_16b_bf16 v[16:19], v[232:233], a[56:57], v[16:19]
v_mfma_f32_4x4x4_16b_bf16 v[20:23], v[232:233], a[58:59], v[20:23]
v_mfma_f32_4x4x4_16b_bf16 v[0:3], v[232:233], a[60:61], v[0:3]
v_mfma_f32_4x4x4_16b_bf16 v[4:7], v[232:233], a[62:63], v[4:7]
v_mfma_f32_4x4x4_16b_bf16 v[8:11], v[232:233], a[64:65], v[8:11]
v_mfma_f32_4x4x4_16b_bf16 v[12:15], v[232:233], a[66:67], v[12:15]
v_mfma_f32_4x4x4_16b_bf16 v[16:19], v[232:233], a[68:69], v[16:19]
v_mfma_f32_4x4x4_16b_bf16 v[20:23], v[232:233], a[70:71], v[20:23]
v_mfma_f32_4x4x4_16b_bf16 v[0:3], v[232:233], a[72:73], v[0:3]
v_mfma_f32_4x4x4_16b_bf16 v[4:7], v[232:233], a[74:75], v[4:7]
v_mfma_f32_4x4x4_16b_bf16 v[8:11], v[232:233], a[76:77], v[8:11]
v_mfma_f32_4x4x4_16b_bf16 v[12:15], v[232:233], a[78:79], v[12:15]
v_mfma_f32_4x4x4_16b_bf16 v[16:19], v[232:233], a[80:81], v[16:19]
v_mfma_f32_4x4x4_16b_bf16 v[20:23], v[232:233], a[82:83], v[20:23]
v_mfma_f32_4x4x4_16b_bf16 v[0:3], v[232:233], a[84:85], v[0:3]
v_mfma_f32_4x4x4_16b_bf16 v[4:7], v[232:233], a[86:87], v[4:7]
v_mfma_f32_4x4x4_16b_bf16 v[8:11], v[232:233], a[88:89], v[8:11]
v_mfma_f32_4x4x4_16b_bf16 v[12:15], v[232:233], a[90:91], v[12:15]
v_mfma_f32_4x4x4_16b_bf16 v[16:19], v[232:233], a[92:93], v[16:19]
v_mfma_f32_4x4x4_16b_bf16 v[20:23], v[232:233], a[94:95], v[20:23]
v_mfma_f32_4x4x4_16b_bf16 v[0:3], v[232:233], a[96:97], v[0:3]
v_mfma_f32_4x4x4_16b_bf16 v[4:7], v[232:233], a[98:99], v[4:7]
v_mfma_f32_4x4x4_16b_bf16 v[8:11], v[232:233], a[100:101], v[8:11]
v_mfma_f32_4x4x4_16b_bf16 v[12:15], v[232:233], a[102:103], v[12:15]
v_mfma_f32_4x4x4_16b_bf16 v[16:19], v[232:233], a[104:105], v[16:19]
v_mfma_f32_4x4x4_16b_bf16 v[20:23], v[232:233], a[106:107], v[20:23]
v_mfma_f32_4x4x4_16b_bf16 v[0:3], v[232:233], a[108:109], v[0:3]
v_mfma_f32_4x4x4_16b_bf16 v[4:7], v[232:233], a[110:111], v[4:7]
v_mfma_f32_4x4x4_16b_bf16 v[8:11], v[232:233], a[112:113], v[8:11]
v_mfma_f32_4x4x4_16b_bf16 v[12:15], v[232:233], a[114:115], v[12:15]
v_mfma_f32_4x4x4_16b_bf16 v[16:19], v[232:233], a[116:117], v[16:19]
v_mfma_f32_4x4x4_16b_bf16 v[20:23], v[232:233], a[118:119], v[20:23]
v_mfma_f32_4x4x4_16b_bf16 v[0:3], v[232:233], a[120:121], v[0:3]
v_mfma_f32_4x4x4_16b_bf16 v[4:7], v[232:233], a[122:123], v[4:7]
v_mfma_f32_4x4x4_16b_bf16 v[8:11], v[232:233], a[124:125], v[8:11]
v_mfma_f32_4x4x4_16b_bf16 v[12:15], v[232:233], a[126:127], v[12:15]
v_mfma_f32_4x4x4_16b_bf16 v[16:19], v[232:233], a[128:129], v[16:19]
v_mfma_f32_4x4x4_16b_bf16 v[20:23], v[232:233], a[130:131], v[20:23]
v_mfma_f32_4x4x4_16b_bf16 v[0:3], v[232:233], a[132:133], v[0:3]
v_mfma_f32_4x4x4_16b_bf16 v[4:7], v[232:233], a[134:135], v[4:7]
v_mfma_f32_4x4x4_16b_bf16 v[8:11], v[232:233], a[136:137], v[8:11]
v_mfma_f32_4x4x4_16b_bf16 v[12:15], v[232:233], a[138:139], v[12:15]
v_mfma_f32_4x4x4_16b_bf16 v[16:19], v[232:233], a[140:141], v[16:19]
v_mfma_f32_4x4x4_16b_bf16 v[20:23], v[232:233], a[142:143], v[20:23]
v_mfma_f32_4x4x4_16b_bf16 v[0:3], v[232:233], a[144:145], v[0:3]
v_mfma_f32_4x4x4_16b_bf16 v[4:7], v[232:233], a[146:147], v[4:7]
v_mfma_f32_4x4x4_16b_bf16 v[8:11], v[232:233], a[148:149], v[8:11]
v_mfma_f32_4x4x4_16b_bf16 v[12:15], v[232:233], a[150:151], v[12:15]
v_mfma_f32_4x4x4_16b_bf16 v[16:19], v[232:233], a[152:153], v[16:19]
v_mfma_f32_4x4x4_16b_bf16 v[20:23], v[232:233], a[154:155], v[20:23]
v_mfma_f32_4x4x4_16b_bf16 v[0:3], v[232:233], a[156:157], v[0:3]
v_mfma_f32_4x4x4_16b_bf16 v[4:7], v[232:233], a[158:159], v[4:7]
v_mfma_f32_4x4x4_16b_bf16 v[8:11], v[232:233], a[160:161], v[8:11]
v_mfma_f32_4x4x4_16b_bf16 v[12:15], v[232:233], a[162:163], v[12:15]
v_mfma_f32_4x4x4_16b_bf16 v[16:19], v[232:233], a[164:165], v[16:19]
v_mfma_f32_4x4x4_16b_bf16 v[20:23], v[232:233], a[166:167], v[20:23]
v_mfma_f32_4x4x4_16b_bf16 v[0:3], v[232:233], a[168:169], v[0:3]
v_mfma_f32_4x4x4_16b_bf16 v[4:7], v[232:233], a[170:171], v[4:7]
v_mfma_f32_4x4x4_16b_bf16 v[8:11], v[232:233], a[172:173], v[8:11]
v_mfma_f32_4x4x4_16b_bf16 v[12:15], v[232:233], a[174:175], v[12:15]
v_mfma_f32_4x4x4_16b_bf16 v[16:19], v[232:233], a[176:177], v[16:19]
v_mfma_f32_4x4x4_16b_bf16 v[20:23], v[232:233], a[178:179], v[20:23]
v_mfma_f32_4x4x4_16b_bf16 v[0:3], v[232:233], a[180:181], v[0:3]
v_mfma_f32_4x4x4_16b_bf16 v[4:7], v[232:233], a[182:183], v[4:7]
v_mfma_f32_4x4x4_16b_bf16 v[8:11], v[232:233], a[184:185], v[8:11]
v_mfma_f32_4x4x4_16b_bf16 v[12:15], v[232:233], a[186:187], v[12:15]
v_mfma_f32_4x4x4_16b_bf16 v[16:19], v[232:233], a[188:189], v[16:19]
v_mfma_f32_4x4x4_16b_bf16 v[20:23], v[232:233], a[190:191], v[20:23]
s_nop 4
v_cvt_pk_bf16_f32 v32, v0, v1
v_cvt_pk_bf16_f32 v33, v2, v3
v_cvt_pk_bf16_f32 v34, v4, v5
v_cvt_pk_bf16_f32 v35, v6, v7
s_nop 0
v_permlane16_swap_b32 v32, v34
v_permlane16_swap_b32 v33, v35
buffer_store_dwordx4 v[32:35], v244, s[16:19], 0 offen
v_cvt_pk_bf16_f32 v36, v8, v9
v_cvt_pk_bf16_f32 v37, v10, v11
v_cvt_pk_bf16_f32 v38, v12, v13
v_cvt_pk_bf16_f32 v39, v14, v15
s_nop 0
v_permlane16_swap_b32 v36, v38
v_permlane16_swap_b32 v37, v39
buffer_store_dwordx4 v[36:39], v245, s[16:19], 0 offen
v_cvt_pk_bf16_f32 v40, v16, v17
v_cvt_pk_bf16_f32 v41, v18, v19
v_cvt_pk_bf16_f32 v42, v20, v21
v_cvt_pk_bf16_f32 v43, v22, v23
s_nop 0
v_permlane16_swap_b32 v40, v42
v_permlane16_swap_b32 v41, v43
buffer_store_dwordx4 v[40:43], v246, s[16:19], 0 offen
s_mov_b32 s34, 0xffff
s_branch L_f_next
L_f2_i:
s_and_b32 s47, s36, 15
s_cbranch_scc0 L_f2_h3
s_bitcmp1_b32 s36, 0
s_cbranch_scc0 L_f2_h0
s_mov_b32 s42, 0
buffer_load_dwordx4 a[0:3], v241, s[12:15], s42 offen sc1
buffer_load_dwordx4 a[4:7], v242, s[12:15], s42 offen sc1
L_f2_h0:
s_bitcmp1_b32 s36, 1
s_cbranch_scc0 L_f2_h1
s_mov_b32 s42, 144384
buffer_load_dwordx4 a[12:15], v241, s[12:15], s42 offen sc1
buffer_load_dwordx4 a[16:19], v242, s[12:15], s42 offen sc1
L_f2_h1:
s_bitcmp1_b32 s36, 2
s_cbranch_scc0 L_f2_h2
s_mov_b32 s42, 288768
buffer_load_dwordx4 a[24:27], v241, s[12:15], s42 offen sc1
buffer_load_dwordx4 a[28:31], v242, s[12:15], s42 offen sc1
L_f2_h2:
s_bitcmp1_b32 s36, 3
s_cbranch_scc0 L_f2_h3
s_mov_b32 s42, 433152
buffer_load_dwordx4 a[36:39], v241, s[12:15], s42 offen sc1
buffer_load_dwordx4 a[40:43], v242, s[12:15], s42 offen sc1
L_f2_h3:
s_and_b32 s47, s36, 240
s_cbranch_scc0 L_f2_h7
s_bitcmp1_b32 s36, 4
s_cbranch_scc0 L_f2_h4
s_mov_b32 s42, 577536
buffer_load_dwordx4 a[48:51], v241, s[12:15], s42 offen sc1
buffer_load_dwordx4 a[52:55], v242, s[12:15], s42 offen sc1
L_f2_h4:
s_bitcmp1_b32 s36, 5
s_cbranch_scc0 L_f2_h5
s_mov_b32 s42, 721920
buffer_load_dwordx4 a[60:63], v241, s[12:15], s42 offen sc1
buffer_load_dwordx4 a[64:67], v242, s[12:15], s42 offen sc1
L_f2_h5:
s_bitcmp1_b32 s36, 6
s_cbranch_scc0 L_f2_h6
s_mov_b32 s42, 866304
buffer_load_dwordx4 a[72:75], v241, s[12:15], s42 offen sc1
buffer_load_dwordx4 a[76:79], v242, s[12:15], s42 offen sc1
L_f2_h6:
s_bitcmp1_b32 s36, 7
s_cbranch_scc0 L_f2_h7
s_mov_b32 s42, 1010688
buffer_load_dwordx4 a[84:87], v241, s[12:15], s42 offen sc1
buffer_load_dwordx4 a[88:91], v242, s[12:15], s42 offen sc1
L_f2_h7:
s_and_b32 s47, s36, 3840
s_cbranch_scc0 L_f2_h11
s_bitcmp1_b32 s36, 8
s_cbranch_scc0 L_f2_h8
s_mov_b32 s42, 1155072
buffer_load_dwordx4 a[96:99], v241, s[12:15], s42 offen sc1
buffer_load_dwordx4 a[100:103], v242, s[12:15], s42 offen sc1
L_f2_h8:
s_bitcmp1_b32 s36, 9
s_cbranch_scc0 L_f2_h9
s_mov_b32 s42, 1299456
buffer_load_dwordx4 a[108:111], v241, s[12:15], s42 offen sc1
buffer_load_dwordx4 a[112:115], v242, s[12:15], s42 offen sc1
L_f2_h9:
s_bitcmp1_b32 s36, 10
s_cbranch_scc0 L_f2_h10
s_mov_b32 s42, 1443840
buffer_load_dwordx4 a[120:123], v241, s[12:15], s42 offen sc1
buffer_load_dwordx4 a[124:127], v242, s[12:15], s42 offen sc1
L_f2_h10:
s_bitcmp1_b32 s36, 11
s_cbranch_scc0 L_f2_h11
s_mov_b32 s42, 1588224
buffer_load_dwordx4 a[132:135], v241, s[12:15], s42 offen sc1
buffer_load_dwordx4 a[136:139], v242, s[12:15], s42 offen sc1
L_f2_h11:
s_and_b32 s47, s36, 61440
s_cbranch_scc0 L_f2_h15
s_bitcmp1_b32 s36, 12
s_cbranch_scc0 L_f2_h12
s_mov_b32 s42, 1732608
buffer_load_dwordx4 a[144:147], v241, s[12:15], s42 offen sc1
buffer_load_dwordx4 a[148:151], v242, s[12:15], s42 offen sc1
L_f2_h12:
s_bitcmp1_b32 s36, 13
s_cbranch_scc0 L_f2_h13
s_mov_b32 s42, 1876992
buffer_load_dwordx4 a[156:159], v241, s[12:15], s42 offen sc1
buffer_load_dwordx4 a[160:163], v242, s[12:15], s42 offen sc1
L_f2_h13:
s_bitcmp1_b32 s36, 14
s_cbranch_scc0 L_f2_h14
s_mov_b32 s42, 2021376
buffer_load_dwordx4 a[168:171], v241, s[12:15], s42 offen sc1
buffer_load_dwordx4 a[172:175], v242, s[12:15], s42 offen sc1
L_f2_h14:
s_bitcmp1_b32 s36, 15
s_cbranch_scc0 L_f2_h15
s_mov_b32 s42, 2165760
buffer_load_dwordx4 a[180:183], v241, s[12:15], s42 offen sc1
buffer_load_dwordx4 a[184:187], v242, s[12:15], s42 offen sc1
L_f2_h15:
s_cmp_eq_u32 s35, 0xffff
s_cbranch_scc1 L_f2_sum
L_f2_spin:
buffer_load_dword v240, v248, s[24:27], 0 offen sc1
s_waitcnt vmcnt(0)
v_readfirstlane_b32 s34, v240
s_and_b32 s34, s34, 0xffff
s_andn2_b32 s36, s34, s35
s_cbranch_scc1 L_f2_got
s_sub_u32 s38, s38, 1
s_cbranch_scc0 L_f2_spin
s_lshl_b32 s47, 0x10000, s33
v_mov_b32 v240, s47
buffer_atomic_or v240, v237, s[8:11], 0 offen sc0
s_waitcnt vmcnt(0)
v_readfirstlane_b32 s34, v240
s_and_b32 s34, s34, 0xffff
s_cmp_lg_u32 s34, 0xffff
s_cbranch_scc1 L_f_end
s_andn2_b32 s36, s34, s35
L_f2_got:
s_or_b32 s35, s35, s36
s_branch L_f2_i
L_f2_sum:
s_waitcnt vmcnt(0)
v_mfma_f32_4x4x4_16b_bf16 v[0:3], v[232:233], a[0:1], 0
v_mfma_f32_4x4x4_16b_bf16 v[4:7], v[232:233], a[2:3], 0
v_mfma_f32_4x4x4_16b_bf16 v[8:11], v[232:233], a[4:5], 0
v_mfma_f32_4x4x4_16b_bf16 v[12:15], v[232:233], a[6:7], 0
v_mfma_f32_4x4x4_16b_bf16 v[0:3], v[232:233], a[12:13], v[0:3]
v_mfma_f32_4x4x4_16b_bf16 v[4:7], v[232:233], a[14:15], v[4:7]
v_mfma_f32_4x4x4_16b_bf16 v[8:11], v[232:233], a[16:17], v[8:11]
v_mfma_f32_4x4x4_16b_bf16 v[12:15], v[232:233], a[18:19], v[12:15]
v_mfma_f32_4x4x4_16b_bf16 v[0:3], v[232:233], a[24:25], v[0:3]
v_mfma_f32_4x4x4_16b_bf16 v[4:7], v[232:233], a[26:27], v[4:7]
v_mfma_f32_4x4x4_16b_bf16 v[8:11], v[232:233], a[28:29], v[8:11]
v_mfma_f32_4x4x4_16b_bf16 v[12:15], v[232:233], a[30:31], v[12:15]
v_mfma_f32_4x4x4_16b_bf16 v[0:3], v[232:233], a[36:37], v[0:3]
v_mfma_f32_4x4x4_16b_bf16 v[4:7], v[232:233], a[38:39], v[4:7]
v_mfma_f32_4x4x4_16b_bf16 v[8:11], v[232:233], a[40:41], v[8:11]
v_mfma_f32_4x4x4_16b_bf16 v[12:15], v[232:233], a[42:43], v[12:15]
v_mfma_f32_4x4x4_16b_bf16 v[0:3], v[232:233], a[48:49], v[0:3]
v_mfma_f32_4x4x4_16b_bf16 v[4:7], v[232:233], a[50:51], v[4:7]
v_mfma_f32_4x4x4_16b_bf16 v[8:11], v[232:233], a[52:53], v[8:11]
v_mfma_f32_4x4x4_16b_bf16 v[12:15], v[232:233], a[54:55], v[12:15]
v_mfma_f32_4x4x4_16b_bf16 v[0:3], v[232:233], a[60:61], v[0:3]
v_mfma_f32_4x4x4_16b_bf16 v[4:7], v[232:233], a[62:63], v[4:7]
v_mfma_f32_4x4x4_16b_bf16 v[8:11], v[232:233], a[64:65], v[8:11]
v_mfma_f32_4x4x4_16b_bf16 v[12:15], v[232:233], a[66:67], v[12:15]
v_mfma_f32_4x4x4_16b_bf16 v[0:3], v[232:233], a[72:73], v[0:3]
v_mfma_f32_4x4x4_16b_bf16 v[4:7], v[232:233], a[74:75], v[4:7]
v_mfma_f32_4x4x4_16b_bf16 v[8:11], v[232:233], a[76:77], v[8:11]
v_mfma_f32_4x4x4_16b_bf16 v[12:15], v[232:233], a[78:79], v[12:15]
v_mfma_f32_4x4x4_16b_bf16 v[0:3], v[232:233], a[84:85], v[0:3]
v_mfma_f32_4x4x4_16b_bf16 v[4:7], v[232:233], a[86:87], v[4:7]
v_mfma_f32_4x4x4_16b_bf16 v[8:11], v[232:233], a[88:89], v[8:11]
v_mfma_f32_4x4x4_16b_bf16 v[12:15], v[232:233], a[90:91], v[12:15]
v_mfma_f32_4x4x4_16b_bf16 v[0:3], v[232:233], a[96:97], v[0:3]
v_mfma_f32_4x4x4_16b_bf16 v[4:7], v[232:233], a[98:99], v[4:7]
v_mfma_f32_4x4x4_16b_bf16 v[8:11], v[232:233], a[100:101], v[8:11]
v_mfma_f32_4x4x4_16b_bf16 v[12:15], v[232:233], a[102:103], v[12:15]
v_mfma_f32_4x4x4_16b_bf16 v[0:3], v[232:233], a[108:109], v[0:3]
v_mfma_f32_4x4x4_16b_bf16 v[4:7], v[232:233], a[110:111], v[4:7]
v_mfma_f32_4x4x4_16b_bf16 v[8:11], v[232:233], a[112:113], v[8:11]
v_mfma_f32_4x4x4_16b_bf16 v[12:15], v[232:233], a[114:115], v[12:15]
v_mfma_f32_4x4x4_16b_bf16 v[0:3], v[232:233], a[120:121], v[0:3]
v_mfma_f32_4x4x4_16b_bf16 v[4:7], v[232:233], a[122:123], v[4:7]
v_mfma_f32_4x4x4_16b_bf16 v[8:11], v[232:233], a[124:125], v[8:11]
v_mfma_f32_4x4x4_16b_bf16 v[12:15], v[232:233], a[126:127], v[12:15]
v_mfma_f32_4x4x4_16b_bf16 v[0:3], v[232:233], a[132:133], v[0:3]
v_mfma_f32_4x4x4_16b_bf16 v[4:7], v[232:233], a[134:135], v[4:7]
v_mfma_f32_4x4x4_16b_bf16 v[8:11], v[232:233], a[136:137], v[8:11]
v_mfma_f32_4x4x4_16b_bf16 v[12:15], v[232:233], a[138:139], v[12:15]
v_mfma_f32_4x4x4_16b_bf16 v[0:3], v[232:233], a[144:145], v[0:3]
v_mfma_f32_4x4x4_16b_bf16 v[4:7], v[232:233], a[146:147], v[4:7]
v_mfma_f32_4x4x4_16b_bf16 v[8:11], v[232:233], a[148:149], v[8:11]
v_mfma_f32_4x4x4_16b_bf16 v[12:15], v[232:233], a[150:151], v[12:15]
v_mfma_f32_4x4x4_16b_bf16 v[0:3], v[232:233], a[156:157], v[0:3]
v_mfma_f32_4x4x4_16b_bf16 v[4:7], v[232:233], a[158:159], v[4:7]
v_mfma_f32_4x4x4_16b_bf16 v[8:11], v[232:233], a[160:161], v[8:11]
v_mfma_f32_4x4x4_16b_bf16 v[12:15], v[232:233], a[162:163], v[12:15]
v_mfma_f32_4x4x4_16b_bf16 v[0:3], v[232:233], a[168:169], v[0:3]
v_mfma_f32_4x4x4_16b_bf16 v[4:7], v[232:233], a[170:171], v[4:7]
v_mfma_f32_4x4x4_16b_bf16 v[8:11], v[232:233], a[172:173], v[8:11]
v_mfma_f32_4x4x4_16b_bf16 v[12:15], v[232:233], a[174:175], v[12:15]
v_mfma_f32_4x4x4_16b_bf16 v[0:3], v[232:233], a[180:181], v[0:3]
v_mfma_f32_4x4x4_16b_bf16 v[4:7], v[232:233], a[182:183], v[4:7]
v_mfma_f32_4x4x4_16b_bf16 v[8:11], v[232:233], a[184:185], v[8:11]
v_mfma_f32_4x4x4_16b_bf16 v[12:15], v[232:233], a[186:187], v[12:15]
s_nop 4
v_cvt_pk_bf16_f32 v32, v0, v1
v_cvt_pk_bf16_f32 v33, v2, v3
v_cvt_pk_bf16_f32 v34, v4, v5
v_cvt_pk_bf16_f32 v35, v6, v7
s_nop 0
v_permlane16_swap_b32 v32, v34
v_permlane16_swap_b32 v33, v35
buffer_store_dwordx4 v[32:35], v244, s[16:19], 0 offen
v_cvt_pk_bf16_f32 v36, v8, v9
v_cvt_pk_bf16_f32 v37, v10, v11
v_cvt_pk_bf16_f32 v38, v12, v13
v_cvt_pk_bf16_f32 v39, v14, v15
s_nop 0
v_permlane16_swap_b32 v36, v38
v_permlane16_swap_b32 v37, v39
buffer_store_dwordx4 v[36:39], v245, s[16:19], 0 offen
s_mov_b32 s34, 0xffff
s_branch L_f_next
L_f1_i:
s_and_b32 s47, s36, 15
s_cbranch_scc0 L_f1_h3
s_bitcmp1_b32 s36, 0
s_cbranch_scc0 L_f1_h0
s_mov_b32 s42, 0
buffer_load_dwordx4 a[0:3], v241, s[12:15], s42 offen sc1
L_f1_h0:
s_bitcmp1_b32 s36, 1
s_cbranch_scc0 L_f1_h1
s_mov_b32 s42, 144384
buffer_load_dwordx4 a[12:15], v241, s[12:15], s42 offen sc1
L_f1_h1:
s_bitcmp1_b32 s36, 2
s_cbranch_scc0 L_f1_h2
s_mov_b32 s42, 288768
buffer_load_dwordx4 a[24:27], v241, s[12:15], s42 offen sc1
L_f1_h2:
s_bitcmp1_b32 s36, 3
s_cbranch_scc0 L_f1_h3
s_mov_b32 s42, 433152
buffer_load_dwordx4 a[36:39], v241, s[12:15], s42 offen sc1
L_f1_h3:
s_and_b32 s47, s36, 240
s_cbranch_scc0 L_f1_h7
s_bitcmp1_b32 s36, 4
s_cbranch_scc0 L_f1_h4
s_mov_b32 s42, 577536
buffer_load_dwordx4 a[48:51], v241, s[12:15], s42 offen sc1
L_f1_h4:
s_bitcmp1_b32 s36, 5
s_cbranch_scc0 L_f1_h5
s_mov_b32 s42, 721920
buffer_load_dwordx4 a[60:63], v241, s[12:15], s42 offen sc1
L_f1_h5:
s_bitcmp1_b32 s36, 6
s_cbranch_scc0 L_f1_h6
s_mov_b32 s42, 866304
buffer_load_dwordx4 a[72:75], v241, s[12:15], s42 offen sc1
L_f1_h6:
s_bitcmp1_b32 s36, 7
s_cbranch_scc0 L_f1_h7
s_mov_b32 s42, 1010688
buffer_load_dwordx4 a[84:87], v241, s[12:15], s42 offen sc1
L_f1_h7:
s_and_b32 s47, s36, 3840
s_cbranch_scc0 L_f1_h11
s_bitcmp1_b32 s36, 8
s_cbranch_scc0 L_f1_h8
s_mov_b32 s42, 1155072
buffer_load_dwordx4 a[96:99], v241, s[12:15], s42 offen sc1
L_f1_h8:
s_bitcmp1_b32 s36, 9
s_cbranch_scc0 L_f1_h9
s_mov_b32 s42, 1299456
buffer_load_dwordx4 a[108:111], v241, s[12:15], s42 offen sc1
L_f1_h9:
s_bitcmp1_b32 s36, 10
s_cbranch_scc0 L_f1_h10
s_mov_b32 s42, 1443840
buffer_load_dwordx4 a[120:123], v241, s[12:15], s42 offen sc1
L_f1_h10:
s_bitcmp1_b32 s36, 11
s_cbranch_scc0 L_f1_h11
s_mov_b32 s42, 1588224
buffer_load_dwordx4 a[132:135], v241, s[12:15], s42 offen sc1
L_f1_h11:
s_and_b32 s47, s36, 61440
s_cbranch_scc0 L_f1_h15
s_bitcmp1_b32 s36, 12
s_cbranch_scc0 L_f1_h12
s_mov_b32 s42, 1732608
buffer_load_dwordx4 a[144:147], v241, s[12:15], s42 offen sc1
L_f1_h12:
s_bitcmp1_b32 s36, 13
s_cbranch_scc0 L_f1_h13
s_mov_b32 s42, 1876992
buffer_load_dwordx4 a[156:159], v241, s[12:15], s42 offen sc1
L_f1_h13:
s_bitcmp1_b32 s36, 14
s_cbranch_scc0 L_f1_h14
s_mov_b32 s42, 2021376
buffer_load_dwordx4 a[168:171], v241, s[12:15], s42 offen sc1
L_f1_h14:
s_bitcmp1_b32 s36, 15
s_cbranch_scc0 L_f1_h15
s_mov_b32 s42, 2165760
buffer_load_dwordx4 a[180:183], v241, s[12:15], s42 offen sc1
L_f1_h15:
s_cmp_eq_u32 s35, 0xffff
s_cbranch_scc1 L_f1_sum
L_f1_spin:
buffer_load_dword v240, v248, s[24:27], 0 offen sc1
s_waitcnt vmcnt(0)
v_readfirstlane_b32 s34, v240
s_and_b32 s34, s34, 0xffff
s_andn2_b32 s36, s34, s35
s_cbranch_scc1 L_f1_got
s_sub_u32 s38, s38, 1
s_cbranch_scc0 L_f1_spin
s_lshl_b32 s47, 0x10000, s33
v_mov_b32 v240, s47
buffer_atomic_or v240, v237, s[8:11], 0 offen sc0
s_waitcnt vmcnt(0)
v_readfirstlane_b32 s34, v240
s_and_b32 s34, s34, 0xffff
s_cmp_lg_u32 s34, 0xffff
s_cbranch_scc1 L_f_end
s_andn2_b32 s36, s34, s35
L_f1_got:
s_or_b32 s35, s35, s36
s_branch L_f1_i
L_f1_sum:
s_waitcnt vmcnt(0)
v_mfma_f32_4x4x4_16b_bf16 v[0:3], v[232:233], a[0:1], 0
v_mfma_f32_4x4x4_16b_bf16 v[4:7], v[232:233], a[2:3], 0
s_nop 0
v_mfma_f32_4x4x4_16b_bf16 v[0:3], v[232:233], a[12:13], v[0:3]
v_mfma_f32_4x4x4_16b_bf16 v[4:7], v[232:233], a[14:15], v[4:7]
s_nop 0
v_mfma_f32_4x4x4_16b_bf16 v[0:3], v[232:233], a[24:25], v[0:3]
v_mfma_f32_4x4x4_16b_bf16 v[4:7], v[232:233], a[26:27], v[4:7]
s_nop 0
v_mfma_f32_4x4x4_16b_bf16 v[0:3], v[232:233], a[36:37], v[0:3]
v_mfma_f32_4x4x4_16b_bf16 v[4:7], v[232:233], a[38:39], v[4:7]
s_nop 0
v_mfma_f32_4x4x4_16b_bf16 v[0:3], v[232:233], a[48:49], v[0:3]
v_mfma_f32_4x4x4_16b_bf16 v[4:7], v[232:233], a[50:51], v[4:7]
s_nop 0
v_mfma_f32_4x4x4_16b_bf16 v[0:3], v[232:233], a[60:61], v[0:3]
v_mfma_f32_4x4x4_16b_bf16 v[4:7], v[232:233], a[62:63], v[4:7]
s_nop 0
v_mfma_f32_4x4x4_16b_bf16 v[0:3], v[232:233], a[72:73], v[0:3]
v_mfma_f32_4x4x4_16b_bf16 v[4:7], v[232:233], a[74:75], v[4:7]
s_nop 0
v_mfma_f32_4x4x4_16b_bf16 v[0:3], v[232:233], a[84:85], v[0:3]
v_mfma_f32_4x4x4_16b_bf16 v[4:7], v[232:233], a[86:87], v[4:7]
s_nop 0
v_mfma_f32_4x4x4_16b_bf16 v[0:3], v[232:233], a[96:97], v[0:3]
v_mfma_f32_4x4x4_16b_bf16 v[4:7], v[232:233], a[98:99], v[4:7]
s_nop 0
v_mfma_f32_4x4x4_16b_bf16 v[0:3], v[232:233], a[108:109], v[0:3]
v_mfma_f32_4x4x4_16b_bf16 v[4:7], v[232:233], a[110:111], v[4:7]
s_nop 0
v_mfma_f32_4x4x4_16b_bf16 v[0:3], v[232:233], a[120:121], v[0:3]
v_mfma_f32_4x4x4_16b_bf16 v[4:7], v[232:233], a[122:123], v[4:7]
s_nop 0
v_mfma_f32_4x4x4_16b_bf16 v[0:3], v[232:233], a[132:133], v[0:3]
v_mfma_f32_4x4x4_16b_bf16 v[4:7], v[232:233], a[134:135], v[4:7]
s_nop 0
v_mfma_f32_4x4x4_16b_bf16 v[0:3], v[232:233], a[144:145], v[0:3]
v_mfma_f32_4x4x4_16b_bf16 v[4:7], v[232:233], a[146:147], v[4:7]
s_nop 0
v_mfma_f32_4x4x4_16b_bf16 v[0:3], v[232:233], a[156:157], v[0:3]
v_mfma_f32_4x4x4_16b_bf16 v[4:7], v[232:233], a[158:159], v[4:7]
s_nop 0
v_mfma_f32_4x4x4_16b_bf16 v[0:3], v[232:233], a[168:169], v[0:3]
v_mfma_f32_4x4x4_16b_bf16 v[4:7], v[232:233], a[170:171], v[4:7]
s_nop 0
v_mfma_f32_4x4x4_16b_bf16 v[0:3], v[232:233], a[180:181], v[0:3]
v_mfma_f32_4x4x4_16b_bf16 v[4:7], v[232:233], a[182:183], v[4:7]
s_nop 0
s_nop 4
v_cvt_pk_bf16_f32 v32, v0, v1
v_cvt_pk_bf16_f32 v33, v2, v3
v_cvt_pk_bf16_f32 v34, v4, v5
v_cvt_pk_bf16_f32 v35, v6, v7
s_nop 0
v_permlane16_swap_b32 v32, v34
v_permlane16_swap_b32 v33, v35
buffer_store_dwordx4 v[32:35], v244, s[16:19], 0 offen
s_mov_b32 s34, 0xffff
s_branch L_f_next
L_f_end:
L_attn_end:
s_endpgm
L_code_end:
L_tmax:
v_mbcnt_lo_u32_b32 v109, -1, 0
v_mbcnt_hi_u32_b32 v109, -1, v109
v_lshrrev_b32 v108, 4, v109
v_lshlrev_b32 v108, 1, v108
s_movk_i32 s36, 0xd8
v_bfe_u32 v108, s36, v108, 2
v_lshlrev_b32 v108, 4, v108
v_and_b32 v109, 15, v109
v_lshl_add_u32 v108, v109, 9, v108
s_and_b32 s36, s28, 1
s_mul_i32 s36, s36, 262400
v_add_u32 v108, s36, v108
v_xor_b32 v109, 256, v108
s_movk_i32 s36, 768
L_tmax_l:
buffer_load_dwordx4 v[4:7], v108, s[8:11], s36 offen offset:0
buffer_load_dwordx4 v[12:15], v108, s[8:11], s36 offen offset:64
buffer_load_dwordx4 v[20:23], v108, s[8:11], s36 offen offset:128
buffer_load_dwordx4 v[28:31], v108, s[8:11], s36 offen offset:192
buffer_load_dwordx4 v[36:39], v109, s[8:11], s36 offen offset:0
buffer_load_dwordx4 v[44:47], v109, s[8:11], s36 offen offset:64
buffer_load_dwordx4 v[52:55], v109, s[8:11], s36 offen offset:128
buffer_load_dwordx4 v[60:63], v109, s[8:11], s36 offen offset:192
s_waitcnt vmcnt(0) lgkmcnt(0)
v_mfma_f32_16x16x32_bf16 v[68:71], v[4:7], v[0:3], 0
v_mfma_f32_16x16x32_bf16 v[76:79], v[4:7], v[32:35], 0
v_mfma_f32_16x16x32_bf16 v[84:87], v[4:7], v[64:67], 0
v_mfma_f32_16x16x32_bf16 v[92:95], v[4:7], v[96:99], 0
v_mfma_f32_16x16x32_bf16 v[100:103], v[4:7], v[128:131], 0
v_mfma_f32_16x16x32_bf16 v[68:71], v[12:15], v[8:11], v[68:71]
v_mfma_f32_16x16x32_bf16 v[76:79], v[12:15], v[40:43], v[76:79]
v_mfma_f32_16x16x32_bf16 v[84:87], v[12:15], v[72:75], v[84:87]
v_mfma_f32_16x16x32_bf16 v[92:95], v[12:15], v[104:107], v[92:95]
v_mfma_f32_16x16x32_bf16 v[100:103], v[12:15], v[136:139], v[100:103]
v_mfma_f32_16x16x32_bf16 v[68:71], v[20:23], v[16:19], v[68:71]
v_mfma_f32_16x16x32_bf16 v[76:79], v[20:23], v[48:51], v[76:79]
v_mfma_f32_16x16x32_bf16 v[84:87], v[20:23], v[80:83], v[84:87]
v_mfma_f32_16x16x32_bf16 v[92:95], v[20:23], v[112:115], v[92:95]
v_mfma_f32_16x16x32_bf16 v[100:103], v[20:23], v[144:147], v[100:103]
v_mfma_f32_16x16x32_bf16 v[68:71], v[28:31], v[24:27], v[68:71]
v_mfma_f32_16x16x32_bf16 v[76:79], v[28:31], v[56:59], v[76:79]
v_mfma_f32_16x16x32_bf16 v[84:87], v[28:31], v[88:91], v[84:87]
v_mfma_f32_16x16x32_bf16 v[92:95], v[28:31], v[120:123], v[92:95]
v_mfma_f32_16x16x32_bf16 v[100:103], v[28:31], v[152:155], v[100:103]
v_mfma_f32_16x16x32_bf16 v[68:71], v[36:39], a[64:67], v[68:71]
v_mfma_f32_16x16x32_bf16 v[76:79], v[36:39], a[68:71], v[76:79]
v_mfma_f32_16x16x32_bf16 v[84:87], v[36:39], a[72:75], v[84:87]
v_mfma_f32_16x16x32_bf16 v[92:95], v[36:39], a[76:79], v[92:95]
v_mfma_f32_16x16x32_bf16 v[100:103], v[36:39], a[80:83], v[100:103]
v_mfma_f32_16x16x32_bf16 v[68:71], v[44:47], a[84:87], v[68:71]
v_mfma_f32_16x16x32_bf16 v[76:79], v[44:47], a[88:91], v[76:79]
v_mfma_f32_16x16x32_bf16 v[84:87], v[44:47], a[92:95], v[84:87]
v_mfma_f32_16x16x32_bf16 v[92:95], v[44:47], a[96:99], v[92:95]
v_mfma_f32_16x16x32_bf16 v[100:103], v[44:47], a[100:103], v[100:103]
v_mfma_f32_16x16x32_bf16 v[68:71], v[52:55], a[104:107], v[68:71]
v_mfma_f32_16x16x32_bf16 v[76:79], v[52:55], a[108:111], v[76:79]
v_mfma_f32_16x16x32_bf16 v[84:87], v[52:55], a[112:115], v[84:87]
v_mfma_f32_16x16x32_bf16 v[92:95], v[52:55], a[116:119], v[92:95]
v_mfma_f32_16x16x32_bf16 v[100:103], v[52:55], a[120:123], v[100:103]
v_mfma_f32_16x16x32_bf16 v[68:71], v[60:63], a[124:127], v[68:71]
v_mfma_f32_16x16x32_bf16 v[76:79], v[60:63], a[128:131], v[76:79]
v_mfma_f32_16x16x32_bf16 v[84:87], v[60:63], a[132:135], v[84:87]
v_mfma_f32_16x16x32_bf16 v[92:95], v[60:63], a[136:139], v[92:95]
v_mfma_f32_16x16x32_bf16 v[100:103], v[60:63], a[140:143], v[100:103]
s_nop 7
s_nop 1
v_min3_f32 v200, v200, -v68, -v69
v_min3_f32 v200, v200, -v70, -v71
v_min3_f32 v204, v204, -v76, -v77
v_min3_f32 v204, v204, -v78, -v79
v_min3_f32 v208, v208, -v84, -v85
v_min3_f32 v208, v208, -v86, -v87
v_min3_f32 v212, v212, -v92, -v93
v_min3_f32 v212, v212, -v94, -v95
v_min3_f32 v216, v216, -v100, -v101
v_min3_f32 v216, v216, -v102, -v103
s_add_u32 s36, s36, 8192
s_cmp_lt_u32 s36, 262144
s_cbranch_scc1 L_tmax_l
s_branch L_tmax_ret
L_redo:
s_cmp_lg_u32 s37, 0
s_cbranch_scc1 L_redo_ret
s_mov_b32 s37, 1
s_waitcnt vmcnt(0) lgkmcnt(0)
s_barrier
v_mbcnt_lo_u32_b32 v0, -1, 0
v_mbcnt_hi_u32_b32 v0, -1, v0
s_lshl_b32 s47, s28, 6
v_add_u32 v0, s47, v0
s_getpc_b64 s[4:5]
L_redo_pc:
s_sub_u32 s4, s4, L_redo_pc-L_again
s_subb_u32 s5, s5, 0
s_setpc_b64 s[4:5]
.section .rodata,"a"
.p2align 6
.amdhsa_kernel concat_heads__mha_block_cached__mha_block_cached__near_ridge_kernel
  .amdhsa_next_free_vgpr 512
  .amdhsa_next_free_sgpr 102
  .amdhsa_accum_offset 256
  .amdhsa_group_segment_fixed_size 0
  .amdhsa_kernarg_size 104
  .amdhsa_user_sgpr_count 2
  .amdhsa_user_sgpr_kernarg_segment_ptr 1
  .amdhsa_system_sgpr_workgroup_id_x 1
.end_amdhsa_kernel
```
